```python
import torch

def _softmax(x, axis=-1):
    return torch.softmax(x, dim=axis)

def _gelu(x):
    return torch.nn.functional.gelu(x, approximate='tanh')

def _silu(x):
    return torch.nn.functional.silu(x)

def _sigmoid(x):
    return torch.sigmoid(x)

def _layernorm(x, axis=-1, eps=1e-05):
    m = x.mean(dim=axis, keepdim=True)
    v = x.var(dim=axis, keepdim=True, unbiased=False)
    return (x - m) / torch.sqrt(v + eps)

def _scatter_add(tgt, idx, src, axis=0):
    return tgt.clone().index_add_(axis, idx, src)

def _segment_sum(src, seg, n):
    out = torch.zeros((n,) + src.shape[1:], dtype=src.dtype)
    return out.index_add_(0, seg, src)

def _pad(x, pw):
    flat = tuple((v for pair in reversed(pw) for v in pair))
    return torch.nn.functional.pad(x, flat)
kernel_name = 'gated_mix__softmax_full_mha__memory_aug_recurrent_mem_tr__prompt'

def setup_inputs():

    _w = lambda a: (lambda t: t.to(torch.bfloat16) if t.is_floating_point() else t)(torch.as_tensor(a))

    def _A_setup():
        B, S, D = (1, 2048, 640)
        return {'x': _w((lambda *s: torch.randn(*s, dtype=torch.bfloat16) * 0.05)(B, S, D)), 'wqkv': _w((lambda *s: torch.randn(*s, dtype=torch.bfloat16) * 0.8)(D, 3 * D)), 'wo': _w((lambda *s: torch.randn(*s, dtype=torch.bfloat16) * 0.05)(D, D))}
    _A_in = _A_setup()

    def _B_setup():
        B, S, Dm = (1, 2048, 640)
        H, Dh = (32, 192)
        M, seg = (8, 32)
        seg = min(seg, S)
        S = S // seg * seg
        return {'x': _w((lambda *s: torch.randn(*s, dtype=torch.bfloat16) * 0.05)(B, S, Dm)), 'mem0': _w((lambda *s: torch.randn(*s, dtype=torch.bfloat16) * 0.8)(B, M, Dm)), 'Wq': _w((lambda *s: torch.randn(*s, dtype=torch.bfloat16) * 3.2)(Dm, H, Dh) * Dm ** (-0.5)), 'Wk': _w((lambda *s: torch.randn(*s, dtype=torch.bfloat16) * 3.2)(Dm, H, Dh) * Dm ** (-0.5)), 'Wv': _w((lambda *s: torch.randn(*s, dtype=torch.bfloat16) * 0.8)(Dm, H, Dh) * Dm ** (-0.5)), 'Wo': _w((lambda *s: torch.randn(*s, dtype=torch.bfloat16) * 0.8)(H, Dh, Dm) * (H * Dh) ** (-0.5)), 'seg_len': seg}
    _B_in = _B_setup()
    return {'A_x': _A_in['x'], 'A_wqkv': _A_in['wqkv'], 'A_wo': _A_in['wo'], 'B_x': _B_in['x'], 'B_mem0': _B_in['mem0'], 'B_Wq': _B_in['Wq'], 'B_Wk': _B_in['Wk'], 'B_Wv': _B_in['Wv'], 'B_Wo': _B_in['Wo'], 'B_seg_len': _B_in['seg_len'], 'gate_w': _w((lambda *s: torch.randn(*s, dtype=torch.bfloat16) * 0.05)(640) * 16.0)}

def reference(A_x, A_wqkv, A_wo, B_x, B_mem0, B_Wq, B_Wk, B_Wv, B_Wo, B_seg_len, gate_w):

    def _A_ref(x, wqkv, wo):
        B, S, D = x.shape
        H = 32
        Dh = D // H
        qkv = (lambda x, *d: x.permute(*d))((x @ wqkv).reshape(B, S, 3, H, Dh), 2, 0, 3, 1, 4)
        q, k, v = (qkv[0], qkv[1], qkv[2])
        scale = Dh ** (-0.5)
        scores = torch.einsum('bhqd,bhkd->bhqk', q, k) * scale
        p = _softmax(scores, axis=-1)
        o = torch.einsum('bhqk,bhkd->bhqd', p, v)
        return (lambda x, *d: x.permute(*d))(o, 0, 2, 1, 3).reshape(B, S, D) @ wo

    def _B_ref(x, mem0, Wq, Wk, Wv, Wo, seg_len):
        B, S, Dm = x.shape
        H, Dh = (Wq.shape[1], Wq.shape[2])
        M = mem0.shape[1]
        scale = Dh ** (-0.5)
        n_seg = S // seg_len
        L = M + seg_len
        idx = torch.arange(L)
        mask = (idx[:, None] < M) | (idx[:, None] >= idx[None, :])
        mem = mem0
        outs = []
        for s in range(n_seg):
            xs = x[:, s * seg_len:(s + 1) * seg_len, :].clone()
            h = torch.concatenate([mem, xs], axis=1)
            q = torch.einsum('btd,dhe->bhte', h, Wq)
            k = torch.einsum('btd,dhe->bhte', h, Wk)
            v = torch.einsum('btd,dhe->bhte', h, Wv)
            scores = torch.einsum('bhqe,bhke->bhqk', q, k) * scale
            scores = torch.where(mask[None, None], scores, -1000000000.0)
            p = _softmax(scores, axis=-1)
            o = torch.einsum('bhqk,bhke->bhqe', p, v)
            o = torch.einsum('bhte,hed->btd', o, Wo)
            mem = o[:, :M, :].clone()
            outs.append(o[:, M:, :])
        return torch.concatenate(outs, axis=1)
    x = A_x
    g = _sigmoid((x * gate_w).sum(-1, keepdims=True))
    a = _A_ref(x, A_wqkv, A_wo)
    b = _B_ref(x, B_mem0, B_Wq, B_Wk, B_Wv, B_Wo, B_seg_len)
    return g * a + (1 - g) * b
```

```asm
; @launch kernel=init_kernel grid=(256,1,1) block=(256,1,1) lds=0
; @launch kernel=main_kernel grid=(256,1,1) block=(256,1,1) lds=163840
.amdgcn_target "amdgcn-amd-amdhsa--gfx950"
.text
.globl init_kernel
.p2align 8
.type init_kernel,@function
init_kernel:
s_cmp_ge_u32 s2, 256
s_cbranch_scc0 init_kernel_go
s_endpgm
init_kernel_go:
s_load_dwordx16 s[72:87], s[0:1], 0
s_load_dwordx8 s[88:95], s[0:1], 64
s_load_dwordx4 s[96:99], s[0:1], 96
v_lshrrev_b32 v1, 6, v0
v_and_b32 v255, 63, v0
s_nop 0
v_readfirstlane_b32 s56, v1
s_waitcnt lgkmcnt(0)
s_mov_b32 s8, s98
s_and_b32 s9, s99, 0xffff
s_mov_b32 s10, 268435456
s_mov_b32 s11, 0x20000
s_mov_b32 s12, s72
s_and_b32 s13, s73, 0xffff
s_mov_b32 s14, 2621440
s_mov_b32 s15, 0x20000
s_mov_b32 s16, s74
s_and_b32 s17, s75, 0xffff
s_mov_b32 s18, 2457600
s_mov_b32 s19, 0x20000
s_mov_b32 s20, s76
s_and_b32 s21, s77, 0xffff
s_mov_b32 s22, 819200
s_mov_b32 s23, 0x20000
s_mov_b32 s24, s82
s_and_b32 s25, s83, 0xffff
s_mov_b32 s26, 7864320
s_mov_b32 s27, 0x20000
s_mov_b32 s28, s84
s_and_b32 s29, s85, 0xffff
s_mov_b32 s30, 7864320
s_mov_b32 s31, 0x20000
s_mov_b32 s32, s86
s_and_b32 s33, s87, 0xffff
s_mov_b32 s34, 7864320
s_mov_b32 s35, 0x20000
s_mov_b32 s36, s88
s_and_b32 s37, s89, 0xffff
s_mov_b32 s38, 7864320
s_mov_b32 s39, 0x20000
s_mov_b32 s40, s94
s_and_b32 s41, s95, 0xffff
s_mov_b32 s42, 2621440
s_mov_b32 s43, 0x20000
s_mov_b32 s44, s80
s_and_b32 s45, s81, 0xffff
s_mov_b32 s46, 10240
s_mov_b32 s47, 0x20000
s_mov_b32 s48, s92
s_and_b32 s49, s93, 0xffff
s_mov_b32 s50, 1280
s_mov_b32 s51, 0x20000
s_and_b32 s97, s97, 0xffff
s_mov_b32 s98, 256
s_mov_b32 s99, 0x20000
s_lshl_b32 s65, s2, 12
v_lshlrev_b32 v1, 4, v0
v_add_u32 v1, s65, v1
v_mov_b32 v4, -1
v_mov_b32 v5, -1
v_mov_b32 v6, -1
v_mov_b32 v7, -1
s_mov_b32 s57, 239206400
buffer_store_dwordx4 v[4:7],v1,s[8:11],s57 offen
s_mov_b32 s57, 240254976
buffer_store_dwordx4 v[4:7],v1,s[8:11],s57 offen
s_mov_b32 s57, 241303552
buffer_store_dwordx4 v[4:7],v1,s[8:11],s57 offen
s_mov_b32 s57, 242352128
buffer_store_dwordx4 v[4:7],v1,s[8:11],s57 offen
s_mov_b32 s57, 243400704
buffer_store_dwordx4 v[4:7],v1,s[8:11],s57 offen
v_cmp_gt_u32 vcc, 4096, v1
v_mov_b32 v2, 1073741824
s_mov_b32 s57, 244449280
v_cndmask_b32 v2, v2, v1, vcc
buffer_store_dwordx4 v[4:7],v2,s[8:11],s57 offen
v_cmp_gt_u32 vcc, 0x8000, v1
v_mov_b32 v2, 1073741824
v_mov_b32 v8, 0
v_mov_b32 v9, 0
v_mov_b32 v10, 0
v_mov_b32 v11, 0
v_cndmask_b32 v2, v2, v1, vcc
s_mov_b32 s57, 244453376
buffer_store_dwordx4 v[8:11],v2,s[8:11],s57 offen
v_lshrrev_b32 v2, 4, v1
v_and_b32 v3, 7, v2
v_mul_u32_u24 v3, 1280, v3
v_lshrrev_b32 v2, 3, v2
v_lshl_add_u32 v3, v2, 4, v3
v_cmp_gt_u32 vcc, 10240, v1
v_mov_b32 v2, 1073741824
s_nop 0
v_cndmask_b32 v3, v2, v3, vcc
v_cndmask_b32 v2, v2, v1, vcc
buffer_load_dwordx4 v[12:15],v3,s[44:47],0 offen
v_and_b32 v16, 31, v255
v_mul_u32_u24 v16, 8, v16
v_lshrrev_b32 v254, 5, v255
v_and_b32 v254, 1, v254
v_mul_u32_u24 v254, 1280, v254
v_add_u32 v17, v254, v16
s_lshl_b32 s65, s2, 2
s_add_u32 s65, s65, s56
s_mul_i32 s57, s65, 2560
buffer_load_dwordx2 v[20:21],v17,s[12:15],s57 offen
buffer_load_dwordx2 v[30:31],v16,s[48:51],0 offen
buffer_load_dwordx2 v[22:23],v17,s[12:15],s57 offen offset:256
buffer_load_dwordx2 v[32:33],v16,s[48:51],0 offen offset:256
buffer_load_dwordx2 v[24:25],v17,s[12:15],s57 offen offset:512
buffer_load_dwordx2 v[34:35],v16,s[48:51],0 offen offset:512
buffer_load_dwordx2 v[26:27],v17,s[12:15],s57 offen offset:768
buffer_load_dwordx2 v[36:37],v16,s[48:51],0 offen offset:768
buffer_load_dwordx2 v[28:29],v17,s[12:15],s57 offen offset:1024
buffer_load_dwordx2 v[38:39],v16,s[48:51],0 offen offset:1024
s_waitcnt vmcnt(10)
v_min_u32 v12, -2, v12
v_min_u32 v13, -2, v13
v_min_u32 v14, -2, v14
v_min_u32 v15, -2, v15
s_mov_b32 s57, 239165440
buffer_store_dwordx4 v[12:15],v2,s[8:11],s57 offen
s_mov_b32 s57, 239175680
buffer_store_dwordx4 v[12:15],v2,s[8:11],s57 offen
s_mov_b32 s57, 239185920
buffer_store_dwordx4 v[12:15],v2,s[8:11],s57 offen
s_mov_b32 s57, 239196160
buffer_store_dwordx4 v[12:15],v2,s[8:11],s57 offen
v_lshrrev_b32 v45, 1, v255
v_and_b32 v45, 15, v45
v_mul_u32_u24 v45, 512, v45
v_lshrrev_b32 v254, 5, v255
v_and_b32 v254, 1, v254
v_mul_u32_u24 v254, 16, v254
v_add_u32 v45, v254, v45
v_and_b32 v254, 1, v255
v_mul_u32_u24 v254, 8, v254
v_add_u32 v45, v254, v45
s_lshr_b32 s68, s65, 4
s_mul_i32 s68, s68, 40960
s_and_b32 s57, s65, 15
s_lshl_b32 s57, s57, 5
s_add_u32 s68, s68, s57
s_waitcnt vmcnt(4)
v_mov_b32 v40, 0
s_add_u32 s57, s68, 236535808
buffer_store_dwordx2 v[20:21],v45,s[8:11],s57 offen
s_add_u32 s57, s68, 236544000
buffer_store_dwordx2 v[22:23],v45,s[8:11],s57 offen
s_add_u32 s57, s68, 236552192
buffer_store_dwordx2 v[24:25],v45,s[8:11],s57 offen
s_add_u32 s57, s68, 236560384
buffer_store_dwordx2 v[26:27],v45,s[8:11],s57 offen
s_add_u32 s57, s68, 236568576
buffer_store_dwordx2 v[28:29],v45,s[8:11],s57 offen
v_lshlrev_b32 v41, 16, v20
v_lshlrev_b32 v42, 16, v30
v_and_b32 v43, 0xffff0000, v20
v_and_b32 v44, 0xffff0000, v30
v_mul_f32 v41, v41, v42
v_mul_f32 v43, v43, v44
v_cvt_pk_bf16_f32 v41, v41, v43
v_lshlrev_b32 v42, 16, v41
v_and_b32 v41, 0xffff0000, v41
v_add_f32 v40, v40, v42
v_add_f32 v40, v40, v41
v_lshlrev_b32 v41, 16, v21
v_lshlrev_b32 v42, 16, v31
v_and_b32 v43, 0xffff0000, v21
v_and_b32 v44, 0xffff0000, v31
v_mul_f32 v41, v41, v42
v_mul_f32 v43, v43, v44
v_cvt_pk_bf16_f32 v41, v41, v43
v_lshlrev_b32 v42, 16, v41
v_and_b32 v41, 0xffff0000, v41
v_add_f32 v40, v40, v42
v_add_f32 v40, v40, v41
v_lshlrev_b32 v41, 16, v22
v_lshlrev_b32 v42, 16, v32
v_and_b32 v43, 0xffff0000, v22
v_and_b32 v44, 0xffff0000, v32
v_mul_f32 v41, v41, v42
v_mul_f32 v43, v43, v44
v_cvt_pk_bf16_f32 v41, v41, v43
v_lshlrev_b32 v42, 16, v41
v_and_b32 v41, 0xffff0000, v41
v_add_f32 v40, v40, v42
v_add_f32 v40, v40, v41
v_lshlrev_b32 v41, 16, v23
v_lshlrev_b32 v42, 16, v33
v_and_b32 v43, 0xffff0000, v23
v_and_b32 v44, 0xffff0000, v33
v_mul_f32 v41, v41, v42
v_mul_f32 v43, v43, v44
v_cvt_pk_bf16_f32 v41, v41, v43
v_lshlrev_b32 v42, 16, v41
v_and_b32 v41, 0xffff0000, v41
v_add_f32 v40, v40, v42
v_add_f32 v40, v40, v41
v_lshlrev_b32 v41, 16, v24
v_lshlrev_b32 v42, 16, v34
v_and_b32 v43, 0xffff0000, v24
v_and_b32 v44, 0xffff0000, v34
v_mul_f32 v41, v41, v42
v_mul_f32 v43, v43, v44
v_cvt_pk_bf16_f32 v41, v41, v43
v_lshlrev_b32 v42, 16, v41
v_and_b32 v41, 0xffff0000, v41
v_add_f32 v40, v40, v42
v_add_f32 v40, v40, v41
v_lshlrev_b32 v41, 16, v25
v_lshlrev_b32 v42, 16, v35
v_and_b32 v43, 0xffff0000, v25
v_and_b32 v44, 0xffff0000, v35
v_mul_f32 v41, v41, v42
v_mul_f32 v43, v43, v44
v_cvt_pk_bf16_f32 v41, v41, v43
v_lshlrev_b32 v42, 16, v41
v_and_b32 v41, 0xffff0000, v41
v_add_f32 v40, v40, v42
v_add_f32 v40, v40, v41
v_lshlrev_b32 v41, 16, v26
v_lshlrev_b32 v42, 16, v36
v_and_b32 v43, 0xffff0000, v26
v_and_b32 v44, 0xffff0000, v36
v_mul_f32 v41, v41, v42
v_mul_f32 v43, v43, v44
v_cvt_pk_bf16_f32 v41, v41, v43
v_lshlrev_b32 v42, 16, v41
v_and_b32 v41, 0xffff0000, v41
v_add_f32 v40, v40, v42
v_add_f32 v40, v40, v41
v_lshlrev_b32 v41, 16, v27
v_lshlrev_b32 v42, 16, v37
v_and_b32 v43, 0xffff0000, v27
v_and_b32 v44, 0xffff0000, v37
v_mul_f32 v41, v41, v42
v_mul_f32 v43, v43, v44
v_cvt_pk_bf16_f32 v41, v41, v43
v_lshlrev_b32 v42, 16, v41
v_and_b32 v41, 0xffff0000, v41
v_add_f32 v40, v40, v42
v_add_f32 v40, v40, v41
v_lshlrev_b32 v41, 16, v28
v_lshlrev_b32 v42, 16, v38
v_and_b32 v43, 0xffff0000, v28
v_and_b32 v44, 0xffff0000, v38
v_mul_f32 v41, v41, v42
v_mul_f32 v43, v43, v44
v_cvt_pk_bf16_f32 v41, v41, v43
v_lshlrev_b32 v42, 16, v41
v_and_b32 v41, 0xffff0000, v41
v_add_f32 v40, v40, v42
v_add_f32 v40, v40, v41
v_lshlrev_b32 v41, 16, v29
v_lshlrev_b32 v42, 16, v39
v_and_b32 v43, 0xffff0000, v29
v_and_b32 v44, 0xffff0000, v39
v_mul_f32 v41, v41, v42
v_mul_f32 v43, v43, v44
v_cvt_pk_bf16_f32 v41, v41, v43
v_lshlrev_b32 v42, 16, v41
v_and_b32 v41, 0xffff0000, v41
v_add_f32 v40, v40, v42
v_add_f32 v40, v40, v41
ds_swizzle_b32 v41, v40 offset:1055
s_waitcnt lgkmcnt(0)
v_add_f32 v40, v40, v41
ds_swizzle_b32 v41, v40 offset:2079
s_waitcnt lgkmcnt(0)
v_add_f32 v40, v40, v41
ds_swizzle_b32 v41, v40 offset:4127
s_waitcnt lgkmcnt(0)
v_add_f32 v40, v40, v41
ds_swizzle_b32 v41, v40 offset:8223
s_waitcnt lgkmcnt(0)
v_add_f32 v40, v40, v41
ds_swizzle_b32 v41, v40 offset:16415
s_waitcnt lgkmcnt(0)
v_add_f32 v40, v40, v41
v_cvt_pk_bf16_f32 v40, v40, v40
v_lshlrev_b32 v40, 16, v40
v_mul_f32 v40, 0xbfb8aa3b, v40
v_exp_f32 v40, v40
s_nop 0
v_add_f32 v40, 1.0, v40
v_rcp_f32 v40, v40
s_nop 0
v_cvt_pk_bf16_f32 v40, v40, v40
v_lshlrev_b32 v40, 16, v40
v_lshrrev_b32 v41, 5, v255
v_and_b32 v41, 1, v41
v_mul_u32_u24 v41, 4, v41
s_lshl_b32 s65, s65, 3
s_add_u32 s65, s65, 239157248
buffer_store_dword v40,v41,s[8:11],s65 offen
s_waitcnt vmcnt(0)
s_endpgm
.globl main_kernel
.p2align 8
.type main_kernel,@function
main_kernel:
s_cmp_ge_u32 s2, 256
s_cbranch_scc0 main_kernel_go
s_endpgm
main_kernel_go:
s_load_dwordx16 s[72:87], s[0:1], 0
s_load_dwordx8 s[88:95], s[0:1], 64
s_load_dwordx4 s[96:99], s[0:1], 96
v_lshrrev_b32 v1, 6, v0
v_and_b32 v255, 63, v0
s_nop 0
v_readfirstlane_b32 s56, v1
s_waitcnt lgkmcnt(0)
s_mov_b32 s8, s98
s_and_b32 s9, s99, 0xffff
s_mov_b32 s10, 268435456
s_mov_b32 s11, 0x20000
s_mov_b32 s12, s72
s_and_b32 s13, s73, 0xffff
s_mov_b32 s14, 2621440
s_mov_b32 s15, 0x20000
s_mov_b32 s16, s74
s_and_b32 s17, s75, 0xffff
s_mov_b32 s18, 2457600
s_mov_b32 s19, 0x20000
s_mov_b32 s20, s76
s_and_b32 s21, s77, 0xffff
s_mov_b32 s22, 819200
s_mov_b32 s23, 0x20000
s_mov_b32 s24, s82
s_and_b32 s25, s83, 0xffff
s_mov_b32 s26, 7864320
s_mov_b32 s27, 0x20000
s_mov_b32 s28, s84
s_and_b32 s29, s85, 0xffff
s_mov_b32 s30, 7864320
s_mov_b32 s31, 0x20000
s_mov_b32 s32, s86
s_and_b32 s33, s87, 0xffff
s_mov_b32 s34, 7864320
s_mov_b32 s35, 0x20000
s_mov_b32 s36, s88
s_and_b32 s37, s89, 0xffff
s_mov_b32 s38, 7864320
s_mov_b32 s39, 0x20000
s_mov_b32 s40, s94
s_and_b32 s41, s95, 0xffff
s_mov_b32 s42, 2621440
s_mov_b32 s43, 0x20000
s_mov_b32 s44, s80
s_and_b32 s45, s81, 0xffff
s_mov_b32 s46, 10240
s_mov_b32 s47, 0x20000
s_mov_b32 s48, s92
s_and_b32 s49, s93, 0xffff
s_mov_b32 s50, 1280
s_mov_b32 s51, 0x20000
s_and_b32 s97, s97, 0xffff
s_mov_b32 s98, 256
s_mov_b32 s99, 0x20000
s_and_b32 s4, s2, 7
s_lshr_b32 s5, s2, 3
s_mov_b32 s71, 0x80000
s_mov_b32 s64, s2
s_cmp_lt_u32 s4, 4
s_cbranch_scc0 WORKER
s_getreg_b32 s57, hwreg(HW_REG_XCC_ID, 0, 4)
s_add_u32 s57, s57, 1
v_mov_b32 v62, s57
s_lshl_b32 s89, s4, 5
v_lshlrev_b32 v63, 8, v0
v_add_u32 v63, s5, v63
buffer_store_byte v62,v63,s[96:99],s89 offen sc1
s_cmp_lt_u32 s5, 8
s_cbranch_scc0 BT0
v_lshlrev_b32 v104, 4, v0
v_lshlrev_b32 v105, 3, v0
v_add_u32 v105, 8192, v105
v_add_u32 v106, 90112, v104
v_add_u32 v107, 90112, v105
v_and_b32 v108, 63, v255
v_mul_u32_u24 v108, 16, v108
v_add_u32 v108, 90112, v108
v_lshrrev_b32 v109, 3, v255
v_and_b32 v109, 1, v109
v_mul_u32_u24 v109, 43690, v109
v_add_u32 v109, 0x4444, v109
s_mul_i32 s6, s4, 10240
s_add_u32 s6, s6, 239165440
s_mov_b32 s70, 0
s_lshl_b32 s62, s4, 3
s_add_u32 s62, s62, s5
s_mov_b32 s68, 0x3dd53b95
v_lshlrev_b32 v116, 4, v255
s_mul_i32 s57, s56, 22528
v_add_u32 v110, s57, v116
v_and_b32 v111, 15, v255
v_mul_u32_u24 v111, 240, v111
v_lshrrev_b32 v254, 5, v255
v_and_b32 v254, 1, v254
v_mul_u32_u24 v254, 40, v254
v_add_u32 v111, v254, v111
v_lshrrev_b32 v254, 4, v255
v_and_b32 v254, 1, v254
v_mul_u32_u24 v254, 8, v254
v_add_u32 v111, v254, v111
v_add_u32 v111, 100352, v111
s_and_b32 s61, s56, 1
s_lshr_b32 s59, s56, 1
s_mul_i32 s57, s61, 3840
s_lshl_b32 s66, s59, 4
s_add_u32 s57, s57, s66
v_add_u32 v111, s57, v111
s_mul_i32 s100, s61, 25165824
s_mul_i32 s57, s62, 12288
s_add_u32 s100, s100, s57
s_add_u32 s100, s100, 132792320
s_mul_i32 s58, s61, 12288
s_add_u32 s58, s58, 108032
v_add_u32 v113, s58, v116
s_mul_i32 s67, s61, 4294956032
s_add_u32 s67, s67, 24576
s_cmp_eq_u32 s56, 1
s_cbranch_scc1 S_A1
v_lshrrev_b32 v112, 5, v255
v_and_b32 v112, 1, v112
v_mul_u32_u24 v112, 640, v112
v_lshrrev_b32 v254, 4, v255
v_and_b32 v254, 1, v254
v_mul_u32_u24 v254, 160, v254
v_add_u32 v112, v254, v112
v_lshrrev_b32 v254, 2, v255
v_and_b32 v254, 3, v254
v_mul_u32_u24 v254, 40, v254
v_add_u32 v112, v254, v112
v_and_b32 v254, 3, v255
v_mul_u32_u24 v254, 8, v254
v_add_u32 v112, v254, v112
v_add_u32 v112, 100352, v112
v_lshrrev_b32 v114, 4, v255
v_and_b32 v114, 3, v114
v_mul_u32_u24 v114, 128, v114
v_and_b32 v254, 7, v255
v_mul_u32_u24 v254, 16, v254
v_add_u32 v114, v254, v114
v_lshrrev_b32 v254, 3, v255
v_and_b32 v254, 1, v254
v_mul_u32_u24 v254, 8, v254
v_add_u32 v114, v254, v114
v_lshrrev_b32 v115, 4, v255
v_and_b32 v115, 1, v115
v_mul_u32_u24 v115, 8, v115
v_and_b32 v254, 7, v255
v_mul_u32_u24 v254, 16, v254
v_add_u32 v115, v254, v115
v_lshrrev_b32 v254, 3, v255
v_and_b32 v254, 1, v254
v_mul_u32_u24 v254, 4, v254
v_add_u32 v115, v254, v115
v_add_u32 v115, 512, v115
v_cmp_gt_u32 vcc, 32, v255
v_mov_b32 v117, 1073741824
v_mov_b32 v1, 0xff800000
v_cndmask_b32 v115, v115, v117, vcc
v_cndmask_b32 v118, 0, v1, vcc
s_mul_i32 s7, s62, 640
s_add_u32 s7, s7, 241827840
s_branch S_A2
S_A1:
v_lshrrev_b32 v112, 5, v255
v_and_b32 v112, 1, v112
v_mul_u32_u24 v112, 160, v112
v_lshrrev_b32 v254, 2, v255
v_and_b32 v254, 3, v254
v_mul_u32_u24 v254, 40, v254
v_add_u32 v112, v254, v112
v_and_b32 v254, 1, v255
v_mul_u32_u24 v254, 8, v254
v_add_u32 v112, v254, v112
v_add_u32 v112, 100368, v112
v_mov_b32 v114, v116
v_and_b32 v115, 31, v255
v_mul_u32_u24 v115, 16, v115
v_lshrrev_b32 v254, 5, v255
v_and_b32 v254, 1, v254
v_mul_u32_u24 v254, 8, v254
v_add_u32 v115, v254, v115
v_add_u32 v115, 2048, v115
v_cmp_gt_u32 vcc, 1, v255
v_mov_b32 v117, 1073741824
v_lshlrev_b32 v118, 7, v255
v_cndmask_b32 v117, v117, v118, vcc
v_mov_b32 v118, 1
s_lshl_b32 s90, s4, 7
s_add_u32 s90, s90, 244455424
s_mul_i32 s7, s62, 2560
s_add_u32 s7, s7, 191512576
S_A2:
s_lshl_b32 s101, s62, 1
s_add_u32 s101, s101, s61
s_lshl_b32 s101, s101, 10
s_add_u32 s101, s101, 183123968
s_cmp_eq_u32 s59, 0
s_cselect_b32 s52, s24, s28
s_cselect_b32 s53, s25, s29
s_mov_b32 s54, 7864320
s_mov_b32 s55, 0x20000
v_lshrrev_b32 v119, 5, v255
v_and_b32 v119, 1, v119
v_mul_u32_u24 v119, 196608, v119
v_lshrrev_b32 v254, 4, v255
v_and_b32 v254, 1, v254
v_mul_u32_u24 v254, 49152, v254
v_add_u32 v119, v254, v119
v_and_b32 v254, 15, v255
v_mul_u32_u24 v254, 12, v254
v_add_u32 v119, v254, v119
s_mul_i32 s66, s62, 384
s_mul_i32 s57, s61, 192
s_add_u32 s66, s66, s57
s_mov_b32 s61, 0x05040100
s_mov_b32 s59, 0x07060302
s_add_u32 s57, s66, 0
buffer_load_dwordx3 v[0:2],v119,s[52:55],s57 offen
s_add_u32 s57, s66, 12288
buffer_load_dwordx3 v[4:6],v119,s[52:55],s57 offen
s_add_u32 s57, s66, 98304
buffer_load_dwordx3 v[8:10],v119,s[52:55],s57 offen
s_add_u32 s57, s66, 110592
buffer_load_dwordx3 v[12:14],v119,s[52:55],s57 offen
s_add_u32 s57, s66, 24576
buffer_load_dwordx3 v[16:18],v119,s[52:55],s57 offen
s_add_u32 s57, s66, 36864
buffer_load_dwordx3 v[20:22],v119,s[52:55],s57 offen
s_add_u32 s57, s66, 122880
buffer_load_dwordx3 v[24:26],v119,s[52:55],s57 offen
s_add_u32 s57, s66, 135168
buffer_load_dwordx3 v[28:30],v119,s[52:55],s57 offen
s_add_u32 s57, s66, 393216
buffer_load_dwordx3 v[32:34],v119,s[52:55],s57 offen
s_add_u32 s57, s66, 405504
buffer_load_dwordx3 v[36:38],v119,s[52:55],s57 offen
s_add_u32 s57, s66, 491520
buffer_load_dwordx3 v[40:42],v119,s[52:55],s57 offen
s_add_u32 s57, s66, 503808
buffer_load_dwordx3 v[44:46],v119,s[52:55],s57 offen
s_add_u32 s57, s66, 417792
buffer_load_dwordx3 v[48:50],v119,s[52:55],s57 offen
s_add_u32 s57, s66, 430080
buffer_load_dwordx3 v[52:54],v119,s[52:55],s57 offen
s_add_u32 s57, s66, 516096
buffer_load_dwordx3 v[56:58],v119,s[52:55],s57 offen
s_add_u32 s57, s66, 528384
buffer_load_dwordx3 v[60:62],v119,s[52:55],s57 offen
s_add_u32 s57, s66, 786432
buffer_load_dwordx3 v[64:66],v119,s[52:55],s57 offen
s_add_u32 s57, s66, 798720
buffer_load_dwordx3 v[68:70],v119,s[52:55],s57 offen
s_add_u32 s57, s66, 884736
buffer_load_dwordx3 v[72:74],v119,s[52:55],s57 offen
s_add_u32 s57, s66, 897024
buffer_load_dwordx3 v[76:78],v119,s[52:55],s57 offen
s_waitcnt vmcnt(18)
v_perm_b32 v96, v4, v0, s61
v_perm_b32 v97, v4, v0, s59
v_perm_b32 v98, v5, v1, s61
v_perm_b32 v99, v5, v1, s59
v_perm_b32 v100, v6, v2, s61
v_perm_b32 v80, v6, v2, s59
v_accvgpr_write_b32 a0, v96
v_accvgpr_write_b32 a8, v97
v_accvgpr_write_b32 a16, v98
v_accvgpr_write_b32 a24, v99
v_accvgpr_write_b32 a32, v100
s_add_u32 s57, s66, 811008
buffer_load_dwordx3 v[0:2],v119,s[52:55],s57 offen
s_add_u32 s57, s66, 823296
buffer_load_dwordx3 v[4:6],v119,s[52:55],s57 offen
s_waitcnt vmcnt(18)
v_perm_b32 v96, v12, v8, s61
v_perm_b32 v97, v12, v8, s59
v_perm_b32 v98, v13, v9, s61
v_perm_b32 v99, v13, v9, s59
v_perm_b32 v100, v14, v10, s61
v_perm_b32 v81, v14, v10, s59
v_accvgpr_write_b32 a1, v96
v_accvgpr_write_b32 a9, v97
v_accvgpr_write_b32 a17, v98
v_accvgpr_write_b32 a25, v99
v_accvgpr_write_b32 a33, v100
s_add_u32 s57, s66, 909312
buffer_load_dwordx3 v[8:10],v119,s[52:55],s57 offen
s_add_u32 s57, s66, 921600
buffer_load_dwordx3 v[12:14],v119,s[52:55],s57 offen
s_waitcnt vmcnt(18)
v_perm_b32 v96, v20, v16, s61
v_perm_b32 v97, v20, v16, s59
v_perm_b32 v98, v21, v17, s61
v_perm_b32 v99, v21, v17, s59
v_perm_b32 v100, v22, v18, s61
v_perm_b32 v82, v22, v18, s59
v_accvgpr_write_b32 a2, v96
v_accvgpr_write_b32 a10, v97
v_accvgpr_write_b32 a18, v98
v_accvgpr_write_b32 a26, v99
v_accvgpr_write_b32 a34, v100
s_add_u32 s57, s66, 1179648
buffer_load_dwordx3 v[16:18],v119,s[52:55],s57 offen
s_add_u32 s57, s66, 1191936
buffer_load_dwordx3 v[20:22],v119,s[52:55],s57 offen
s_waitcnt vmcnt(18)
v_perm_b32 v96, v28, v24, s61
v_perm_b32 v97, v28, v24, s59
v_perm_b32 v98, v29, v25, s61
v_perm_b32 v99, v29, v25, s59
v_perm_b32 v100, v30, v26, s61
v_perm_b32 v83, v30, v26, s59
v_accvgpr_write_b32 a3, v96
v_accvgpr_write_b32 a11, v97
v_accvgpr_write_b32 a19, v98
v_accvgpr_write_b32 a27, v99
v_accvgpr_write_b32 a35, v100
ds_write_b128 v110, v[80:83] offset:0
s_add_u32 s57, s66, 1277952
buffer_load_dwordx3 v[24:26],v119,s[52:55],s57 offen
s_add_u32 s57, s66, 1290240
buffer_load_dwordx3 v[28:30],v119,s[52:55],s57 offen
s_waitcnt vmcnt(18)
v_perm_b32 v96, v36, v32, s61
v_perm_b32 v97, v36, v32, s59
v_perm_b32 v98, v37, v33, s61
v_perm_b32 v99, v37, v33, s59
v_perm_b32 v100, v38, v34, s61
v_perm_b32 v84, v38, v34, s59
v_accvgpr_write_b32 a4, v96
v_accvgpr_write_b32 a12, v97
v_accvgpr_write_b32 a20, v98
v_accvgpr_write_b32 a28, v99
v_accvgpr_write_b32 a36, v100
s_add_u32 s57, s66, 1204224
buffer_load_dwordx3 v[32:34],v119,s[52:55],s57 offen
s_add_u32 s57, s66, 1216512
buffer_load_dwordx3 v[36:38],v119,s[52:55],s57 offen
s_waitcnt vmcnt(18)
v_perm_b32 v96, v44, v40, s61
v_perm_b32 v97, v44, v40, s59
v_perm_b32 v98, v45, v41, s61
v_perm_b32 v99, v45, v41, s59
v_perm_b32 v100, v46, v42, s61
v_perm_b32 v85, v46, v42, s59
v_accvgpr_write_b32 a5, v96
v_accvgpr_write_b32 a13, v97
v_accvgpr_write_b32 a21, v98
v_accvgpr_write_b32 a29, v99
v_accvgpr_write_b32 a37, v100
s_add_u32 s57, s66, 1302528
buffer_load_dwordx3 v[40:42],v119,s[52:55],s57 offen
s_add_u32 s57, s66, 1314816
buffer_load_dwordx3 v[44:46],v119,s[52:55],s57 offen
s_waitcnt vmcnt(18)
v_perm_b32 v96, v52, v48, s61
v_perm_b32 v97, v52, v48, s59
v_perm_b32 v98, v53, v49, s61
v_perm_b32 v99, v53, v49, s59
v_perm_b32 v100, v54, v50, s61
v_perm_b32 v86, v54, v50, s59
v_accvgpr_write_b32 a6, v96
v_accvgpr_write_b32 a14, v97
v_accvgpr_write_b32 a22, v98
v_accvgpr_write_b32 a30, v99
v_accvgpr_write_b32 a38, v100
s_add_u32 s57, s66, 1572864
buffer_load_dwordx3 v[48:50],v119,s[52:55],s57 offen
s_add_u32 s57, s66, 1585152
buffer_load_dwordx3 v[52:54],v119,s[52:55],s57 offen
s_waitcnt vmcnt(18)
v_perm_b32 v96, v60, v56, s61
v_perm_b32 v97, v60, v56, s59
v_perm_b32 v98, v61, v57, s61
v_perm_b32 v99, v61, v57, s59
v_perm_b32 v100, v62, v58, s61
v_perm_b32 v87, v62, v58, s59
v_accvgpr_write_b32 a7, v96
v_accvgpr_write_b32 a15, v97
v_accvgpr_write_b32 a23, v98
v_accvgpr_write_b32 a31, v99
v_accvgpr_write_b32 a39, v100
ds_write_b128 v110, v[84:87] offset:1024
s_add_u32 s57, s66, 1671168
buffer_load_dwordx3 v[56:58],v119,s[52:55],s57 offen
s_add_u32 s57, s66, 1683456
buffer_load_dwordx3 v[60:62],v119,s[52:55],s57 offen
s_waitcnt vmcnt(18)
v_perm_b32 v96, v68, v64, s61
v_perm_b32 v97, v68, v64, s59
v_perm_b32 v98, v69, v65, s61
v_perm_b32 v99, v69, v65, s59
v_perm_b32 v100, v70, v66, s61
v_perm_b32 v80, v70, v66, s59
v_accvgpr_write_b32 a40, v96
v_accvgpr_write_b32 a48, v97
v_accvgpr_write_b32 a56, v98
v_accvgpr_write_b32 a64, v99
v_accvgpr_write_b32 a72, v100
s_add_u32 s57, s66, 1597440
buffer_load_dwordx3 v[64:66],v119,s[52:55],s57 offen
s_add_u32 s57, s66, 1609728
buffer_load_dwordx3 v[68:70],v119,s[52:55],s57 offen
s_waitcnt vmcnt(18)
v_perm_b32 v96, v76, v72, s61
v_perm_b32 v97, v76, v72, s59
v_perm_b32 v98, v77, v73, s61
v_perm_b32 v99, v77, v73, s59
v_perm_b32 v100, v78, v74, s61
v_perm_b32 v81, v78, v74, s59
v_accvgpr_write_b32 a41, v96
v_accvgpr_write_b32 a49, v97
v_accvgpr_write_b32 a57, v98
v_accvgpr_write_b32 a65, v99
v_accvgpr_write_b32 a73, v100
s_add_u32 s57, s66, 1695744
buffer_load_dwordx3 v[72:74],v119,s[52:55],s57 offen
s_add_u32 s57, s66, 1708032
buffer_load_dwordx3 v[76:78],v119,s[52:55],s57 offen
s_waitcnt vmcnt(18)
v_perm_b32 v96, v4, v0, s61
v_perm_b32 v97, v4, v0, s59
v_perm_b32 v98, v5, v1, s61
v_perm_b32 v99, v5, v1, s59
v_perm_b32 v100, v6, v2, s61
v_perm_b32 v82, v6, v2, s59
v_accvgpr_write_b32 a42, v96
v_accvgpr_write_b32 a50, v97
v_accvgpr_write_b32 a58, v98
v_accvgpr_write_b32 a66, v99
v_accvgpr_write_b32 a74, v100
s_add_u32 s57, s66, 1966080
buffer_load_dwordx3 v[0:2],v119,s[52:55],s57 offen
s_add_u32 s57, s66, 1978368
buffer_load_dwordx3 v[4:6],v119,s[52:55],s57 offen
s_waitcnt vmcnt(18)
v_perm_b32 v96, v12, v8, s61
v_perm_b32 v97, v12, v8, s59
v_perm_b32 v98, v13, v9, s61
v_perm_b32 v99, v13, v9, s59
v_perm_b32 v100, v14, v10, s61
v_perm_b32 v83, v14, v10, s59
v_accvgpr_write_b32 a43, v96
v_accvgpr_write_b32 a51, v97
v_accvgpr_write_b32 a59, v98
v_accvgpr_write_b32 a67, v99
v_accvgpr_write_b32 a75, v100
ds_write_b128 v110, v[80:83] offset:2048
s_add_u32 s57, s66, 2064384
buffer_load_dwordx3 v[8:10],v119,s[52:55],s57 offen
s_add_u32 s57, s66, 2076672
buffer_load_dwordx3 v[12:14],v119,s[52:55],s57 offen
s_waitcnt vmcnt(18)
v_perm_b32 v96, v20, v16, s61
v_perm_b32 v97, v20, v16, s59
v_perm_b32 v98, v21, v17, s61
v_perm_b32 v99, v21, v17, s59
v_perm_b32 v100, v22, v18, s61
v_perm_b32 v84, v22, v18, s59
v_accvgpr_write_b32 a44, v96
v_accvgpr_write_b32 a52, v97
v_accvgpr_write_b32 a60, v98
v_accvgpr_write_b32 a68, v99
v_accvgpr_write_b32 a76, v100
s_add_u32 s57, s66, 1990656
buffer_load_dwordx3 v[16:18],v119,s[52:55],s57 offen
s_add_u32 s57, s66, 2002944
buffer_load_dwordx3 v[20:22],v119,s[52:55],s57 offen
s_waitcnt vmcnt(18)
v_perm_b32 v96, v28, v24, s61
v_perm_b32 v97, v28, v24, s59
v_perm_b32 v98, v29, v25, s61
v_perm_b32 v99, v29, v25, s59
v_perm_b32 v100, v30, v26, s61
v_perm_b32 v85, v30, v26, s59
v_accvgpr_write_b32 a45, v96
v_accvgpr_write_b32 a53, v97
v_accvgpr_write_b32 a61, v98
v_accvgpr_write_b32 a69, v99
v_accvgpr_write_b32 a77, v100
s_add_u32 s57, s66, 2088960
buffer_load_dwordx3 v[24:26],v119,s[52:55],s57 offen
s_add_u32 s57, s66, 2101248
buffer_load_dwordx3 v[28:30],v119,s[52:55],s57 offen
s_waitcnt vmcnt(18)
v_perm_b32 v96, v36, v32, s61
v_perm_b32 v97, v36, v32, s59
v_perm_b32 v98, v37, v33, s61
v_perm_b32 v99, v37, v33, s59
v_perm_b32 v100, v38, v34, s61
v_perm_b32 v86, v38, v34, s59
v_accvgpr_write_b32 a46, v96
v_accvgpr_write_b32 a54, v97
v_accvgpr_write_b32 a62, v98
v_accvgpr_write_b32 a70, v99
v_accvgpr_write_b32 a78, v100
s_add_u32 s57, s66, 2359296
buffer_load_dwordx3 v[32:34],v119,s[52:55],s57 offen
s_add_u32 s57, s66, 2371584
buffer_load_dwordx3 v[36:38],v119,s[52:55],s57 offen
s_waitcnt vmcnt(18)
v_perm_b32 v96, v44, v40, s61
v_perm_b32 v97, v44, v40, s59
v_perm_b32 v98, v45, v41, s61
v_perm_b32 v99, v45, v41, s59
v_perm_b32 v100, v46, v42, s61
v_perm_b32 v87, v46, v42, s59
v_accvgpr_write_b32 a47, v96
v_accvgpr_write_b32 a55, v97
v_accvgpr_write_b32 a63, v98
v_accvgpr_write_b32 a71, v99
v_accvgpr_write_b32 a79, v100
ds_write_b128 v110, v[84:87] offset:3072
s_add_u32 s57, s66, 2457600
buffer_load_dwordx3 v[40:42],v119,s[52:55],s57 offen
s_add_u32 s57, s66, 2469888
buffer_load_dwordx3 v[44:46],v119,s[52:55],s57 offen
s_waitcnt vmcnt(18)
v_perm_b32 v96, v52, v48, s61
v_perm_b32 v97, v52, v48, s59
v_perm_b32 v98, v53, v49, s61
v_perm_b32 v99, v53, v49, s59
v_perm_b32 v100, v54, v50, s61
v_perm_b32 v80, v54, v50, s59
v_accvgpr_write_b32 a80, v96
v_accvgpr_write_b32 a88, v97
v_accvgpr_write_b32 a96, v98
v_accvgpr_write_b32 a104, v99
v_accvgpr_write_b32 a112, v100
s_add_u32 s57, s66, 2383872
buffer_load_dwordx3 v[48:50],v119,s[52:55],s57 offen
s_add_u32 s57, s66, 2396160
buffer_load_dwordx3 v[52:54],v119,s[52:55],s57 offen
s_waitcnt vmcnt(18)
v_perm_b32 v96, v60, v56, s61
v_perm_b32 v97, v60, v56, s59
v_perm_b32 v98, v61, v57, s61
v_perm_b32 v99, v61, v57, s59
v_perm_b32 v100, v62, v58, s61
v_perm_b32 v81, v62, v58, s59
v_accvgpr_write_b32 a81, v96
v_accvgpr_write_b32 a89, v97
v_accvgpr_write_b32 a97, v98
v_accvgpr_write_b32 a105, v99
v_accvgpr_write_b32 a113, v100
s_add_u32 s57, s66, 2482176
buffer_load_dwordx3 v[56:58],v119,s[52:55],s57 offen
s_add_u32 s57, s66, 2494464
buffer_load_dwordx3 v[60:62],v119,s[52:55],s57 offen
s_waitcnt vmcnt(18)
v_perm_b32 v96, v68, v64, s61
v_perm_b32 v97, v68, v64, s59
v_perm_b32 v98, v69, v65, s61
v_perm_b32 v99, v69, v65, s59
v_perm_b32 v100, v70, v66, s61
v_perm_b32 v82, v70, v66, s59
v_accvgpr_write_b32 a82, v96
v_accvgpr_write_b32 a90, v97
v_accvgpr_write_b32 a98, v98
v_accvgpr_write_b32 a106, v99
v_accvgpr_write_b32 a114, v100
s_add_u32 s57, s66, 2752512
buffer_load_dwordx3 v[64:66],v119,s[52:55],s57 offen
s_add_u32 s57, s66, 2764800
buffer_load_dwordx3 v[68:70],v119,s[52:55],s57 offen
s_waitcnt vmcnt(18)
v_perm_b32 v96, v76, v72, s61
v_perm_b32 v97, v76, v72, s59
v_perm_b32 v98, v77, v73, s61
v_perm_b32 v99, v77, v73, s59
v_perm_b32 v100, v78, v74, s61
v_perm_b32 v83, v78, v74, s59
v_accvgpr_write_b32 a83, v96
v_accvgpr_write_b32 a91, v97
v_accvgpr_write_b32 a99, v98
v_accvgpr_write_b32 a107, v99
v_accvgpr_write_b32 a115, v100
ds_write_b128 v110, v[80:83] offset:4096
s_add_u32 s57, s66, 2850816
buffer_load_dwordx3 v[72:74],v119,s[52:55],s57 offen
s_add_u32 s57, s66, 2863104
buffer_load_dwordx3 v[76:78],v119,s[52:55],s57 offen
s_waitcnt vmcnt(18)
v_perm_b32 v96, v4, v0, s61
v_perm_b32 v97, v4, v0, s59
v_perm_b32 v98, v5, v1, s61
v_perm_b32 v99, v5, v1, s59
v_perm_b32 v100, v6, v2, s61
v_perm_b32 v84, v6, v2, s59
v_accvgpr_write_b32 a84, v96
v_accvgpr_write_b32 a92, v97
v_accvgpr_write_b32 a100, v98
v_accvgpr_write_b32 a108, v99
v_accvgpr_write_b32 a116, v100
s_add_u32 s57, s66, 2777088
buffer_load_dwordx3 v[0:2],v119,s[52:55],s57 offen
s_add_u32 s57, s66, 2789376
buffer_load_dwordx3 v[4:6],v119,s[52:55],s57 offen
s_waitcnt vmcnt(18)
v_perm_b32 v96, v12, v8, s61
v_perm_b32 v97, v12, v8, s59
v_perm_b32 v98, v13, v9, s61
v_perm_b32 v99, v13, v9, s59
v_perm_b32 v100, v14, v10, s61
v_perm_b32 v85, v14, v10, s59
v_accvgpr_write_b32 a85, v96
v_accvgpr_write_b32 a93, v97
v_accvgpr_write_b32 a101, v98
v_accvgpr_write_b32 a109, v99
v_accvgpr_write_b32 a117, v100
s_add_u32 s57, s66, 2875392
buffer_load_dwordx3 v[8:10],v119,s[52:55],s57 offen
s_add_u32 s57, s66, 2887680
buffer_load_dwordx3 v[12:14],v119,s[52:55],s57 offen
s_waitcnt vmcnt(18)
v_perm_b32 v96, v20, v16, s61
v_perm_b32 v97, v20, v16, s59
v_perm_b32 v98, v21, v17, s61
v_perm_b32 v99, v21, v17, s59
v_perm_b32 v100, v22, v18, s61
v_perm_b32 v86, v22, v18, s59
v_accvgpr_write_b32 a86, v96
v_accvgpr_write_b32 a94, v97
v_accvgpr_write_b32 a102, v98
v_accvgpr_write_b32 a110, v99
v_accvgpr_write_b32 a118, v100
s_add_u32 s57, s66, 3145728
buffer_load_dwordx3 v[16:18],v119,s[52:55],s57 offen
s_add_u32 s57, s66, 3158016
buffer_load_dwordx3 v[20:22],v119,s[52:55],s57 offen
s_waitcnt vmcnt(18)
v_perm_b32 v96, v28, v24, s61
v_perm_b32 v97, v28, v24, s59
v_perm_b32 v98, v29, v25, s61
v_perm_b32 v99, v29, v25, s59
v_perm_b32 v100, v30, v26, s61
v_perm_b32 v87, v30, v26, s59
v_accvgpr_write_b32 a87, v96
v_accvgpr_write_b32 a95, v97
v_accvgpr_write_b32 a103, v98
v_accvgpr_write_b32 a111, v99
v_accvgpr_write_b32 a119, v100
ds_write_b128 v110, v[84:87] offset:5120
s_add_u32 s57, s66, 3244032
buffer_load_dwordx3 v[24:26],v119,s[52:55],s57 offen
s_add_u32 s57, s66, 3256320
buffer_load_dwordx3 v[28:30],v119,s[52:55],s57 offen
s_waitcnt vmcnt(18)
v_perm_b32 v96, v36, v32, s61
v_perm_b32 v97, v36, v32, s59
v_perm_b32 v98, v37, v33, s61
v_perm_b32 v99, v37, v33, s59
v_perm_b32 v100, v38, v34, s61
v_perm_b32 v80, v38, v34, s59
v_accvgpr_write_b32 a120, v96
v_accvgpr_write_b32 a128, v97
v_accvgpr_write_b32 a136, v98
v_accvgpr_write_b32 a144, v99
v_accvgpr_write_b32 a152, v100
s_add_u32 s57, s66, 3170304
buffer_load_dwordx3 v[32:34],v119,s[52:55],s57 offen
s_add_u32 s57, s66, 3182592
buffer_load_dwordx3 v[36:38],v119,s[52:55],s57 offen
s_waitcnt vmcnt(18)
v_perm_b32 v96, v44, v40, s61
v_perm_b32 v97, v44, v40, s59
v_perm_b32 v98, v45, v41, s61
v_perm_b32 v99, v45, v41, s59
v_perm_b32 v100, v46, v42, s61
v_perm_b32 v81, v46, v42, s59
v_accvgpr_write_b32 a121, v96
v_accvgpr_write_b32 a129, v97
v_accvgpr_write_b32 a137, v98
v_accvgpr_write_b32 a145, v99
v_accvgpr_write_b32 a153, v100
s_add_u32 s57, s66, 3268608
buffer_load_dwordx3 v[40:42],v119,s[52:55],s57 offen
s_add_u32 s57, s66, 3280896
buffer_load_dwordx3 v[44:46],v119,s[52:55],s57 offen
s_waitcnt vmcnt(18)
v_perm_b32 v96, v52, v48, s61
v_perm_b32 v97, v52, v48, s59
v_perm_b32 v98, v53, v49, s61
v_perm_b32 v99, v53, v49, s59
v_perm_b32 v100, v54, v50, s61
v_perm_b32 v82, v54, v50, s59
v_accvgpr_write_b32 a122, v96
v_accvgpr_write_b32 a130, v97
v_accvgpr_write_b32 a138, v98
v_accvgpr_write_b32 a146, v99
v_accvgpr_write_b32 a154, v100
s_add_u32 s57, s66, 3538944
buffer_load_dwordx3 v[48:50],v119,s[52:55],s57 offen
s_add_u32 s57, s66, 3551232
buffer_load_dwordx3 v[52:54],v119,s[52:55],s57 offen
s_waitcnt vmcnt(18)
v_perm_b32 v96, v60, v56, s61
v_perm_b32 v97, v60, v56, s59
v_perm_b32 v98, v61, v57, s61
v_perm_b32 v99, v61, v57, s59
v_perm_b32 v100, v62, v58, s61
v_perm_b32 v83, v62, v58, s59
v_accvgpr_write_b32 a123, v96
v_accvgpr_write_b32 a131, v97
v_accvgpr_write_b32 a139, v98
v_accvgpr_write_b32 a147, v99
v_accvgpr_write_b32 a155, v100
ds_write_b128 v110, v[80:83] offset:6144
s_add_u32 s57, s66, 3637248
buffer_load_dwordx3 v[56:58],v119,s[52:55],s57 offen
s_add_u32 s57, s66, 3649536
buffer_load_dwordx3 v[60:62],v119,s[52:55],s57 offen
s_waitcnt vmcnt(18)
v_perm_b32 v96, v68, v64, s61
v_perm_b32 v97, v68, v64, s59
v_perm_b32 v98, v69, v65, s61
v_perm_b32 v99, v69, v65, s59
v_perm_b32 v100, v70, v66, s61
v_perm_b32 v84, v70, v66, s59
v_accvgpr_write_b32 a124, v96
v_accvgpr_write_b32 a132, v97
v_accvgpr_write_b32 a140, v98
v_accvgpr_write_b32 a148, v99
v_accvgpr_write_b32 a156, v100
s_add_u32 s57, s66, 3563520
buffer_load_dwordx3 v[64:66],v119,s[52:55],s57 offen
s_add_u32 s57, s66, 3575808
buffer_load_dwordx3 v[68:70],v119,s[52:55],s57 offen
s_waitcnt vmcnt(18)
v_perm_b32 v96, v76, v72, s61
v_perm_b32 v97, v76, v72, s59
v_perm_b32 v98, v77, v73, s61
v_perm_b32 v99, v77, v73, s59
v_perm_b32 v100, v78, v74, s61
v_perm_b32 v85, v78, v74, s59
v_accvgpr_write_b32 a125, v96
v_accvgpr_write_b32 a133, v97
v_accvgpr_write_b32 a141, v98
v_accvgpr_write_b32 a149, v99
v_accvgpr_write_b32 a157, v100
s_add_u32 s57, s66, 3661824
buffer_load_dwordx3 v[72:74],v119,s[52:55],s57 offen
s_add_u32 s57, s66, 3674112
buffer_load_dwordx3 v[76:78],v119,s[52:55],s57 offen
s_waitcnt vmcnt(18)
v_perm_b32 v96, v4, v0, s61
v_perm_b32 v97, v4, v0, s59
v_perm_b32 v98, v5, v1, s61
v_perm_b32 v99, v5, v1, s59
v_perm_b32 v100, v6, v2, s61
v_perm_b32 v86, v6, v2, s59
v_accvgpr_write_b32 a126, v96
v_accvgpr_write_b32 a134, v97
v_accvgpr_write_b32 a142, v98
v_accvgpr_write_b32 a150, v99
v_accvgpr_write_b32 a158, v100
s_add_u32 s57, s66, 3932160
buffer_load_dwordx3 v[0:2],v119,s[52:55],s57 offen
s_add_u32 s57, s66, 3944448
buffer_load_dwordx3 v[4:6],v119,s[52:55],s57 offen
s_waitcnt vmcnt(18)
v_perm_b32 v96, v12, v8, s61
v_perm_b32 v97, v12, v8, s59
v_perm_b32 v98, v13, v9, s61
v_perm_b32 v99, v13, v9, s59
v_perm_b32 v100, v14, v10, s61
v_perm_b32 v87, v14, v10, s59
v_accvgpr_write_b32 a127, v96
v_accvgpr_write_b32 a135, v97
v_accvgpr_write_b32 a143, v98
v_accvgpr_write_b32 a151, v99
v_accvgpr_write_b32 a159, v100
ds_write_b128 v110, v[84:87] offset:7168
s_add_u32 s57, s66, 4030464
buffer_load_dwordx3 v[8:10],v119,s[52:55],s57 offen
s_add_u32 s57, s66, 4042752
buffer_load_dwordx3 v[12:14],v119,s[52:55],s57 offen
s_waitcnt vmcnt(18)
v_perm_b32 v96, v20, v16, s61
v_perm_b32 v97, v20, v16, s59
v_perm_b32 v98, v21, v17, s61
v_perm_b32 v99, v21, v17, s59
v_perm_b32 v100, v22, v18, s61
v_perm_b32 v80, v22, v18, s59
v_accvgpr_write_b32 a160, v96
v_accvgpr_write_b32 a168, v97
v_accvgpr_write_b32 a176, v98
v_accvgpr_write_b32 a184, v99
v_accvgpr_write_b32 a192, v100
s_add_u32 s57, s66, 3956736
buffer_load_dwordx3 v[16:18],v119,s[52:55],s57 offen
s_add_u32 s57, s66, 3969024
buffer_load_dwordx3 v[20:22],v119,s[52:55],s57 offen
s_waitcnt vmcnt(18)
v_perm_b32 v96, v28, v24, s61
v_perm_b32 v97, v28, v24, s59
v_perm_b32 v98, v29, v25, s61
v_perm_b32 v99, v29, v25, s59
v_perm_b32 v100, v30, v26, s61
v_perm_b32 v81, v30, v26, s59
v_accvgpr_write_b32 a161, v96
v_accvgpr_write_b32 a169, v97
v_accvgpr_write_b32 a177, v98
v_accvgpr_write_b32 a185, v99
v_accvgpr_write_b32 a193, v100
s_add_u32 s57, s66, 4055040
buffer_load_dwordx3 v[24:26],v119,s[52:55],s57 offen
s_add_u32 s57, s66, 4067328
buffer_load_dwordx3 v[28:30],v119,s[52:55],s57 offen
s_waitcnt vmcnt(18)
v_perm_b32 v96, v36, v32, s61
v_perm_b32 v97, v36, v32, s59
v_perm_b32 v98, v37, v33, s61
v_perm_b32 v99, v37, v33, s59
v_perm_b32 v100, v38, v34, s61
v_perm_b32 v82, v38, v34, s59
v_accvgpr_write_b32 a162, v96
v_accvgpr_write_b32 a170, v97
v_accvgpr_write_b32 a178, v98
v_accvgpr_write_b32 a186, v99
v_accvgpr_write_b32 a194, v100
s_add_u32 s57, s66, 4325376
buffer_load_dwordx3 v[32:34],v119,s[52:55],s57 offen
s_add_u32 s57, s66, 4337664
buffer_load_dwordx3 v[36:38],v119,s[52:55],s57 offen
s_waitcnt vmcnt(18)
v_perm_b32 v96, v44, v40, s61
v_perm_b32 v97, v44, v40, s59
v_perm_b32 v98, v45, v41, s61
v_perm_b32 v99, v45, v41, s59
v_perm_b32 v100, v46, v42, s61
v_perm_b32 v83, v46, v42, s59
v_accvgpr_write_b32 a163, v96
v_accvgpr_write_b32 a171, v97
v_accvgpr_write_b32 a179, v98
v_accvgpr_write_b32 a187, v99
v_accvgpr_write_b32 a195, v100
ds_write_b128 v110, v[80:83] offset:8192
s_add_u32 s57, s66, 4423680
buffer_load_dwordx3 v[40:42],v119,s[52:55],s57 offen
s_add_u32 s57, s66, 4435968
buffer_load_dwordx3 v[44:46],v119,s[52:55],s57 offen
s_waitcnt vmcnt(18)
v_perm_b32 v96, v52, v48, s61
v_perm_b32 v97, v52, v48, s59
v_perm_b32 v98, v53, v49, s61
v_perm_b32 v99, v53, v49, s59
v_perm_b32 v100, v54, v50, s61
v_perm_b32 v84, v54, v50, s59
v_accvgpr_write_b32 a164, v96
v_accvgpr_write_b32 a172, v97
v_accvgpr_write_b32 a180, v98
v_accvgpr_write_b32 a188, v99
v_accvgpr_write_b32 a196, v100
s_add_u32 s57, s66, 4349952
buffer_load_dwordx3 v[48:50],v119,s[52:55],s57 offen
s_add_u32 s57, s66, 4362240
buffer_load_dwordx3 v[52:54],v119,s[52:55],s57 offen
s_waitcnt vmcnt(18)
v_perm_b32 v96, v60, v56, s61
v_perm_b32 v97, v60, v56, s59
v_perm_b32 v98, v61, v57, s61
v_perm_b32 v99, v61, v57, s59
v_perm_b32 v100, v62, v58, s61
v_perm_b32 v85, v62, v58, s59
v_accvgpr_write_b32 a165, v96
v_accvgpr_write_b32 a173, v97
v_accvgpr_write_b32 a181, v98
v_accvgpr_write_b32 a189, v99
v_accvgpr_write_b32 a197, v100
s_add_u32 s57, s66, 4448256
buffer_load_dwordx3 v[56:58],v119,s[52:55],s57 offen
s_add_u32 s57, s66, 4460544
buffer_load_dwordx3 v[60:62],v119,s[52:55],s57 offen
s_waitcnt vmcnt(18)
v_perm_b32 v96, v68, v64, s61
v_perm_b32 v97, v68, v64, s59
v_perm_b32 v98, v69, v65, s61
v_perm_b32 v99, v69, v65, s59
v_perm_b32 v100, v70, v66, s61
v_perm_b32 v86, v70, v66, s59
v_accvgpr_write_b32 a166, v96
v_accvgpr_write_b32 a174, v97
v_accvgpr_write_b32 a182, v98
v_accvgpr_write_b32 a190, v99
v_accvgpr_write_b32 a198, v100
s_add_u32 s57, s66, 4718592
buffer_load_dwordx3 v[64:66],v119,s[52:55],s57 offen
s_add_u32 s57, s66, 4730880
buffer_load_dwordx3 v[68:70],v119,s[52:55],s57 offen
s_waitcnt vmcnt(18)
v_perm_b32 v96, v76, v72, s61
v_perm_b32 v97, v76, v72, s59
v_perm_b32 v98, v77, v73, s61
v_perm_b32 v99, v77, v73, s59
v_perm_b32 v100, v78, v74, s61
v_perm_b32 v87, v78, v74, s59
v_accvgpr_write_b32 a167, v96
v_accvgpr_write_b32 a175, v97
v_accvgpr_write_b32 a183, v98
v_accvgpr_write_b32 a191, v99
v_accvgpr_write_b32 a199, v100
ds_write_b128 v110, v[84:87] offset:9216
s_add_u32 s57, s66, 4816896
buffer_load_dwordx3 v[72:74],v119,s[52:55],s57 offen
s_add_u32 s57, s66, 4829184
buffer_load_dwordx3 v[76:78],v119,s[52:55],s57 offen
s_waitcnt vmcnt(18)
v_perm_b32 v96, v4, v0, s61
v_perm_b32 v97, v4, v0, s59
v_perm_b32 v98, v5, v1, s61
v_perm_b32 v99, v5, v1, s59
v_perm_b32 v88, v6, v2, s61
v_perm_b32 v80, v6, v2, s59
v_accvgpr_write_b32 a200, v96
v_accvgpr_write_b32 a208, v97
v_accvgpr_write_b32 a216, v98
v_accvgpr_write_b32 a224, v99
s_add_u32 s57, s66, 4743168
buffer_load_dwordx3 v[0:2],v119,s[52:55],s57 offen
s_add_u32 s57, s66, 4755456
buffer_load_dwordx3 v[4:6],v119,s[52:55],s57 offen
s_waitcnt vmcnt(18)
v_perm_b32 v96, v12, v8, s61
v_perm_b32 v97, v12, v8, s59
v_perm_b32 v98, v13, v9, s61
v_perm_b32 v99, v13, v9, s59
v_perm_b32 v89, v14, v10, s61
v_perm_b32 v81, v14, v10, s59
v_accvgpr_write_b32 a201, v96
v_accvgpr_write_b32 a209, v97
v_accvgpr_write_b32 a217, v98
v_accvgpr_write_b32 a225, v99
s_add_u32 s57, s66, 4841472
buffer_load_dwordx3 v[8:10],v119,s[52:55],s57 offen
s_add_u32 s57, s66, 4853760
buffer_load_dwordx3 v[12:14],v119,s[52:55],s57 offen
s_waitcnt vmcnt(18)
v_perm_b32 v96, v20, v16, s61
v_perm_b32 v97, v20, v16, s59
v_perm_b32 v98, v21, v17, s61
v_perm_b32 v99, v21, v17, s59
v_perm_b32 v90, v22, v18, s61
v_perm_b32 v82, v22, v18, s59
v_accvgpr_write_b32 a202, v96
v_accvgpr_write_b32 a210, v97
v_accvgpr_write_b32 a218, v98
v_accvgpr_write_b32 a226, v99
s_add_u32 s57, s66, 5111808
buffer_load_dwordx3 v[16:18],v119,s[52:55],s57 offen
s_add_u32 s57, s66, 5124096
buffer_load_dwordx3 v[20:22],v119,s[52:55],s57 offen
s_waitcnt vmcnt(18)
v_perm_b32 v96, v28, v24, s61
v_perm_b32 v97, v28, v24, s59
v_perm_b32 v98, v29, v25, s61
v_perm_b32 v99, v29, v25, s59
v_perm_b32 v91, v30, v26, s61
v_perm_b32 v83, v30, v26, s59
v_accvgpr_write_b32 a203, v96
v_accvgpr_write_b32 a211, v97
v_accvgpr_write_b32 a219, v98
v_accvgpr_write_b32 a227, v99
ds_write_b128 v110, v[88:91] offset:10240
ds_write_b128 v110, v[80:83] offset:12288
s_add_u32 s57, s66, 5210112
buffer_load_dwordx3 v[24:26],v119,s[52:55],s57 offen
s_add_u32 s57, s66, 5222400
buffer_load_dwordx3 v[28:30],v119,s[52:55],s57 offen
s_waitcnt vmcnt(18)
v_perm_b32 v96, v36, v32, s61
v_perm_b32 v97, v36, v32, s59
v_perm_b32 v98, v37, v33, s61
v_perm_b32 v99, v37, v33, s59
v_perm_b32 v92, v38, v34, s61
v_perm_b32 v84, v38, v34, s59
v_accvgpr_write_b32 a204, v96
v_accvgpr_write_b32 a212, v97
v_accvgpr_write_b32 a220, v98
v_accvgpr_write_b32 a228, v99
s_add_u32 s57, s66, 5136384
buffer_load_dwordx3 v[32:34],v119,s[52:55],s57 offen
s_add_u32 s57, s66, 5148672
buffer_load_dwordx3 v[36:38],v119,s[52:55],s57 offen
s_waitcnt vmcnt(18)
v_perm_b32 v96, v44, v40, s61
v_perm_b32 v97, v44, v40, s59
v_perm_b32 v98, v45, v41, s61
v_perm_b32 v99, v45, v41, s59
v_perm_b32 v93, v46, v42, s61
v_perm_b32 v85, v46, v42, s59
v_accvgpr_write_b32 a205, v96
v_accvgpr_write_b32 a213, v97
v_accvgpr_write_b32 a221, v98
v_accvgpr_write_b32 a229, v99
s_add_u32 s57, s66, 5234688
buffer_load_dwordx3 v[40:42],v119,s[52:55],s57 offen
s_add_u32 s57, s66, 5246976
buffer_load_dwordx3 v[44:46],v119,s[52:55],s57 offen
s_waitcnt vmcnt(18)
v_perm_b32 v96, v52, v48, s61
v_perm_b32 v97, v52, v48, s59
v_perm_b32 v98, v53, v49, s61
v_perm_b32 v99, v53, v49, s59
v_perm_b32 v94, v54, v50, s61
v_perm_b32 v86, v54, v50, s59
v_accvgpr_write_b32 a206, v96
v_accvgpr_write_b32 a214, v97
v_accvgpr_write_b32 a222, v98
v_accvgpr_write_b32 a230, v99
s_add_u32 s57, s66, 5505024
buffer_load_dwordx3 v[48:50],v119,s[52:55],s57 offen
s_add_u32 s57, s66, 5517312
buffer_load_dwordx3 v[52:54],v119,s[52:55],s57 offen
s_waitcnt vmcnt(18)
v_perm_b32 v96, v60, v56, s61
v_perm_b32 v97, v60, v56, s59
v_perm_b32 v98, v61, v57, s61
v_perm_b32 v99, v61, v57, s59
v_perm_b32 v95, v62, v58, s61
v_perm_b32 v87, v62, v58, s59
v_accvgpr_write_b32 a207, v96
v_accvgpr_write_b32 a215, v97
v_accvgpr_write_b32 a223, v98
v_accvgpr_write_b32 a231, v99
ds_write_b128 v110, v[92:95] offset:11264
ds_write_b128 v110, v[84:87] offset:13312
s_add_u32 s57, s66, 5603328
buffer_load_dwordx3 v[56:58],v119,s[52:55],s57 offen
s_add_u32 s57, s66, 5615616
buffer_load_dwordx3 v[60:62],v119,s[52:55],s57 offen
s_waitcnt vmcnt(18)
v_perm_b32 v96, v68, v64, s61
v_perm_b32 v97, v68, v64, s59
v_perm_b32 v98, v69, v65, s61
v_perm_b32 v120, v69, v65, s59
v_perm_b32 v128, v70, v66, s61
v_perm_b32 v80, v70, v66, s59
v_accvgpr_write_b32 a232, v96
v_accvgpr_write_b32 a240, v97
v_accvgpr_write_b32 a248, v98
s_add_u32 s57, s66, 5529600
buffer_load_dwordx3 v[64:66],v119,s[52:55],s57 offen
s_add_u32 s57, s66, 5541888
buffer_load_dwordx3 v[68:70],v119,s[52:55],s57 offen
s_waitcnt vmcnt(18)
v_perm_b32 v96, v76, v72, s61
v_perm_b32 v97, v76, v72, s59
v_perm_b32 v98, v77, v73, s61
v_perm_b32 v121, v77, v73, s59
v_perm_b32 v129, v78, v74, s61
v_perm_b32 v81, v78, v74, s59
v_accvgpr_write_b32 a233, v96
v_accvgpr_write_b32 a241, v97
v_accvgpr_write_b32 a249, v98
s_add_u32 s57, s66, 5627904
buffer_load_dwordx3 v[72:74],v119,s[52:55],s57 offen
s_add_u32 s57, s66, 5640192
buffer_load_dwordx3 v[76:78],v119,s[52:55],s57 offen
s_waitcnt vmcnt(18)
v_perm_b32 v96, v4, v0, s61
v_perm_b32 v97, v4, v0, s59
v_perm_b32 v98, v5, v1, s61
v_perm_b32 v122, v5, v1, s59
v_perm_b32 v130, v6, v2, s61
v_perm_b32 v82, v6, v2, s59
v_accvgpr_write_b32 a234, v96
v_accvgpr_write_b32 a242, v97
v_accvgpr_write_b32 a250, v98
s_add_u32 s57, s66, 5898240
buffer_load_dwordx3 v[0:2],v119,s[52:55],s57 offen
s_add_u32 s57, s66, 5910528
buffer_load_dwordx3 v[4:6],v119,s[52:55],s57 offen
s_waitcnt vmcnt(18)
v_perm_b32 v96, v12, v8, s61
v_perm_b32 v97, v12, v8, s59
v_perm_b32 v98, v13, v9, s61
v_perm_b32 v123, v13, v9, s59
v_perm_b32 v131, v14, v10, s61
v_perm_b32 v83, v14, v10, s59
v_accvgpr_write_b32 a235, v96
v_accvgpr_write_b32 a243, v97
v_accvgpr_write_b32 a251, v98
ds_write_b128 v110, v[80:83] offset:14336
s_add_u32 s57, s66, 5996544
buffer_load_dwordx3 v[8:10],v119,s[52:55],s57 offen
s_add_u32 s57, s66, 6008832
buffer_load_dwordx3 v[12:14],v119,s[52:55],s57 offen
s_waitcnt vmcnt(18)
v_perm_b32 v96, v20, v16, s61
v_perm_b32 v97, v20, v16, s59
v_perm_b32 v98, v21, v17, s61
v_perm_b32 v124, v21, v17, s59
v_perm_b32 v132, v22, v18, s61
v_perm_b32 v84, v22, v18, s59
v_accvgpr_write_b32 a236, v96
v_accvgpr_write_b32 a244, v97
v_accvgpr_write_b32 a252, v98
s_add_u32 s57, s66, 5922816
buffer_load_dwordx3 v[16:18],v119,s[52:55],s57 offen
s_add_u32 s57, s66, 5935104
buffer_load_dwordx3 v[20:22],v119,s[52:55],s57 offen
s_waitcnt vmcnt(18)
v_perm_b32 v96, v28, v24, s61
v_perm_b32 v97, v28, v24, s59
v_perm_b32 v98, v29, v25, s61
v_perm_b32 v125, v29, v25, s59
v_perm_b32 v133, v30, v26, s61
v_perm_b32 v85, v30, v26, s59
v_accvgpr_write_b32 a237, v96
v_accvgpr_write_b32 a245, v97
v_accvgpr_write_b32 a253, v98
s_add_u32 s57, s66, 6021120
buffer_load_dwordx3 v[24:26],v119,s[52:55],s57 offen
s_add_u32 s57, s66, 6033408
buffer_load_dwordx3 v[28:30],v119,s[52:55],s57 offen
s_waitcnt vmcnt(18)
v_perm_b32 v96, v36, v32, s61
v_perm_b32 v97, v36, v32, s59
v_perm_b32 v98, v37, v33, s61
v_perm_b32 v126, v37, v33, s59
v_perm_b32 v134, v38, v34, s61
v_perm_b32 v86, v38, v34, s59
v_accvgpr_write_b32 a238, v96
v_accvgpr_write_b32 a246, v97
v_accvgpr_write_b32 a254, v98
s_add_u32 s57, s66, 6291456
buffer_load_dwordx3 v[32:34],v119,s[52:55],s57 offen
s_add_u32 s57, s66, 6303744
buffer_load_dwordx3 v[36:38],v119,s[52:55],s57 offen
s_waitcnt vmcnt(18)
v_perm_b32 v96, v44, v40, s61
v_perm_b32 v97, v44, v40, s59
v_perm_b32 v98, v45, v41, s61
v_perm_b32 v127, v45, v41, s59
v_perm_b32 v135, v46, v42, s61
v_perm_b32 v87, v46, v42, s59
v_accvgpr_write_b32 a239, v96
v_accvgpr_write_b32 a247, v97
v_accvgpr_write_b32 a255, v98
ds_write_b128 v110, v[84:87] offset:15360
s_add_u32 s57, s66, 6389760
buffer_load_dwordx3 v[40:42],v119,s[52:55],s57 offen
s_add_u32 s57, s66, 6402048
buffer_load_dwordx3 v[44:46],v119,s[52:55],s57 offen
s_waitcnt vmcnt(18)
v_perm_b32 v136, v52, v48, s61
v_perm_b32 v144, v52, v48, s59
v_perm_b32 v152, v53, v49, s61
v_perm_b32 v160, v53, v49, s59
v_perm_b32 v168, v54, v50, s61
v_perm_b32 v80, v54, v50, s59
s_add_u32 s57, s66, 6316032
buffer_load_dwordx3 v[48:50],v119,s[52:55],s57 offen
s_add_u32 s57, s66, 6328320
buffer_load_dwordx3 v[52:54],v119,s[52:55],s57 offen
s_waitcnt vmcnt(18)
v_perm_b32 v137, v60, v56, s61
v_perm_b32 v145, v60, v56, s59
v_perm_b32 v153, v61, v57, s61
v_perm_b32 v161, v61, v57, s59
v_perm_b32 v169, v62, v58, s61
v_perm_b32 v81, v62, v58, s59
s_add_u32 s57, s66, 6414336
buffer_load_dwordx3 v[56:58],v119,s[52:55],s57 offen
s_add_u32 s57, s66, 6426624
buffer_load_dwordx3 v[60:62],v119,s[52:55],s57 offen
s_waitcnt vmcnt(18)
v_perm_b32 v138, v68, v64, s61
v_perm_b32 v146, v68, v64, s59
v_perm_b32 v154, v69, v65, s61
v_perm_b32 v162, v69, v65, s59
v_perm_b32 v170, v70, v66, s61
v_perm_b32 v82, v70, v66, s59
s_add_u32 s57, s66, 6684672
buffer_load_dwordx3 v[64:66],v119,s[52:55],s57 offen
s_add_u32 s57, s66, 6696960
buffer_load_dwordx3 v[68:70],v119,s[52:55],s57 offen
s_waitcnt vmcnt(18)
v_perm_b32 v139, v76, v72, s61
v_perm_b32 v147, v76, v72, s59
v_perm_b32 v155, v77, v73, s61
v_perm_b32 v163, v77, v73, s59
v_perm_b32 v171, v78, v74, s61
v_perm_b32 v83, v78, v74, s59
ds_write_b128 v110, v[80:83] offset:16384
s_add_u32 s57, s66, 6782976
buffer_load_dwordx3 v[72:74],v119,s[52:55],s57 offen
s_add_u32 s57, s66, 6795264
buffer_load_dwordx3 v[76:78],v119,s[52:55],s57 offen
s_waitcnt vmcnt(18)
v_perm_b32 v140, v4, v0, s61
v_perm_b32 v148, v4, v0, s59
v_perm_b32 v156, v5, v1, s61
v_perm_b32 v164, v5, v1, s59
v_perm_b32 v172, v6, v2, s61
v_perm_b32 v84, v6, v2, s59
s_add_u32 s57, s66, 6709248
buffer_load_dwordx3 v[0:2],v119,s[52:55],s57 offen
s_add_u32 s57, s66, 6721536
buffer_load_dwordx3 v[4:6],v119,s[52:55],s57 offen
s_waitcnt vmcnt(18)
v_perm_b32 v141, v12, v8, s61
v_perm_b32 v149, v12, v8, s59
v_perm_b32 v157, v13, v9, s61
v_perm_b32 v165, v13, v9, s59
v_perm_b32 v173, v14, v10, s61
v_perm_b32 v85, v14, v10, s59
s_add_u32 s57, s66, 6807552
buffer_load_dwordx3 v[8:10],v119,s[52:55],s57 offen
s_add_u32 s57, s66, 6819840
buffer_load_dwordx3 v[12:14],v119,s[52:55],s57 offen
s_waitcnt vmcnt(18)
v_perm_b32 v142, v20, v16, s61
v_perm_b32 v150, v20, v16, s59
v_perm_b32 v158, v21, v17, s61
v_perm_b32 v166, v21, v17, s59
v_perm_b32 v174, v22, v18, s61
v_perm_b32 v86, v22, v18, s59
s_add_u32 s57, s66, 7077888
buffer_load_dwordx3 v[16:18],v119,s[52:55],s57 offen
s_add_u32 s57, s66, 7090176
buffer_load_dwordx3 v[20:22],v119,s[52:55],s57 offen
s_waitcnt vmcnt(18)
v_perm_b32 v143, v28, v24, s61
v_perm_b32 v151, v28, v24, s59
v_perm_b32 v159, v29, v25, s61
v_perm_b32 v167, v29, v25, s59
v_perm_b32 v175, v30, v26, s61
v_perm_b32 v87, v30, v26, s59
ds_write_b128 v110, v[84:87] offset:17408
s_add_u32 s57, s66, 7176192
buffer_load_dwordx3 v[24:26],v119,s[52:55],s57 offen
s_add_u32 s57, s66, 7188480
buffer_load_dwordx3 v[28:30],v119,s[52:55],s57 offen
s_waitcnt vmcnt(18)
v_perm_b32 v176, v36, v32, s61
v_perm_b32 v184, v36, v32, s59
v_perm_b32 v192, v37, v33, s61
v_perm_b32 v200, v37, v33, s59
v_perm_b32 v208, v38, v34, s61
v_perm_b32 v80, v38, v34, s59
s_add_u32 s57, s66, 7102464
buffer_load_dwordx3 v[32:34],v119,s[52:55],s57 offen
s_add_u32 s57, s66, 7114752
buffer_load_dwordx3 v[36:38],v119,s[52:55],s57 offen
s_waitcnt vmcnt(18)
v_perm_b32 v177, v44, v40, s61
v_perm_b32 v185, v44, v40, s59
v_perm_b32 v193, v45, v41, s61
v_perm_b32 v201, v45, v41, s59
v_perm_b32 v209, v46, v42, s61
v_perm_b32 v81, v46, v42, s59
s_add_u32 s57, s66, 7200768
buffer_load_dwordx3 v[40:42],v119,s[52:55],s57 offen
s_add_u32 s57, s66, 7213056
buffer_load_dwordx3 v[44:46],v119,s[52:55],s57 offen
s_waitcnt vmcnt(18)
v_perm_b32 v178, v52, v48, s61
v_perm_b32 v186, v52, v48, s59
v_perm_b32 v194, v53, v49, s61
v_perm_b32 v202, v53, v49, s59
v_perm_b32 v210, v54, v50, s61
v_perm_b32 v82, v54, v50, s59
s_add_u32 s57, s66, 7471104
buffer_load_dwordx3 v[48:50],v119,s[52:55],s57 offen
s_add_u32 s57, s66, 7483392
buffer_load_dwordx3 v[52:54],v119,s[52:55],s57 offen
s_waitcnt vmcnt(18)
v_perm_b32 v179, v60, v56, s61
v_perm_b32 v187, v60, v56, s59
v_perm_b32 v195, v61, v57, s61
v_perm_b32 v203, v61, v57, s59
v_perm_b32 v211, v62, v58, s61
v_perm_b32 v83, v62, v58, s59
ds_write_b128 v110, v[80:83] offset:18432
s_add_u32 s57, s66, 7569408
buffer_load_dwordx3 v[56:58],v119,s[52:55],s57 offen
s_add_u32 s57, s66, 7581696
buffer_load_dwordx3 v[60:62],v119,s[52:55],s57 offen
s_waitcnt vmcnt(18)
v_perm_b32 v180, v68, v64, s61
v_perm_b32 v188, v68, v64, s59
v_perm_b32 v196, v69, v65, s61
v_perm_b32 v204, v69, v65, s59
v_perm_b32 v212, v70, v66, s61
v_perm_b32 v84, v70, v66, s59
s_add_u32 s57, s66, 7495680
buffer_load_dwordx3 v[64:66],v119,s[52:55],s57 offen
s_add_u32 s57, s66, 7507968
buffer_load_dwordx3 v[68:70],v119,s[52:55],s57 offen
s_waitcnt vmcnt(18)
v_perm_b32 v181, v76, v72, s61
v_perm_b32 v189, v76, v72, s59
v_perm_b32 v197, v77, v73, s61
v_perm_b32 v205, v77, v73, s59
v_perm_b32 v213, v78, v74, s61
v_perm_b32 v85, v78, v74, s59
s_add_u32 s57, s66, 7593984
buffer_load_dwordx3 v[72:74],v119,s[52:55],s57 offen
s_add_u32 s57, s66, 7606272
buffer_load_dwordx3 v[76:78],v119,s[52:55],s57 offen
s_waitcnt vmcnt(18)
v_perm_b32 v182, v4, v0, s61
v_perm_b32 v190, v4, v0, s59
v_perm_b32 v198, v5, v1, s61
v_perm_b32 v206, v5, v1, s59
v_perm_b32 v214, v6, v2, s61
v_perm_b32 v86, v6, v2, s59
s_waitcnt vmcnt(16)
v_perm_b32 v183, v12, v8, s61
v_perm_b32 v191, v12, v8, s59
v_perm_b32 v199, v13, v9, s61
v_perm_b32 v207, v13, v9, s59
v_perm_b32 v215, v14, v10, s61
v_perm_b32 v87, v14, v10, s59
ds_write_b128 v110, v[84:87] offset:19456
s_waitcnt vmcnt(14)
v_perm_b32 v216, v20, v16, s61
v_perm_b32 v224, v20, v16, s59
v_perm_b32 v232, v21, v17, s61
v_perm_b32 v240, v21, v17, s59
v_perm_b32 v248, v22, v18, s61
v_perm_b32 v80, v22, v18, s59
s_waitcnt vmcnt(12)
v_perm_b32 v217, v28, v24, s61
v_perm_b32 v225, v28, v24, s59
v_perm_b32 v233, v29, v25, s61
v_perm_b32 v241, v29, v25, s59
v_perm_b32 v249, v30, v26, s61
v_perm_b32 v81, v30, v26, s59
s_waitcnt vmcnt(10)
v_perm_b32 v218, v36, v32, s61
v_perm_b32 v226, v36, v32, s59
v_perm_b32 v234, v37, v33, s61
v_perm_b32 v242, v37, v33, s59
v_perm_b32 v250, v38, v34, s61
v_perm_b32 v82, v38, v34, s59
s_waitcnt vmcnt(8)
v_perm_b32 v219, v44, v40, s61
v_perm_b32 v227, v44, v40, s59
v_perm_b32 v235, v45, v41, s61
v_perm_b32 v243, v45, v41, s59
v_perm_b32 v251, v46, v42, s61
v_perm_b32 v83, v46, v42, s59
ds_write_b128 v110, v[80:83] offset:20480
s_waitcnt vmcnt(6)
v_perm_b32 v220, v52, v48, s61
v_perm_b32 v228, v52, v48, s59
v_perm_b32 v236, v53, v49, s61
v_perm_b32 v244, v53, v49, s59
v_perm_b32 v252, v54, v50, s61
v_perm_b32 v84, v54, v50, s59
s_waitcnt vmcnt(4)
v_perm_b32 v221, v60, v56, s61
v_perm_b32 v229, v60, v56, s59
v_perm_b32 v237, v61, v57, s61
v_perm_b32 v245, v61, v57, s59
v_perm_b32 v253, v62, v58, s61
v_perm_b32 v85, v62, v58, s59
s_waitcnt vmcnt(2)
v_perm_b32 v222, v68, v64, s61
v_perm_b32 v230, v68, v64, s59
v_perm_b32 v238, v69, v65, s61
v_perm_b32 v246, v69, v65, s59
v_perm_b32 v254, v70, v66, s61
v_perm_b32 v86, v70, v66, s59
s_waitcnt vmcnt(0)
v_perm_b32 v223, v76, v72, s61
v_perm_b32 v231, v76, v72, s59
v_perm_b32 v239, v77, v73, s61
v_perm_b32 v247, v77, v73, s59
v_perm_b32 v255, v78, v74, s61
v_perm_b32 v87, v78, v74, s59
ds_write_b128 v110, v[84:87] offset:21504
v_lshrrev_b32 v76, 4, v116
s_getreg_b32 s57, hwreg(HW_REG_XCC_ID, 0, 4)
s_add_u32 s57, s57, 1
v_mov_b32 v72, s57
s_lshl_b32 s89, s4, 5
v_and_b32 v73, 31, v76
s_waitcnt vmcnt(0)
PL1:
s_sleep 4
buffer_load_ubyte v74,v73,s[96:99],s89 offen sc1
s_sub_u32 s71, s71, 1
s_cbranch_scc1 EX0
s_waitcnt vmcnt(0)
v_cmp_eq_u32 vcc, 0, v74
s_cbranch_vccnz PL1
v_cmp_ne_u32 vcc, v72, v74
s_cmp_eq_u64 vcc, 0
s_cselect_b32 s69, 1, 0
s_cmp_lt_u32 s56, 2
s_cbranch_scc1 S_LOOP
s_lshl_b32 s89, s4, 11
s_add_u32 s89, s89, 244457472
v_mov_b32 v72, 0
s_branch FW2b
FW2:
s_sleep 1
FW2b:
buffer_load_dword v73,v72,s[8:11],s89 offen sc1
s_sub_u32 s71, s71, 1
s_cbranch_scc1 EX0
s_waitcnt vmcnt(0)
v_cmp_gt_u32 vcc, 8, v73
s_cbranch_vccnz FW2
s_add_u32 m0, s58, 0
s_add_u32 s57, s100, 0
buffer_load_dwordx4 v116,s[8:11],s57 offen offset:0 sc1 nt lds
buffer_load_dwordx4 v116,s[8:11],s57 offen offset:1024 sc1 nt lds
buffer_load_dwordx4 v116,s[8:11],s57 offen offset:2048 sc1 nt lds
buffer_load_dwordx4 v116,s[8:11],s57 offen offset:3072 sc1 nt lds
s_add_u32 m0, s58, 4096
s_add_u32 s57, s100, 4096
buffer_load_dwordx4 v116,s[8:11],s57 offen offset:0 sc1 nt lds
buffer_load_dwordx4 v116,s[8:11],s57 offen offset:1024 sc1 nt lds
buffer_load_dwordx4 v116,s[8:11],s57 offen offset:2048 sc1 nt lds
buffer_load_dwordx4 v116,s[8:11],s57 offen offset:3072 sc1 nt lds
s_add_u32 m0, s58, 8192
s_add_u32 s57, s100, 8192
buffer_load_dwordx4 v116,s[8:11],s57 offen offset:0 sc1 nt lds
buffer_load_dwordx4 v116,s[8:11],s57 offen offset:1024 sc1 nt lds
buffer_load_dwordx4 v116,s[8:11],s57 offen offset:2048 sc1 nt lds
buffer_load_dwordx4 v116,s[8:11],s57 offen offset:3072 sc1 nt lds
s_add_u32 m0, s58, s67
s_add_u32 s100, s100, 393216
buffer_load_dwordx4 v116,s[8:11],s101 offen sc1 nt lds
s_add_u32 s101, s101, 65536
s_mul_i32 s92, s62, 640
s_add_u32 s93, s92, 241827840
s_lshl_b32 s92, s92, 1
s_add_u32 s92, s92, 239206400
s_cmp_eq_u32 s56, 2
s_cselect_b32 s93, s93, s92
s_cselect_b32 s92, 1, 2
s_mul_i32 s57, s92, 80
s_mul_i32 s92, s92, 20480
v_cmp_gt_u32 vcc, s57, v116
v_lshlrev_b32 v72, 3, v116
v_mov_b32 v119, 1073741824
v_cndmask_b32 v119, v119, v72, vcc
S_LOOP:
ds_read_b128 v[64:67], v110 offset:0
ds_read_b128 v[68:71], v110 offset:1024
ds_read_b128 v[72:75], v110 offset:2048
ds_read_b128 v[76:79], v110 offset:3072
ds_read_b128 v[80:83], v110 offset:4096
ds_read_b128 v[84:87], v110 offset:5120
v_mov_b32 v40, 0
v_mov_b32 v41, 0
v_mov_b32 v42, 0
v_mov_b32 v43, 0
v_mov_b32 v44, 0
v_mov_b32 v45, 0
v_mov_b32 v46, 0
v_mov_b32 v47, 0
v_mov_b32 v48, 0
v_mov_b32 v49, 0
v_mov_b32 v50, 0
v_mov_b32 v51, 0
v_mov_b32 v52, 0
v_mov_b32 v53, 0
v_mov_b32 v54, 0
v_mov_b32 v55, 0
v_mov_b32 v56, 0
v_mov_b32 v57, 0
v_mov_b32 v58, 0
v_mov_b32 v59, 0
v_mov_b32 v60, 0
v_mov_b32 v61, 0
v_mov_b32 v62, 0
v_mov_b32 v63, 0
s_sleep 20
s_add_u32 s57, s6, 4096
PL3:
buffer_load_dwordx4 v[88:91],v104,s[8:11],s6 offen sc1
buffer_load_dwordx4 v[92:95],v104,s[8:11],s57 offen sc1
buffer_load_dwordx2 v[96:97],v105,s[8:11],s6 offen sc1
s_sub_u32 s71, s71, 1
s_cbranch_scc1 EX0
s_waitcnt vmcnt(0)
v_max3_u32 v98, v88, v89, v90
v_max3_u32 v98, v98, v91, v92
v_max3_u32 v98, v98, v93, v94
v_max3_u32 v98, v98, v95, v96
v_max_u32 v98, v98, v97
v_cmp_eq_u32 vcc, -1, v98
s_cbranch_vccnz PL3
ds_write_b128 v106, v[88:91]
ds_write_b128 v106, v[92:95] offset:4096
ds_write_b64 v107, v[96:97]
s_waitcnt lgkmcnt(0)
s_barrier
ds_read_b128 v[0:3], v108 offset:0
ds_read_b128 v[4:7], v108 offset:1024
ds_read_b128 v[8:11], v108 offset:2048
ds_read_b128 v[12:15], v108 offset:3072
ds_read_b128 v[16:19], v108 offset:4096
ds_read_b128 v[20:23], v108 offset:5120
ds_read_b128 v[24:27], v108 offset:6144
s_waitcnt lgkmcnt(6)
v_smfmac_f32_16x16x64_bf16 v[40:43],v[0:3],a[0:7],v109
v_smfmac_f32_16x16x64_bf16 v[44:47],v[0:3],a[8:15],v109
v_smfmac_f32_16x16x64_bf16 v[48:51],v[0:3],a[16:23],v109
v_smfmac_f32_16x16x64_bf16 v[52:55],v[0:3],a[24:31],v109
v_smfmac_f32_16x16x64_bf16 v[56:59],v[0:3],a[32:39],v109
v_smfmac_f32_16x16x64_bf16 v[60:63],v[0:3],v[64:71],v109
s_waitcnt lgkmcnt(5)
v_smfmac_f32_16x16x64_bf16 v[40:43],v[4:7],a[40:47],v109
v_smfmac_f32_16x16x64_bf16 v[44:47],v[4:7],a[48:55],v109
ds_read_b128 v[64:67], v110 offset:6144
ds_read_b128 v[68:71], v110 offset:7168
v_smfmac_f32_16x16x64_bf16 v[48:51],v[4:7],a[56:63],v109
v_smfmac_f32_16x16x64_bf16 v[52:55],v[4:7],a[64:71],v109
v_smfmac_f32_16x16x64_bf16 v[56:59],v[4:7],a[72:79],v109
v_smfmac_f32_16x16x64_bf16 v[60:63],v[4:7],v[72:79],v109
s_waitcnt lgkmcnt(6)
v_smfmac_f32_16x16x64_bf16 v[40:43],v[8:11],a[80:87],v109
v_smfmac_f32_16x16x64_bf16 v[44:47],v[8:11],a[88:95],v109
ds_read_b128 v[72:75], v110 offset:8192
ds_read_b128 v[76:79], v110 offset:9216
v_smfmac_f32_16x16x64_bf16 v[48:51],v[8:11],a[96:103],v109
v_smfmac_f32_16x16x64_bf16 v[52:55],v[8:11],a[104:111],v109
v_smfmac_f32_16x16x64_bf16 v[56:59],v[8:11],a[112:119],v109
s_waitcnt vmcnt(0)
ds_read_b128 v[28:31], v108 offset:7168
ds_read_b128 v[32:35], v108 offset:8192
ds_read_b128 v[36:39], v108 offset:9216
v_smfmac_f32_16x16x64_bf16 v[60:63],v[8:11],v[80:87],v109
s_waitcnt lgkmcnt(10)
v_smfmac_f32_16x16x64_bf16 v[40:43],v[12:15],a[120:127],v109
v_smfmac_f32_16x16x64_bf16 v[44:47],v[12:15],a[128:135],v109
ds_read_b128 v[80:83], v110 offset:10240
ds_read_b128 v[84:87], v110 offset:11264
v_smfmac_f32_16x16x64_bf16 v[48:51],v[12:15],a[136:143],v109
ds_read_b128 v[88:91], v113 offset:7168
ds_read_b128 v[92:95], v113 offset:8192
v_smfmac_f32_16x16x64_bf16 v[52:55],v[12:15],a[144:151],v109
v_smfmac_f32_16x16x64_bf16 v[56:59],v[12:15],a[152:159],v109
s_waitcnt lgkmcnt(9)
v_smfmac_f32_16x16x64_bf16 v[60:63],v[12:15],v[64:71],v109
v_smfmac_f32_16x16x64_bf16 v[40:43],v[16:19],a[160:167],v109
v_smfmac_f32_16x16x64_bf16 v[44:47],v[16:19],a[168:175],v109
ds_read_b128 v[64:67], v110 offset:12288
ds_read_b128 v[68:71], v110 offset:13312
v_smfmac_f32_16x16x64_bf16 v[48:51],v[16:19],a[176:183],v109
ds_read_b128 v[96:99], v113 offset:9216
ds_read_b128 v[100:103], v113 offset:10240
v_smfmac_f32_16x16x64_bf16 v[52:55],v[16:19],a[184:191],v109
v_smfmac_f32_16x16x64_bf16 v[56:59],v[16:19],a[192:199],v109
s_waitcnt lgkmcnt(11)
v_smfmac_f32_16x16x64_bf16 v[60:63],v[16:19],v[72:79],v109
v_smfmac_f32_16x16x64_bf16 v[40:43],v[20:23],a[200:207],v109
ds_read_b128 v[0:3], v113 offset:0
ds_read_b128 v[4:7], v113 offset:1024
v_smfmac_f32_16x16x64_bf16 v[44:47],v[20:23],a[208:215],v109
ds_read_b128 v[72:75], v110 offset:14336
ds_read_b128 v[76:79], v110 offset:15360
v_smfmac_f32_16x16x64_bf16 v[48:51],v[20:23],a[216:223],v109
v_smfmac_f32_16x16x64_bf16 v[52:55],v[20:23],a[224:231],v109
s_waitcnt lgkmcnt(10)
v_smfmac_f32_16x16x64_bf16 v[56:59],v[20:23],v[80:87],v109
ds_read_b128 v[8:11], v113 offset:2048
ds_read_b128 v[12:15], v113 offset:3072
s_waitcnt lgkmcnt(8)
v_smfmac_f32_16x16x64_bf16 v[60:63],v[20:23],v[64:71],v109
v_smfmac_f32_16x16x64_bf16 v[40:43],v[24:27],a[232:239],v109
ds_read_b128 v[80:83], v110 offset:16384
ds_read_b128 v[84:87], v110 offset:17408
v_smfmac_f32_16x16x64_bf16 v[44:47],v[24:27],a[240:247],v109
ds_read_b128 v[64:67], v110 offset:18432
ds_read_b128 v[68:71], v110 offset:19456
v_smfmac_f32_16x16x64_bf16 v[48:51],v[24:27],a[248:255],v109
ds_read_b128 v[16:19], v113 offset:4096
v_smfmac_f32_16x16x64_bf16 v[52:55],v[24:27],v[120:127],v109
v_smfmac_f32_16x16x64_bf16 v[56:59],v[24:27],v[128:135],v109
s_waitcnt lgkmcnt(7)
v_smfmac_f32_16x16x64_bf16 v[60:63],v[24:27],v[72:79],v109
ds_read_b128 v[20:23], v113 offset:5120
v_smfmac_f32_16x16x64_bf16 v[40:43],v[28:31],v[136:143],v109
v_smfmac_f32_16x16x64_bf16 v[44:47],v[28:31],v[144:151],v109
ds_read_b128 v[72:75], v110 offset:20480
ds_read_b128 v[76:79], v110 offset:21504
v_smfmac_f32_16x16x64_bf16 v[40:43],v[32:35],v[176:183],v109
ds_read_b128 v[24:27], v113 offset:6144
v_smfmac_f32_16x16x64_bf16 v[44:47],v[32:35],v[184:191],v109
v_smfmac_f32_16x16x64_bf16 v[40:43],v[36:39],v[216:223],v109
v_smfmac_f32_16x16x64_bf16 v[44:47],v[36:39],v[224:231],v109
v_smfmac_f32_16x16x64_bf16 v[48:51],v[28:31],v[152:159],v109
v_smfmac_f32_16x16x64_bf16 v[52:55],v[28:31],v[160:167],v109
v_smfmac_f32_16x16x64_bf16 v[48:51],v[32:35],v[192:199],v109
v_smfmac_f32_16x16x64_bf16 v[52:55],v[32:35],v[200:207],v109
v_smfmac_f32_16x16x64_bf16 v[48:51],v[36:39],v[232:239],v109
v_smfmac_f32_16x16x64_bf16 v[52:55],v[36:39],v[240:247],v109
v_smfmac_f32_16x16x64_bf16 v[56:59],v[28:31],v[168:175],v109
s_waitcnt lgkmcnt(7)
v_smfmac_f32_16x16x64_bf16 v[60:63],v[28:31],v[80:87],v109
v_smfmac_f32_16x16x64_bf16 v[56:59],v[32:35],v[208:215],v109
s_waitcnt lgkmcnt(5)
v_smfmac_f32_16x16x64_bf16 v[60:63],v[32:35],v[64:71],v109
v_smfmac_f32_16x16x64_bf16 v[56:59],v[36:39],v[248:255],v109
s_waitcnt lgkmcnt(1)
v_smfmac_f32_16x16x64_bf16 v[60:63],v[36:39],v[72:79],v109
s_cmp_eq_u32 s56, 0
s_cbranch_scc0 S_W1
ds_read_b128 v[28:31], v113 offset:11264
v_permlane32_swap_b32 v40, v44
v_permlane32_swap_b32 v41, v45
v_permlane32_swap_b32 v42, v46
v_permlane32_swap_b32 v43, v47
v_add_f32 v40, v40, v44
v_add_f32 v41, v41, v45
v_add_f32 v42, v42, v46
v_add_f32 v43, v43, v47
v_cvt_pk_bf16_f32 v40, v40, v41
v_cvt_pk_bf16_f32 v41, v42, v43
ds_write_b64 v111, v[40:41] offset:0
v_permlane32_swap_b32 v48, v52
v_permlane32_swap_b32 v49, v53
v_permlane32_swap_b32 v50, v54
v_permlane32_swap_b32 v51, v55
v_add_f32 v48, v48, v52
v_add_f32 v49, v49, v53
v_add_f32 v50, v50, v54
v_add_f32 v51, v51, v55
v_cvt_pk_bf16_f32 v48, v48, v49
v_cvt_pk_bf16_f32 v49, v50, v51
ds_write_b64 v111, v[48:49] offset:80
v_permlane32_swap_b32 v56, v60
v_permlane32_swap_b32 v57, v61
v_permlane32_swap_b32 v58, v62
v_permlane32_swap_b32 v59, v63
v_add_f32 v56, v56, v60
v_add_f32 v57, v57, v61
v_add_f32 v58, v58, v62
v_add_f32 v59, v59, v63
v_cvt_pk_bf16_f32 v56, v56, v57
v_cvt_pk_bf16_f32 v57, v58, v59
ds_write_b64 v111, v[56:57] offset:160
v_mov_b32 v80, v118
v_mov_b32 v81, v118
v_mov_b32 v82, v118
v_mov_b32 v83, v118
s_waitcnt lgkmcnt(0)
s_barrier
ds_read_b64_tr_b16 v[40:41], v112 offset:0
ds_read_b64_tr_b16 v[42:43], v112 offset:320
ds_read_b64_tr_b16 v[44:45], v112 offset:1280
ds_read_b64_tr_b16 v[46:47], v112 offset:1600
ds_read_b64_tr_b16 v[48:49], v112 offset:2560
ds_read_b64_tr_b16 v[50:51], v112 offset:2880
ds_read_b64_tr_b16 v[52:53], v112 offset:3840
ds_read_b64_tr_b16 v[54:55], v112 offset:4160
ds_read_b64_tr_b16 v[56:57], v112 offset:5120
ds_read_b64_tr_b16 v[58:59], v112 offset:5440
ds_read_b64_tr_b16 v[60:61], v112 offset:6400
ds_read_b64_tr_b16 v[62:63], v112 offset:6720
s_waitcnt lgkmcnt(10)
v_mfma_f32_16x16x32_bf16 v[72:75],v[0:3],v[40:43],0
v_mfma_f32_16x16x32_bf16 v[76:79],v[4:7],v[40:43],0
v_mfma_f32_16x16x32_bf16 v[80:83],v[40:43],v[40:43],v[80:83]
s_waitcnt lgkmcnt(8)
v_mfma_f32_16x16x32_bf16 v[72:75],v[8:11],v[44:47],v[72:75]
v_mfma_f32_16x16x32_bf16 v[76:79],v[12:15],v[44:47],v[76:79]
v_mfma_f32_16x16x32_bf16 v[80:83],v[44:47],v[44:47],v[80:83]
s_waitcnt lgkmcnt(6)
v_mfma_f32_16x16x32_bf16 v[72:75],v[16:19],v[48:51],v[72:75]
v_mfma_f32_16x16x32_bf16 v[76:79],v[20:23],v[48:51],v[76:79]
v_mfma_f32_16x16x32_bf16 v[80:83],v[48:51],v[48:51],v[80:83]
s_waitcnt lgkmcnt(4)
v_mfma_f32_16x16x32_bf16 v[72:75],v[24:27],v[52:55],v[72:75]
v_mfma_f32_16x16x32_bf16 v[76:79],v[88:91],v[52:55],v[76:79]
v_mfma_f32_16x16x32_bf16 v[80:83],v[52:55],v[52:55],v[80:83]
s_waitcnt lgkmcnt(2)
v_mfma_f32_16x16x32_bf16 v[72:75],v[92:95],v[56:59],v[72:75]
v_mfma_f32_16x16x32_bf16 v[76:79],v[96:99],v[56:59],v[76:79]
v_mfma_f32_16x16x32_bf16 v[80:83],v[56:59],v[56:59],v[80:83]
s_waitcnt lgkmcnt(0)
v_mfma_f32_16x16x32_bf16 v[72:75],v[100:103],v[60:63],v[72:75]
v_mfma_f32_16x16x32_bf16 v[76:79],v[28:31],v[60:63],v[76:79]
v_mfma_f32_16x16x32_bf16 v[80:83],v[60:63],v[60:63],v[80:83]
s_nop 6
v_mov_b32_dpp v72, v76 row_ror:8 row_mask:0xf bank_mask:0xc
v_mov_b32_dpp v73, v77 row_ror:8 row_mask:0xf bank_mask:0xc
v_mov_b32_dpp v74, v78 row_ror:8 row_mask:0xf bank_mask:0xc
v_mov_b32_dpp v75, v79 row_ror:8 row_mask:0xf bank_mask:0xc
v_mov_b32_dpp v80, v82 row_ror:8 row_mask:0xf bank_mask:0xc
v_mov_b32_dpp v81, v83 row_ror:8 row_mask:0xf bank_mask:0xc
v_max3_f32 v84, v72, v73, v74
v_max3_f32 v85, v75, v80, v81
v_max_f32 v86, v84, v85
v_max_f32 v84, v84, v85
s_nop 1
v_permlane32_swap_b32 v84, v86
v_max_f32 v85, v84, v86
v_max_f32 v84, v84, v86
s_nop 1
v_permlane16_swap_b32 v84, v85
v_max_f32 v84, v84, v85
s_nop 1
v_max_f32_dpp v84, v84, v84 row_ror:8 row_mask:0xf bank_mask:0xf
v_mul_f32 v84, s68, v84
v_fma_f32 v72, v72, s68, -v84
v_fma_f32 v73, v73, s68, -v84
v_fma_f32 v74, v74, s68, -v84
v_fma_f32 v75, v75, s68, -v84
v_fma_f32 v80, v80, s68, -v84
v_fma_f32 v81, v81, s68, -v84
v_exp_f32 v72, v72
v_exp_f32 v73, v73
v_exp_f32 v74, v74
v_exp_f32 v75, v75
v_exp_f32 v80, v80
v_exp_f32 v81, v81
v_add_f32 v84, v72, v73
v_add_f32 v85, v74, v75
v_add_f32 v87, v80, v81
v_add_f32 v84, v84, v85
v_add_f32 v86, v84, v87
v_add_f32 v84, v84, v87
s_nop 1
v_permlane32_swap_b32 v84, v86
v_add_f32 v85, v84, v86
v_add_f32 v84, v84, v86
s_nop 1
v_permlane16_swap_b32 v84, v85
v_add_f32 v84, v84, v85
s_nop 1
v_add_f32_dpp v84, v84, v84 row_ror:8 row_mask:0xf bank_mask:0xf
v_rcp_f32 v84, v84
s_cmp_eq_u32 s69, 0
v_mul_f32 v72, v72, v84
v_mul_f32 v73, v73, v84
v_mul_f32 v74, v74, v84
v_mul_f32 v75, v75, v84
v_mul_f32 v80, v80, v84
v_mul_f32 v81, v81, v84
v_cvt_pk_bf16_f32 v72, |v72|, |v73|
v_cvt_pk_bf16_f32 v73, |v74|, |v75|
v_cvt_pk_bf16_f32 v74, |v80|, |v81|
s_cbranch_scc1 PB4s
buffer_store_dwordx2 v[72:73],v114,s[8:11],s7 offen
buffer_store_dword v74,v115,s[8:11],s7 offen
s_branch PB4e
PB4s:
buffer_store_dwordx2 v[72:73],v114,s[8:11],s7 offen sc1
buffer_store_dword v74,v115,s[8:11],s7 offen sc1
PB4e:
s_add_u32 s7, s7, 20480
s_branch S_END
S_W1:
s_cmp_eq_u32 s56, 1
s_cbranch_scc1 S_W1B
ds_read_b128 v[28:31], v113 offset:11264
v_permlane32_swap_b32 v40, v44
v_permlane32_swap_b32 v41, v45
v_permlane32_swap_b32 v42, v46
v_permlane32_swap_b32 v43, v47
v_add_f32 v40, v40, v44
v_add_f32 v41, v41, v45
v_add_f32 v42, v42, v46
v_add_f32 v43, v43, v47
v_cvt_pk_bf16_f32 v40, v40, v41
v_cvt_pk_bf16_f32 v41, v42, v43
ds_write_b64 v111, v[40:41] offset:0
v_permlane32_swap_b32 v48, v52
v_permlane32_swap_b32 v49, v53
v_permlane32_swap_b32 v50, v54
v_permlane32_swap_b32 v51, v55
v_add_f32 v48, v48, v52
v_add_f32 v49, v49, v53
v_add_f32 v50, v50, v54
v_add_f32 v51, v51, v55
v_cvt_pk_bf16_f32 v48, v48, v49
v_cvt_pk_bf16_f32 v49, v50, v51
ds_write_b64 v111, v[48:49] offset:80
v_permlane32_swap_b32 v56, v60
v_permlane32_swap_b32 v57, v61
v_permlane32_swap_b32 v58, v62
v_permlane32_swap_b32 v59, v63
v_add_f32 v56, v56, v60
v_add_f32 v57, v57, v61
v_add_f32 v58, v58, v62
v_add_f32 v59, v59, v63
v_cvt_pk_bf16_f32 v56, v56, v57
v_cvt_pk_bf16_f32 v57, v58, v59
ds_write_b64 v111, v[56:57] offset:160
s_waitcnt lgkmcnt(0)
s_barrier
s_bitcmp1_b32 s70, 0
s_cselect_b32 s57, -1, 1
s_mul_i32 s57, s57, 26624
s_add_u32 s58, s58, s57
s_add_u32 s57, s70, 1
s_and_b32 s57, s57, 67
s_cbranch_scc1 FC5
s_add_u32 s89, s89, 128
v_mov_b32 v72, 0
s_branch FW6b
FW6:
s_sleep 1
FW6b:
buffer_load_dword v73,v72,s[8:11],s89 offen sc1
s_sub_u32 s71, s71, 1
s_cbranch_scc1 EX0
s_waitcnt vmcnt(0)
v_cmp_gt_u32 vcc, 8, v73
s_cbranch_vccnz FW6
FC5:
s_add_u32 m0, s58, 0
s_add_u32 s57, s100, 0
buffer_load_dwordx4 v116,s[8:11],s57 offen offset:0 sc1 nt lds
buffer_load_dwordx4 v116,s[8:11],s57 offen offset:1024 sc1 nt lds
buffer_load_dwordx4 v116,s[8:11],s57 offen offset:2048 sc1 nt lds
buffer_load_dwordx4 v116,s[8:11],s57 offen offset:3072 sc1 nt lds
s_add_u32 m0, s58, 4096
s_add_u32 s57, s100, 4096
buffer_load_dwordx4 v116,s[8:11],s57 offen offset:0 sc1 nt lds
buffer_load_dwordx4 v116,s[8:11],s57 offen offset:1024 sc1 nt lds
buffer_load_dwordx4 v116,s[8:11],s57 offen offset:2048 sc1 nt lds
buffer_load_dwordx4 v116,s[8:11],s57 offen offset:3072 sc1 nt lds
s_add_u32 m0, s58, 8192
s_add_u32 s57, s100, 8192
buffer_load_dwordx4 v116,s[8:11],s57 offen offset:0 sc1 nt lds
buffer_load_dwordx4 v116,s[8:11],s57 offen offset:1024 sc1 nt lds
buffer_load_dwordx4 v116,s[8:11],s57 offen offset:2048 sc1 nt lds
buffer_load_dwordx4 v116,s[8:11],s57 offen offset:3072 sc1 nt lds
s_add_u32 m0, s58, s67
s_add_u32 s100, s100, 393216
buffer_load_dwordx4 v116,s[8:11],s101 offen sc1 nt lds
s_add_u32 s101, s101, 65536
s_branch S_END
S_W1B:
ds_read_b128 v[28:31], v113 offset:11264
v_permlane32_swap_b32 v40, v44
v_permlane32_swap_b32 v41, v45
v_permlane32_swap_b32 v42, v46
v_permlane32_swap_b32 v43, v47
v_add_f32 v40, v40, v44
v_add_f32 v41, v41, v45
v_add_f32 v42, v42, v46
v_add_f32 v43, v43, v47
v_cvt_pk_bf16_f32 v40, v40, v41
v_cvt_pk_bf16_f32 v41, v42, v43
ds_write_b64 v111, v[40:41] offset:0
v_permlane32_swap_b32 v48, v52
v_permlane32_swap_b32 v49, v53
v_permlane32_swap_b32 v50, v54
v_permlane32_swap_b32 v51, v55
v_add_f32 v48, v48, v52
v_add_f32 v49, v49, v53
v_add_f32 v50, v50, v54
v_add_f32 v51, v51, v55
v_cvt_pk_bf16_f32 v48, v48, v49
v_cvt_pk_bf16_f32 v49, v50, v51
ds_write_b64 v111, v[48:49] offset:80
v_permlane32_swap_b32 v56, v60
v_permlane32_swap_b32 v57, v61
v_permlane32_swap_b32 v58, v62
v_permlane32_swap_b32 v59, v63
v_add_f32 v56, v56, v60
v_add_f32 v57, v57, v61
v_add_f32 v58, v58, v62
v_add_f32 v59, v59, v63
v_cvt_pk_bf16_f32 v56, v56, v57
v_cvt_pk_bf16_f32 v57, v58, v59
ds_write_b64 v111, v[56:57] offset:160
s_waitcnt lgkmcnt(0)
s_barrier
ds_read_b64_tr_b16 v[40:41], v112 offset:0
ds_read_b64_tr_b16 v[42:43], v112 offset:320
ds_read_b64_tr_b16 v[44:45], v112 offset:640
ds_read_b64_tr_b16 v[46:47], v112 offset:960
ds_read_b64_tr_b16 v[48:49], v112 offset:1280
ds_read_b64_tr_b16 v[50:51], v112 offset:1600
ds_read_b64_tr_b16 v[52:53], v112 offset:1920
ds_read_b64_tr_b16 v[54:55], v112 offset:2240
ds_read_b64_tr_b16 v[56:57], v112 offset:2560
ds_read_b64_tr_b16 v[58:59], v112 offset:2880
ds_read_b64_tr_b16 v[60:61], v112 offset:3200
ds_read_b64_tr_b16 v[62:63], v112 offset:3520
s_waitcnt lgkmcnt(10)
v_mfma_f32_32x32x16_bf16 v[72:87],v[40:43],v[0:3],0
s_waitcnt lgkmcnt(8)
v_mfma_f32_32x32x16_bf16 v[72:87],v[44:47],v[4:7],v[72:87]
s_waitcnt lgkmcnt(6)
v_mfma_f32_32x32x16_bf16 v[72:87],v[48:51],v[8:11],v[72:87]
s_waitcnt lgkmcnt(4)
v_mfma_f32_32x32x16_bf16 v[72:87],v[52:55],v[12:15],v[72:87]
s_waitcnt lgkmcnt(2)
v_mfma_f32_32x32x16_bf16 v[72:87],v[56:59],v[16:19],v[72:87]
s_waitcnt lgkmcnt(0)
v_mfma_f32_32x32x16_bf16 v[72:87],v[60:63],v[20:23],v[72:87]
s_nop 7
ds_read_b64_tr_b16 v[40:41], v112 offset:3840
ds_read_b64_tr_b16 v[42:43], v112 offset:4160
ds_read_b64_tr_b16 v[44:45], v112 offset:4480
ds_read_b64_tr_b16 v[46:47], v112 offset:4800
ds_read_b64_tr_b16 v[48:49], v112 offset:5120
ds_read_b64_tr_b16 v[50:51], v112 offset:5440
ds_read_b64_tr_b16 v[52:53], v112 offset:5760
ds_read_b64_tr_b16 v[54:55], v112 offset:6080
ds_read_b64_tr_b16 v[56:57], v112 offset:6400
ds_read_b64_tr_b16 v[58:59], v112 offset:6720
ds_read_b64_tr_b16 v[60:61], v112 offset:7040
ds_read_b64_tr_b16 v[62:63], v112 offset:7360
s_waitcnt lgkmcnt(10)
v_mfma_f32_32x32x16_bf16 v[72:87],v[40:43],v[24:27],v[72:87]
s_waitcnt lgkmcnt(8)
v_mfma_f32_32x32x16_bf16 v[72:87],v[44:47],v[88:91],v[72:87]
s_waitcnt lgkmcnt(6)
v_mfma_f32_32x32x16_bf16 v[72:87],v[48:51],v[92:95],v[72:87]
s_waitcnt lgkmcnt(4)
v_mfma_f32_32x32x16_bf16 v[72:87],v[52:55],v[96:99],v[72:87]
s_waitcnt lgkmcnt(2)
v_mfma_f32_32x32x16_bf16 v[72:87],v[56:59],v[100:103],v[72:87]
s_waitcnt lgkmcnt(0)
v_mfma_f32_32x32x16_bf16 v[72:87],v[60:63],v[28:31],v[72:87]
s_nop 7
ds_read_b128 v[32:35], v113 offset:12288
ds_read_b128 v[36:39], v113 offset:13312
s_waitcnt lgkmcnt(0)
v_lshlrev_b32 v88, 16, v32
v_and_b32 v89, 0xffff0000, v32
v_lshlrev_b32 v90, 16, v33
v_and_b32 v91, 0xffff0000, v33
v_lshlrev_b32 v92, 16, v34
v_and_b32 v93, 0xffff0000, v34
v_lshlrev_b32 v94, 16, v35
v_and_b32 v95, 0xffff0000, v35
v_lshlrev_b32 v96, 16, v36
v_and_b32 v97, 0xffff0000, v36
v_lshlrev_b32 v98, 16, v37
v_and_b32 v99, 0xffff0000, v37
v_lshlrev_b32 v100, 16, v38
v_and_b32 v101, 0xffff0000, v38
v_lshlrev_b32 v102, 16, v39
v_and_b32 v103, 0xffff0000, v39
v_max3_f32 v76, v88, v89, v90
v_max3_f32 v76, v76, v91, v92
v_max3_f32 v76, v76, v93, v94
v_max3_f32 v76, v76, v95, v96
v_max3_f32 v76, v76, v97, v98
v_max3_f32 v76, v76, v99, v100
v_max3_f32 v76, v76, v101, v102
v_max3_f32 v76, v76, v103, v72
v_max3_f32 v76, v76, v73, v74
v_max_f32 v76, v76, v75
v_mov_b32 v77, v76
s_nop 1
v_permlane32_swap_b32 v76, v77
v_max_f32 v76, v76, v77
v_mul_f32 v76, s68, v76
v_fma_f32 v88, v88, s68, -v76
v_fma_f32 v89, v89, s68, -v76
v_fma_f32 v90, v90, s68, -v76
v_fma_f32 v91, v91, s68, -v76
v_fma_f32 v92, v92, s68, -v76
v_fma_f32 v93, v93, s68, -v76
v_fma_f32 v94, v94, s68, -v76
v_fma_f32 v95, v95, s68, -v76
v_fma_f32 v96, v96, s68, -v76
v_fma_f32 v97, v97, s68, -v76
v_fma_f32 v98, v98, s68, -v76
v_fma_f32 v99, v99, s68, -v76
v_fma_f32 v100, v100, s68, -v76
v_fma_f32 v101, v101, s68, -v76
v_fma_f32 v102, v102, s68, -v76
v_fma_f32 v103, v103, s68, -v76
v_fma_f32 v72, v72, s68, -v76
v_fma_f32 v73, v73, s68, -v76
v_fma_f32 v74, v74, s68, -v76
v_fma_f32 v75, v75, s68, -v76
v_exp_f32 v88, v88
v_exp_f32 v89, v89
v_exp_f32 v90, v90
v_exp_f32 v91, v91
v_exp_f32 v92, v92
v_exp_f32 v93, v93
v_exp_f32 v94, v94
v_exp_f32 v95, v95
v_exp_f32 v96, v96
v_exp_f32 v97, v97
v_exp_f32 v98, v98
v_exp_f32 v99, v99
v_exp_f32 v100, v100
v_exp_f32 v101, v101
v_exp_f32 v102, v102
v_exp_f32 v103, v103
v_exp_f32 v72, v72
v_exp_f32 v73, v73
v_exp_f32 v74, v74
v_exp_f32 v75, v75
v_add_f32 v76, v88, v89
v_add_f32 v77, v90, v91
v_add_f32 v76, v76, v92
v_add_f32 v77, v77, v93
v_add_f32 v76, v76, v94
v_add_f32 v77, v77, v95
v_add_f32 v76, v76, v96
v_add_f32 v77, v77, v97
v_add_f32 v76, v76, v98
v_add_f32 v77, v77, v99
v_add_f32 v76, v76, v100
v_add_f32 v77, v77, v101
v_add_f32 v76, v76, v102
v_add_f32 v77, v77, v103
v_add_f32 v76, v76, v72
v_add_f32 v77, v77, v73
v_add_f32 v76, v76, v74
v_add_f32 v77, v77, v75
v_add_f32 v76, v76, v77
v_mov_b32 v77, v76
s_nop 1
v_permlane32_swap_b32 v76, v77
v_add_f32 v76, v76, v77
v_rcp_f32 v76, v76
s_nop 0
v_mul_f32 v88, v88, v76
v_mul_f32 v89, v89, v76
v_mul_f32 v90, v90, v76
v_mul_f32 v91, v91, v76
v_mul_f32 v92, v92, v76
v_mul_f32 v93, v93, v76
v_mul_f32 v94, v94, v76
v_mul_f32 v95, v95, v76
v_mul_f32 v96, v96, v76
v_mul_f32 v97, v97, v76
v_mul_f32 v98, v98, v76
v_mul_f32 v99, v99, v76
v_mul_f32 v100, v100, v76
v_mul_f32 v101, v101, v76
v_mul_f32 v102, v102, v76
v_mul_f32 v103, v103, v76
v_mul_f32 v72, v72, v76
v_mul_f32 v73, v73, v76
v_mul_f32 v74, v74, v76
v_mul_f32 v75, v75, v76
v_cvt_pk_bf16_f32 v88, v88, v89
v_cvt_pk_bf16_f32 v89, v90, v91
v_cvt_pk_bf16_f32 v90, v92, v93
v_cvt_pk_bf16_f32 v91, v94, v95
v_cvt_pk_bf16_f32 v92, v96, v97
v_cvt_pk_bf16_f32 v93, v98, v99
v_cvt_pk_bf16_f32 v94, v100, v101
v_cvt_pk_bf16_f32 v95, v102, v103
v_cvt_pk_bf16_f32 v72, v72, v73
v_cvt_pk_bf16_f32 v73, v74, v75
s_cmp_eq_u32 s69, 0
s_cbranch_scc1 PB7s
buffer_store_dwordx4 v[88:91],v114,s[8:11],s7 offen
buffer_store_dwordx4 v[92:95],v114,s[8:11],s7 offen offset:1024
buffer_store_dwordx2 v[72:73],v115,s[8:11],s7 offen
s_branch PB7e
PB7s:
buffer_store_dwordx4 v[88:91],v114,s[8:11],s7 offen sc1
buffer_store_dwordx4 v[92:95],v114,s[8:11],s7 offen offset:1024 sc1
buffer_store_dwordx2 v[72:73],v115,s[8:11],s7 offen sc1
PB7e:
s_add_u32 s7, s7, 81920
s_cmp_lt_u32 s7, 191840256
s_cselect_b32 s57, 0, 327680
s_sub_u32 s7, s7, s57
S_END:
s_bitcmp1_b32 s70, 0
s_cselect_b32 s57, -1, 1
s_mul_i32 s57, s57, 26624
v_add_u32 v113, s57, v113
s_add_u32 s6, s6, 40960
s_add_u32 s70, s70, 1
s_cmp_lt_u32 s70, 64
s_cbranch_scc1 S_LOOP
s_cmp_eq_u32 s56, 1
s_cbranch_scc0 EX0
s_waitcnt vmcnt(0)
buffer_atomic_add v118,v117,s[8:11],s90 offen sc1
s_branch EX0
EX0:
s_endpgm
BT0:
v_lshrrev_b32 v224, 5, v255
v_and_b32 v224, 1, v224
v_mul_u32_u24 v224, 6144, v224
v_lshrrev_b32 v254, 2, v255
v_and_b32 v254, 3, v254
v_mul_u32_u24 v254, 64, v254
v_add_u32 v224, v254, v224
v_lshrrev_b32 v254, 4, v255
v_and_b32 v254, 1, v254
v_mul_u32_u24 v254, 32, v254
v_add_u32 v224, v254, v224
v_and_b32 v254, 3, v255
v_mul_u32_u24 v254, 8, v254
v_add_u32 v224, v254, v224
v_add_u32 v225, 49152, v224
v_add_u32 v226, 98304, v224
v_lshrrev_b32 v227, 5, v255
v_and_b32 v227, 1, v227
v_mul_u32_u24 v227, 256, v227
v_lshrrev_b32 v254, 2, v255
v_and_b32 v254, 3, v254
v_mul_u32_u24 v254, 64, v254
v_add_u32 v227, v254, v227
v_lshrrev_b32 v254, 4, v255
v_and_b32 v254, 1, v254
v_mul_u32_u24 v254, 32, v254
v_add_u32 v227, v254, v227
v_and_b32 v254, 3, v255
v_mul_u32_u24 v254, 8, v254
v_add_u32 v227, v254, v227
v_add_u32 v228, 49152, v227
v_add_u32 v229, 98304, v227
v_lshlrev_b32 v233, 4, v255
v_lshrrev_b32 v231, 2, v255
v_and_b32 v231, 7, v231
v_mul_u32_u24 v231, 1280, v231
v_lshrrev_b32 v254, 5, v255
v_and_b32 v254, 1, v254
v_mul_u32_u24 v254, 64, v254
v_add_u32 v231, v254, v231
v_and_b32 v254, 3, v255
v_mul_u32_u24 v254, 16, v254
v_add_u32 v231, v254, v231
s_mul_i32 s57, s56, 10240
v_add_u32 v231, s57, v231
s_mul_i32 s58, s56, 6144
v_or_b32 v239, s56, v255
v_cmp_eq_u32 vcc, 0, v239
v_mov_b32 v239, 1
v_mov_b32 v238, 1073741824
v_cndmask_b32 v238, v238, 0, vcc
s_sub_u32 s6, s5, 8
BT1:
s_and_b32 s62, s6, 7
s_lshl_b32 s57, s4, 3
s_add_u32 s62, s62, s57
s_lshr_b32 s63, s6, 3
s_lshl_b32 s92, s4, 7
s_add_u32 s92, s92, 244453376
s_mul_i32 s60, s62, 245760
v_and_b32 v230, 31, v255
v_mul_u32_u24 v230, 12288, v230
v_lshrrev_b32 v254, 5, v255
v_and_b32 v254, 1, v254
v_mul_u32_u24 v254, 8, v254
v_add_u32 v230, v254, v230
v_lshrrev_b32 v234, 3, v255
v_and_b32 v234, 3, v234
v_mul_u32_u24 v234, 83200, v234
v_lshrrev_b32 v254, 5, v255
v_and_b32 v254, 1, v254
v_mul_u32_u24 v254, 256, v254
v_add_u32 v234, v254, v234
v_and_b32 v254, 7, v255
v_mul_u32_u24 v254, 16, v254
v_add_u32 v234, v254, v234
s_lshl_b32 s66, s63, 2
s_add_u32 s66, s66, s56
s_mul_i32 s61, s66, 393216
s_mul_i32 s57, s62, 384
s_add_u32 s61, s61, s57
s_lshr_b32 s67, s62, 3
s_mul_i32 s67, s67, 6656000
s_bfe_u32 s57, s62, 0x20001
s_mul_i32 s57, s57, 20480
s_add_u32 s67, s67, s57
s_and_b32 s57, s62, 1
s_lshl_b32 s57, s57, 7
s_add_u32 s67, s67, s57
s_lshl_b32 s57, s66, 10
s_add_u32 s67, s67, s57
s_add_u32 s67, s67, 106168320
s_barrier
s_add_u32 m0, s58, 0
s_add_u32 s57, s60, 0
buffer_load_dwordx4 v231,s[36:39],s57 offen lds
s_add_u32 m0, s58, 1024
s_add_u32 s57, s60, 40960
buffer_load_dwordx4 v231,s[36:39],s57 offen lds
s_add_u32 m0, s58, 2048
s_add_u32 s57, s60, 81920
buffer_load_dwordx4 v231,s[36:39],s57 offen lds
s_add_u32 m0, s58, 3072
s_add_u32 s57, s60, 122880
buffer_load_dwordx4 v231,s[36:39],s57 offen lds
s_add_u32 m0, s58, 4096
s_add_u32 s57, s60, 163840
buffer_load_dwordx4 v231,s[36:39],s57 offen lds
s_add_u32 m0, s58, 5120
s_add_u32 s57, s60, 204800
buffer_load_dwordx4 v231,s[36:39],s57 offen lds
s_add_u32 m0, s58, 24576
s_add_u32 s57, s60, 128
buffer_load_dwordx4 v231,s[36:39],s57 offen lds
s_add_u32 m0, s58, 25600
s_add_u32 s57, s60, 41088
buffer_load_dwordx4 v231,s[36:39],s57 offen lds
s_add_u32 m0, s58, 26624
s_add_u32 s57, s60, 82048
buffer_load_dwordx4 v231,s[36:39],s57 offen lds
s_add_u32 m0, s58, 27648
s_add_u32 s57, s60, 123008
buffer_load_dwordx4 v231,s[36:39],s57 offen lds
s_add_u32 m0, s58, 28672
s_add_u32 s57, s60, 163968
buffer_load_dwordx4 v231,s[36:39],s57 offen lds
s_add_u32 m0, s58, 29696
s_add_u32 s57, s60, 204928
buffer_load_dwordx4 v231,s[36:39],s57 offen lds
buffer_load_dwordx2 v[96:97],v230,s[32:35],s61 offen
buffer_load_dwordx2 v[98:99],v230,s[32:35],s61 offen offset:16
buffer_load_dwordx2 v[100:101],v230,s[32:35],s61 offen offset:32
buffer_load_dwordx2 v[102:103],v230,s[32:35],s61 offen offset:48
buffer_load_dwordx2 v[104:105],v230,s[32:35],s61 offen offset:64
buffer_load_dwordx2 v[106:107],v230,s[32:35],s61 offen offset:80
buffer_load_dwordx2 v[108:109],v230,s[32:35],s61 offen offset:96
buffer_load_dwordx2 v[110:111],v230,s[32:35],s61 offen offset:112
buffer_load_dwordx2 v[112:113],v230,s[32:35],s61 offen offset:128
buffer_load_dwordx2 v[114:115],v230,s[32:35],s61 offen offset:144
buffer_load_dwordx2 v[116:117],v230,s[32:35],s61 offen offset:160
buffer_load_dwordx2 v[118:119],v230,s[32:35],s61 offen offset:176
buffer_load_dwordx2 v[120:121],v230,s[32:35],s61 offen offset:192
buffer_load_dwordx2 v[122:123],v230,s[32:35],s61 offen offset:208
buffer_load_dwordx2 v[124:125],v230,s[32:35],s61 offen offset:224
buffer_load_dwordx2 v[126:127],v230,s[32:35],s61 offen offset:240
buffer_load_dwordx2 v[128:129],v230,s[32:35],s61 offen offset:256
buffer_load_dwordx2 v[130:131],v230,s[32:35],s61 offen offset:272
buffer_load_dwordx2 v[132:133],v230,s[32:35],s61 offen offset:288
buffer_load_dwordx2 v[134:135],v230,s[32:35],s61 offen offset:304
buffer_load_dwordx2 v[136:137],v230,s[32:35],s61 offen offset:320
buffer_load_dwordx2 v[138:139],v230,s[32:35],s61 offen offset:336
buffer_load_dwordx2 v[140:141],v230,s[32:35],s61 offen offset:352
buffer_load_dwordx2 v[142:143],v230,s[32:35],s61 offen offset:368
s_mov_b32 s69, 0
s_cmp_lt_u32 s6, 24
s_cbranch_scc0 BT3
s_getreg_b32 s57, hwreg(HW_REG_XCC_ID, 0, 4)
s_add_u32 s57, s57, 1
v_mov_b32 v62, s57
s_lshl_b32 s89, s4, 5
v_and_b32 v63, 31, v255
s_waitcnt vmcnt(0)
PL8:
s_sleep 4
buffer_load_ubyte v64,v63,s[96:99],s89 offen sc1
s_sub_u32 s71, s71, 1
s_cbranch_scc1 EX0
s_waitcnt vmcnt(0)
v_cmp_eq_u32 vcc, 0, v64
s_cbranch_vccnz PL8
v_cmp_ne_u32 vcc, v62, v64
s_cmp_eq_u64 vcc, 0
s_cselect_b32 s69, 1, 0
BT3:
s_add_u32 m0, s58, 49152
s_add_u32 s57, s60, 256
buffer_load_dwordx4 v231,s[36:39],s57 offen lds
s_add_u32 m0, s58, 50176
s_add_u32 s57, s60, 41216
buffer_load_dwordx4 v231,s[36:39],s57 offen lds
s_add_u32 m0, s58, 51200
s_add_u32 s57, s60, 82176
buffer_load_dwordx4 v231,s[36:39],s57 offen lds
s_add_u32 m0, s58, 52224
s_add_u32 s57, s60, 123136
buffer_load_dwordx4 v231,s[36:39],s57 offen lds
s_add_u32 m0, s58, 53248
s_add_u32 s57, s60, 164096
buffer_load_dwordx4 v231,s[36:39],s57 offen lds
s_add_u32 m0, s58, 54272
s_add_u32 s57, s60, 205056
buffer_load_dwordx4 v231,s[36:39],s57 offen lds
s_add_u32 m0, s58, 73728
s_add_u32 s57, s60, 384
buffer_load_dwordx4 v231,s[36:39],s57 offen lds
s_add_u32 m0, s58, 74752
s_add_u32 s57, s60, 41344
buffer_load_dwordx4 v231,s[36:39],s57 offen lds
s_add_u32 m0, s58, 75776
s_add_u32 s57, s60, 82304
buffer_load_dwordx4 v231,s[36:39],s57 offen lds
s_add_u32 m0, s58, 76800
s_add_u32 s57, s60, 123264
buffer_load_dwordx4 v231,s[36:39],s57 offen lds
s_add_u32 m0, s58, 77824
s_add_u32 s57, s60, 164224
buffer_load_dwordx4 v231,s[36:39],s57 offen lds
s_add_u32 m0, s58, 78848
s_add_u32 s57, s60, 205184
buffer_load_dwordx4 v231,s[36:39],s57 offen lds
s_waitcnt vmcnt(42)
s_waitcnt vmcnt(12)
s_barrier
ds_read_b64_tr_b16 v[192:193],v227 offset:0
ds_read_b64_tr_b16 v[194:195],v227 offset:6144
ds_read_b64_tr_b16 v[196:197],v227 offset:512
ds_read_b64_tr_b16 v[198:199],v227 offset:6656
ds_read_b64_tr_b16 v[200:201],v227 offset:12288
ds_read_b64_tr_b16 v[202:203],v227 offset:18432
ds_read_b64_tr_b16 v[204:205],v227 offset:12800
ds_read_b64_tr_b16 v[206:207],v227 offset:18944
ds_read_b64_tr_b16 v[208:209],v227 offset:1024
ds_read_b64_tr_b16 v[210:211],v227 offset:7168
ds_read_b64_tr_b16 v[212:213],v227 offset:1536
ds_read_b64_tr_b16 v[214:215],v227 offset:7680
ds_read_b64_tr_b16 v[216:217],v227 offset:13312
ds_read_b64_tr_b16 v[218:219],v227 offset:19456
s_waitcnt lgkmcnt(12)
v_mfma_f32_32x32x16_bf16 v[0:15],v[96:99],v[192:195],0
ds_read_b64_tr_b16 v[220:221],v227 offset:13824
ds_read_b64_tr_b16 v[222:223],v227 offset:19968
s_waitcnt lgkmcnt(12)
v_mfma_f32_32x32x16_bf16 v[16:31],v[96:99],v[196:199],0
s_add_u32 m0, s58, 98304
s_add_u32 s57, s60, 512
buffer_load_dwordx4 v231,s[36:39],s57 offen lds
ds_read_b64_tr_b16 v[192:193],v227 offset:2048
ds_read_b64_tr_b16 v[194:195],v227 offset:8192
s_waitcnt lgkmcnt(12)
v_mfma_f32_32x32x16_bf16 v[0:15],v[100:103],v[200:203],v[0:15]
ds_read_b64_tr_b16 v[196:197],v227 offset:2560
ds_read_b64_tr_b16 v[198:199],v227 offset:8704
s_waitcnt lgkmcnt(12)
v_mfma_f32_32x32x16_bf16 v[16:31],v[100:103],v[204:207],v[16:31]
s_add_u32 m0, s58, 99328
s_add_u32 s57, s60, 41472
buffer_load_dwordx4 v231,s[36:39],s57 offen lds
ds_read_b64_tr_b16 v[200:201],v227 offset:14336
ds_read_b64_tr_b16 v[202:203],v227 offset:20480
s_waitcnt lgkmcnt(12)
v_mfma_f32_32x32x16_bf16 v[0:15],v[104:107],v[208:211],v[0:15]
ds_read_b64_tr_b16 v[204:205],v227 offset:14848
ds_read_b64_tr_b16 v[206:207],v227 offset:20992
s_waitcnt lgkmcnt(12)
v_mfma_f32_32x32x16_bf16 v[16:31],v[104:107],v[212:215],v[16:31]
s_add_u32 m0, s58, 100352
s_add_u32 s57, s60, 82432
buffer_load_dwordx4 v231,s[36:39],s57 offen lds
ds_read_b64_tr_b16 v[208:209],v227 offset:3072
ds_read_b64_tr_b16 v[210:211],v227 offset:9216
s_waitcnt lgkmcnt(12)
v_mfma_f32_32x32x16_bf16 v[0:15],v[108:111],v[216:219],v[0:15]
ds_read_b64_tr_b16 v[212:213],v227 offset:3584
ds_read_b64_tr_b16 v[214:215],v227 offset:9728
s_waitcnt lgkmcnt(12)
v_mfma_f32_32x32x16_bf16 v[16:31],v[108:111],v[220:223],v[16:31]
s_add_u32 m0, s58, 101376
s_add_u32 s57, s60, 123392
buffer_load_dwordx4 v231,s[36:39],s57 offen lds
ds_read_b64_tr_b16 v[216:217],v227 offset:15360
ds_read_b64_tr_b16 v[218:219],v227 offset:21504
s_waitcnt lgkmcnt(12)
v_mfma_f32_32x32x16_bf16 v[0:15],v[112:115],v[192:195],v[0:15]
ds_read_b64_tr_b16 v[220:221],v227 offset:15872
ds_read_b64_tr_b16 v[222:223],v227 offset:22016
s_waitcnt lgkmcnt(12)
v_mfma_f32_32x32x16_bf16 v[16:31],v[112:115],v[196:199],v[16:31]
s_add_u32 m0, s58, 102400
s_add_u32 s57, s60, 164352
buffer_load_dwordx4 v231,s[36:39],s57 offen lds
ds_read_b64_tr_b16 v[192:193],v227 offset:4096
ds_read_b64_tr_b16 v[194:195],v227 offset:10240
s_waitcnt lgkmcnt(12)
v_mfma_f32_32x32x16_bf16 v[0:15],v[116:119],v[200:203],v[0:15]
ds_read_b64_tr_b16 v[196:197],v227 offset:4608
ds_read_b64_tr_b16 v[198:199],v227 offset:10752
s_waitcnt lgkmcnt(12)
v_mfma_f32_32x32x16_bf16 v[16:31],v[116:119],v[204:207],v[16:31]
s_add_u32 m0, s58, 103424
s_add_u32 s57, s60, 205312
buffer_load_dwordx4 v231,s[36:39],s57 offen lds
ds_read_b64_tr_b16 v[200:201],v227 offset:16384
ds_read_b64_tr_b16 v[202:203],v227 offset:22528
s_waitcnt lgkmcnt(12)
v_mfma_f32_32x32x16_bf16 v[0:15],v[120:123],v[208:211],v[0:15]
ds_read_b64_tr_b16 v[204:205],v227 offset:16896
ds_read_b64_tr_b16 v[206:207],v227 offset:23040
s_waitcnt lgkmcnt(12)
v_mfma_f32_32x32x16_bf16 v[16:31],v[120:123],v[212:215],v[16:31]
ds_read_b64_tr_b16 v[208:209],v227 offset:5120
ds_read_b64_tr_b16 v[210:211],v227 offset:11264
s_waitcnt lgkmcnt(12)
v_mfma_f32_32x32x16_bf16 v[0:15],v[124:127],v[216:219],v[0:15]
ds_read_b64_tr_b16 v[212:213],v227 offset:5632
ds_read_b64_tr_b16 v[214:215],v227 offset:11776
s_waitcnt lgkmcnt(12)
v_mfma_f32_32x32x16_bf16 v[16:31],v[124:127],v[220:223],v[16:31]
ds_read_b64_tr_b16 v[216:217],v227 offset:17408
ds_read_b64_tr_b16 v[218:219],v227 offset:23552
s_waitcnt lgkmcnt(12)
v_mfma_f32_32x32x16_bf16 v[0:15],v[128:131],v[192:195],v[0:15]
ds_read_b64_tr_b16 v[220:221],v227 offset:17920
ds_read_b64_tr_b16 v[222:223],v227 offset:24064
s_waitcnt lgkmcnt(12)
v_mfma_f32_32x32x16_bf16 v[16:31],v[128:131],v[196:199],v[16:31]
s_barrier
ds_read_b64_tr_b16 v[192:193],v227 offset:24576
ds_read_b64_tr_b16 v[194:195],v227 offset:30720
s_waitcnt lgkmcnt(12)
v_mfma_f32_32x32x16_bf16 v[0:15],v[132:135],v[200:203],v[0:15]
ds_read_b64_tr_b16 v[196:197],v227 offset:25088
ds_read_b64_tr_b16 v[198:199],v227 offset:31232
s_waitcnt lgkmcnt(12)
v_mfma_f32_32x32x16_bf16 v[16:31],v[132:135],v[204:207],v[16:31]
ds_read_b64_tr_b16 v[200:201],v227 offset:36864
ds_read_b64_tr_b16 v[202:203],v227 offset:43008
s_waitcnt lgkmcnt(12)
v_mfma_f32_32x32x16_bf16 v[0:15],v[136:139],v[208:211],v[0:15]
ds_read_b64_tr_b16 v[204:205],v227 offset:37376
ds_read_b64_tr_b16 v[206:207],v227 offset:43520
s_waitcnt lgkmcnt(12)
v_mfma_f32_32x32x16_bf16 v[16:31],v[136:139],v[212:215],v[16:31]
ds_read_b64_tr_b16 v[208:209],v227 offset:25600
ds_read_b64_tr_b16 v[210:211],v227 offset:31744
s_waitcnt lgkmcnt(12)
v_mfma_f32_32x32x16_bf16 v[0:15],v[140:143],v[216:219],v[0:15]
ds_read_b64_tr_b16 v[212:213],v227 offset:26112
ds_read_b64_tr_b16 v[214:215],v227 offset:32256
s_waitcnt lgkmcnt(12)
v_mfma_f32_32x32x16_bf16 v[16:31],v[140:143],v[220:223],v[16:31]
ds_read_b64_tr_b16 v[216:217],v227 offset:37888
ds_read_b64_tr_b16 v[218:219],v227 offset:44032
s_waitcnt lgkmcnt(12)
v_mfma_f32_32x32x16_bf16 v[32:47],v[96:99],v[192:195],0
ds_read_b64_tr_b16 v[220:221],v227 offset:38400
ds_read_b64_tr_b16 v[222:223],v227 offset:44544
s_waitcnt lgkmcnt(12)
v_mfma_f32_32x32x16_bf16 v[48:63],v[96:99],v[196:199],0
s_add_u32 m0, s58, 0
s_add_u32 s57, s60, 640
buffer_load_dwordx4 v231,s[36:39],s57 offen lds
ds_read_b64_tr_b16 v[192:193],v227 offset:26624
ds_read_b64_tr_b16 v[194:195],v227 offset:32768
s_waitcnt lgkmcnt(12)
v_mfma_f32_32x32x16_bf16 v[32:47],v[100:103],v[200:203],v[32:47]
ds_read_b64_tr_b16 v[196:197],v227 offset:27136
ds_read_b64_tr_b16 v[198:199],v227 offset:33280
s_waitcnt lgkmcnt(12)
v_mfma_f32_32x32x16_bf16 v[48:63],v[100:103],v[204:207],v[48:63]
s_add_u32 m0, s58, 1024
s_add_u32 s57, s60, 41600
buffer_load_dwordx4 v231,s[36:39],s57 offen lds
ds_read_b64_tr_b16 v[200:201],v227 offset:38912
ds_read_b64_tr_b16 v[202:203],v227 offset:45056
s_waitcnt lgkmcnt(12)
v_mfma_f32_32x32x16_bf16 v[32:47],v[104:107],v[208:211],v[32:47]
ds_read_b64_tr_b16 v[204:205],v227 offset:39424
ds_read_b64_tr_b16 v[206:207],v227 offset:45568
s_waitcnt lgkmcnt(12)
v_mfma_f32_32x32x16_bf16 v[48:63],v[104:107],v[212:215],v[48:63]
s_add_u32 m0, s58, 2048
s_add_u32 s57, s60, 82560
buffer_load_dwordx4 v231,s[36:39],s57 offen lds
ds_read_b64_tr_b16 v[208:209],v227 offset:27648
ds_read_b64_tr_b16 v[210:211],v227 offset:33792
s_waitcnt lgkmcnt(12)
v_mfma_f32_32x32x16_bf16 v[32:47],v[108:111],v[216:219],v[32:47]
ds_read_b64_tr_b16 v[212:213],v227 offset:28160
ds_read_b64_tr_b16 v[214:215],v227 offset:34304
s_waitcnt lgkmcnt(12)
v_mfma_f32_32x32x16_bf16 v[48:63],v[108:111],v[220:223],v[48:63]
s_add_u32 m0, s58, 3072
s_add_u32 s57, s60, 123520
buffer_load_dwordx4 v231,s[36:39],s57 offen lds
ds_read_b64_tr_b16 v[216:217],v227 offset:39936
ds_read_b64_tr_b16 v[218:219],v227 offset:46080
s_waitcnt lgkmcnt(12)
v_mfma_f32_32x32x16_bf16 v[32:47],v[112:115],v[192:195],v[32:47]
v_cvt_pk_bf16_f32 v144, v0, v1
v_cvt_pk_bf16_f32 v146, v2, v3
v_cvt_pk_bf16_f32 v145, v4, v5
v_cvt_pk_bf16_f32 v147, v6, v7
v_cvt_pk_bf16_f32 v148, v8, v9
v_cvt_pk_bf16_f32 v150, v10, v11
v_cvt_pk_bf16_f32 v149, v12, v13
v_cvt_pk_bf16_f32 v151, v14, v15
s_add_u32 s57, s67, 0
s_cmp_eq_u32 s69, 0
s_cbranch_scc1 BS0_0
buffer_store_dwordx4 v[144:147],v234,s[8:11],s57 offen
buffer_store_dwordx4 v[148:151],v234,s[8:11],s57 offen offset:512
s_branch BS0_0e
BS0_0:
buffer_store_dwordx4 v[144:147],v234,s[8:11],s57 offen sc1
buffer_store_dwordx4 v[148:151],v234,s[8:11],s57 offen offset:512 sc1
BS0_0e:
v_cvt_pk_bf16_f32 v152, v16, v17
v_cvt_pk_bf16_f32 v154, v18, v19
v_cvt_pk_bf16_f32 v153, v20, v21
v_cvt_pk_bf16_f32 v155, v22, v23
v_cvt_pk_bf16_f32 v156, v24, v25
v_cvt_pk_bf16_f32 v158, v26, v27
v_cvt_pk_bf16_f32 v157, v28, v29
v_cvt_pk_bf16_f32 v159, v30, v31
s_add_u32 s57, s67, 332800
s_cmp_eq_u32 s69, 0
s_cbranch_scc1 BS0_1
buffer_store_dwordx4 v[152:155],v234,s[8:11],s57 offen
buffer_store_dwordx4 v[156:159],v234,s[8:11],s57 offen offset:512
s_branch BS0_1e
BS0_1:
buffer_store_dwordx4 v[152:155],v234,s[8:11],s57 offen sc1
buffer_store_dwordx4 v[156:159],v234,s[8:11],s57 offen offset:512 sc1
BS0_1e:
ds_read_b64_tr_b16 v[220:221],v227 offset:40448
ds_read_b64_tr_b16 v[222:223],v227 offset:46592
s_waitcnt lgkmcnt(12)
v_mfma_f32_32x32x16_bf16 v[48:63],v[112:115],v[196:199],v[48:63]
s_add_u32 m0, s58, 4096
s_add_u32 s57, s60, 164480
buffer_load_dwordx4 v231,s[36:39],s57 offen lds
ds_read_b64_tr_b16 v[192:193],v227 offset:28672
ds_read_b64_tr_b16 v[194:195],v227 offset:34816
s_waitcnt lgkmcnt(12)
v_mfma_f32_32x32x16_bf16 v[32:47],v[116:119],v[200:203],v[32:47]
ds_read_b64_tr_b16 v[196:197],v227 offset:29184
ds_read_b64_tr_b16 v[198:199],v227 offset:35328
s_waitcnt lgkmcnt(12)
v_mfma_f32_32x32x16_bf16 v[48:63],v[116:119],v[204:207],v[48:63]
s_add_u32 m0, s58, 5120
s_add_u32 s57, s60, 205440
buffer_load_dwordx4 v231,s[36:39],s57 offen lds
ds_read_b64_tr_b16 v[200:201],v227 offset:40960
ds_read_b64_tr_b16 v[202:203],v227 offset:47104
s_waitcnt lgkmcnt(12)
v_mfma_f32_32x32x16_bf16 v[32:47],v[120:123],v[208:211],v[32:47]
ds_read_b64_tr_b16 v[204:205],v227 offset:41472
ds_read_b64_tr_b16 v[206:207],v227 offset:47616
s_waitcnt lgkmcnt(12)
v_mfma_f32_32x32x16_bf16 v[48:63],v[120:123],v[212:215],v[48:63]
ds_read_b64_tr_b16 v[208:209],v227 offset:29696
ds_read_b64_tr_b16 v[210:211],v227 offset:35840
s_waitcnt lgkmcnt(12)
v_mfma_f32_32x32x16_bf16 v[32:47],v[124:127],v[216:219],v[32:47]
ds_read_b64_tr_b16 v[212:213],v227 offset:30208
ds_read_b64_tr_b16 v[214:215],v227 offset:36352
s_waitcnt lgkmcnt(12)
v_mfma_f32_32x32x16_bf16 v[48:63],v[124:127],v[220:223],v[48:63]
ds_read_b64_tr_b16 v[216:217],v227 offset:41984
ds_read_b64_tr_b16 v[218:219],v227 offset:48128
s_waitcnt lgkmcnt(12)
v_mfma_f32_32x32x16_bf16 v[32:47],v[128:131],v[192:195],v[32:47]
ds_read_b64_tr_b16 v[220:221],v227 offset:42496
ds_read_b64_tr_b16 v[222:223],v227 offset:48640
s_waitcnt lgkmcnt(12)
v_mfma_f32_32x32x16_bf16 v[48:63],v[128:131],v[196:199],v[48:63]
s_waitcnt vmcnt(22)
s_barrier
ds_read_b64_tr_b16 v[192:193],v228 offset:0
ds_read_b64_tr_b16 v[194:195],v228 offset:6144
s_waitcnt lgkmcnt(12)
v_mfma_f32_32x32x16_bf16 v[32:47],v[132:135],v[200:203],v[32:47]
ds_read_b64_tr_b16 v[196:197],v228 offset:512
ds_read_b64_tr_b16 v[198:199],v228 offset:6656
s_waitcnt lgkmcnt(12)
v_mfma_f32_32x32x16_bf16 v[48:63],v[132:135],v[204:207],v[48:63]
ds_read_b64_tr_b16 v[200:201],v228 offset:12288
ds_read_b64_tr_b16 v[202:203],v228 offset:18432
s_waitcnt lgkmcnt(12)
v_mfma_f32_32x32x16_bf16 v[32:47],v[136:139],v[208:211],v[32:47]
ds_read_b64_tr_b16 v[204:205],v228 offset:12800
ds_read_b64_tr_b16 v[206:207],v228 offset:18944
s_waitcnt lgkmcnt(12)
v_mfma_f32_32x32x16_bf16 v[48:63],v[136:139],v[212:215],v[48:63]
ds_read_b64_tr_b16 v[208:209],v228 offset:1024
ds_read_b64_tr_b16 v[210:211],v228 offset:7168
s_waitcnt lgkmcnt(12)
v_mfma_f32_32x32x16_bf16 v[32:47],v[140:143],v[216:219],v[32:47]
ds_read_b64_tr_b16 v[212:213],v228 offset:1536
ds_read_b64_tr_b16 v[214:215],v228 offset:7680
s_waitcnt lgkmcnt(12)
v_mfma_f32_32x32x16_bf16 v[48:63],v[140:143],v[220:223],v[48:63]
ds_read_b64_tr_b16 v[216:217],v228 offset:13312
ds_read_b64_tr_b16 v[218:219],v228 offset:19456
s_waitcnt lgkmcnt(12)
v_mfma_f32_32x32x16_bf16 v[0:15],v[96:99],v[192:195],0
ds_read_b64_tr_b16 v[220:221],v228 offset:13824
ds_read_b64_tr_b16 v[222:223],v228 offset:19968
s_waitcnt lgkmcnt(12)
v_mfma_f32_32x32x16_bf16 v[16:31],v[96:99],v[196:199],0
s_add_u32 m0, s58, 24576
s_add_u32 s57, s60, 768
buffer_load_dwordx4 v231,s[36:39],s57 offen lds
ds_read_b64_tr_b16 v[192:193],v228 offset:2048
ds_read_b64_tr_b16 v[194:195],v228 offset:8192
s_waitcnt lgkmcnt(12)
v_mfma_f32_32x32x16_bf16 v[0:15],v[100:103],v[200:203],v[0:15]
ds_read_b64_tr_b16 v[196:197],v228 offset:2560
ds_read_b64_tr_b16 v[198:199],v228 offset:8704
s_waitcnt lgkmcnt(12)
v_mfma_f32_32x32x16_bf16 v[16:31],v[100:103],v[204:207],v[16:31]
s_add_u32 m0, s58, 25600
s_add_u32 s57, s60, 41728
buffer_load_dwordx4 v231,s[36:39],s57 offen lds
ds_read_b64_tr_b16 v[200:201],v228 offset:14336
ds_read_b64_tr_b16 v[202:203],v228 offset:20480
s_waitcnt lgkmcnt(12)
v_mfma_f32_32x32x16_bf16 v[0:15],v[104:107],v[208:211],v[0:15]
ds_read_b64_tr_b16 v[204:205],v228 offset:14848
ds_read_b64_tr_b16 v[206:207],v228 offset:20992
s_waitcnt lgkmcnt(12)
v_mfma_f32_32x32x16_bf16 v[16:31],v[104:107],v[212:215],v[16:31]
s_add_u32 m0, s58, 26624
s_add_u32 s57, s60, 82688
buffer_load_dwordx4 v231,s[36:39],s57 offen lds
ds_read_b64_tr_b16 v[208:209],v228 offset:3072
ds_read_b64_tr_b16 v[210:211],v228 offset:9216
s_waitcnt lgkmcnt(12)
v_mfma_f32_32x32x16_bf16 v[0:15],v[108:111],v[216:219],v[0:15]
ds_read_b64_tr_b16 v[212:213],v228 offset:3584
ds_read_b64_tr_b16 v[214:215],v228 offset:9728
s_waitcnt lgkmcnt(12)
v_mfma_f32_32x32x16_bf16 v[16:31],v[108:111],v[220:223],v[16:31]
s_add_u32 m0, s58, 27648
s_add_u32 s57, s60, 123648
buffer_load_dwordx4 v231,s[36:39],s57 offen lds
ds_read_b64_tr_b16 v[216:217],v228 offset:15360
ds_read_b64_tr_b16 v[218:219],v228 offset:21504
s_waitcnt lgkmcnt(12)
v_mfma_f32_32x32x16_bf16 v[0:15],v[112:115],v[192:195],v[0:15]
v_cvt_pk_bf16_f32 v144, v32, v33
v_cvt_pk_bf16_f32 v146, v34, v35
v_cvt_pk_bf16_f32 v145, v36, v37
v_cvt_pk_bf16_f32 v147, v38, v39
v_cvt_pk_bf16_f32 v148, v40, v41
v_cvt_pk_bf16_f32 v150, v42, v43
v_cvt_pk_bf16_f32 v149, v44, v45
v_cvt_pk_bf16_f32 v151, v46, v47
s_add_u32 s57, s67, 665600
s_cmp_eq_u32 s69, 0
s_cbranch_scc1 BS1_0
buffer_store_dwordx4 v[144:147],v234,s[8:11],s57 offen
buffer_store_dwordx4 v[148:151],v234,s[8:11],s57 offen offset:512
s_branch BS1_0e
BS1_0:
buffer_store_dwordx4 v[144:147],v234,s[8:11],s57 offen sc1
buffer_store_dwordx4 v[148:151],v234,s[8:11],s57 offen offset:512 sc1
BS1_0e:
v_cvt_pk_bf16_f32 v152, v48, v49
v_cvt_pk_bf16_f32 v154, v50, v51
v_cvt_pk_bf16_f32 v153, v52, v53
v_cvt_pk_bf16_f32 v155, v54, v55
v_cvt_pk_bf16_f32 v156, v56, v57
v_cvt_pk_bf16_f32 v158, v58, v59
v_cvt_pk_bf16_f32 v157, v60, v61
v_cvt_pk_bf16_f32 v159, v62, v63
s_add_u32 s57, s67, 998400
s_cmp_eq_u32 s69, 0
s_cbranch_scc1 BS1_1
buffer_store_dwordx4 v[152:155],v234,s[8:11],s57 offen
buffer_store_dwordx4 v[156:159],v234,s[8:11],s57 offen offset:512
s_branch BS1_1e
BS1_1:
buffer_store_dwordx4 v[152:155],v234,s[8:11],s57 offen sc1
buffer_store_dwordx4 v[156:159],v234,s[8:11],s57 offen offset:512 sc1
BS1_1e:
ds_read_b64_tr_b16 v[220:221],v228 offset:15872
ds_read_b64_tr_b16 v[222:223],v228 offset:22016
s_waitcnt lgkmcnt(12)
v_mfma_f32_32x32x16_bf16 v[16:31],v[112:115],v[196:199],v[16:31]
s_add_u32 m0, s58, 28672
s_add_u32 s57, s60, 164608
buffer_load_dwordx4 v231,s[36:39],s57 offen lds
ds_read_b64_tr_b16 v[192:193],v228 offset:4096
ds_read_b64_tr_b16 v[194:195],v228 offset:10240
s_waitcnt lgkmcnt(12)
v_mfma_f32_32x32x16_bf16 v[0:15],v[116:119],v[200:203],v[0:15]
ds_read_b64_tr_b16 v[196:197],v228 offset:4608
ds_read_b64_tr_b16 v[198:199],v228 offset:10752
s_waitcnt lgkmcnt(12)
v_mfma_f32_32x32x16_bf16 v[16:31],v[116:119],v[204:207],v[16:31]
s_add_u32 m0, s58, 29696
s_add_u32 s57, s60, 205568
buffer_load_dwordx4 v231,s[36:39],s57 offen lds
ds_read_b64_tr_b16 v[200:201],v228 offset:16384
ds_read_b64_tr_b16 v[202:203],v228 offset:22528
s_waitcnt lgkmcnt(12)
v_mfma_f32_32x32x16_bf16 v[0:15],v[120:123],v[208:211],v[0:15]
ds_read_b64_tr_b16 v[204:205],v228 offset:16896
ds_read_b64_tr_b16 v[206:207],v228 offset:23040
s_waitcnt lgkmcnt(12)
v_mfma_f32_32x32x16_bf16 v[16:31],v[120:123],v[212:215],v[16:31]
ds_read_b64_tr_b16 v[208:209],v228 offset:5120
ds_read_b64_tr_b16 v[210:211],v228 offset:11264
s_waitcnt lgkmcnt(12)
v_mfma_f32_32x32x16_bf16 v[0:15],v[124:127],v[216:219],v[0:15]
ds_read_b64_tr_b16 v[212:213],v228 offset:5632
ds_read_b64_tr_b16 v[214:215],v228 offset:11776
s_waitcnt lgkmcnt(12)
v_mfma_f32_32x32x16_bf16 v[16:31],v[124:127],v[220:223],v[16:31]
ds_read_b64_tr_b16 v[216:217],v228 offset:17408
ds_read_b64_tr_b16 v[218:219],v228 offset:23552
s_waitcnt lgkmcnt(12)
v_mfma_f32_32x32x16_bf16 v[0:15],v[128:131],v[192:195],v[0:15]
ds_read_b64_tr_b16 v[220:221],v228 offset:17920
ds_read_b64_tr_b16 v[222:223],v228 offset:24064
s_waitcnt lgkmcnt(12)
v_mfma_f32_32x32x16_bf16 v[16:31],v[128:131],v[196:199],v[16:31]
s_waitcnt vmcnt(26)
s_barrier
ds_read_b64_tr_b16 v[192:193],v228 offset:24576
ds_read_b64_tr_b16 v[194:195],v228 offset:30720
s_waitcnt lgkmcnt(12)
v_mfma_f32_32x32x16_bf16 v[0:15],v[132:135],v[200:203],v[0:15]
ds_read_b64_tr_b16 v[196:197],v228 offset:25088
ds_read_b64_tr_b16 v[198:199],v228 offset:31232
s_waitcnt lgkmcnt(12)
v_mfma_f32_32x32x16_bf16 v[16:31],v[132:135],v[204:207],v[16:31]
ds_read_b64_tr_b16 v[200:201],v228 offset:36864
ds_read_b64_tr_b16 v[202:203],v228 offset:43008
s_waitcnt lgkmcnt(12)
v_mfma_f32_32x32x16_bf16 v[0:15],v[136:139],v[208:211],v[0:15]
ds_read_b64_tr_b16 v[204:205],v228 offset:37376
ds_read_b64_tr_b16 v[206:207],v228 offset:43520
s_waitcnt lgkmcnt(12)
v_mfma_f32_32x32x16_bf16 v[16:31],v[136:139],v[212:215],v[16:31]
ds_read_b64_tr_b16 v[208:209],v228 offset:25600
ds_read_b64_tr_b16 v[210:211],v228 offset:31744
s_waitcnt lgkmcnt(12)
v_mfma_f32_32x32x16_bf16 v[0:15],v[140:143],v[216:219],v[0:15]
ds_read_b64_tr_b16 v[212:213],v228 offset:26112
ds_read_b64_tr_b16 v[214:215],v228 offset:32256
s_waitcnt lgkmcnt(12)
v_mfma_f32_32x32x16_bf16 v[16:31],v[140:143],v[220:223],v[16:31]
ds_read_b64_tr_b16 v[216:217],v228 offset:37888
ds_read_b64_tr_b16 v[218:219],v228 offset:44032
s_waitcnt lgkmcnt(12)
v_mfma_f32_32x32x16_bf16 v[32:47],v[96:99],v[192:195],0
ds_read_b64_tr_b16 v[220:221],v228 offset:38400
ds_read_b64_tr_b16 v[222:223],v228 offset:44544
s_waitcnt lgkmcnt(12)
v_mfma_f32_32x32x16_bf16 v[48:63],v[96:99],v[196:199],0
s_add_u32 m0, s58, 49152
s_add_u32 s57, s60, 896
buffer_load_dwordx4 v231,s[36:39],s57 offen lds
ds_read_b64_tr_b16 v[192:193],v228 offset:26624
ds_read_b64_tr_b16 v[194:195],v228 offset:32768
s_waitcnt lgkmcnt(12)
v_mfma_f32_32x32x16_bf16 v[32:47],v[100:103],v[200:203],v[32:47]
ds_read_b64_tr_b16 v[196:197],v228 offset:27136
ds_read_b64_tr_b16 v[198:199],v228 offset:33280
s_waitcnt lgkmcnt(12)
v_mfma_f32_32x32x16_bf16 v[48:63],v[100:103],v[204:207],v[48:63]
s_add_u32 m0, s58, 50176
s_add_u32 s57, s60, 41856
buffer_load_dwordx4 v231,s[36:39],s57 offen lds
ds_read_b64_tr_b16 v[200:201],v228 offset:38912
ds_read_b64_tr_b16 v[202:203],v228 offset:45056
s_waitcnt lgkmcnt(12)
v_mfma_f32_32x32x16_bf16 v[32:47],v[104:107],v[208:211],v[32:47]
ds_read_b64_tr_b16 v[204:205],v228 offset:39424
ds_read_b64_tr_b16 v[206:207],v228 offset:45568
s_waitcnt lgkmcnt(12)
v_mfma_f32_32x32x16_bf16 v[48:63],v[104:107],v[212:215],v[48:63]
s_add_u32 m0, s58, 51200
s_add_u32 s57, s60, 82816
buffer_load_dwordx4 v231,s[36:39],s57 offen lds
ds_read_b64_tr_b16 v[208:209],v228 offset:27648
ds_read_b64_tr_b16 v[210:211],v228 offset:33792
s_waitcnt lgkmcnt(12)
v_mfma_f32_32x32x16_bf16 v[32:47],v[108:111],v[216:219],v[32:47]
ds_read_b64_tr_b16 v[212:213],v228 offset:28160
ds_read_b64_tr_b16 v[214:215],v228 offset:34304
s_waitcnt lgkmcnt(12)
v_mfma_f32_32x32x16_bf16 v[48:63],v[108:111],v[220:223],v[48:63]
s_add_u32 m0, s58, 52224
s_add_u32 s57, s60, 123776
buffer_load_dwordx4 v231,s[36:39],s57 offen lds
ds_read_b64_tr_b16 v[216:217],v228 offset:39936
ds_read_b64_tr_b16 v[218:219],v228 offset:46080
s_waitcnt lgkmcnt(12)
v_mfma_f32_32x32x16_bf16 v[32:47],v[112:115],v[192:195],v[32:47]
v_cvt_pk_bf16_f32 v144, v0, v1
v_cvt_pk_bf16_f32 v146, v2, v3
v_cvt_pk_bf16_f32 v145, v4, v5
v_cvt_pk_bf16_f32 v147, v6, v7
v_cvt_pk_bf16_f32 v148, v8, v9
v_cvt_pk_bf16_f32 v150, v10, v11
v_cvt_pk_bf16_f32 v149, v12, v13
v_cvt_pk_bf16_f32 v151, v14, v15
s_add_u32 s57, s67, 1331200
s_cmp_eq_u32 s69, 0
s_cbranch_scc1 BS2_0
buffer_store_dwordx4 v[144:147],v234,s[8:11],s57 offen
buffer_store_dwordx4 v[148:151],v234,s[8:11],s57 offen offset:512
s_branch BS2_0e
BS2_0:
buffer_store_dwordx4 v[144:147],v234,s[8:11],s57 offen sc1
buffer_store_dwordx4 v[148:151],v234,s[8:11],s57 offen offset:512 sc1
BS2_0e:
v_cvt_pk_bf16_f32 v152, v16, v17
v_cvt_pk_bf16_f32 v154, v18, v19
v_cvt_pk_bf16_f32 v153, v20, v21
v_cvt_pk_bf16_f32 v155, v22, v23
v_cvt_pk_bf16_f32 v156, v24, v25
v_cvt_pk_bf16_f32 v158, v26, v27
v_cvt_pk_bf16_f32 v157, v28, v29
v_cvt_pk_bf16_f32 v159, v30, v31
s_add_u32 s57, s67, 1664000
s_cmp_eq_u32 s69, 0
s_cbranch_scc1 BS2_1
buffer_store_dwordx4 v[152:155],v234,s[8:11],s57 offen
buffer_store_dwordx4 v[156:159],v234,s[8:11],s57 offen offset:512
s_branch BS2_1e
BS2_1:
buffer_store_dwordx4 v[152:155],v234,s[8:11],s57 offen sc1
buffer_store_dwordx4 v[156:159],v234,s[8:11],s57 offen offset:512 sc1
BS2_1e:
ds_read_b64_tr_b16 v[220:221],v228 offset:40448
ds_read_b64_tr_b16 v[222:223],v228 offset:46592
s_waitcnt lgkmcnt(12)
v_mfma_f32_32x32x16_bf16 v[48:63],v[112:115],v[196:199],v[48:63]
s_add_u32 m0, s58, 53248
s_add_u32 s57, s60, 164736
buffer_load_dwordx4 v231,s[36:39],s57 offen lds
ds_read_b64_tr_b16 v[192:193],v228 offset:28672
ds_read_b64_tr_b16 v[194:195],v228 offset:34816
s_waitcnt lgkmcnt(12)
v_mfma_f32_32x32x16_bf16 v[32:47],v[116:119],v[200:203],v[32:47]
ds_read_b64_tr_b16 v[196:197],v228 offset:29184
ds_read_b64_tr_b16 v[198:199],v228 offset:35328
s_waitcnt lgkmcnt(12)
v_mfma_f32_32x32x16_bf16 v[48:63],v[116:119],v[204:207],v[48:63]
s_add_u32 m0, s58, 54272
s_add_u32 s57, s60, 205696
buffer_load_dwordx4 v231,s[36:39],s57 offen lds
ds_read_b64_tr_b16 v[200:201],v228 offset:40960
ds_read_b64_tr_b16 v[202:203],v228 offset:47104
s_waitcnt lgkmcnt(12)
v_mfma_f32_32x32x16_bf16 v[32:47],v[120:123],v[208:211],v[32:47]
ds_read_b64_tr_b16 v[204:205],v228 offset:41472
ds_read_b64_tr_b16 v[206:207],v228 offset:47616
s_waitcnt lgkmcnt(12)
v_mfma_f32_32x32x16_bf16 v[48:63],v[120:123],v[212:215],v[48:63]
ds_read_b64_tr_b16 v[208:209],v228 offset:29696
ds_read_b64_tr_b16 v[210:211],v228 offset:35840
s_waitcnt lgkmcnt(12)
v_mfma_f32_32x32x16_bf16 v[32:47],v[124:127],v[216:219],v[32:47]
ds_read_b64_tr_b16 v[212:213],v228 offset:30208
ds_read_b64_tr_b16 v[214:215],v228 offset:36352
s_waitcnt lgkmcnt(12)
v_mfma_f32_32x32x16_bf16 v[48:63],v[124:127],v[220:223],v[48:63]
ds_read_b64_tr_b16 v[216:217],v228 offset:41984
ds_read_b64_tr_b16 v[218:219],v228 offset:48128
s_waitcnt lgkmcnt(12)
v_mfma_f32_32x32x16_bf16 v[32:47],v[128:131],v[192:195],v[32:47]
ds_read_b64_tr_b16 v[220:221],v228 offset:42496
ds_read_b64_tr_b16 v[222:223],v228 offset:48640
s_waitcnt lgkmcnt(12)
v_mfma_f32_32x32x16_bf16 v[48:63],v[128:131],v[196:199],v[48:63]
s_waitcnt vmcnt(30)
s_barrier
ds_read_b64_tr_b16 v[192:193],v229 offset:0
ds_read_b64_tr_b16 v[194:195],v229 offset:6144
s_waitcnt lgkmcnt(12)
v_mfma_f32_32x32x16_bf16 v[32:47],v[132:135],v[200:203],v[32:47]
ds_read_b64_tr_b16 v[196:197],v229 offset:512
ds_read_b64_tr_b16 v[198:199],v229 offset:6656
s_waitcnt lgkmcnt(12)
v_mfma_f32_32x32x16_bf16 v[48:63],v[132:135],v[204:207],v[48:63]
ds_read_b64_tr_b16 v[200:201],v229 offset:12288
ds_read_b64_tr_b16 v[202:203],v229 offset:18432
s_waitcnt lgkmcnt(12)
v_mfma_f32_32x32x16_bf16 v[32:47],v[136:139],v[208:211],v[32:47]
ds_read_b64_tr_b16 v[204:205],v229 offset:12800
ds_read_b64_tr_b16 v[206:207],v229 offset:18944
s_waitcnt lgkmcnt(12)
v_mfma_f32_32x32x16_bf16 v[48:63],v[136:139],v[212:215],v[48:63]
ds_read_b64_tr_b16 v[208:209],v229 offset:1024
ds_read_b64_tr_b16 v[210:211],v229 offset:7168
s_waitcnt lgkmcnt(12)
v_mfma_f32_32x32x16_bf16 v[32:47],v[140:143],v[216:219],v[32:47]
ds_read_b64_tr_b16 v[212:213],v229 offset:1536
ds_read_b64_tr_b16 v[214:215],v229 offset:7680
s_waitcnt lgkmcnt(12)
v_mfma_f32_32x32x16_bf16 v[48:63],v[140:143],v[220:223],v[48:63]
ds_read_b64_tr_b16 v[216:217],v229 offset:13312
ds_read_b64_tr_b16 v[218:219],v229 offset:19456
s_waitcnt lgkmcnt(12)
v_mfma_f32_32x32x16_bf16 v[0:15],v[96:99],v[192:195],0
ds_read_b64_tr_b16 v[220:221],v229 offset:13824
ds_read_b64_tr_b16 v[222:223],v229 offset:19968
s_waitcnt lgkmcnt(12)
v_mfma_f32_32x32x16_bf16 v[16:31],v[96:99],v[196:199],0
s_add_u32 m0, s58, 73728
s_add_u32 s57, s60, 1024
buffer_load_dwordx4 v231,s[36:39],s57 offen lds
ds_read_b64_tr_b16 v[192:193],v229 offset:2048
ds_read_b64_tr_b16 v[194:195],v229 offset:8192
s_waitcnt lgkmcnt(12)
v_mfma_f32_32x32x16_bf16 v[0:15],v[100:103],v[200:203],v[0:15]
ds_read_b64_tr_b16 v[196:197],v229 offset:2560
ds_read_b64_tr_b16 v[198:199],v229 offset:8704
s_waitcnt lgkmcnt(12)
v_mfma_f32_32x32x16_bf16 v[16:31],v[100:103],v[204:207],v[16:31]
s_add_u32 m0, s58, 74752
s_add_u32 s57, s60, 41984
buffer_load_dwordx4 v231,s[36:39],s57 offen lds
ds_read_b64_tr_b16 v[200:201],v229 offset:14336
ds_read_b64_tr_b16 v[202:203],v229 offset:20480
s_waitcnt lgkmcnt(12)
v_mfma_f32_32x32x16_bf16 v[0:15],v[104:107],v[208:211],v[0:15]
ds_read_b64_tr_b16 v[204:205],v229 offset:14848
ds_read_b64_tr_b16 v[206:207],v229 offset:20992
s_waitcnt lgkmcnt(12)
v_mfma_f32_32x32x16_bf16 v[16:31],v[104:107],v[212:215],v[16:31]
s_add_u32 m0, s58, 75776
s_add_u32 s57, s60, 82944
buffer_load_dwordx4 v231,s[36:39],s57 offen lds
ds_read_b64_tr_b16 v[208:209],v229 offset:3072
ds_read_b64_tr_b16 v[210:211],v229 offset:9216
s_waitcnt lgkmcnt(12)
v_mfma_f32_32x32x16_bf16 v[0:15],v[108:111],v[216:219],v[0:15]
ds_read_b64_tr_b16 v[212:213],v229 offset:3584
ds_read_b64_tr_b16 v[214:215],v229 offset:9728
s_waitcnt lgkmcnt(12)
v_mfma_f32_32x32x16_bf16 v[16:31],v[108:111],v[220:223],v[16:31]
s_add_u32 m0, s58, 76800
s_add_u32 s57, s60, 123904
buffer_load_dwordx4 v231,s[36:39],s57 offen lds
ds_read_b64_tr_b16 v[216:217],v229 offset:15360
ds_read_b64_tr_b16 v[218:219],v229 offset:21504
s_waitcnt lgkmcnt(12)
v_mfma_f32_32x32x16_bf16 v[0:15],v[112:115],v[192:195],v[0:15]
v_cvt_pk_bf16_f32 v144, v32, v33
v_cvt_pk_bf16_f32 v146, v34, v35
v_cvt_pk_bf16_f32 v145, v36, v37
v_cvt_pk_bf16_f32 v147, v38, v39
v_cvt_pk_bf16_f32 v148, v40, v41
v_cvt_pk_bf16_f32 v150, v42, v43
v_cvt_pk_bf16_f32 v149, v44, v45
v_cvt_pk_bf16_f32 v151, v46, v47
s_add_u32 s57, s67, 1996800
s_cmp_eq_u32 s69, 0
s_cbranch_scc1 BS3_0
buffer_store_dwordx4 v[144:147],v234,s[8:11],s57 offen
buffer_store_dwordx4 v[148:151],v234,s[8:11],s57 offen offset:512
s_branch BS3_0e
BS3_0:
buffer_store_dwordx4 v[144:147],v234,s[8:11],s57 offen sc1
buffer_store_dwordx4 v[148:151],v234,s[8:11],s57 offen offset:512 sc1
BS3_0e:
v_cvt_pk_bf16_f32 v152, v48, v49
v_cvt_pk_bf16_f32 v154, v50, v51
v_cvt_pk_bf16_f32 v153, v52, v53
v_cvt_pk_bf16_f32 v155, v54, v55
v_cvt_pk_bf16_f32 v156, v56, v57
v_cvt_pk_bf16_f32 v158, v58, v59
v_cvt_pk_bf16_f32 v157, v60, v61
v_cvt_pk_bf16_f32 v159, v62, v63
s_add_u32 s57, s67, 2329600
s_cmp_eq_u32 s69, 0
s_cbranch_scc1 BS3_1
buffer_store_dwordx4 v[152:155],v234,s[8:11],s57 offen
buffer_store_dwordx4 v[156:159],v234,s[8:11],s57 offen offset:512
s_branch BS3_1e
BS3_1:
buffer_store_dwordx4 v[152:155],v234,s[8:11],s57 offen sc1
buffer_store_dwordx4 v[156:159],v234,s[8:11],s57 offen offset:512 sc1
BS3_1e:
ds_read_b64_tr_b16 v[220:221],v229 offset:15872
ds_read_b64_tr_b16 v[222:223],v229 offset:22016
s_waitcnt lgkmcnt(12)
v_mfma_f32_32x32x16_bf16 v[16:31],v[112:115],v[196:199],v[16:31]
s_add_u32 m0, s58, 77824
s_add_u32 s57, s60, 164864
buffer_load_dwordx4 v231,s[36:39],s57 offen lds
ds_read_b64_tr_b16 v[192:193],v229 offset:4096
ds_read_b64_tr_b16 v[194:195],v229 offset:10240
s_waitcnt lgkmcnt(12)
v_mfma_f32_32x32x16_bf16 v[0:15],v[116:119],v[200:203],v[0:15]
ds_read_b64_tr_b16 v[196:197],v229 offset:4608
ds_read_b64_tr_b16 v[198:199],v229 offset:10752
s_waitcnt lgkmcnt(12)
v_mfma_f32_32x32x16_bf16 v[16:31],v[116:119],v[204:207],v[16:31]
s_add_u32 m0, s58, 78848
s_add_u32 s57, s60, 205824
buffer_load_dwordx4 v231,s[36:39],s57 offen lds
ds_read_b64_tr_b16 v[200:201],v229 offset:16384
ds_read_b64_tr_b16 v[202:203],v229 offset:22528
s_waitcnt lgkmcnt(12)
v_mfma_f32_32x32x16_bf16 v[0:15],v[120:123],v[208:211],v[0:15]
ds_read_b64_tr_b16 v[204:205],v229 offset:16896
ds_read_b64_tr_b16 v[206:207],v229 offset:23040
s_waitcnt lgkmcnt(12)
v_mfma_f32_32x32x16_bf16 v[16:31],v[120:123],v[212:215],v[16:31]
ds_read_b64_tr_b16 v[208:209],v229 offset:5120
ds_read_b64_tr_b16 v[210:211],v229 offset:11264
s_waitcnt lgkmcnt(12)
v_mfma_f32_32x32x16_bf16 v[0:15],v[124:127],v[216:219],v[0:15]
ds_read_b64_tr_b16 v[212:213],v229 offset:5632
ds_read_b64_tr_b16 v[214:215],v229 offset:11776
s_waitcnt lgkmcnt(12)
v_mfma_f32_32x32x16_bf16 v[16:31],v[124:127],v[220:223],v[16:31]
ds_read_b64_tr_b16 v[216:217],v229 offset:17408
ds_read_b64_tr_b16 v[218:219],v229 offset:23552
s_waitcnt lgkmcnt(12)
v_mfma_f32_32x32x16_bf16 v[0:15],v[128:131],v[192:195],v[0:15]
ds_read_b64_tr_b16 v[220:221],v229 offset:17920
ds_read_b64_tr_b16 v[222:223],v229 offset:24064
s_waitcnt lgkmcnt(12)
v_mfma_f32_32x32x16_bf16 v[16:31],v[128:131],v[196:199],v[16:31]
s_waitcnt vmcnt(30)
s_barrier
ds_read_b64_tr_b16 v[192:193],v227 offset:0
ds_read_b64_tr_b16 v[194:195],v227 offset:6144
s_waitcnt lgkmcnt(12)
v_mfma_f32_32x32x16_bf16 v[0:15],v[132:135],v[200:203],v[0:15]
ds_read_b64_tr_b16 v[196:197],v227 offset:512
ds_read_b64_tr_b16 v[198:199],v227 offset:6656
s_waitcnt lgkmcnt(12)
v_mfma_f32_32x32x16_bf16 v[16:31],v[132:135],v[204:207],v[16:31]
ds_read_b64_tr_b16 v[200:201],v227 offset:12288
ds_read_b64_tr_b16 v[202:203],v227 offset:18432
s_waitcnt lgkmcnt(12)
v_mfma_f32_32x32x16_bf16 v[0:15],v[136:139],v[208:211],v[0:15]
ds_read_b64_tr_b16 v[204:205],v227 offset:12800
ds_read_b64_tr_b16 v[206:207],v227 offset:18944
s_waitcnt lgkmcnt(12)
v_mfma_f32_32x32x16_bf16 v[16:31],v[136:139],v[212:215],v[16:31]
ds_read_b64_tr_b16 v[208:209],v227 offset:1024
ds_read_b64_tr_b16 v[210:211],v227 offset:7168
s_waitcnt lgkmcnt(12)
v_mfma_f32_32x32x16_bf16 v[0:15],v[140:143],v[216:219],v[0:15]
ds_read_b64_tr_b16 v[212:213],v227 offset:1536
ds_read_b64_tr_b16 v[214:215],v227 offset:7680
s_waitcnt lgkmcnt(12)
v_mfma_f32_32x32x16_bf16 v[16:31],v[140:143],v[220:223],v[16:31]
ds_read_b64_tr_b16 v[216:217],v227 offset:13312
ds_read_b64_tr_b16 v[218:219],v227 offset:19456
s_waitcnt lgkmcnt(12)
v_mfma_f32_32x32x16_bf16 v[32:47],v[96:99],v[192:195],0
ds_read_b64_tr_b16 v[220:221],v227 offset:13824
ds_read_b64_tr_b16 v[222:223],v227 offset:19968
s_waitcnt lgkmcnt(12)
v_mfma_f32_32x32x16_bf16 v[48:63],v[96:99],v[196:199],0
s_add_u32 m0, s58, 98304
s_add_u32 s57, s60, 1152
buffer_load_dwordx4 v231,s[36:39],s57 offen lds
ds_read_b64_tr_b16 v[192:193],v227 offset:2048
ds_read_b64_tr_b16 v[194:195],v227 offset:8192
s_waitcnt lgkmcnt(12)
v_mfma_f32_32x32x16_bf16 v[32:47],v[100:103],v[200:203],v[32:47]
ds_read_b64_tr_b16 v[196:197],v227 offset:2560
ds_read_b64_tr_b16 v[198:199],v227 offset:8704
s_waitcnt lgkmcnt(12)
v_mfma_f32_32x32x16_bf16 v[48:63],v[100:103],v[204:207],v[48:63]
s_add_u32 m0, s58, 99328
s_add_u32 s57, s60, 42112
buffer_load_dwordx4 v231,s[36:39],s57 offen lds
ds_read_b64_tr_b16 v[200:201],v227 offset:14336
ds_read_b64_tr_b16 v[202:203],v227 offset:20480
s_waitcnt lgkmcnt(12)
v_mfma_f32_32x32x16_bf16 v[32:47],v[104:107],v[208:211],v[32:47]
ds_read_b64_tr_b16 v[204:205],v227 offset:14848
ds_read_b64_tr_b16 v[206:207],v227 offset:20992
s_waitcnt lgkmcnt(12)
v_mfma_f32_32x32x16_bf16 v[48:63],v[104:107],v[212:215],v[48:63]
s_add_u32 m0, s58, 100352
s_add_u32 s57, s60, 83072
buffer_load_dwordx4 v231,s[36:39],s57 offen lds
ds_read_b64_tr_b16 v[208:209],v227 offset:3072
ds_read_b64_tr_b16 v[210:211],v227 offset:9216
s_waitcnt lgkmcnt(12)
v_mfma_f32_32x32x16_bf16 v[32:47],v[108:111],v[216:219],v[32:47]
ds_read_b64_tr_b16 v[212:213],v227 offset:3584
ds_read_b64_tr_b16 v[214:215],v227 offset:9728
s_waitcnt lgkmcnt(12)
v_mfma_f32_32x32x16_bf16 v[48:63],v[108:111],v[220:223],v[48:63]
s_add_u32 m0, s58, 101376
s_add_u32 s57, s60, 124032
buffer_load_dwordx4 v231,s[36:39],s57 offen lds
ds_read_b64_tr_b16 v[216:217],v227 offset:15360
ds_read_b64_tr_b16 v[218:219],v227 offset:21504
s_waitcnt lgkmcnt(12)
v_mfma_f32_32x32x16_bf16 v[32:47],v[112:115],v[192:195],v[32:47]
v_cvt_pk_bf16_f32 v144, v0, v1
v_cvt_pk_bf16_f32 v146, v2, v3
v_cvt_pk_bf16_f32 v145, v4, v5
v_cvt_pk_bf16_f32 v147, v6, v7
v_cvt_pk_bf16_f32 v148, v8, v9
v_cvt_pk_bf16_f32 v150, v10, v11
v_cvt_pk_bf16_f32 v149, v12, v13
v_cvt_pk_bf16_f32 v151, v14, v15
s_add_u32 s57, s67, 2662400
s_cmp_eq_u32 s69, 0
s_cbranch_scc1 BS4_0
buffer_store_dwordx4 v[144:147],v234,s[8:11],s57 offen
buffer_store_dwordx4 v[148:151],v234,s[8:11],s57 offen offset:512
s_branch BS4_0e
BS4_0:
buffer_store_dwordx4 v[144:147],v234,s[8:11],s57 offen sc1
buffer_store_dwordx4 v[148:151],v234,s[8:11],s57 offen offset:512 sc1
BS4_0e:
v_cvt_pk_bf16_f32 v152, v16, v17
v_cvt_pk_bf16_f32 v154, v18, v19
v_cvt_pk_bf16_f32 v153, v20, v21
v_cvt_pk_bf16_f32 v155, v22, v23
v_cvt_pk_bf16_f32 v156, v24, v25
v_cvt_pk_bf16_f32 v158, v26, v27
v_cvt_pk_bf16_f32 v157, v28, v29
v_cvt_pk_bf16_f32 v159, v30, v31
s_add_u32 s57, s67, 2995200
s_cmp_eq_u32 s69, 0
s_cbranch_scc1 BS4_1
buffer_store_dwordx4 v[152:155],v234,s[8:11],s57 offen
buffer_store_dwordx4 v[156:159],v234,s[8:11],s57 offen offset:512
s_branch BS4_1e
BS4_1:
buffer_store_dwordx4 v[152:155],v234,s[8:11],s57 offen sc1
buffer_store_dwordx4 v[156:159],v234,s[8:11],s57 offen offset:512 sc1
BS4_1e:
ds_read_b64_tr_b16 v[220:221],v227 offset:15872
ds_read_b64_tr_b16 v[222:223],v227 offset:22016
s_waitcnt lgkmcnt(12)
v_mfma_f32_32x32x16_bf16 v[48:63],v[112:115],v[196:199],v[48:63]
s_add_u32 m0, s58, 102400
s_add_u32 s57, s60, 164992
buffer_load_dwordx4 v231,s[36:39],s57 offen lds
ds_read_b64_tr_b16 v[192:193],v227 offset:4096
ds_read_b64_tr_b16 v[194:195],v227 offset:10240
s_waitcnt lgkmcnt(12)
v_mfma_f32_32x32x16_bf16 v[32:47],v[116:119],v[200:203],v[32:47]
ds_read_b64_tr_b16 v[196:197],v227 offset:4608
ds_read_b64_tr_b16 v[198:199],v227 offset:10752
s_waitcnt lgkmcnt(12)
v_mfma_f32_32x32x16_bf16 v[48:63],v[116:119],v[204:207],v[48:63]
s_add_u32 m0, s58, 103424
s_add_u32 s57, s60, 205952
buffer_load_dwordx4 v231,s[36:39],s57 offen lds
ds_read_b64_tr_b16 v[200:201],v227 offset:16384
ds_read_b64_tr_b16 v[202:203],v227 offset:22528
s_waitcnt lgkmcnt(12)
v_mfma_f32_32x32x16_bf16 v[32:47],v[120:123],v[208:211],v[32:47]
ds_read_b64_tr_b16 v[204:205],v227 offset:16896
ds_read_b64_tr_b16 v[206:207],v227 offset:23040
s_waitcnt lgkmcnt(12)
v_mfma_f32_32x32x16_bf16 v[48:63],v[120:123],v[212:215],v[48:63]
ds_read_b64_tr_b16 v[208:209],v227 offset:5120
ds_read_b64_tr_b16 v[210:211],v227 offset:11264
s_waitcnt lgkmcnt(12)
v_mfma_f32_32x32x16_bf16 v[32:47],v[124:127],v[216:219],v[32:47]
ds_read_b64_tr_b16 v[212:213],v227 offset:5632
ds_read_b64_tr_b16 v[214:215],v227 offset:11776
s_waitcnt lgkmcnt(12)
v_mfma_f32_32x32x16_bf16 v[48:63],v[124:127],v[220:223],v[48:63]
ds_read_b64_tr_b16 v[216:217],v227 offset:17408
ds_read_b64_tr_b16 v[218:219],v227 offset:23552
s_waitcnt lgkmcnt(12)
v_mfma_f32_32x32x16_bf16 v[32:47],v[128:131],v[192:195],v[32:47]
ds_read_b64_tr_b16 v[220:221],v227 offset:17920
ds_read_b64_tr_b16 v[222:223],v227 offset:24064
s_waitcnt lgkmcnt(12)
v_mfma_f32_32x32x16_bf16 v[48:63],v[128:131],v[196:199],v[48:63]
s_waitcnt vmcnt(30)
s_barrier
ds_read_b64_tr_b16 v[192:193],v227 offset:24576
ds_read_b64_tr_b16 v[194:195],v227 offset:30720
s_waitcnt lgkmcnt(12)
v_mfma_f32_32x32x16_bf16 v[32:47],v[132:135],v[200:203],v[32:47]
ds_read_b64_tr_b16 v[196:197],v227 offset:25088
ds_read_b64_tr_b16 v[198:199],v227 offset:31232
s_waitcnt lgkmcnt(12)
v_mfma_f32_32x32x16_bf16 v[48:63],v[132:135],v[204:207],v[48:63]
ds_read_b64_tr_b16 v[200:201],v227 offset:36864
ds_read_b64_tr_b16 v[202:203],v227 offset:43008
s_waitcnt lgkmcnt(12)
v_mfma_f32_32x32x16_bf16 v[32:47],v[136:139],v[208:211],v[32:47]
ds_read_b64_tr_b16 v[204:205],v227 offset:37376
ds_read_b64_tr_b16 v[206:207],v227 offset:43520
s_waitcnt lgkmcnt(12)
v_mfma_f32_32x32x16_bf16 v[48:63],v[136:139],v[212:215],v[48:63]
s_cmp_lt_u32 s6, 24
s_cbranch_scc1 BT4
s_lshl_b32 s57, s56, 6
v_add_u32 v64, s57, v255
v_mul_u32_u24 v64, 12288, v64
s_mul_i32 s57, s62, 384
s_add_u32 s57, s57, 4718592
s_cmp_lt_u32 s5, 16
s_cbranch_scc1 BT5
buffer_load_dword v65,v64,s[28:31],s57 offen
buffer_load_dword v66,v64,s[28:31],s57 offen offset:128
buffer_load_dword v67,v64,s[28:31],s57 offen offset:256
s_branch BT4
BT5:
buffer_load_dword v65,v64,s[24:27],s57 offen
buffer_load_dword v66,v64,s[24:27],s57 offen offset:128
buffer_load_dword v67,v64,s[24:27],s57 offen offset:256
BT4:
ds_read_b64_tr_b16 v[208:209],v227 offset:25600
ds_read_b64_tr_b16 v[210:211],v227 offset:31744
s_waitcnt lgkmcnt(12)
v_mfma_f32_32x32x16_bf16 v[32:47],v[140:143],v[216:219],v[32:47]
ds_read_b64_tr_b16 v[212:213],v227 offset:26112
ds_read_b64_tr_b16 v[214:215],v227 offset:32256
s_waitcnt lgkmcnt(12)
v_mfma_f32_32x32x16_bf16 v[48:63],v[140:143],v[220:223],v[48:63]
ds_read_b64_tr_b16 v[216:217],v227 offset:37888
ds_read_b64_tr_b16 v[218:219],v227 offset:44032
s_waitcnt lgkmcnt(12)
v_mfma_f32_32x32x16_bf16 v[0:15],v[96:99],v[192:195],0
ds_read_b64_tr_b16 v[220:221],v227 offset:38400
ds_read_b64_tr_b16 v[222:223],v227 offset:44544
s_waitcnt lgkmcnt(12)
v_mfma_f32_32x32x16_bf16 v[16:31],v[96:99],v[196:199],0
ds_read_b64_tr_b16 v[192:193],v227 offset:26624
ds_read_b64_tr_b16 v[194:195],v227 offset:32768
s_waitcnt lgkmcnt(12)
v_mfma_f32_32x32x16_bf16 v[0:15],v[100:103],v[200:203],v[0:15]
ds_read_b64_tr_b16 v[196:197],v227 offset:27136
ds_read_b64_tr_b16 v[198:199],v227 offset:33280
s_waitcnt lgkmcnt(12)
v_mfma_f32_32x32x16_bf16 v[16:31],v[100:103],v[204:207],v[16:31]
ds_read_b64_tr_b16 v[200:201],v227 offset:38912
ds_read_b64_tr_b16 v[202:203],v227 offset:45056
s_waitcnt lgkmcnt(12)
v_mfma_f32_32x32x16_bf16 v[0:15],v[104:107],v[208:211],v[0:15]
ds_read_b64_tr_b16 v[204:205],v227 offset:39424
ds_read_b64_tr_b16 v[206:207],v227 offset:45568
s_waitcnt lgkmcnt(12)
v_mfma_f32_32x32x16_bf16 v[16:31],v[104:107],v[212:215],v[16:31]
ds_read_b64_tr_b16 v[208:209],v227 offset:27648
ds_read_b64_tr_b16 v[210:211],v227 offset:33792
s_waitcnt lgkmcnt(12)
v_mfma_f32_32x32x16_bf16 v[0:15],v[108:111],v[216:219],v[0:15]
ds_read_b64_tr_b16 v[212:213],v227 offset:28160
ds_read_b64_tr_b16 v[214:215],v227 offset:34304
s_waitcnt lgkmcnt(12)
v_mfma_f32_32x32x16_bf16 v[16:31],v[108:111],v[220:223],v[16:31]
ds_read_b64_tr_b16 v[216:217],v227 offset:39936
ds_read_b64_tr_b16 v[218:219],v227 offset:46080
s_waitcnt lgkmcnt(12)
v_mfma_f32_32x32x16_bf16 v[0:15],v[112:115],v[192:195],v[0:15]
v_cvt_pk_bf16_f32 v144, v32, v33
v_cvt_pk_bf16_f32 v146, v34, v35
v_cvt_pk_bf16_f32 v145, v36, v37
v_cvt_pk_bf16_f32 v147, v38, v39
v_cvt_pk_bf16_f32 v148, v40, v41
v_cvt_pk_bf16_f32 v150, v42, v43
v_cvt_pk_bf16_f32 v149, v44, v45
v_cvt_pk_bf16_f32 v151, v46, v47
s_add_u32 s57, s67, 3328000
s_cmp_eq_u32 s69, 0
s_cbranch_scc1 BS5_0
buffer_store_dwordx4 v[144:147],v234,s[8:11],s57 offen
buffer_store_dwordx4 v[148:151],v234,s[8:11],s57 offen offset:512
s_branch BS5_0e
BS5_0:
buffer_store_dwordx4 v[144:147],v234,s[8:11],s57 offen sc1
buffer_store_dwordx4 v[148:151],v234,s[8:11],s57 offen offset:512 sc1
BS5_0e:
v_cvt_pk_bf16_f32 v152, v48, v49
v_cvt_pk_bf16_f32 v154, v50, v51
v_cvt_pk_bf16_f32 v153, v52, v53
v_cvt_pk_bf16_f32 v155, v54, v55
v_cvt_pk_bf16_f32 v156, v56, v57
v_cvt_pk_bf16_f32 v158, v58, v59
v_cvt_pk_bf16_f32 v157, v60, v61
v_cvt_pk_bf16_f32 v159, v62, v63
s_add_u32 s57, s67, 3660800
s_cmp_eq_u32 s69, 0
s_cbranch_scc1 BS5_1
buffer_store_dwordx4 v[152:155],v234,s[8:11],s57 offen
buffer_store_dwordx4 v[156:159],v234,s[8:11],s57 offen offset:512
s_branch BS5_1e
BS5_1:
buffer_store_dwordx4 v[152:155],v234,s[8:11],s57 offen sc1
buffer_store_dwordx4 v[156:159],v234,s[8:11],s57 offen offset:512 sc1
BS5_1e:
ds_read_b64_tr_b16 v[220:221],v227 offset:40448
ds_read_b64_tr_b16 v[222:223],v227 offset:46592
s_waitcnt lgkmcnt(12)
v_mfma_f32_32x32x16_bf16 v[16:31],v[112:115],v[196:199],v[16:31]
ds_read_b64_tr_b16 v[192:193],v227 offset:28672
ds_read_b64_tr_b16 v[194:195],v227 offset:34816
s_waitcnt lgkmcnt(12)
v_mfma_f32_32x32x16_bf16 v[0:15],v[116:119],v[200:203],v[0:15]
ds_read_b64_tr_b16 v[196:197],v227 offset:29184
ds_read_b64_tr_b16 v[198:199],v227 offset:35328
s_waitcnt lgkmcnt(12)
v_mfma_f32_32x32x16_bf16 v[16:31],v[116:119],v[204:207],v[16:31]
ds_read_b64_tr_b16 v[200:201],v227 offset:40960
ds_read_b64_tr_b16 v[202:203],v227 offset:47104
s_waitcnt lgkmcnt(12)
v_mfma_f32_32x32x16_bf16 v[0:15],v[120:123],v[208:211],v[0:15]
ds_read_b64_tr_b16 v[204:205],v227 offset:41472
ds_read_b64_tr_b16 v[206:207],v227 offset:47616
s_waitcnt lgkmcnt(12)
v_mfma_f32_32x32x16_bf16 v[16:31],v[120:123],v[212:215],v[16:31]
ds_read_b64_tr_b16 v[208:209],v227 offset:29696
ds_read_b64_tr_b16 v[210:211],v227 offset:35840
s_waitcnt lgkmcnt(12)
v_mfma_f32_32x32x16_bf16 v[0:15],v[124:127],v[216:219],v[0:15]
ds_read_b64_tr_b16 v[212:213],v227 offset:30208
ds_read_b64_tr_b16 v[214:215],v227 offset:36352
s_waitcnt lgkmcnt(12)
v_mfma_f32_32x32x16_bf16 v[16:31],v[124:127],v[220:223],v[16:31]
ds_read_b64_tr_b16 v[216:217],v227 offset:41984
ds_read_b64_tr_b16 v[218:219],v227 offset:48128
s_waitcnt lgkmcnt(12)
v_mfma_f32_32x32x16_bf16 v[0:15],v[128:131],v[192:195],v[0:15]
ds_read_b64_tr_b16 v[220:221],v227 offset:42496
ds_read_b64_tr_b16 v[222:223],v227 offset:48640
s_waitcnt lgkmcnt(12)
v_mfma_f32_32x32x16_bf16 v[16:31],v[128:131],v[196:199],v[16:31]
s_waitcnt vmcnt(24)
s_barrier
ds_read_b64_tr_b16 v[192:193],v228 offset:0
ds_read_b64_tr_b16 v[194:195],v228 offset:6144
s_waitcnt lgkmcnt(12)
v_mfma_f32_32x32x16_bf16 v[0:15],v[132:135],v[200:203],v[0:15]
ds_read_b64_tr_b16 v[196:197],v228 offset:512
ds_read_b64_tr_b16 v[198:199],v228 offset:6656
s_waitcnt lgkmcnt(12)
v_mfma_f32_32x32x16_bf16 v[16:31],v[132:135],v[204:207],v[16:31]
ds_read_b64_tr_b16 v[200:201],v228 offset:12288
ds_read_b64_tr_b16 v[202:203],v228 offset:18432
s_waitcnt lgkmcnt(12)
v_mfma_f32_32x32x16_bf16 v[0:15],v[136:139],v[208:211],v[0:15]
ds_read_b64_tr_b16 v[204:205],v228 offset:12800
ds_read_b64_tr_b16 v[206:207],v228 offset:18944
s_waitcnt lgkmcnt(12)
v_mfma_f32_32x32x16_bf16 v[16:31],v[136:139],v[212:215],v[16:31]
ds_read_b64_tr_b16 v[208:209],v228 offset:1024
ds_read_b64_tr_b16 v[210:211],v228 offset:7168
s_waitcnt lgkmcnt(12)
v_mfma_f32_32x32x16_bf16 v[0:15],v[140:143],v[216:219],v[0:15]
ds_read_b64_tr_b16 v[212:213],v228 offset:1536
ds_read_b64_tr_b16 v[214:215],v228 offset:7680
s_waitcnt lgkmcnt(12)
v_mfma_f32_32x32x16_bf16 v[16:31],v[140:143],v[220:223],v[16:31]
ds_read_b64_tr_b16 v[216:217],v228 offset:13312
ds_read_b64_tr_b16 v[218:219],v228 offset:19456
s_waitcnt lgkmcnt(12)
v_mfma_f32_32x32x16_bf16 v[32:47],v[96:99],v[192:195],0
ds_read_b64_tr_b16 v[220:221],v228 offset:13824
ds_read_b64_tr_b16 v[222:223],v228 offset:19968
s_waitcnt lgkmcnt(12)
v_mfma_f32_32x32x16_bf16 v[48:63],v[96:99],v[196:199],0
ds_read_b64_tr_b16 v[192:193],v228 offset:2048
ds_read_b64_tr_b16 v[194:195],v228 offset:8192
s_waitcnt lgkmcnt(12)
v_mfma_f32_32x32x16_bf16 v[32:47],v[100:103],v[200:203],v[32:47]
ds_read_b64_tr_b16 v[196:197],v228 offset:2560
ds_read_b64_tr_b16 v[198:199],v228 offset:8704
s_waitcnt lgkmcnt(12)
v_mfma_f32_32x32x16_bf16 v[48:63],v[100:103],v[204:207],v[48:63]
ds_read_b64_tr_b16 v[200:201],v228 offset:14336
ds_read_b64_tr_b16 v[202:203],v228 offset:20480
s_waitcnt lgkmcnt(12)
v_mfma_f32_32x32x16_bf16 v[32:47],v[104:107],v[208:211],v[32:47]
ds_read_b64_tr_b16 v[204:205],v228 offset:14848
ds_read_b64_tr_b16 v[206:207],v228 offset:20992
s_waitcnt lgkmcnt(12)
v_mfma_f32_32x32x16_bf16 v[48:63],v[104:107],v[212:215],v[48:63]
ds_read_b64_tr_b16 v[208:209],v228 offset:3072
ds_read_b64_tr_b16 v[210:211],v228 offset:9216
s_waitcnt lgkmcnt(12)
v_mfma_f32_32x32x16_bf16 v[32:47],v[108:111],v[216:219],v[32:47]
ds_read_b64_tr_b16 v[212:213],v228 offset:3584
ds_read_b64_tr_b16 v[214:215],v228 offset:9728
s_waitcnt lgkmcnt(12)
v_mfma_f32_32x32x16_bf16 v[48:63],v[108:111],v[220:223],v[48:63]
ds_read_b64_tr_b16 v[216:217],v228 offset:15360
ds_read_b64_tr_b16 v[218:219],v228 offset:21504
s_waitcnt lgkmcnt(12)
v_mfma_f32_32x32x16_bf16 v[32:47],v[112:115],v[192:195],v[32:47]
v_cvt_pk_bf16_f32 v144, v0, v1
v_cvt_pk_bf16_f32 v146, v2, v3
v_cvt_pk_bf16_f32 v145, v4, v5
v_cvt_pk_bf16_f32 v147, v6, v7
v_cvt_pk_bf16_f32 v148, v8, v9
v_cvt_pk_bf16_f32 v150, v10, v11
v_cvt_pk_bf16_f32 v149, v12, v13
v_cvt_pk_bf16_f32 v151, v14, v15
s_add_u32 s57, s67, 3993600
s_cmp_eq_u32 s69, 0
s_cbranch_scc1 BS6_0
buffer_store_dwordx4 v[144:147],v234,s[8:11],s57 offen
buffer_store_dwordx4 v[148:151],v234,s[8:11],s57 offen offset:512
s_branch BS6_0e
BS6_0:
buffer_store_dwordx4 v[144:147],v234,s[8:11],s57 offen sc1
buffer_store_dwordx4 v[148:151],v234,s[8:11],s57 offen offset:512 sc1
BS6_0e:
v_cvt_pk_bf16_f32 v152, v16, v17
v_cvt_pk_bf16_f32 v154, v18, v19
v_cvt_pk_bf16_f32 v153, v20, v21
v_cvt_pk_bf16_f32 v155, v22, v23
v_cvt_pk_bf16_f32 v156, v24, v25
v_cvt_pk_bf16_f32 v158, v26, v27
v_cvt_pk_bf16_f32 v157, v28, v29
v_cvt_pk_bf16_f32 v159, v30, v31
s_add_u32 s57, s67, 4326400
s_cmp_eq_u32 s69, 0
s_cbranch_scc1 BS6_1
buffer_store_dwordx4 v[152:155],v234,s[8:11],s57 offen
buffer_store_dwordx4 v[156:159],v234,s[8:11],s57 offen offset:512
s_branch BS6_1e
BS6_1:
buffer_store_dwordx4 v[152:155],v234,s[8:11],s57 offen sc1
buffer_store_dwordx4 v[156:159],v234,s[8:11],s57 offen offset:512 sc1
BS6_1e:
ds_read_b64_tr_b16 v[220:221],v228 offset:15872
ds_read_b64_tr_b16 v[222:223],v228 offset:22016
s_waitcnt lgkmcnt(12)
v_mfma_f32_32x32x16_bf16 v[48:63],v[112:115],v[196:199],v[48:63]
ds_read_b64_tr_b16 v[192:193],v228 offset:4096
ds_read_b64_tr_b16 v[194:195],v228 offset:10240
s_waitcnt lgkmcnt(12)
v_mfma_f32_32x32x16_bf16 v[32:47],v[116:119],v[200:203],v[32:47]
ds_read_b64_tr_b16 v[196:197],v228 offset:4608
ds_read_b64_tr_b16 v[198:199],v228 offset:10752
s_waitcnt lgkmcnt(12)
v_mfma_f32_32x32x16_bf16 v[48:63],v[116:119],v[204:207],v[48:63]
ds_read_b64_tr_b16 v[200:201],v228 offset:16384
ds_read_b64_tr_b16 v[202:203],v228 offset:22528
s_waitcnt lgkmcnt(12)
v_mfma_f32_32x32x16_bf16 v[32:47],v[120:123],v[208:211],v[32:47]
ds_read_b64_tr_b16 v[204:205],v228 offset:16896
ds_read_b64_tr_b16 v[206:207],v228 offset:23040
s_waitcnt lgkmcnt(12)
v_mfma_f32_32x32x16_bf16 v[48:63],v[120:123],v[212:215],v[48:63]
ds_read_b64_tr_b16 v[208:209],v228 offset:5120
ds_read_b64_tr_b16 v[210:211],v228 offset:11264
s_waitcnt lgkmcnt(12)
v_mfma_f32_32x32x16_bf16 v[32:47],v[124:127],v[216:219],v[32:47]
ds_read_b64_tr_b16 v[212:213],v228 offset:5632
ds_read_b64_tr_b16 v[214:215],v228 offset:11776
s_waitcnt lgkmcnt(12)
v_mfma_f32_32x32x16_bf16 v[48:63],v[124:127],v[220:223],v[48:63]
ds_read_b64_tr_b16 v[216:217],v228 offset:17408
ds_read_b64_tr_b16 v[218:219],v228 offset:23552
s_waitcnt lgkmcnt(12)
v_mfma_f32_32x32x16_bf16 v[32:47],v[128:131],v[192:195],v[32:47]
ds_read_b64_tr_b16 v[220:221],v228 offset:17920
ds_read_b64_tr_b16 v[222:223],v228 offset:24064
s_waitcnt lgkmcnt(12)
v_mfma_f32_32x32x16_bf16 v[48:63],v[128:131],v[196:199],v[48:63]
s_waitcnt vmcnt(18)
s_barrier
ds_read_b64_tr_b16 v[192:193],v228 offset:24576
ds_read_b64_tr_b16 v[194:195],v228 offset:30720
s_waitcnt lgkmcnt(12)
v_mfma_f32_32x32x16_bf16 v[32:47],v[132:135],v[200:203],v[32:47]
ds_read_b64_tr_b16 v[196:197],v228 offset:25088
ds_read_b64_tr_b16 v[198:199],v228 offset:31232
s_waitcnt lgkmcnt(12)
v_mfma_f32_32x32x16_bf16 v[48:63],v[132:135],v[204:207],v[48:63]
ds_read_b64_tr_b16 v[200:201],v228 offset:36864
ds_read_b64_tr_b16 v[202:203],v228 offset:43008
s_waitcnt lgkmcnt(12)
v_mfma_f32_32x32x16_bf16 v[32:47],v[136:139],v[208:211],v[32:47]
ds_read_b64_tr_b16 v[204:205],v228 offset:37376
ds_read_b64_tr_b16 v[206:207],v228 offset:43520
s_waitcnt lgkmcnt(12)
v_mfma_f32_32x32x16_bf16 v[48:63],v[136:139],v[212:215],v[48:63]
ds_read_b64_tr_b16 v[208:209],v228 offset:25600
ds_read_b64_tr_b16 v[210:211],v228 offset:31744
s_waitcnt lgkmcnt(12)
v_mfma_f32_32x32x16_bf16 v[32:47],v[140:143],v[216:219],v[32:47]
ds_read_b64_tr_b16 v[212:213],v228 offset:26112
ds_read_b64_tr_b16 v[214:215],v228 offset:32256
s_waitcnt lgkmcnt(12)
v_mfma_f32_32x32x16_bf16 v[48:63],v[140:143],v[220:223],v[48:63]
ds_read_b64_tr_b16 v[216:217],v228 offset:37888
ds_read_b64_tr_b16 v[218:219],v228 offset:44032
s_waitcnt lgkmcnt(12)
v_mfma_f32_32x32x16_bf16 v[0:15],v[96:99],v[192:195],0
ds_read_b64_tr_b16 v[220:221],v228 offset:38400
ds_read_b64_tr_b16 v[222:223],v228 offset:44544
s_waitcnt lgkmcnt(12)
v_mfma_f32_32x32x16_bf16 v[16:31],v[96:99],v[196:199],0
ds_read_b64_tr_b16 v[192:193],v228 offset:26624
ds_read_b64_tr_b16 v[194:195],v228 offset:32768
s_waitcnt lgkmcnt(12)
v_mfma_f32_32x32x16_bf16 v[0:15],v[100:103],v[200:203],v[0:15]
ds_read_b64_tr_b16 v[196:197],v228 offset:27136
ds_read_b64_tr_b16 v[198:199],v228 offset:33280
s_waitcnt lgkmcnt(12)
v_mfma_f32_32x32x16_bf16 v[16:31],v[100:103],v[204:207],v[16:31]
ds_read_b64_tr_b16 v[200:201],v228 offset:38912
ds_read_b64_tr_b16 v[202:203],v228 offset:45056
s_waitcnt lgkmcnt(12)
v_mfma_f32_32x32x16_bf16 v[0:15],v[104:107],v[208:211],v[0:15]
ds_read_b64_tr_b16 v[204:205],v228 offset:39424
ds_read_b64_tr_b16 v[206:207],v228 offset:45568
s_waitcnt lgkmcnt(12)
v_mfma_f32_32x32x16_bf16 v[16:31],v[104:107],v[212:215],v[16:31]
ds_read_b64_tr_b16 v[208:209],v228 offset:27648
ds_read_b64_tr_b16 v[210:211],v228 offset:33792
s_waitcnt lgkmcnt(12)
v_mfma_f32_32x32x16_bf16 v[0:15],v[108:111],v[216:219],v[0:15]
ds_read_b64_tr_b16 v[212:213],v228 offset:28160
ds_read_b64_tr_b16 v[214:215],v228 offset:34304
s_waitcnt lgkmcnt(12)
v_mfma_f32_32x32x16_bf16 v[16:31],v[108:111],v[220:223],v[16:31]
ds_read_b64_tr_b16 v[216:217],v228 offset:39936
ds_read_b64_tr_b16 v[218:219],v228 offset:46080
s_waitcnt lgkmcnt(12)
v_mfma_f32_32x32x16_bf16 v[0:15],v[112:115],v[192:195],v[0:15]
v_cvt_pk_bf16_f32 v144, v32, v33
v_cvt_pk_bf16_f32 v146, v34, v35
v_cvt_pk_bf16_f32 v145, v36, v37
v_cvt_pk_bf16_f32 v147, v38, v39
v_cvt_pk_bf16_f32 v148, v40, v41
v_cvt_pk_bf16_f32 v150, v42, v43
v_cvt_pk_bf16_f32 v149, v44, v45
v_cvt_pk_bf16_f32 v151, v46, v47
s_add_u32 s57, s67, 4659200
s_cmp_eq_u32 s69, 0
s_cbranch_scc1 BS7_0
buffer_store_dwordx4 v[144:147],v234,s[8:11],s57 offen
buffer_store_dwordx4 v[148:151],v234,s[8:11],s57 offen offset:512
s_branch BS7_0e
BS7_0:
buffer_store_dwordx4 v[144:147],v234,s[8:11],s57 offen sc1
buffer_store_dwordx4 v[148:151],v234,s[8:11],s57 offen offset:512 sc1
BS7_0e:
v_cvt_pk_bf16_f32 v152, v48, v49
v_cvt_pk_bf16_f32 v154, v50, v51
v_cvt_pk_bf16_f32 v153, v52, v53
v_cvt_pk_bf16_f32 v155, v54, v55
v_cvt_pk_bf16_f32 v156, v56, v57
v_cvt_pk_bf16_f32 v158, v58, v59
v_cvt_pk_bf16_f32 v157, v60, v61
v_cvt_pk_bf16_f32 v159, v62, v63
s_add_u32 s57, s67, 4992000
s_cmp_eq_u32 s69, 0
s_cbranch_scc1 BS7_1
buffer_store_dwordx4 v[152:155],v234,s[8:11],s57 offen
buffer_store_dwordx4 v[156:159],v234,s[8:11],s57 offen offset:512
s_branch BS7_1e
BS7_1:
buffer_store_dwordx4 v[152:155],v234,s[8:11],s57 offen sc1
buffer_store_dwordx4 v[156:159],v234,s[8:11],s57 offen offset:512 sc1
BS7_1e:
ds_read_b64_tr_b16 v[220:221],v228 offset:40448
ds_read_b64_tr_b16 v[222:223],v228 offset:46592
s_waitcnt lgkmcnt(12)
v_mfma_f32_32x32x16_bf16 v[16:31],v[112:115],v[196:199],v[16:31]
ds_read_b64_tr_b16 v[192:193],v228 offset:28672
ds_read_b64_tr_b16 v[194:195],v228 offset:34816
s_waitcnt lgkmcnt(12)
v_mfma_f32_32x32x16_bf16 v[0:15],v[116:119],v[200:203],v[0:15]
ds_read_b64_tr_b16 v[196:197],v228 offset:29184
ds_read_b64_tr_b16 v[198:199],v228 offset:35328
s_waitcnt lgkmcnt(12)
v_mfma_f32_32x32x16_bf16 v[16:31],v[116:119],v[204:207],v[16:31]
ds_read_b64_tr_b16 v[200:201],v228 offset:40960
ds_read_b64_tr_b16 v[202:203],v228 offset:47104
s_waitcnt lgkmcnt(12)
v_mfma_f32_32x32x16_bf16 v[0:15],v[120:123],v[208:211],v[0:15]
ds_read_b64_tr_b16 v[204:205],v228 offset:41472
ds_read_b64_tr_b16 v[206:207],v228 offset:47616
s_waitcnt lgkmcnt(12)
v_mfma_f32_32x32x16_bf16 v[16:31],v[120:123],v[212:215],v[16:31]
ds_read_b64_tr_b16 v[208:209],v228 offset:29696
ds_read_b64_tr_b16 v[210:211],v228 offset:35840
s_waitcnt lgkmcnt(12)
v_mfma_f32_32x32x16_bf16 v[0:15],v[124:127],v[216:219],v[0:15]
ds_read_b64_tr_b16 v[212:213],v228 offset:30208
ds_read_b64_tr_b16 v[214:215],v228 offset:36352
s_waitcnt lgkmcnt(12)
v_mfma_f32_32x32x16_bf16 v[16:31],v[124:127],v[220:223],v[16:31]
ds_read_b64_tr_b16 v[216:217],v228 offset:41984
ds_read_b64_tr_b16 v[218:219],v228 offset:48128
s_waitcnt lgkmcnt(12)
v_mfma_f32_32x32x16_bf16 v[0:15],v[128:131],v[192:195],v[0:15]
ds_read_b64_tr_b16 v[220:221],v228 offset:42496
ds_read_b64_tr_b16 v[222:223],v228 offset:48640
s_waitcnt lgkmcnt(12)
v_mfma_f32_32x32x16_bf16 v[16:31],v[128:131],v[196:199],v[16:31]
s_waitcnt vmcnt(12)
s_barrier
ds_read_b64_tr_b16 v[192:193],v229 offset:0
ds_read_b64_tr_b16 v[194:195],v229 offset:6144
s_waitcnt lgkmcnt(12)
v_mfma_f32_32x32x16_bf16 v[0:15],v[132:135],v[200:203],v[0:15]
ds_read_b64_tr_b16 v[196:197],v229 offset:512
ds_read_b64_tr_b16 v[198:199],v229 offset:6656
s_waitcnt lgkmcnt(12)
v_mfma_f32_32x32x16_bf16 v[16:31],v[132:135],v[204:207],v[16:31]
ds_read_b64_tr_b16 v[200:201],v229 offset:12288
ds_read_b64_tr_b16 v[202:203],v229 offset:18432
s_waitcnt lgkmcnt(12)
v_mfma_f32_32x32x16_bf16 v[0:15],v[136:139],v[208:211],v[0:15]
ds_read_b64_tr_b16 v[204:205],v229 offset:12800
ds_read_b64_tr_b16 v[206:207],v229 offset:18944
s_waitcnt lgkmcnt(12)
v_mfma_f32_32x32x16_bf16 v[16:31],v[136:139],v[212:215],v[16:31]
ds_read_b64_tr_b16 v[208:209],v229 offset:1024
ds_read_b64_tr_b16 v[210:211],v229 offset:7168
s_waitcnt lgkmcnt(12)
v_mfma_f32_32x32x16_bf16 v[0:15],v[140:143],v[216:219],v[0:15]
ds_read_b64_tr_b16 v[212:213],v229 offset:1536
ds_read_b64_tr_b16 v[214:215],v229 offset:7680
s_waitcnt lgkmcnt(12)
v_mfma_f32_32x32x16_bf16 v[16:31],v[140:143],v[220:223],v[16:31]
ds_read_b64_tr_b16 v[216:217],v229 offset:13312
ds_read_b64_tr_b16 v[218:219],v229 offset:19456
s_waitcnt lgkmcnt(12)
v_mfma_f32_32x32x16_bf16 v[32:47],v[96:99],v[192:195],0
ds_read_b64_tr_b16 v[220:221],v229 offset:13824
ds_read_b64_tr_b16 v[222:223],v229 offset:19968
s_waitcnt lgkmcnt(12)
v_mfma_f32_32x32x16_bf16 v[48:63],v[96:99],v[196:199],0
ds_read_b64_tr_b16 v[192:193],v229 offset:2048
ds_read_b64_tr_b16 v[194:195],v229 offset:8192
s_waitcnt lgkmcnt(12)
v_mfma_f32_32x32x16_bf16 v[32:47],v[100:103],v[200:203],v[32:47]
ds_read_b64_tr_b16 v[196:197],v229 offset:2560
ds_read_b64_tr_b16 v[198:199],v229 offset:8704
s_waitcnt lgkmcnt(12)
v_mfma_f32_32x32x16_bf16 v[48:63],v[100:103],v[204:207],v[48:63]
ds_read_b64_tr_b16 v[200:201],v229 offset:14336
ds_read_b64_tr_b16 v[202:203],v229 offset:20480
s_waitcnt lgkmcnt(12)
v_mfma_f32_32x32x16_bf16 v[32:47],v[104:107],v[208:211],v[32:47]
ds_read_b64_tr_b16 v[204:205],v229 offset:14848
ds_read_b64_tr_b16 v[206:207],v229 offset:20992
s_waitcnt lgkmcnt(12)
v_mfma_f32_32x32x16_bf16 v[48:63],v[104:107],v[212:215],v[48:63]
ds_read_b64_tr_b16 v[208:209],v229 offset:3072
ds_read_b64_tr_b16 v[210:211],v229 offset:9216
s_waitcnt lgkmcnt(12)
v_mfma_f32_32x32x16_bf16 v[32:47],v[108:111],v[216:219],v[32:47]
ds_read_b64_tr_b16 v[212:213],v229 offset:3584
ds_read_b64_tr_b16 v[214:215],v229 offset:9728
s_waitcnt lgkmcnt(12)
v_mfma_f32_32x32x16_bf16 v[48:63],v[108:111],v[220:223],v[48:63]
ds_read_b64_tr_b16 v[216:217],v229 offset:15360
ds_read_b64_tr_b16 v[218:219],v229 offset:21504
s_waitcnt lgkmcnt(12)
v_mfma_f32_32x32x16_bf16 v[32:47],v[112:115],v[192:195],v[32:47]
v_cvt_pk_bf16_f32 v144, v0, v1
v_cvt_pk_bf16_f32 v146, v2, v3
v_cvt_pk_bf16_f32 v145, v4, v5
v_cvt_pk_bf16_f32 v147, v6, v7
v_cvt_pk_bf16_f32 v148, v8, v9
v_cvt_pk_bf16_f32 v150, v10, v11
v_cvt_pk_bf16_f32 v149, v12, v13
v_cvt_pk_bf16_f32 v151, v14, v15
s_add_u32 s57, s67, 5324800
s_cmp_eq_u32 s69, 0
s_cbranch_scc1 BS8_0
buffer_store_dwordx4 v[144:147],v234,s[8:11],s57 offen
buffer_store_dwordx4 v[148:151],v234,s[8:11],s57 offen offset:512
s_branch BS8_0e
BS8_0:
buffer_store_dwordx4 v[144:147],v234,s[8:11],s57 offen sc1
buffer_store_dwordx4 v[148:151],v234,s[8:11],s57 offen offset:512 sc1
BS8_0e:
v_cvt_pk_bf16_f32 v152, v16, v17
v_cvt_pk_bf16_f32 v154, v18, v19
v_cvt_pk_bf16_f32 v153, v20, v21
v_cvt_pk_bf16_f32 v155, v22, v23
v_cvt_pk_bf16_f32 v156, v24, v25
v_cvt_pk_bf16_f32 v158, v26, v27
v_cvt_pk_bf16_f32 v157, v28, v29
v_cvt_pk_bf16_f32 v159, v30, v31
s_add_u32 s57, s67, 5657600
s_cmp_eq_u32 s69, 0
s_cbranch_scc1 BS8_1
buffer_store_dwordx4 v[152:155],v234,s[8:11],s57 offen
buffer_store_dwordx4 v[156:159],v234,s[8:11],s57 offen offset:512
s_branch BS8_1e
BS8_1:
buffer_store_dwordx4 v[152:155],v234,s[8:11],s57 offen sc1
buffer_store_dwordx4 v[156:159],v234,s[8:11],s57 offen offset:512 sc1
BS8_1e:
ds_read_b64_tr_b16 v[220:221],v229 offset:15872
ds_read_b64_tr_b16 v[222:223],v229 offset:22016
s_waitcnt lgkmcnt(12)
v_mfma_f32_32x32x16_bf16 v[48:63],v[112:115],v[196:199],v[48:63]
ds_read_b64_tr_b16 v[192:193],v229 offset:4096
ds_read_b64_tr_b16 v[194:195],v229 offset:10240
s_waitcnt lgkmcnt(12)
v_mfma_f32_32x32x16_bf16 v[32:47],v[116:119],v[200:203],v[32:47]
ds_read_b64_tr_b16 v[196:197],v229 offset:4608
ds_read_b64_tr_b16 v[198:199],v229 offset:10752
s_waitcnt lgkmcnt(12)
v_mfma_f32_32x32x16_bf16 v[48:63],v[116:119],v[204:207],v[48:63]
ds_read_b64_tr_b16 v[200:201],v229 offset:16384
ds_read_b64_tr_b16 v[202:203],v229 offset:22528
s_waitcnt lgkmcnt(12)
v_mfma_f32_32x32x16_bf16 v[32:47],v[120:123],v[208:211],v[32:47]
ds_read_b64_tr_b16 v[204:205],v229 offset:16896
ds_read_b64_tr_b16 v[206:207],v229 offset:23040
s_waitcnt lgkmcnt(12)
v_mfma_f32_32x32x16_bf16 v[48:63],v[120:123],v[212:215],v[48:63]
ds_read_b64_tr_b16 v[208:209],v229 offset:5120
ds_read_b64_tr_b16 v[210:211],v229 offset:11264
s_waitcnt lgkmcnt(12)
v_mfma_f32_32x32x16_bf16 v[32:47],v[124:127],v[216:219],v[32:47]
ds_read_b64_tr_b16 v[212:213],v229 offset:5632
ds_read_b64_tr_b16 v[214:215],v229 offset:11776
s_waitcnt lgkmcnt(12)
v_mfma_f32_32x32x16_bf16 v[48:63],v[124:127],v[220:223],v[48:63]
ds_read_b64_tr_b16 v[216:217],v229 offset:17408
ds_read_b64_tr_b16 v[218:219],v229 offset:23552
s_waitcnt lgkmcnt(12)
v_mfma_f32_32x32x16_bf16 v[32:47],v[128:131],v[192:195],v[32:47]
ds_read_b64_tr_b16 v[220:221],v229 offset:17920
ds_read_b64_tr_b16 v[222:223],v229 offset:24064
s_waitcnt lgkmcnt(12)
v_mfma_f32_32x32x16_bf16 v[48:63],v[128:131],v[196:199],v[48:63]
s_waitcnt lgkmcnt(10)
v_mfma_f32_32x32x16_bf16 v[32:47],v[132:135],v[200:203],v[32:47]
s_waitcnt lgkmcnt(8)
v_mfma_f32_32x32x16_bf16 v[48:63],v[132:135],v[204:207],v[48:63]
s_waitcnt lgkmcnt(6)
v_mfma_f32_32x32x16_bf16 v[32:47],v[136:139],v[208:211],v[32:47]
s_waitcnt lgkmcnt(4)
v_mfma_f32_32x32x16_bf16 v[48:63],v[136:139],v[212:215],v[48:63]
s_waitcnt lgkmcnt(2)
v_mfma_f32_32x32x16_bf16 v[32:47],v[140:143],v[216:219],v[32:47]
s_waitcnt lgkmcnt(0)
v_mfma_f32_32x32x16_bf16 v[48:63],v[140:143],v[220:223],v[48:63]
s_nop 11
v_cvt_pk_bf16_f32 v144, v32, v33
v_cvt_pk_bf16_f32 v146, v34, v35
v_cvt_pk_bf16_f32 v145, v36, v37
v_cvt_pk_bf16_f32 v147, v38, v39
v_cvt_pk_bf16_f32 v148, v40, v41
v_cvt_pk_bf16_f32 v150, v42, v43
v_cvt_pk_bf16_f32 v149, v44, v45
v_cvt_pk_bf16_f32 v151, v46, v47
s_add_u32 s57, s67, 5990400
s_cmp_eq_u32 s69, 0
s_cbranch_scc1 BS9_0
buffer_store_dwordx4 v[144:147],v234,s[8:11],s57 offen
buffer_store_dwordx4 v[148:151],v234,s[8:11],s57 offen offset:512
s_branch BS9_0e
BS9_0:
buffer_store_dwordx4 v[144:147],v234,s[8:11],s57 offen sc1
buffer_store_dwordx4 v[148:151],v234,s[8:11],s57 offen offset:512 sc1
BS9_0e:
v_cvt_pk_bf16_f32 v152, v48, v49
v_cvt_pk_bf16_f32 v154, v50, v51
v_cvt_pk_bf16_f32 v153, v52, v53
v_cvt_pk_bf16_f32 v155, v54, v55
v_cvt_pk_bf16_f32 v156, v56, v57
v_cvt_pk_bf16_f32 v158, v58, v59
v_cvt_pk_bf16_f32 v157, v60, v61
v_cvt_pk_bf16_f32 v159, v62, v63
s_add_u32 s57, s67, 6323200
s_cmp_eq_u32 s69, 0
s_cbranch_scc1 BS9_1
buffer_store_dwordx4 v[152:155],v234,s[8:11],s57 offen
buffer_store_dwordx4 v[156:159],v234,s[8:11],s57 offen offset:512
s_branch BS9_1e
BS9_1:
buffer_store_dwordx4 v[152:155],v234,s[8:11],s57 offen sc1
buffer_store_dwordx4 v[156:159],v234,s[8:11],s57 offen offset:512 sc1
BS9_1e:
s_waitcnt vmcnt(0)
s_barrier
buffer_atomic_add v239,v238,s[8:11],s92 offen sc1
s_cmp_lt_u32 s6, 24
s_cbranch_scc1 BT6
s_add_u32 s61, s56, 8
s_mul_i32 s61, s61, 40960
s_add_u32 s61, s61, 236535808
s_add_u32 s57, s61, 0
buffer_load_dwordx4 a[0:3],v233,s[8:11],s57 offen
buffer_load_dwordx4 a[4:7],v233,s[8:11],s57 offen offset:1024
buffer_load_dwordx4 a[8:11],v233,s[8:11],s57 offen offset:2048
buffer_load_dwordx4 a[12:15],v233,s[8:11],s57 offen offset:3072
s_add_u32 s57, s61, 4096
buffer_load_dwordx4 a[16:19],v233,s[8:11],s57 offen
buffer_load_dwordx4 a[20:23],v233,s[8:11],s57 offen offset:1024
buffer_load_dwordx4 a[24:27],v233,s[8:11],s57 offen offset:2048
buffer_load_dwordx4 a[28:31],v233,s[8:11],s57 offen offset:3072
s_add_u32 s57, s61, 8192
buffer_load_dwordx4 a[32:35],v233,s[8:11],s57 offen
buffer_load_dwordx4 a[36:39],v233,s[8:11],s57 offen offset:1024
buffer_load_dwordx4 a[40:43],v233,s[8:11],s57 offen offset:2048
buffer_load_dwordx4 a[44:47],v233,s[8:11],s57 offen offset:3072
s_add_u32 s57, s61, 12288
buffer_load_dwordx4 a[48:51],v233,s[8:11],s57 offen
buffer_load_dwordx4 a[52:55],v233,s[8:11],s57 offen offset:1024
buffer_load_dwordx4 a[56:59],v233,s[8:11],s57 offen offset:2048
buffer_load_dwordx4 a[60:63],v233,s[8:11],s57 offen offset:3072
s_add_u32 s57, s61, 16384
buffer_load_dwordx4 a[64:67],v233,s[8:11],s57 offen
buffer_load_dwordx4 a[68:71],v233,s[8:11],s57 offen offset:1024
buffer_load_dwordx4 a[72:75],v233,s[8:11],s57 offen offset:2048
buffer_load_dwordx4 a[76:79],v233,s[8:11],s57 offen offset:3072
s_add_u32 s57, s61, 20480
buffer_load_dwordx4 a[80:83],v233,s[8:11],s57 offen
buffer_load_dwordx4 a[84:87],v233,s[8:11],s57 offen offset:1024
buffer_load_dwordx4 a[88:91],v233,s[8:11],s57 offen offset:2048
buffer_load_dwordx4 a[92:95],v233,s[8:11],s57 offen offset:3072
s_add_u32 s57, s61, 24576
buffer_load_dwordx4 a[96:99],v233,s[8:11],s57 offen
buffer_load_dwordx4 a[100:103],v233,s[8:11],s57 offen offset:1024
buffer_load_dwordx4 a[104:107],v233,s[8:11],s57 offen offset:2048
buffer_load_dwordx4 a[108:111],v233,s[8:11],s57 offen offset:3072
s_add_u32 s57, s61, 28672
buffer_load_dwordx4 a[112:115],v233,s[8:11],s57 offen
buffer_load_dwordx4 a[116:119],v233,s[8:11],s57 offen offset:1024
buffer_load_dwordx4 a[120:123],v233,s[8:11],s57 offen offset:2048
buffer_load_dwordx4 a[124:127],v233,s[8:11],s57 offen offset:3072
s_add_u32 s57, s61, 32768
buffer_load_dwordx4 a[128:131],v233,s[8:11],s57 offen
buffer_load_dwordx4 a[132:135],v233,s[8:11],s57 offen offset:1024
buffer_load_dwordx4 a[136:139],v233,s[8:11],s57 offen offset:2048
buffer_load_dwordx4 a[140:143],v233,s[8:11],s57 offen offset:3072
s_add_u32 s57, s61, 36864
buffer_load_dwordx4 a[144:147],v233,s[8:11],s57 offen
buffer_load_dwordx4 a[148:151],v233,s[8:11],s57 offen offset:1024
buffer_load_dwordx4 a[152:155],v233,s[8:11],s57 offen offset:2048
buffer_load_dwordx4 a[156:159],v233,s[8:11],s57 offen offset:3072
BT6:
s_cmp_lt_u32 s6, 24
s_cbranch_scc0 WORK2
s_cmp_lt_u32 s5, 28
s_cbranch_scc0 SPARE
s_lshl_b32 s57, s56, 6
v_add_u32 v0, s57, v255
v_lshlrev_b32 v144, 4, v0
v_lshlrev_b32 v145, 3, v0
v_add_u32 v145, 8192, v145
v_add_u32 v146, 0, v144
v_add_u32 v147, 0, v145
v_and_b32 v148, 63, v255
v_mul_u32_u24 v148, 16, v148
v_lshrrev_b32 v149, 3, v255
v_and_b32 v149, 1, v149
v_mul_u32_u24 v149, 43690, v149
v_add_u32 v149, 0x4444, v149
s_mul_i32 s6, s4, 10240
s_add_u32 s6, s6, 239165440
s_mov_b32 s70, 0
v_lshrrev_b32 v150, 3, v255
v_and_b32 v150, 1, v150
v_mul_u32_u24 v150, 640, v150
v_lshrrev_b32 v254, 4, v255
v_and_b32 v254, 3, v254
v_mul_u32_u24 v254, 128, v254
v_add_u32 v150, v254, v150
v_and_b32 v254, 7, v255
v_mul_u32_u24 v254, 16, v254
v_add_u32 v150, v254, v150
v_lshrrev_b32 v151, 5, v255
v_and_b32 v151, 1, v151
v_mul_u32_u24 v151, 1280, v151
v_lshrrev_b32 v254, 3, v255
v_and_b32 v254, 1, v254
v_mul_u32_u24 v254, 640, v254
v_add_u32 v151, v254, v151
v_and_b32 v254, 7, v255
v_mul_u32_u24 v254, 16, v254
v_add_u32 v151, v254, v151
v_lshrrev_b32 v254, 4, v255
v_and_b32 v254, 1, v254
v_mul_u32_u24 v254, 8, v254
v_add_u32 v151, v254, v151
v_add_u32 v151, 512, v151
v_lshrrev_b32 v152, 3, v255
v_and_b32 v152, 1, v152
v_mul_u32_u24 v152, 81920, v152
v_lshrrev_b32 v254, 4, v255
v_and_b32 v254, 3, v254
v_mul_u32_u24 v254, 64, v254
v_add_u32 v152, v254, v152
v_and_b32 v254, 7, v255
v_mul_u32_u24 v254, 8, v254
v_add_u32 v152, v254, v152
v_lshrrev_b32 v153, 3, v255
v_and_b32 v153, 1, v153
v_mul_u32_u24 v153, 512, v153
v_lshrrev_b32 v254, 4, v255
v_and_b32 v254, 3, v254
v_mul_u32_u24 v254, 64, v254
v_add_u32 v153, v254, v153
v_and_b32 v254, 7, v255
v_mul_u32_u24 v254, 8, v254
v_add_u32 v153, v254, v153
v_and_b32 v154, 7, v255
v_mul_u32_u24 v154, 16, v154
v_lshrrev_b32 v254, 4, v255
v_and_b32 v254, 1, v254
v_mul_u32_u24 v254, 8, v254
v_add_u32 v154, v254, v154
v_lshrrev_b32 v254, 5, v255
v_and_b32 v254, 1, v254
v_mul_u32_u24 v254, 4, v254
v_add_u32 v154, v254, v154
v_and_b32 v1, 8, v255
v_cmp_eq_u32 vcc, 0, v1
v_mov_b32 v1, 1073741824
v_lshlrev_b32 v155, 4, v255
v_cndmask_b32 v154, v1, v154, vcc
v_lshrrev_b32 v2, 3, v255
v_and_b32 v2, 1, v2
v_add_u32 v3, 2, v2
v_lshlrev_b32 v4, 1, v2
v_add_u32 v5, 1, v4
s_lshr_b32 s57, s4, 1
v_cmp_eq_u32 vcc, s4, v3
s_nop 1
v_cndmask_b32 v156, v152, v1, vcc
v_cmp_eq_u32 vcc, s4, v2
s_nop 1
v_cndmask_b32 v152, v152, v1, vcc
v_cmp_eq_u32 vcc, s4, v5
s_nop 1
v_cndmask_b32 v157, v153, v1, vcc
v_cmp_eq_u32 vcc, s4, v4
s_nop 1
v_cndmask_b32 v153, v153, v1, vcc
v_cmp_eq_u32 vcc, s57, v2
s_nop 1
v_cndmask_b32 v158, 0, -1, vcc
v_lshlrev_b32 v159, 4, v0
v_lshlrev_b32 v160, 2, v0
v_add_u32 v160, 4096, v160
s_sub_u32 s66, s5, 8
s_lshl_b32 s66, s66, 2
s_add_u32 s66, s66, s56
s_mul_i32 s57, s4, 5120
s_add_u32 s7, s57, 241827840
s_mul_i32 s100, s66, 20736
s_add_u32 s100, s100, s57
s_lshl_b32 s57, s66, 10
s_add_u32 s57, s57, 243138560
s_lshl_b32 s61, s4, 8
s_add_u32 s61, s61, s57
s_mul_i32 s59, s4, 81920
s_add_u32 s59, s59, s57
s_lshl_b32 s101, s66, 7
s_add_u32 s101, s101, 40960
s_mul_i32 s67, s4, 80
s_add_u32 s67, s67, s66
s_mul_i32 s67, s67, 83200
s_add_u32 s67, s67, 106168320
v_lshrrev_b32 v188, 3, v255
v_and_b32 v188, 1, v188
v_mul_u32_u24 v188, 2688, v188
v_lshrrev_b32 v254, 4, v255
v_and_b32 v254, 3, v254
v_mul_u32_u24 v254, 512, v254
v_add_u32 v188, v254, v188
v_and_b32 v254, 7, v255
v_mul_u32_u24 v254, 16, v254
v_add_u32 v188, v254, v188
v_add_u32 v188, 32768, v188
v_lshrrev_b32 v190, 5, v255
v_and_b32 v190, 1, v190
v_mul_u32_u24 v190, 5120, v190
v_lshrrev_b32 v254, 3, v255
v_and_b32 v254, 1, v254
v_mul_u32_u24 v254, 2688, v254
v_add_u32 v190, v254, v190
v_and_b32 v254, 7, v255
v_mul_u32_u24 v254, 16, v254
v_add_u32 v190, v254, v190
v_lshrrev_b32 v254, 4, v255
v_and_b32 v254, 1, v254
v_mul_u32_u24 v254, 8, v254
v_add_u32 v190, v254, v190
v_add_u32 v190, 34816, v190
v_lshrrev_b32 v189, 3, v255
v_and_b32 v189, 1, v189
v_mul_u32_u24 v189, 2432, v189
v_lshrrev_b32 v254, 4, v255
v_and_b32 v254, 3, v254
v_mul_u32_u24 v254, 512, v254
v_add_u32 v189, v254, v189
v_and_b32 v254, 7, v255
v_mul_u32_u24 v254, 16, v254
v_add_u32 v189, v254, v189
v_add_u32 v189, 32896, v189
v_lshrrev_b32 v191, 5, v255
v_and_b32 v191, 1, v191
v_mul_u32_u24 v191, 5120, v191
v_lshrrev_b32 v254, 3, v255
v_and_b32 v254, 1, v254
v_mul_u32_u24 v254, 2432, v254
v_add_u32 v191, v254, v191
v_and_b32 v254, 7, v255
v_mul_u32_u24 v254, 16, v254
v_add_u32 v191, v254, v191
v_lshrrev_b32 v254, 4, v255
v_and_b32 v254, 1, v254
v_mul_u32_u24 v254, 8, v254
v_add_u32 v191, v254, v191
v_add_u32 v191, 34944, v191
v_lshrrev_b32 v166, 4, v255
v_and_b32 v166, 1, v166
v_mul_u32_u24 v166, 512, v166
v_lshrrev_b32 v254, 3, v255
v_and_b32 v254, 1, v254
v_mul_u32_u24 v254, 128, v254
v_add_u32 v166, v254, v166
v_and_b32 v254, 7, v255
v_mul_u32_u24 v254, 16, v254
v_add_u32 v166, v254, v166
v_lshrrev_b32 v254, 5, v255
v_and_b32 v254, 1, v254
v_mul_u32_u24 v254, 8, v254
v_add_u32 v166, v254, v166
s_mul_i32 s58, s56, 5120
s_mul_i32 s92, s4, 20480
s_add_u32 s92, s92, s58
s_add_u32 s92, s92, 191676416
s_add_u32 s58, s58, 32768
s_lshl_b32 s93, s66, 2
s_add_u32 s93, s93, s4
s_lshl_b32 s93, s93, 10
s_add_u32 s93, s93, 214581248
v_mov_b32 v161, v238
s_cmp_eq_u32 s2, 64
s_cselect_b32 s57, 0, 1073741824
v_or_b32 v163, s57, v238
v_mov_b32 v164, -1
v_mov_b32 v165, -1
s_mov_b32 s90, 244473856
s_lshl_b32 s89, s4, 7
s_add_u32 s89, s89, 244453376
v_mov_b32 v0, 0
s_branch FW9b
FW9:
s_sleep 2
FW9b:
buffer_load_dword v1,v0,s[8:11],s89 offen sc1
s_sub_u32 s71, s71, 1
s_cbranch_scc1 EX0
s_waitcnt vmcnt(0)
v_cmp_gt_u32 vcc, 40, v1
s_cbranch_vccnz FW9
s_add_u32 s57, s67, 0
buffer_load_dwordx4 a[0:3],v155,s[8:11],s57 offen sc1
buffer_load_dwordx4 a[4:7],v155,s[8:11],s57 offen offset:1024 sc1
buffer_load_dwordx4 a[8:11],v155,s[8:11],s57 offen offset:2048 sc1
buffer_load_dwordx4 a[12:15],v155,s[8:11],s57 offen offset:3072 sc1
s_add_u32 s57, s67, 4096
buffer_load_dwordx4 a[16:19],v155,s[8:11],s57 offen sc1
buffer_load_dwordx4 a[20:23],v155,s[8:11],s57 offen offset:1024 sc1
buffer_load_dwordx4 a[24:27],v155,s[8:11],s57 offen offset:2048 sc1
buffer_load_dwordx4 a[28:31],v155,s[8:11],s57 offen offset:3072 sc1
s_add_u32 s57, s67, 8192
buffer_load_dwordx4 a[32:35],v155,s[8:11],s57 offen sc1
buffer_load_dwordx4 a[36:39],v155,s[8:11],s57 offen offset:1024 sc1
buffer_load_dwordx4 a[40:43],v155,s[8:11],s57 offen offset:2048 sc1
buffer_load_dwordx4 a[44:47],v155,s[8:11],s57 offen offset:3072 sc1
s_add_u32 s57, s67, 12288
buffer_load_dwordx4 a[48:51],v155,s[8:11],s57 offen sc1
buffer_load_dwordx4 a[52:55],v155,s[8:11],s57 offen offset:1024 sc1
buffer_load_dwordx4 a[56:59],v155,s[8:11],s57 offen offset:2048 sc1
buffer_load_dwordx4 a[60:63],v155,s[8:11],s57 offen offset:3072 sc1
s_add_u32 s57, s67, 16384
buffer_load_dwordx4 a[64:67],v155,s[8:11],s57 offen sc1
buffer_load_dwordx4 a[68:71],v155,s[8:11],s57 offen offset:1024 sc1
buffer_load_dwordx4 a[72:75],v155,s[8:11],s57 offen offset:2048 sc1
buffer_load_dwordx4 a[76:79],v155,s[8:11],s57 offen offset:3072 sc1
s_add_u32 s57, s67, 20480
buffer_load_dwordx4 a[80:83],v155,s[8:11],s57 offen sc1
buffer_load_dwordx4 a[84:87],v155,s[8:11],s57 offen offset:1024 sc1
buffer_load_dwordx4 a[88:91],v155,s[8:11],s57 offen offset:2048 sc1
buffer_load_dwordx4 a[92:95],v155,s[8:11],s57 offen offset:3072 sc1
s_add_u32 s57, s67, 24576
buffer_load_dwordx4 a[96:99],v155,s[8:11],s57 offen sc1
buffer_load_dwordx4 a[100:103],v155,s[8:11],s57 offen offset:1024 sc1
buffer_load_dwordx4 a[104:107],v155,s[8:11],s57 offen offset:2048 sc1
buffer_load_dwordx4 a[108:111],v155,s[8:11],s57 offen offset:3072 sc1
s_add_u32 s57, s67, 28672
buffer_load_dwordx4 a[112:115],v155,s[8:11],s57 offen sc1
buffer_load_dwordx4 a[116:119],v155,s[8:11],s57 offen offset:1024 sc1
buffer_load_dwordx4 a[120:123],v155,s[8:11],s57 offen offset:2048 sc1
buffer_load_dwordx4 a[124:127],v155,s[8:11],s57 offen offset:3072 sc1
s_add_u32 s57, s67, 32768
buffer_load_dwordx4 a[128:131],v155,s[8:11],s57 offen sc1
buffer_load_dwordx4 a[132:135],v155,s[8:11],s57 offen offset:1024 sc1
buffer_load_dwordx4 a[136:139],v155,s[8:11],s57 offen offset:2048 sc1
buffer_load_dwordx4 a[140:143],v155,s[8:11],s57 offen offset:3072 sc1
s_add_u32 s57, s67, 36864
buffer_load_dwordx4 a[144:147],v155,s[8:11],s57 offen sc1
buffer_load_dwordx4 a[148:151],v155,s[8:11],s57 offen offset:1024 sc1
buffer_load_dwordx4 a[152:155],v155,s[8:11],s57 offen offset:2048 sc1
buffer_load_dwordx4 a[156:159],v155,s[8:11],s57 offen offset:3072 sc1
s_add_u32 s57, s67, 40960
buffer_load_dwordx4 a[160:163],v155,s[8:11],s57 offen sc1
buffer_load_dwordx4 a[164:167],v155,s[8:11],s57 offen offset:1024 sc1
buffer_load_dwordx4 a[168:171],v155,s[8:11],s57 offen offset:2048 sc1
buffer_load_dwordx4 a[172:175],v155,s[8:11],s57 offen offset:3072 sc1
s_add_u32 s57, s67, 45056
buffer_load_dwordx4 a[176:179],v155,s[8:11],s57 offen sc1
buffer_load_dwordx4 a[180:183],v155,s[8:11],s57 offen offset:1024 sc1
buffer_load_dwordx4 a[184:187],v155,s[8:11],s57 offen offset:2048 sc1
buffer_load_dwordx4 a[188:191],v155,s[8:11],s57 offen offset:3072 sc1
s_add_u32 s57, s67, 49152
buffer_load_dwordx4 a[192:195],v155,s[8:11],s57 offen sc1
buffer_load_dwordx4 a[196:199],v155,s[8:11],s57 offen offset:1024 sc1
buffer_load_dwordx4 a[200:203],v155,s[8:11],s57 offen offset:2048 sc1
buffer_load_dwordx4 a[204:207],v155,s[8:11],s57 offen offset:3072 sc1
s_add_u32 s57, s67, 53248
buffer_load_dwordx4 a[208:211],v155,s[8:11],s57 offen sc1
buffer_load_dwordx4 a[212:215],v155,s[8:11],s57 offen offset:1024 sc1
buffer_load_dwordx4 a[216:219],v155,s[8:11],s57 offen offset:2048 sc1
buffer_load_dwordx4 a[220:223],v155,s[8:11],s57 offen offset:3072 sc1
s_add_u32 s57, s67, 57344
buffer_load_dwordx4 a[224:227],v155,s[8:11],s57 offen sc1
buffer_load_dwordx4 a[228:231],v155,s[8:11],s57 offen offset:1024 sc1
buffer_load_dwordx4 a[232:235],v155,s[8:11],s57 offen offset:2048 sc1
buffer_load_dwordx4 a[236:239],v155,s[8:11],s57 offen offset:3072 sc1
s_add_u32 s57, s67, 61440
buffer_load_dwordx4 a[240:243],v155,s[8:11],s57 offen sc1
buffer_load_dwordx4 a[244:247],v155,s[8:11],s57 offen offset:1024 sc1
buffer_load_dwordx4 a[248:251],v155,s[8:11],s57 offen offset:2048 sc1
buffer_load_dwordx4 a[252:255],v155,s[8:11],s57 offen offset:3072 sc1
s_add_u32 s57, s67, 65536
buffer_load_dwordx4 v[192:195],v155,s[8:11],s57 offen sc1
buffer_load_dwordx4 v[196:199],v155,s[8:11],s57 offen offset:1024 sc1
buffer_load_dwordx4 v[200:203],v155,s[8:11],s57 offen offset:2048 sc1
buffer_load_dwordx4 v[204:207],v155,s[8:11],s57 offen offset:3072 sc1
s_add_u32 s57, s67, 69632
buffer_load_dwordx4 v[208:211],v155,s[8:11],s57 offen sc1
buffer_load_dwordx4 v[212:215],v155,s[8:11],s57 offen offset:1024 sc1
buffer_load_dwordx4 v[216:219],v155,s[8:11],s57 offen offset:2048 sc1
buffer_load_dwordx4 v[220:223],v155,s[8:11],s57 offen offset:3072 sc1
s_add_u32 s57, s67, 73728
buffer_load_dwordx4 v[224:227],v155,s[8:11],s57 offen sc1
buffer_load_dwordx4 v[228:231],v155,s[8:11],s57 offen offset:1024 sc1
buffer_load_dwordx4 v[232:235],v155,s[8:11],s57 offen offset:2048 sc1
buffer_load_dwordx4 v[236:239],v155,s[8:11],s57 offen offset:3072 sc1
s_add_u32 s57, s67, 77824
buffer_load_dwordx4 v[240:243],v155,s[8:11],s57 offen sc1
buffer_load_dwordx4 v[244:247],v155,s[8:11],s57 offen offset:1024 sc1
buffer_load_dwordx4 v[248:251],v155,s[8:11],s57 offen offset:2048 sc1
buffer_load_dwordx4 v[252:255],v155,s[8:11],s57 offen offset:3072 sc1
s_lshl_b32 s89, s4, 11
s_add_u32 s89, s89, 244465664
v_mov_b32 v0, 0
s_branch FW10b
FW10:
s_sleep 1
FW10b:
buffer_load_dword v1,v0,s[8:11],s89 offen sc1
s_sub_u32 s71, s71, 1
s_cbranch_scc1 EX0
s_waitcnt vmcnt(0)
v_cmp_gt_u32 vcc, 8, v1
s_cbranch_vccnz FW10
buffer_load_dwordx4 v[80:83],v150,s[8:11],s100 offen sc1 nt
buffer_load_dwordx4 v[84:87],v150,s[8:11],s100 offen offset:1280 sc1 nt
buffer_load_dwordx4 v[88:91],v150,s[8:11],s100 offen offset:2560 sc1 nt
buffer_load_dwordx4 v[92:95],v150,s[8:11],s100 offen offset:3840 sc1 nt
s_waitcnt vmcnt(0)
V_LOOP:
s_add_u32 s57, s70, 1
s_and_b32 s57, s57, 67
s_cbranch_scc1 FC11
s_add_u32 s89, s89, 128
v_mov_b32 v116, 0
s_branch FW12b
FW12:
s_sleep 1
FW12b:
buffer_load_dword v117,v116,s[8:11],s89 offen sc1
s_sub_u32 s71, s71, 1
s_cbranch_scc1 EX0
s_waitcnt vmcnt(0)
v_cmp_gt_u32 vcc, 8, v117
s_cbranch_vccnz FW12
FC11:
v_mov_b32 v96, v168
v_mov_b32 v97, v169
v_mov_b32 v98, v170
v_mov_b32 v99, v171
v_mov_b32 v100, v172
v_mov_b32 v101, v173
v_mov_b32 v102, v174
v_mov_b32 v103, v175
v_mov_b32 v104, v176
v_mov_b32 v105, v177
v_mov_b32 v106, v178
v_mov_b32 v107, v179
v_mov_b32 v108, v180
v_mov_b32 v109, v181
v_mov_b32 v110, v182
v_mov_b32 v111, v183
v_mov_b32 v112, v184
v_mov_b32 v113, v185
v_mov_b32 v114, v186
v_mov_b32 v115, v187
v_mov_b32 v168, v64
v_mov_b32 v169, v65
v_mov_b32 v170, v66
v_mov_b32 v171, v67
v_mov_b32 v172, v68
v_mov_b32 v173, v69
v_mov_b32 v174, v70
v_mov_b32 v175, v71
v_mov_b32 v176, v72
v_mov_b32 v177, v73
v_mov_b32 v178, v74
v_mov_b32 v179, v75
v_mov_b32 v180, v76
v_mov_b32 v181, v77
v_mov_b32 v182, v78
v_mov_b32 v183, v79
v_mov_b32 v184, v128
v_mov_b32 v185, v129
v_mov_b32 v186, v130
v_mov_b32 v187, v131
v_mov_b32 v64, v80
v_mov_b32 v65, v81
v_mov_b32 v66, v82
v_mov_b32 v67, v83
v_mov_b32 v68, v84
v_mov_b32 v69, v85
v_mov_b32 v70, v86
v_mov_b32 v71, v87
v_mov_b32 v72, v88
v_mov_b32 v73, v89
v_mov_b32 v74, v90
v_mov_b32 v75, v91
v_mov_b32 v76, v92
v_mov_b32 v77, v93
v_mov_b32 v78, v94
v_mov_b32 v79, v95
v_mov_b32 v40, 0
v_mov_b32 v41, 0
v_mov_b32 v42, 0
v_mov_b32 v43, 0
v_mov_b32 v44, 0
v_mov_b32 v45, 0
v_mov_b32 v46, 0
v_mov_b32 v47, 0
v_mov_b32 v48, 0
v_mov_b32 v49, 0
v_mov_b32 v50, 0
v_mov_b32 v51, 0
v_mov_b32 v52, 0
v_mov_b32 v53, 0
v_mov_b32 v54, 0
v_mov_b32 v55, 0
s_add_u32 s57, s6, 4096
PL13:
buffer_load_dwordx4 v[116:119],v144,s[8:11],s6 offen sc1
buffer_load_dwordx4 v[120:123],v144,s[8:11],s57 offen sc1
buffer_load_dwordx2 v[124:125],v145,s[8:11],s6 offen sc1
s_sub_u32 s71, s71, 1
s_cbranch_scc1 EX0
s_waitcnt vmcnt(0)
v_max3_u32 v126, v116, v117, v118
v_max3_u32 v126, v126, v119, v120
v_max3_u32 v126, v126, v121, v122
v_max3_u32 v126, v126, v123, v124
v_max_u32 v126, v126, v125
v_cmp_eq_u32 vcc, -1, v126
s_cbranch_vccnz PL13
ds_write_b128 v146, v[116:119]
ds_write_b128 v146, v[120:123] offset:4096
ds_write_b64 v147, v[124:125]
s_waitcnt lgkmcnt(0)
s_barrier
ds_read_b128 v[0:3], v148 offset:0
ds_read_b128 v[4:7], v148 offset:1024
ds_read_b128 v[8:11], v148 offset:2048
ds_read_b128 v[12:15], v148 offset:3072
ds_read_b128 v[16:19], v148 offset:4096
ds_read_b128 v[20:23], v148 offset:5120
ds_read_b128 v[24:27], v148 offset:6144
ds_read_b128 v[28:31], v148 offset:7168
ds_read_b128 v[32:35], v148 offset:8192
ds_read_b128 v[36:39], v148 offset:9216
s_add_u32 s57, s100, 1658880
buffer_load_dwordx4 v[80:83],v150,s[8:11],s57 offen sc1 nt
buffer_load_dwordx4 v[84:87],v150,s[8:11],s57 offen offset:1280 sc1 nt
buffer_load_dwordx4 v[88:91],v150,s[8:11],s57 offen offset:2560 sc1 nt
buffer_load_dwordx4 v[92:95],v150,s[8:11],s57 offen offset:3840 sc1 nt
s_waitcnt lgkmcnt(9)
v_smfmac_f32_16x16x64_bf16 v[40:43],v[0:3],a[0:7],v149
v_smfmac_f32_16x16x64_bf16 v[44:47],v[0:3],a[80:87],v149
s_bitcmp1_b32 s70, 1
s_cselect_b32 s91, -1, 1
s_mul_i32 s91, s91, 655360
s_add_u32 s91, s91, s61
s_add_u32 s57, s91, 163840
buffer_store_dwordx2 v[164:165],v152,s[8:11],s91 offen sc1
v_smfmac_f32_16x16x64_bf16 v[48:51],v[0:3],a[160:167],v149
v_smfmac_f32_16x16x64_bf16 v[52:55],v[0:3],a[240:247],v149
buffer_store_dwordx2 v[164:165],v156,s[8:11],s57 offen sc1
s_waitcnt lgkmcnt(8)
v_smfmac_f32_16x16x64_bf16 v[40:43],v[4:7],a[8:15],v149
v_smfmac_f32_16x16x64_bf16 v[44:47],v[4:7],a[88:95],v149
buffer_store_dwordx2 v[56:57],v166,s[8:11],s93 offen sc1
v_smfmac_f32_16x16x64_bf16 v[48:51],v[4:7],a[168:175],v149
v_smfmac_f32_16x16x64_bf16 v[52:55],v[4:7],a[248:255],v149
buffer_store_dwordx2 v[58:59],v166,s[8:11],s93 offen offset:256 sc1
s_waitcnt lgkmcnt(7)
v_smfmac_f32_16x16x64_bf16 v[40:43],v[8:11],a[16:23],v149
v_smfmac_f32_16x16x64_bf16 v[44:47],v[8:11],a[96:103],v149
s_add_u32 s93, s93, 327680
v_mov_b32 v162, s70
buffer_store_dword v162,v163,s[8:11],s90 offen sc1
v_smfmac_f32_16x16x64_bf16 v[48:51],v[8:11],a[176:183],v149
v_smfmac_f32_16x16x64_bf16 v[52:55],v[8:11],v[192:199],v149
s_mov_b32 m0, s58
s_nop 0
buffer_load_dwordx4 v155,s[8:11],s92 offen offset:0 sc1 lds
s_waitcnt lgkmcnt(6)
v_smfmac_f32_16x16x64_bf16 v[40:43],v[12:15],a[24:31],v149
v_smfmac_f32_16x16x64_bf16 v[44:47],v[12:15],a[104:111],v149
buffer_load_dwordx4 v155,s[8:11],s92 offen offset:1024 sc1 lds
v_smfmac_f32_16x16x64_bf16 v[48:51],v[12:15],a[184:191],v149
v_smfmac_f32_16x16x64_bf16 v[52:55],v[12:15],v[200:207],v149
buffer_load_dwordx4 v155,s[8:11],s92 offen offset:2048 sc1 lds
s_waitcnt lgkmcnt(5)
v_smfmac_f32_16x16x64_bf16 v[40:43],v[16:19],a[32:39],v149
v_smfmac_f32_16x16x64_bf16 v[44:47],v[16:19],a[112:119],v149
buffer_load_dwordx4 v155,s[8:11],s92 offen offset:3072 sc1 lds
v_smfmac_f32_16x16x64_bf16 v[48:51],v[16:19],a[192:199],v149
v_smfmac_f32_16x16x64_bf16 v[52:55],v[16:19],v[208:215],v149
s_add_u32 m0, s58, 1024
s_add_u32 s57, s92, 1024
s_add_u32 s92, s92, 81920
buffer_load_dwordx4 v155,s[8:11],s57 offen offset:3072 sc1 lds
s_waitcnt lgkmcnt(4)
v_smfmac_f32_16x16x64_bf16 v[40:43],v[20:23],a[40:47],v149
v_smfmac_f32_16x16x64_bf16 v[44:47],v[20:23],a[120:127],v149
s_cmp_lt_u32 s92, 191840256
s_cselect_b32 s57, 0, 327680
s_sub_u32 s92, s92, s57
v_smfmac_f32_16x16x64_bf16 v[48:51],v[20:23],a[200:207],v149
v_smfmac_f32_16x16x64_bf16 v[52:55],v[20:23],v[216:223],v149
s_waitcnt lgkmcnt(3)
v_smfmac_f32_16x16x64_bf16 v[40:43],v[24:27],a[48:55],v149
v_smfmac_f32_16x16x64_bf16 v[44:47],v[24:27],a[128:135],v149
v_smfmac_f32_16x16x64_bf16 v[48:51],v[24:27],a[208:215],v149
v_smfmac_f32_16x16x64_bf16 v[52:55],v[24:27],v[224:231],v149
s_waitcnt lgkmcnt(2)
v_smfmac_f32_16x16x64_bf16 v[40:43],v[28:31],a[56:63],v149
v_smfmac_f32_16x16x64_bf16 v[44:47],v[28:31],a[136:143],v149
v_smfmac_f32_16x16x64_bf16 v[48:51],v[28:31],a[216:223],v149
v_smfmac_f32_16x16x64_bf16 v[52:55],v[28:31],v[232:239],v149
s_waitcnt lgkmcnt(1)
v_smfmac_f32_16x16x64_bf16 v[40:43],v[32:35],a[64:71],v149
v_smfmac_f32_16x16x64_bf16 v[44:47],v[32:35],a[144:151],v149
v_smfmac_f32_16x16x64_bf16 v[48:51],v[32:35],a[224:231],v149
v_smfmac_f32_16x16x64_bf16 v[52:55],v[32:35],v[240:247],v149
s_waitcnt lgkmcnt(0)
v_smfmac_f32_16x16x64_bf16 v[40:43],v[36:39],a[72:79],v149
v_smfmac_f32_16x16x64_bf16 v[44:47],v[36:39],a[152:159],v149
v_smfmac_f32_16x16x64_bf16 v[48:51],v[36:39],a[232:239],v149
v_smfmac_f32_16x16x64_bf16 v[52:55],v[36:39],v[248:255],v149
s_bitcmp1_b32 s70, 0
s_cselect_b32 s57, -1, 1
s_mul_i32 s57, s57, 10240
v_add_u32 v146, s57, v146
v_add_u32 v147, s57, v147
v_add_u32 v148, s57, v148
s_nop 2
v_permlane32_swap_b32 v40, v44
v_permlane32_swap_b32 v41, v45
v_permlane32_swap_b32 v42, v46
v_permlane32_swap_b32 v43, v47
v_add_f32 v40, v40, v44
v_add_f32 v41, v41, v45
v_add_f32 v42, v42, v46
v_add_f32 v43, v43, v47
v_permlane32_swap_b32 v48, v52
v_permlane32_swap_b32 v49, v53
v_permlane32_swap_b32 v50, v54
v_permlane32_swap_b32 v51, v55
v_add_f32 v48, v48, v52
v_add_f32 v49, v49, v53
v_add_f32 v50, v50, v54
v_add_f32 v51, v51, v55
v_cvt_pk_bf16_f32 v128, v40, v41
v_cvt_pk_bf16_f32 v129, v42, v43
v_cvt_pk_bf16_f32 v130, v48, v49
v_cvt_pk_bf16_f32 v131, v50, v51
buffer_load_dwordx4 v[116:119],v159,s[8:11],s7 offen sc1
buffer_load_dword v120,v160,s[8:11],s7 offen sc1
s_sleep 2
PQ14:
buffer_load_dwordx4 v[122:125],v159,s[8:11],s7 offen sc1
buffer_load_dword v126,v160,s[8:11],s7 offen sc1
s_waitcnt vmcnt(2)
v_max3_u32 v121, v116, v117, v118
v_max3_u32 v121, v121, v119, v120
v_cmp_eq_u32 vcc, -1, v121
s_cbranch_vccz PQ14a
s_sub_u32 s71, s71, 1
s_cbranch_scc1 EX0
buffer_load_dwordx4 v[116:119],v159,s[8:11],s7 offen sc1
buffer_load_dword v120,v160,s[8:11],s7 offen sc1
s_waitcnt vmcnt(2)
v_max3_u32 v121, v122, v123, v124
v_max3_u32 v121, v121, v125, v126
v_cmp_eq_u32 vcc, -1, v121
s_cbranch_vccnz PQ14
ds_write_b128 v159, v[122:125] offset:20480
ds_write_b32 v160, v126 offset:20480
s_branch PQ14e
PQ14a:
ds_write_b128 v159, v[116:119] offset:20480
ds_write_b32 v160, v120 offset:20480
PQ14e:
s_cmp_eq_u32 s70, 63
s_waitcnt lgkmcnt(0)
s_barrier
s_cbranch_scc1 V_END
ds_read_b128 v[0:3], v150 offset:20480
ds_read_b128 v[4:7], v150 offset:21760
ds_read_b128 v[8:11], v150 offset:23040
ds_read_b128 v[12:15], v150 offset:24320
ds_read_b64 v[16:17], v151 offset:20480
ds_read_b64 v[18:19], v151 offset:23040
s_waitcnt lgkmcnt(5)
v_mfma_f32_16x16x32_bf16 v[132:135],v[64:67],v[0:3],0
s_waitcnt lgkmcnt(4)
v_mfma_f32_16x16x32_bf16 v[132:135],v[68:71],v[4:7],v[132:135]
s_waitcnt lgkmcnt(3)
v_mfma_f32_16x16x32_bf16 v[132:135],v[72:75],v[8:11],v[132:135]
s_waitcnt lgkmcnt(2)
v_mfma_f32_16x16x32_bf16 v[132:135],v[76:79],v[12:15],v[132:135]
s_waitcnt lgkmcnt(0)
v_mfma_f32_16x16x32_bf16 v[132:135],v[128:131],v[16:19],v[132:135]
s_add_u32 s57, s61, 163840
s_nop 6
v_permlane32_swap_b32 v132, v134
v_permlane32_swap_b32 v133, v135
s_nop 0
v_add_f32_dpp v136, v134, v132 row_ror:8 row_mask:0xf bank_mask:0x3
v_add_f32_dpp v136, v132, v134 row_ror:8 row_mask:0xf bank_mask:0xc
v_add_f32_dpp v137, v135, v133 row_ror:8 row_mask:0xf bank_mask:0x3
v_add_f32_dpp v137, v133, v135 row_ror:8 row_mask:0xf bank_mask:0xc
v_min_u32 v136, -2, v136
v_min_u32 v137, -2, v137
buffer_store_dwordx2 v[136:137],v152,s[8:11],s61 offen sc1
buffer_store_dwordx2 v[136:137],v156,s[8:11],s57 offen sc1
v_and_b32 v132, v136, v158
v_and_b32 v133, v137, v158
ds_read_b128 v[0:3], v188 offset:0
ds_read_b128 v[20:23], v189 offset:0
ds_read_b128 v[4:7], v188 offset:5120
ds_read_b128 v[24:27], v189 offset:5120
ds_read_b128 v[8:11], v188 offset:10240
ds_read_b128 v[28:31], v189 offset:10240
ds_read_b128 v[12:15], v188 offset:15360
ds_read_b128 v[32:35], v189 offset:15360
ds_read_b64 v[16:17], v190 offset:0
ds_read_b64 v[18:19], v190 offset:10240
ds_read_b64 v[36:37], v191 offset:0
ds_read_b64 v[38:39], v191 offset:10240
s_waitcnt lgkmcnt(10)
v_mfma_f32_16x16x32_bf16 v[40:43],v[96:99],v[0:3],0
v_mfma_f32_16x16x32_bf16 v[44:47],v[96:99],v[20:23],0
ds_read_b128 v[0:3], v188 offset:256
ds_read_b128 v[20:23], v189 offset:256
s_waitcnt lgkmcnt(10)
v_mfma_f32_16x16x32_bf16 v[40:43],v[100:103],v[4:7],v[40:43]
v_mfma_f32_16x16x32_bf16 v[44:47],v[100:103],v[24:27],v[44:47]
ds_read_b128 v[4:7], v188 offset:5376
ds_read_b128 v[24:27], v189 offset:5376
s_waitcnt lgkmcnt(10)
v_mfma_f32_16x16x32_bf16 v[40:43],v[104:107],v[8:11],v[40:43]
v_mfma_f32_16x16x32_bf16 v[44:47],v[104:107],v[28:31],v[44:47]
ds_read_b128 v[8:11], v188 offset:10496
ds_read_b128 v[28:31], v189 offset:10496
s_waitcnt lgkmcnt(10)
v_mfma_f32_16x16x32_bf16 v[40:43],v[108:111],v[12:15],v[40:43]
v_mfma_f32_16x16x32_bf16 v[44:47],v[108:111],v[32:35],v[44:47]
ds_read_b128 v[12:15], v188 offset:15616
ds_read_b128 v[32:35], v189 offset:15616
s_waitcnt lgkmcnt(8)
v_mfma_f32_16x16x32_bf16 v[40:43],v[112:115],v[16:19],v[40:43]
v_mfma_f32_16x16x32_bf16 v[44:47],v[112:115],v[36:39],v[44:47]
ds_read_b64 v[16:17], v190 offset:256
ds_read_b64 v[18:19], v190 offset:10496
ds_read_b64 v[36:37], v191 offset:256
ds_read_b64 v[38:39], v191 offset:10496
s_waitcnt lgkmcnt(10)
v_mfma_f32_16x16x32_bf16 v[48:51],v[96:99],v[0:3],0
v_mfma_f32_16x16x32_bf16 v[52:55],v[96:99],v[20:23],0
s_waitcnt lgkmcnt(8)
v_mfma_f32_16x16x32_bf16 v[48:51],v[100:103],v[4:7],v[48:51]
v_mfma_f32_16x16x32_bf16 v[52:55],v[100:103],v[24:27],v[52:55]
s_waitcnt lgkmcnt(6)
v_mfma_f32_16x16x32_bf16 v[48:51],v[104:107],v[8:11],v[48:51]
v_mfma_f32_16x16x32_bf16 v[52:55],v[104:107],v[28:31],v[52:55]
s_waitcnt lgkmcnt(4)
v_mfma_f32_16x16x32_bf16 v[48:51],v[108:111],v[12:15],v[48:51]
v_mfma_f32_16x16x32_bf16 v[52:55],v[108:111],v[32:35],v[52:55]
s_waitcnt lgkmcnt(0)
v_mfma_f32_16x16x32_bf16 v[48:51],v[112:115],v[16:19],v[48:51]
v_mfma_f32_16x16x32_bf16 v[52:55],v[112:115],v[36:39],v[52:55]
s_nop 3
v_permlane32_swap_b32 v40, v42
v_permlane32_swap_b32 v41, v43
v_permlane32_swap_b32 v44, v46
v_permlane32_swap_b32 v45, v47
v_permlane32_swap_b32 v48, v50
v_permlane32_swap_b32 v49, v51
v_permlane32_swap_b32 v52, v54
v_permlane32_swap_b32 v53, v55
s_nop 0
v_add_f32_dpp v56, v46, v40 row_ror:8 row_mask:0xf bank_mask:0x3
v_add_f32_dpp v56, v44, v42 row_ror:8 row_mask:0xf bank_mask:0xc
v_add_f32_dpp v57, v47, v41 row_ror:8 row_mask:0xf bank_mask:0x3
v_add_f32_dpp v57, v45, v43 row_ror:8 row_mask:0xf bank_mask:0xc
v_add_f32_dpp v58, v54, v48 row_ror:8 row_mask:0xf bank_mask:0x3
v_add_f32_dpp v58, v52, v50 row_ror:8 row_mask:0xf bank_mask:0xc
v_add_f32_dpp v59, v55, v49 row_ror:8 row_mask:0xf bank_mask:0x3
v_add_f32_dpp v59, v53, v51 row_ror:8 row_mask:0xf bank_mask:0xc
buffer_load_dwordx2 v[0:1],v153,s[8:11],s59 offen sc1
buffer_load_dwordx2 v[2:3],v157,s[8:11],s59 offen offset:256 sc1
s_sleep 4
PQ15:
buffer_load_dwordx2 v[4:5],v153,s[8:11],s59 offen sc1
buffer_load_dwordx2 v[6:7],v157,s[8:11],s59 offen offset:256 sc1
s_waitcnt vmcnt(2)
v_max3_u32 v116, v0, v1, v2
v_max_u32 v116, v116, v3
v_cmp_eq_u32 vcc, -1, v116
s_cbranch_vccz PQ15a
s_sub_u32 s71, s71, 1
s_cbranch_scc1 EX0
buffer_load_dwordx2 v[0:1],v153,s[8:11],s59 offen sc1
buffer_load_dwordx2 v[2:3],v157,s[8:11],s59 offen offset:256 sc1
s_waitcnt vmcnt(2)
v_max3_u32 v116, v4, v5, v6
v_max_u32 v116, v116, v7
v_cmp_eq_u32 vcc, -1, v116
s_cbranch_vccnz PQ15
v_add_f32 v138, v4, v6
v_add_f32 v139, v5, v7
s_branch PQ15e
PQ15a:
v_add_f32 v138, v0, v2
v_add_f32 v139, v1, v3
PQ15e:
v_add_f32 v138, v138, v132
v_add_f32 v139, v139, v133
s_add_u32 s57, s6, s101
s_nop 0
v_add_f32_dpp v140, v138, v138 row_ror:8 row_mask:0xf bank_mask:0xf
v_add_f32_dpp v141, v139, v139 row_ror:8 row_mask:0xf bank_mask:0xf
v_cvt_pk_bf16_f32 v142, v140, v141
v_min_u32 v142, -2, v142
s_cmp_eq_u32 s69, 0
s_cbranch_scc1 PB16s
buffer_store_dword v142,v154,s[8:11],s57 offen
s_branch PB16e
PB16s:
buffer_store_dword v142,v154,s[8:11],s57 offen sc1
PB16e:
s_add_u32 s6, s6, 40960
s_add_u32 s7, s7, 20480
s_add_u32 s100, s100, 1658880
s_add_u32 s70, s70, 1
s_and_b32 s57, s70, 3
s_cselect_b32 s57, 1, -3
s_mul_i32 s57, s57, 327680
s_add_u32 s61, s61, s57
s_add_u32 s59, s59, s57
s_branch V_LOOP
V_END:
s_add_u32 s58, s58, 20480
s_mov_b32 m0, s58
s_nop 0
buffer_load_dwordx4 v155,s[8:11],s92 offen offset:0 sc1 lds
buffer_load_dwordx4 v155,s[8:11],s92 offen offset:1024 sc1 lds
buffer_load_dwordx4 v155,s[8:11],s92 offen offset:2048 sc1 lds
buffer_load_dwordx4 v155,s[8:11],s92 offen offset:3072 sc1 lds
s_add_u32 m0, s58, 1024
s_add_u32 s57, s92, 1024
s_add_u32 s92, s92, 81920
buffer_load_dwordx4 v155,s[8:11],s57 offen offset:3072 sc1 lds
s_cmp_lt_u32 s92, 191840256
s_cselect_b32 s57, 0, 327680
s_sub_u32 s92, s92, s57
s_lshl_b32 s89, s4, 7
s_add_u32 s89, s89, 244455424
V_E1:
ds_read_b128 v[0:3], v188 offset:0
ds_read_b128 v[20:23], v189 offset:0
ds_read_b128 v[4:7], v188 offset:5120
ds_read_b128 v[24:27], v189 offset:5120
ds_read_b128 v[8:11], v188 offset:10240
ds_read_b128 v[28:31], v189 offset:10240
ds_read_b128 v[12:15], v188 offset:15360
ds_read_b128 v[32:35], v189 offset:15360
ds_read_b64 v[16:17], v190 offset:0
ds_read_b64 v[18:19], v190 offset:10240
ds_read_b64 v[36:37], v191 offset:0
ds_read_b64 v[38:39], v191 offset:10240
s_waitcnt lgkmcnt(10)
v_mfma_f32_16x16x32_bf16 v[40:43],v[96:99],v[0:3],0
v_mfma_f32_16x16x32_bf16 v[44:47],v[96:99],v[20:23],0
ds_read_b128 v[0:3], v188 offset:256
ds_read_b128 v[20:23], v189 offset:256
s_waitcnt lgkmcnt(10)
v_mfma_f32_16x16x32_bf16 v[40:43],v[100:103],v[4:7],v[40:43]
v_mfma_f32_16x16x32_bf16 v[44:47],v[100:103],v[24:27],v[44:47]
ds_read_b128 v[4:7], v188 offset:5376
ds_read_b128 v[24:27], v189 offset:5376
s_waitcnt lgkmcnt(10)
v_mfma_f32_16x16x32_bf16 v[40:43],v[104:107],v[8:11],v[40:43]
v_mfma_f32_16x16x32_bf16 v[44:47],v[104:107],v[28:31],v[44:47]
ds_read_b128 v[8:11], v188 offset:10496
ds_read_b128 v[28:31], v189 offset:10496
s_waitcnt lgkmcnt(10)
v_mfma_f32_16x16x32_bf16 v[40:43],v[108:111],v[12:15],v[40:43]
v_mfma_f32_16x16x32_bf16 v[44:47],v[108:111],v[32:35],v[44:47]
ds_read_b128 v[12:15], v188 offset:15616
ds_read_b128 v[32:35], v189 offset:15616
s_waitcnt lgkmcnt(8)
v_mfma_f32_16x16x32_bf16 v[40:43],v[112:115],v[16:19],v[40:43]
v_mfma_f32_16x16x32_bf16 v[44:47],v[112:115],v[36:39],v[44:47]
ds_read_b64 v[16:17], v190 offset:256
ds_read_b64 v[18:19], v190 offset:10496
ds_read_b64 v[36:37], v191 offset:256
ds_read_b64 v[38:39], v191 offset:10496
s_waitcnt lgkmcnt(10)
v_mfma_f32_16x16x32_bf16 v[48:51],v[96:99],v[0:3],0
v_mfma_f32_16x16x32_bf16 v[52:55],v[96:99],v[20:23],0
s_waitcnt lgkmcnt(8)
v_mfma_f32_16x16x32_bf16 v[48:51],v[100:103],v[4:7],v[48:51]
v_mfma_f32_16x16x32_bf16 v[52:55],v[100:103],v[24:27],v[52:55]
s_waitcnt lgkmcnt(6)
v_mfma_f32_16x16x32_bf16 v[48:51],v[104:107],v[8:11],v[48:51]
v_mfma_f32_16x16x32_bf16 v[52:55],v[104:107],v[28:31],v[52:55]
s_waitcnt lgkmcnt(4)
v_mfma_f32_16x16x32_bf16 v[48:51],v[108:111],v[12:15],v[48:51]
v_mfma_f32_16x16x32_bf16 v[52:55],v[108:111],v[32:35],v[52:55]
s_waitcnt lgkmcnt(0)
v_mfma_f32_16x16x32_bf16 v[48:51],v[112:115],v[16:19],v[48:51]
v_mfma_f32_16x16x32_bf16 v[52:55],v[112:115],v[36:39],v[52:55]
s_nop 3
v_permlane32_swap_b32 v40, v42
v_permlane32_swap_b32 v41, v43
v_permlane32_swap_b32 v44, v46
v_permlane32_swap_b32 v45, v47
v_permlane32_swap_b32 v48, v50
v_permlane32_swap_b32 v49, v51
v_permlane32_swap_b32 v52, v54
v_permlane32_swap_b32 v53, v55
s_nop 0
v_add_f32_dpp v56, v46, v40 row_ror:8 row_mask:0xf bank_mask:0x3
v_add_f32_dpp v56, v44, v42 row_ror:8 row_mask:0xf bank_mask:0xc
v_add_f32_dpp v57, v47, v41 row_ror:8 row_mask:0xf bank_mask:0x3
v_add_f32_dpp v57, v45, v43 row_ror:8 row_mask:0xf bank_mask:0xc
v_add_f32_dpp v58, v54, v48 row_ror:8 row_mask:0xf bank_mask:0x3
v_add_f32_dpp v58, v52, v50 row_ror:8 row_mask:0xf bank_mask:0xc
v_add_f32_dpp v59, v55, v49 row_ror:8 row_mask:0xf bank_mask:0x3
v_add_f32_dpp v59, v53, v51 row_ror:8 row_mask:0xf bank_mask:0xc
buffer_store_dwordx2 v[56:57],v166,s[8:11],s93 offen sc1
buffer_store_dwordx2 v[58:59],v166,s[8:11],s93 offen offset:256 sc1
s_add_u32 s93, s93, 327680
s_cmp_eq_u32 s70, 65
s_cbranch_scc1 V_E2
v_mov_b32 v96, v168
v_mov_b32 v97, v169
v_mov_b32 v98, v170
v_mov_b32 v99, v171
v_mov_b32 v100, v172
v_mov_b32 v101, v173
v_mov_b32 v102, v174
v_mov_b32 v103, v175
v_mov_b32 v104, v176
v_mov_b32 v105, v177
v_mov_b32 v106, v178
v_mov_b32 v107, v179
v_mov_b32 v108, v180
v_mov_b32 v109, v181
v_mov_b32 v110, v182
v_mov_b32 v111, v183
v_mov_b32 v112, v184
v_mov_b32 v113, v185
v_mov_b32 v114, v186
v_mov_b32 v115, v187
v_mov_b32 v168, v64
v_mov_b32 v169, v65
v_mov_b32 v170, v66
v_mov_b32 v171, v67
v_mov_b32 v172, v68
v_mov_b32 v173, v69
v_mov_b32 v174, v70
v_mov_b32 v175, v71
v_mov_b32 v176, v72
v_mov_b32 v177, v73
v_mov_b32 v178, v74
v_mov_b32 v179, v75
v_mov_b32 v180, v76
v_mov_b32 v181, v77
v_mov_b32 v182, v78
v_mov_b32 v183, v79
v_mov_b32 v184, v128
v_mov_b32 v185, v129
v_mov_b32 v186, v130
v_mov_b32 v187, v131
v_add_u32 v188, 20480, v188
v_add_u32 v189, 20480, v189
v_add_u32 v190, 20480, v190
v_add_u32 v191, 20480, v191
s_add_u32 s70, s70, 1
s_cmp_eq_u32 s70, 65
s_cbranch_scc1 V_E3
v_mov_b32 v116, 0
s_branch FW17b
FW17:
s_sleep 1
FW17b:
buffer_load_dword v117,v116,s[8:11],s89 offen sc1
s_sub_u32 s71, s71, 1
s_cbranch_scc1 EX0
s_waitcnt vmcnt(0)
v_cmp_gt_u32 vcc, 8, v117
s_cbranch_vccnz FW17
s_add_u32 s58, s58, 20480
s_mov_b32 m0, s58
s_nop 0
buffer_load_dwordx4 v155,s[8:11],s92 offen offset:0 sc1 lds
buffer_load_dwordx4 v155,s[8:11],s92 offen offset:1024 sc1 lds
buffer_load_dwordx4 v155,s[8:11],s92 offen offset:2048 sc1 lds
buffer_load_dwordx4 v155,s[8:11],s92 offen offset:3072 sc1 lds
s_add_u32 m0, s58, 1024
s_add_u32 s57, s92, 1024
s_add_u32 s92, s92, 81920
buffer_load_dwordx4 v155,s[8:11],s57 offen offset:3072 sc1 lds
s_cmp_lt_u32 s92, 191840256
s_cselect_b32 s57, 0, 327680
s_sub_u32 s92, s92, s57
s_barrier
s_branch V_E1
V_E3:
s_waitcnt vmcnt(2)
s_barrier
s_branch V_E1
V_E2:
s_lshr_b32 s57, s66, 4
s_lshl_b32 s57, s57, 7
s_add_u32 s57, s57, 244473984
s_waitcnt vmcnt(0)
v_mov_b32 v162, 1
s_barrier
buffer_atomic_add v162,v161,s[8:11],s57 offen sc1
s_branch EX0
SPARE:
s_sub_u32 s6, s5, 24
s_lshl_b32 s6, s6, 2
s_branch W_A2
WORKER:
v_lshrrev_b32 v224, 5, v255
v_and_b32 v224, 1, v224
v_mul_u32_u24 v224, 6144, v224
v_lshrrev_b32 v254, 2, v255
v_and_b32 v254, 3, v254
v_mul_u32_u24 v254, 64, v254
v_add_u32 v224, v254, v224
v_lshrrev_b32 v254, 4, v255
v_and_b32 v254, 1, v254
v_mul_u32_u24 v254, 32, v254
v_add_u32 v224, v254, v224
v_and_b32 v254, 3, v255
v_mul_u32_u24 v254, 8, v254
v_add_u32 v224, v254, v224
v_add_u32 v225, 49152, v224
v_add_u32 v226, 98304, v224
v_lshrrev_b32 v227, 5, v255
v_and_b32 v227, 1, v227
v_mul_u32_u24 v227, 256, v227
v_lshrrev_b32 v254, 2, v255
v_and_b32 v254, 3, v254
v_mul_u32_u24 v254, 64, v254
v_add_u32 v227, v254, v227
v_lshrrev_b32 v254, 4, v255
v_and_b32 v254, 1, v254
v_mul_u32_u24 v254, 32, v254
v_add_u32 v227, v254, v227
v_and_b32 v254, 3, v255
v_mul_u32_u24 v254, 8, v254
v_add_u32 v227, v254, v227
v_add_u32 v228, 49152, v227
v_add_u32 v229, 98304, v227
v_lshlrev_b32 v233, 4, v255
v_lshrrev_b32 v231, 2, v255
v_and_b32 v231, 7, v231
v_mul_u32_u24 v231, 1280, v231
v_lshrrev_b32 v254, 5, v255
v_and_b32 v254, 1, v254
v_mul_u32_u24 v254, 64, v254
v_add_u32 v231, v254, v231
v_and_b32 v254, 3, v255
v_mul_u32_u24 v254, 16, v254
v_add_u32 v231, v254, v231
s_mul_i32 s57, s56, 10240
v_add_u32 v231, s57, v231
s_mul_i32 s58, s56, 6144
v_or_b32 v239, s56, v255
v_cmp_eq_u32 vcc, 0, v239
v_mov_b32 v239, 1
v_mov_b32 v238, 1073741824
v_cndmask_b32 v238, v238, 0, vcc
s_sub_u32 s4, s4, 4
s_and_b32 s7, s5, 15
s_lshr_b32 s6, s5, 4
s_lshl_b32 s6, s6, 3
s_add_u32 s6, s6, s7
s_add_u32 s6, s6, 16
s_bitcmp1_b32 s7, 3
s_cbranch_scc1 BT1
WORK2:
s_lshl_b32 s62, s4, 3
s_and_b32 s57, s5, 7
s_add_u32 s62, s62, s57
s_bfe_u32 s63, s5, 0x10003
s_lshl_b32 s63, s63, 1
s_lshl_b32 s57, s4, 4
s_lshl_b32 s92, s57, 7
s_add_u32 s92, s92, 244457472
s_cmp_lt_u32 s5, 16
s_cbranch_scc0 W_VO
v_lshrrev_b32 v230, 2, v255
v_and_b32 v230, 7, v230
v_mul_u32_u24 v230, 12288, v230
v_lshrrev_b32 v254, 5, v255
v_and_b32 v254, 1, v254
v_mul_u32_u24 v254, 64, v254
v_add_u32 v230, v254, v230
v_and_b32 v254, 3, v255
v_mul_u32_u24 v254, 16, v254
v_add_u32 v230, v254, v230
s_mul_i32 s57, s56, 98304
v_add_u32 v230, s57, v230
s_lshl_b32 s66, s63, 2
s_add_u32 s66, s66, s56
s_mul_i32 s61, s66, 40960
s_add_u32 s61, s61, 236535808
s_mul_i32 s59, s62, 384
s_mov_b32 s93, 244486016
v_lshlrev_b32 v246, 7, v255
s_barrier
s_add_u32 m0, s58, 0
s_add_u32 s57, s59, 0
buffer_load_dwordx4 v230,s[24:27],s57 offen lds
s_add_u32 m0, s58, 1024
s_add_u32 s57, s59, 128
buffer_load_dwordx4 v230,s[24:27],s57 offen lds
s_add_u32 m0, s58, 2048
s_add_u32 s57, s59, 256
buffer_load_dwordx4 v230,s[24:27],s57 offen lds
s_add_u32 m0, s58, 3072
s_add_u32 s57, s59, 0
buffer_load_dwordx4 v230,s[28:31],s57 offen lds
s_add_u32 m0, s58, 4096
s_add_u32 s57, s59, 128
buffer_load_dwordx4 v230,s[28:31],s57 offen lds
s_add_u32 m0, s58, 5120
s_add_u32 s57, s59, 256
buffer_load_dwordx4 v230,s[28:31],s57 offen lds
s_add_u32 m0, s58, 24576
s_add_u32 s57, s59, 393216
buffer_load_dwordx4 v230,s[24:27],s57 offen lds
s_add_u32 m0, s58, 25600
s_add_u32 s57, s59, 393344
buffer_load_dwordx4 v230,s[24:27],s57 offen lds
s_add_u32 m0, s58, 26624
s_add_u32 s57, s59, 393472
buffer_load_dwordx4 v230,s[24:27],s57 offen lds
s_add_u32 m0, s58, 27648
s_add_u32 s57, s59, 393216
buffer_load_dwordx4 v230,s[28:31],s57 offen lds
s_add_u32 m0, s58, 28672
s_add_u32 s57, s59, 393344
buffer_load_dwordx4 v230,s[28:31],s57 offen lds
s_add_u32 m0, s58, 29696
s_add_u32 s57, s59, 393472
buffer_load_dwordx4 v230,s[28:31],s57 offen lds
s_bitcmp1_b32 s7, 3
s_cbranch_scc1 TL0x
s_add_u32 s57, s61, 0
buffer_load_dwordx4 a[0:3],v233,s[8:11],s57 offen
buffer_load_dwordx4 a[4:7],v233,s[8:11],s57 offen offset:1024
buffer_load_dwordx4 a[8:11],v233,s[8:11],s57 offen offset:2048
buffer_load_dwordx4 a[12:15],v233,s[8:11],s57 offen offset:3072
s_add_u32 s57, s61, 4096
buffer_load_dwordx4 a[16:19],v233,s[8:11],s57 offen
buffer_load_dwordx4 a[20:23],v233,s[8:11],s57 offen offset:1024
buffer_load_dwordx4 a[24:27],v233,s[8:11],s57 offen offset:2048
buffer_load_dwordx4 a[28:31],v233,s[8:11],s57 offen offset:3072
s_add_u32 s57, s61, 8192
buffer_load_dwordx4 a[32:35],v233,s[8:11],s57 offen
buffer_load_dwordx4 a[36:39],v233,s[8:11],s57 offen offset:1024
buffer_load_dwordx4 a[40:43],v233,s[8:11],s57 offen offset:2048
buffer_load_dwordx4 a[44:47],v233,s[8:11],s57 offen offset:3072
s_add_u32 s57, s61, 12288
buffer_load_dwordx4 a[48:51],v233,s[8:11],s57 offen
buffer_load_dwordx4 a[52:55],v233,s[8:11],s57 offen offset:1024
buffer_load_dwordx4 a[56:59],v233,s[8:11],s57 offen offset:2048
buffer_load_dwordx4 a[60:63],v233,s[8:11],s57 offen offset:3072
s_add_u32 s57, s61, 16384
buffer_load_dwordx4 a[64:67],v233,s[8:11],s57 offen
buffer_load_dwordx4 a[68:71],v233,s[8:11],s57 offen offset:1024
buffer_load_dwordx4 a[72:75],v233,s[8:11],s57 offen offset:2048
buffer_load_dwordx4 a[76:79],v233,s[8:11],s57 offen offset:3072
s_add_u32 s57, s61, 20480
buffer_load_dwordx4 a[80:83],v233,s[8:11],s57 offen
buffer_load_dwordx4 a[84:87],v233,s[8:11],s57 offen offset:1024
buffer_load_dwordx4 a[88:91],v233,s[8:11],s57 offen offset:2048
buffer_load_dwordx4 a[92:95],v233,s[8:11],s57 offen offset:3072
s_add_u32 s57, s61, 24576
buffer_load_dwordx4 a[96:99],v233,s[8:11],s57 offen
buffer_load_dwordx4 a[100:103],v233,s[8:11],s57 offen offset:1024
buffer_load_dwordx4 a[104:107],v233,s[8:11],s57 offen offset:2048
buffer_load_dwordx4 a[108:111],v233,s[8:11],s57 offen offset:3072
s_add_u32 s57, s61, 28672
buffer_load_dwordx4 a[112:115],v233,s[8:11],s57 offen
buffer_load_dwordx4 a[116:119],v233,s[8:11],s57 offen offset:1024
buffer_load_dwordx4 a[120:123],v233,s[8:11],s57 offen offset:2048
buffer_load_dwordx4 a[124:127],v233,s[8:11],s57 offen offset:3072
s_add_u32 s57, s61, 32768
buffer_load_dwordx4 a[128:131],v233,s[8:11],s57 offen
buffer_load_dwordx4 a[132:135],v233,s[8:11],s57 offen offset:1024
buffer_load_dwordx4 a[136:139],v233,s[8:11],s57 offen offset:2048
buffer_load_dwordx4 a[140:143],v233,s[8:11],s57 offen offset:3072
s_add_u32 s57, s61, 36864
buffer_load_dwordx4 a[144:147],v233,s[8:11],s57 offen
buffer_load_dwordx4 a[148:151],v233,s[8:11],s57 offen offset:1024
buffer_load_dwordx4 a[152:155],v233,s[8:11],s57 offen offset:2048
buffer_load_dwordx4 a[156:159],v233,s[8:11],s57 offen offset:3072
TL0x:
s_add_u32 m0, s58, 49152
s_add_u32 s57, s59, 786432
buffer_load_dwordx4 v230,s[24:27],s57 offen lds
s_add_u32 m0, s58, 50176
s_add_u32 s57, s59, 786560
buffer_load_dwordx4 v230,s[24:27],s57 offen lds
s_add_u32 m0, s58, 51200
s_add_u32 s57, s59, 786688
buffer_load_dwordx4 v230,s[24:27],s57 offen lds
s_add_u32 m0, s58, 52224
s_add_u32 s57, s59, 786432
buffer_load_dwordx4 v230,s[28:31],s57 offen lds
s_add_u32 m0, s58, 53248
s_add_u32 s57, s59, 786560
buffer_load_dwordx4 v230,s[28:31],s57 offen lds
s_add_u32 m0, s58, 54272
s_add_u32 s57, s59, 786688
buffer_load_dwordx4 v230,s[28:31],s57 offen lds
s_add_u32 m0, s58, 73728
s_add_u32 s57, s59, 1179648
buffer_load_dwordx4 v230,s[24:27],s57 offen lds
s_add_u32 m0, s58, 74752
s_add_u32 s57, s59, 1179776
buffer_load_dwordx4 v230,s[24:27],s57 offen lds
s_add_u32 m0, s58, 75776
s_add_u32 s57, s59, 1179904
buffer_load_dwordx4 v230,s[24:27],s57 offen lds
s_add_u32 m0, s58, 76800
s_add_u32 s57, s59, 1179648
buffer_load_dwordx4 v230,s[28:31],s57 offen lds
s_add_u32 m0, s58, 77824
s_add_u32 s57, s59, 1179776
buffer_load_dwordx4 v230,s[28:31],s57 offen lds
s_add_u32 m0, s58, 78848
s_add_u32 s57, s59, 1179904
buffer_load_dwordx4 v230,s[28:31],s57 offen lds
s_waitcnt vmcnt(0)
s_barrier
s_mov_b32 s65, 0
ds_read_b64_tr_b16 v[192:193],v224 offset:0
ds_read_b64_tr_b16 v[194:195],v224 offset:256
ds_read_b64_tr_b16 v[196:197],v224 offset:512
ds_read_b64_tr_b16 v[198:199],v224 offset:768
ds_read_b64_tr_b16 v[200:201],v224 offset:1024
ds_read_b64_tr_b16 v[202:203],v224 offset:1280
ds_read_b64_tr_b16 v[204:205],v224 offset:1536
ds_read_b64_tr_b16 v[206:207],v224 offset:1792
ds_read_b64_tr_b16 v[208:209],v224 offset:2048
ds_read_b64_tr_b16 v[210:211],v224 offset:2304
ds_read_b64_tr_b16 v[212:213],v224 offset:2560
ds_read_b64_tr_b16 v[214:215],v224 offset:2816
s_waitcnt vmcnt(0)
TL0:
ds_read_b64_tr_b16 v[216:217],v224 offset:3072
ds_read_b64_tr_b16 v[218:219],v224 offset:3328
s_waitcnt lgkmcnt(12)
v_mfma_f32_32x32x16_bf16 v[0:15],v[192:195],a[0:3],0
s_add_u32 s57, s65, 1
s_min_u32 s57, s57, 7
s_and_b32 s86, s57, 6
s_lshl_b32 s86, s86, 1
s_lshr_b32 s87, s7, 2
s_add_u32 s87, s87, s86
s_and_b32 s57, s57, 1
s_lshl_b32 s57, s57, 2
s_and_b32 s86, s62, 27
s_or_b32 s86, s86, s57
s_bitcmp1_b32 s65, 0
s_cselect_b32 s57, 3, 1
s_add_u32 s57, s63, s57
s_cmp_lt_u32 s65, 3
s_cselect_b32 s86, s62, s86
s_cselect_b32 s87, s57, s87
s_sub_u32 s57, s87, s63
s_mul_i32 s57, s57, 163840
s_add_u32 s91, s61, s57
ds_read_b64_tr_b16 v[220:221],v224 offset:3584
ds_read_b64_tr_b16 v[222:223],v224 offset:3840
s_waitcnt lgkmcnt(12)
v_mfma_f32_32x32x16_bf16 v[16:31],v[196:199],a[0:3],0
s_add_u32 m0, s58, 98304
s_add_u32 s57, s59, 1572864
buffer_load_dwordx4 v230,s[24:27],s57 offen lds
ds_read_b64_tr_b16 v[192:193],v224 offset:4096
ds_read_b64_tr_b16 v[194:195],v224 offset:4352
s_waitcnt lgkmcnt(12)
v_mfma_f32_32x32x16_bf16 v[32:47],v[200:203],a[0:3],0
ds_read_b64_tr_b16 v[196:197],v224 offset:4608
ds_read_b64_tr_b16 v[198:199],v224 offset:4864
s_waitcnt lgkmcnt(12)
v_mfma_f32_32x32x16_bf16 v[48:63],v[204:207],a[0:3],0
s_add_u32 m0, s58, 99328
s_add_u32 s57, s59, 1572992
buffer_load_dwordx4 v230,s[24:27],s57 offen lds
ds_read_b64_tr_b16 v[200:201],v224 offset:5120
ds_read_b64_tr_b16 v[202:203],v224 offset:5376
s_waitcnt lgkmcnt(12)
v_mfma_f32_32x32x16_bf16 v[64:79],v[208:211],a[0:3],0
ds_read_b64_tr_b16 v[204:205],v224 offset:5632
ds_read_b64_tr_b16 v[206:207],v224 offset:5888
s_waitcnt lgkmcnt(12)
v_mfma_f32_32x32x16_bf16 v[80:95],v[212:215],a[0:3],0
s_add_u32 m0, s58, 100352
s_add_u32 s57, s59, 1573120
buffer_load_dwordx4 v230,s[24:27],s57 offen lds
ds_read_b64_tr_b16 v[208:209],v224 offset:12288
ds_read_b64_tr_b16 v[210:211],v224 offset:12544
s_waitcnt lgkmcnt(12)
v_mfma_f32_32x32x16_bf16 v[96:111],v[216:219],a[0:3],0
ds_read_b64_tr_b16 v[212:213],v224 offset:12800
ds_read_b64_tr_b16 v[214:215],v224 offset:13056
s_waitcnt lgkmcnt(12)
v_mfma_f32_32x32x16_bf16 v[112:127],v[220:223],a[0:3],0
s_add_u32 m0, s58, 101376
s_add_u32 s57, s59, 1572864
buffer_load_dwordx4 v230,s[28:31],s57 offen lds
ds_read_b64_tr_b16 v[216:217],v224 offset:13312
ds_read_b64_tr_b16 v[218:219],v224 offset:13568
s_waitcnt lgkmcnt(12)
v_mfma_f32_32x32x16_bf16 v[128:143],v[192:195],a[0:3],0
ds_read_b64_tr_b16 v[220:221],v224 offset:13824
ds_read_b64_tr_b16 v[222:223],v224 offset:14080
s_waitcnt lgkmcnt(12)
v_mfma_f32_32x32x16_bf16 v[144:159],v[196:199],a[0:3],0
s_add_u32 m0, s58, 102400
s_add_u32 s57, s59, 1572992
buffer_load_dwordx4 v230,s[28:31],s57 offen lds
ds_read_b64_tr_b16 v[192:193],v224 offset:14336
ds_read_b64_tr_b16 v[194:195],v224 offset:14592
s_waitcnt lgkmcnt(12)
v_mfma_f32_32x32x16_bf16 v[160:175],v[200:203],a[0:3],0
ds_read_b64_tr_b16 v[196:197],v224 offset:14848
ds_read_b64_tr_b16 v[198:199],v224 offset:15104
s_waitcnt lgkmcnt(12)
v_mfma_f32_32x32x16_bf16 v[176:191],v[204:207],a[0:3],0
s_add_u32 m0, s58, 103424
s_add_u32 s57, s59, 1573120
buffer_load_dwordx4 v230,s[28:31],s57 offen lds
ds_read_b64_tr_b16 v[200:201],v224 offset:15360
ds_read_b64_tr_b16 v[202:203],v224 offset:15616
s_waitcnt lgkmcnt(12)
v_mfma_f32_32x32x16_bf16 v[0:15],v[208:211],a[4:7],v[0:15]
ds_read_b64_tr_b16 v[204:205],v224 offset:15872
ds_read_b64_tr_b16 v[206:207],v224 offset:16128
s_waitcnt lgkmcnt(12)
v_mfma_f32_32x32x16_bf16 v[16:31],v[212:215],a[4:7],v[16:31]
ds_read_b64_tr_b16 v[208:209],v224 offset:16384
ds_read_b64_tr_b16 v[210:211],v224 offset:16640
s_waitcnt lgkmcnt(12)
v_mfma_f32_32x32x16_bf16 v[32:47],v[216:219],a[4:7],v[32:47]
ds_read_b64_tr_b16 v[212:213],v224 offset:16896
ds_read_b64_tr_b16 v[214:215],v224 offset:17152
s_waitcnt lgkmcnt(12)
v_mfma_f32_32x32x16_bf16 v[48:63],v[220:223],a[4:7],v[48:63]
ds_read_b64_tr_b16 v[216:217],v224 offset:17408
ds_read_b64_tr_b16 v[218:219],v224 offset:17664
s_waitcnt lgkmcnt(12)
v_mfma_f32_32x32x16_bf16 v[64:79],v[192:195],a[4:7],v[64:79]
ds_read_b64_tr_b16 v[220:221],v224 offset:17920
ds_read_b64_tr_b16 v[222:223],v224 offset:18176
s_waitcnt lgkmcnt(12)
v_mfma_f32_32x32x16_bf16 v[80:95],v[196:199],a[4:7],v[80:95]
s_waitcnt vmcnt(44)
s_barrier
ds_read_b64_tr_b16 v[192:193],v224 offset:24576
ds_read_b64_tr_b16 v[194:195],v224 offset:24832
s_waitcnt lgkmcnt(12)
v_mfma_f32_32x32x16_bf16 v[96:111],v[200:203],a[4:7],v[96:111]
ds_read_b64_tr_b16 v[196:197],v224 offset:25088
ds_read_b64_tr_b16 v[198:199],v224 offset:25344
s_waitcnt lgkmcnt(12)
v_mfma_f32_32x32x16_bf16 v[112:127],v[204:207],a[4:7],v[112:127]
ds_read_b64_tr_b16 v[200:201],v224 offset:25600
ds_read_b64_tr_b16 v[202:203],v224 offset:25856
s_waitcnt lgkmcnt(12)
v_mfma_f32_32x32x16_bf16 v[128:143],v[208:211],a[4:7],v[128:143]
ds_read_b64_tr_b16 v[204:205],v224 offset:26112
ds_read_b64_tr_b16 v[206:207],v224 offset:26368
s_waitcnt lgkmcnt(12)
v_mfma_f32_32x32x16_bf16 v[144:159],v[212:215],a[4:7],v[144:159]
ds_read_b64_tr_b16 v[208:209],v224 offset:26624
ds_read_b64_tr_b16 v[210:211],v224 offset:26880
s_waitcnt lgkmcnt(12)
v_mfma_f32_32x32x16_bf16 v[160:175],v[216:219],a[4:7],v[160:175]
ds_read_b64_tr_b16 v[212:213],v224 offset:27136
ds_read_b64_tr_b16 v[214:215],v224 offset:27392
s_waitcnt lgkmcnt(12)
v_mfma_f32_32x32x16_bf16 v[176:191],v[220:223],a[4:7],v[176:191]
s_cmp_eq_u32 s91, s61
s_cbranch_scc1 XL0_0
s_add_u32 s57, s91, 0
buffer_load_dwordx4 a[0:3],v233,s[8:11],s57 offen
buffer_load_dwordx4 a[4:7],v233,s[8:11],s57 offen offset:1024
XL0_0:
ds_read_b64_tr_b16 v[216:217],v224 offset:27648
ds_read_b64_tr_b16 v[218:219],v224 offset:27904
s_waitcnt lgkmcnt(12)
v_mfma_f32_32x32x16_bf16 v[0:15],v[192:195],a[8:11],v[0:15]
ds_read_b64_tr_b16 v[220:221],v224 offset:28160
ds_read_b64_tr_b16 v[222:223],v224 offset:28416
s_waitcnt lgkmcnt(12)
v_mfma_f32_32x32x16_bf16 v[16:31],v[196:199],a[8:11],v[16:31]
s_add_u32 m0, s58, 0
s_add_u32 s57, s59, 1966080
buffer_load_dwordx4 v230,s[24:27],s57 offen lds
ds_read_b64_tr_b16 v[192:193],v224 offset:28672
ds_read_b64_tr_b16 v[194:195],v224 offset:28928
s_waitcnt lgkmcnt(12)
v_mfma_f32_32x32x16_bf16 v[32:47],v[200:203],a[8:11],v[32:47]
ds_read_b64_tr_b16 v[196:197],v224 offset:29184
ds_read_b64_tr_b16 v[198:199],v224 offset:29440
s_waitcnt lgkmcnt(12)
v_mfma_f32_32x32x16_bf16 v[48:63],v[204:207],a[8:11],v[48:63]
s_add_u32 m0, s58, 1024
s_add_u32 s57, s59, 1966208
buffer_load_dwordx4 v230,s[24:27],s57 offen lds
ds_read_b64_tr_b16 v[200:201],v224 offset:29696
ds_read_b64_tr_b16 v[202:203],v224 offset:29952
s_waitcnt lgkmcnt(12)
v_mfma_f32_32x32x16_bf16 v[64:79],v[208:211],a[8:11],v[64:79]
ds_read_b64_tr_b16 v[204:205],v224 offset:30208
ds_read_b64_tr_b16 v[206:207],v224 offset:30464
s_waitcnt lgkmcnt(12)
v_mfma_f32_32x32x16_bf16 v[80:95],v[212:215],a[8:11],v[80:95]
s_add_u32 m0, s58, 2048
s_add_u32 s57, s59, 1966336
buffer_load_dwordx4 v230,s[24:27],s57 offen lds
ds_read_b64_tr_b16 v[208:209],v224 offset:36864
ds_read_b64_tr_b16 v[210:211],v224 offset:37120
s_waitcnt lgkmcnt(12)
v_mfma_f32_32x32x16_bf16 v[96:111],v[216:219],a[8:11],v[96:111]
ds_read_b64_tr_b16 v[212:213],v224 offset:37376
ds_read_b64_tr_b16 v[214:215],v224 offset:37632
s_waitcnt lgkmcnt(12)
v_mfma_f32_32x32x16_bf16 v[112:127],v[220:223],a[8:11],v[112:127]
s_add_u32 m0, s58, 3072
s_add_u32 s57, s59, 1966080
buffer_load_dwordx4 v230,s[28:31],s57 offen lds
ds_read_b64_tr_b16 v[216:217],v224 offset:37888
ds_read_b64_tr_b16 v[218:219],v224 offset:38144
s_waitcnt lgkmcnt(12)
v_mfma_f32_32x32x16_bf16 v[128:143],v[192:195],a[8:11],v[128:143]
ds_read_b64_tr_b16 v[220:221],v224 offset:38400
ds_read_b64_tr_b16 v[222:223],v224 offset:38656
s_waitcnt lgkmcnt(12)
v_mfma_f32_32x32x16_bf16 v[144:159],v[196:199],a[8:11],v[144:159]
s_add_u32 m0, s58, 4096
s_add_u32 s57, s59, 1966208
buffer_load_dwordx4 v230,s[28:31],s57 offen lds
ds_read_b64_tr_b16 v[192:193],v224 offset:38912
ds_read_b64_tr_b16 v[194:195],v224 offset:39168
s_waitcnt lgkmcnt(12)
v_mfma_f32_32x32x16_bf16 v[160:175],v[200:203],a[8:11],v[160:175]
ds_read_b64_tr_b16 v[196:197],v224 offset:39424
ds_read_b64_tr_b16 v[198:199],v224 offset:39680
s_waitcnt lgkmcnt(12)
v_mfma_f32_32x32x16_bf16 v[176:191],v[204:207],a[8:11],v[176:191]
s_add_u32 m0, s58, 5120
s_add_u32 s57, s59, 1966336
buffer_load_dwordx4 v230,s[28:31],s57 offen lds
ds_read_b64_tr_b16 v[200:201],v224 offset:39936
ds_read_b64_tr_b16 v[202:203],v224 offset:40192
s_waitcnt lgkmcnt(12)
v_mfma_f32_32x32x16_bf16 v[0:15],v[208:211],a[12:15],v[0:15]
ds_read_b64_tr_b16 v[204:205],v224 offset:40448
ds_read_b64_tr_b16 v[206:207],v224 offset:40704
s_waitcnt lgkmcnt(12)
v_mfma_f32_32x32x16_bf16 v[16:31],v[212:215],a[12:15],v[16:31]
ds_read_b64_tr_b16 v[208:209],v224 offset:40960
ds_read_b64_tr_b16 v[210:211],v224 offset:41216
s_waitcnt lgkmcnt(12)
v_mfma_f32_32x32x16_bf16 v[32:47],v[216:219],a[12:15],v[32:47]
ds_read_b64_tr_b16 v[212:213],v224 offset:41472
ds_read_b64_tr_b16 v[214:215],v224 offset:41728
s_waitcnt lgkmcnt(12)
v_mfma_f32_32x32x16_bf16 v[48:63],v[220:223],a[12:15],v[48:63]
ds_read_b64_tr_b16 v[216:217],v224 offset:41984
ds_read_b64_tr_b16 v[218:219],v224 offset:42240
s_waitcnt lgkmcnt(12)
v_mfma_f32_32x32x16_bf16 v[64:79],v[192:195],a[12:15],v[64:79]
ds_read_b64_tr_b16 v[220:221],v224 offset:42496
ds_read_b64_tr_b16 v[222:223],v224 offset:42752
s_waitcnt lgkmcnt(12)
v_mfma_f32_32x32x16_bf16 v[80:95],v[196:199],a[12:15],v[80:95]
s_waitcnt vmcnt(44)
s_barrier
ds_read_b64_tr_b16 v[192:193],v225 offset:0
ds_read_b64_tr_b16 v[194:195],v225 offset:256
s_waitcnt lgkmcnt(12)
v_mfma_f32_32x32x16_bf16 v[96:111],v[200:203],a[12:15],v[96:111]
ds_read_b64_tr_b16 v[196:197],v225 offset:512
ds_read_b64_tr_b16 v[198:199],v225 offset:768
s_waitcnt lgkmcnt(12)
v_mfma_f32_32x32x16_bf16 v[112:127],v[204:207],a[12:15],v[112:127]
ds_read_b64_tr_b16 v[200:201],v225 offset:1024
ds_read_b64_tr_b16 v[202:203],v225 offset:1280
s_waitcnt lgkmcnt(12)
v_mfma_f32_32x32x16_bf16 v[128:143],v[208:211],a[12:15],v[128:143]
ds_read_b64_tr_b16 v[204:205],v225 offset:1536
ds_read_b64_tr_b16 v[206:207],v225 offset:1792
s_waitcnt lgkmcnt(12)
v_mfma_f32_32x32x16_bf16 v[144:159],v[212:215],a[12:15],v[144:159]
ds_read_b64_tr_b16 v[208:209],v225 offset:2048
ds_read_b64_tr_b16 v[210:211],v225 offset:2304
s_waitcnt lgkmcnt(12)
v_mfma_f32_32x32x16_bf16 v[160:175],v[216:219],a[12:15],v[160:175]
ds_read_b64_tr_b16 v[212:213],v225 offset:2560
ds_read_b64_tr_b16 v[214:215],v225 offset:2816
s_waitcnt lgkmcnt(12)
v_mfma_f32_32x32x16_bf16 v[176:191],v[220:223],a[12:15],v[176:191]
s_cmp_eq_u32 s91, s61
s_cbranch_scc1 XL0_2
s_add_u32 s57, s91, 2048
buffer_load_dwordx4 a[8:11],v233,s[8:11],s57 offen
buffer_load_dwordx4 a[12:15],v233,s[8:11],s57 offen offset:1024
XL0_2:
ds_read_b64_tr_b16 v[216:217],v225 offset:3072
ds_read_b64_tr_b16 v[218:219],v225 offset:3328
s_waitcnt lgkmcnt(12)
v_mfma_f32_32x32x16_bf16 v[0:15],v[192:195],a[16:19],v[0:15]
ds_read_b64_tr_b16 v[220:221],v225 offset:3584
ds_read_b64_tr_b16 v[222:223],v225 offset:3840
s_waitcnt lgkmcnt(12)
v_mfma_f32_32x32x16_bf16 v[16:31],v[196:199],a[16:19],v[16:31]
s_add_u32 m0, s58, 24576
s_add_u32 s57, s59, 2359296
buffer_load_dwordx4 v230,s[24:27],s57 offen lds
ds_read_b64_tr_b16 v[192:193],v225 offset:4096
ds_read_b64_tr_b16 v[194:195],v225 offset:4352
s_waitcnt lgkmcnt(12)
v_mfma_f32_32x32x16_bf16 v[32:47],v[200:203],a[16:19],v[32:47]
ds_read_b64_tr_b16 v[196:197],v225 offset:4608
ds_read_b64_tr_b16 v[198:199],v225 offset:4864
s_waitcnt lgkmcnt(12)
v_mfma_f32_32x32x16_bf16 v[48:63],v[204:207],a[16:19],v[48:63]
s_add_u32 m0, s58, 25600
s_add_u32 s57, s59, 2359424
buffer_load_dwordx4 v230,s[24:27],s57 offen lds
ds_read_b64_tr_b16 v[200:201],v225 offset:5120
ds_read_b64_tr_b16 v[202:203],v225 offset:5376
s_waitcnt lgkmcnt(12)
v_mfma_f32_32x32x16_bf16 v[64:79],v[208:211],a[16:19],v[64:79]
ds_read_b64_tr_b16 v[204:205],v225 offset:5632
ds_read_b64_tr_b16 v[206:207],v225 offset:5888
s_waitcnt lgkmcnt(12)
v_mfma_f32_32x32x16_bf16 v[80:95],v[212:215],a[16:19],v[80:95]
s_add_u32 m0, s58, 26624
s_add_u32 s57, s59, 2359552
buffer_load_dwordx4 v230,s[24:27],s57 offen lds
ds_read_b64_tr_b16 v[208:209],v225 offset:12288
ds_read_b64_tr_b16 v[210:211],v225 offset:12544
s_waitcnt lgkmcnt(12)
v_mfma_f32_32x32x16_bf16 v[96:111],v[216:219],a[16:19],v[96:111]
ds_read_b64_tr_b16 v[212:213],v225 offset:12800
ds_read_b64_tr_b16 v[214:215],v225 offset:13056
s_waitcnt lgkmcnt(12)
v_mfma_f32_32x32x16_bf16 v[112:127],v[220:223],a[16:19],v[112:127]
s_add_u32 m0, s58, 27648
s_add_u32 s57, s59, 2359296
buffer_load_dwordx4 v230,s[28:31],s57 offen lds
ds_read_b64_tr_b16 v[216:217],v225 offset:13312
ds_read_b64_tr_b16 v[218:219],v225 offset:13568
s_waitcnt lgkmcnt(12)
v_mfma_f32_32x32x16_bf16 v[128:143],v[192:195],a[16:19],v[128:143]
ds_read_b64_tr_b16 v[220:221],v225 offset:13824
ds_read_b64_tr_b16 v[222:223],v225 offset:14080
s_waitcnt lgkmcnt(12)
v_mfma_f32_32x32x16_bf16 v[144:159],v[196:199],a[16:19],v[144:159]
s_add_u32 m0, s58, 28672
s_add_u32 s57, s59, 2359424
buffer_load_dwordx4 v230,s[28:31],s57 offen lds
ds_read_b64_tr_b16 v[192:193],v225 offset:14336
ds_read_b64_tr_b16 v[194:195],v225 offset:14592
s_waitcnt lgkmcnt(12)
v_mfma_f32_32x32x16_bf16 v[160:175],v[200:203],a[16:19],v[160:175]
ds_read_b64_tr_b16 v[196:197],v225 offset:14848
ds_read_b64_tr_b16 v[198:199],v225 offset:15104
s_waitcnt lgkmcnt(12)
v_mfma_f32_32x32x16_bf16 v[176:191],v[204:207],a[16:19],v[176:191]
s_add_u32 m0, s58, 29696
s_add_u32 s57, s59, 2359552
buffer_load_dwordx4 v230,s[28:31],s57 offen lds
ds_read_b64_tr_b16 v[200:201],v225 offset:15360
ds_read_b64_tr_b16 v[202:203],v225 offset:15616
s_waitcnt lgkmcnt(12)
v_mfma_f32_32x32x16_bf16 v[0:15],v[208:211],a[20:23],v[0:15]
ds_read_b64_tr_b16 v[204:205],v225 offset:15872
ds_read_b64_tr_b16 v[206:207],v225 offset:16128
s_waitcnt lgkmcnt(12)
v_mfma_f32_32x32x16_bf16 v[16:31],v[212:215],a[20:23],v[16:31]
ds_read_b64_tr_b16 v[208:209],v225 offset:16384
ds_read_b64_tr_b16 v[210:211],v225 offset:16640
s_waitcnt lgkmcnt(12)
v_mfma_f32_32x32x16_bf16 v[32:47],v[216:219],a[20:23],v[32:47]
ds_read_b64_tr_b16 v[212:213],v225 offset:16896
ds_read_b64_tr_b16 v[214:215],v225 offset:17152
s_waitcnt lgkmcnt(12)
v_mfma_f32_32x32x16_bf16 v[48:63],v[220:223],a[20:23],v[48:63]
ds_read_b64_tr_b16 v[216:217],v225 offset:17408
ds_read_b64_tr_b16 v[218:219],v225 offset:17664
s_waitcnt lgkmcnt(12)
v_mfma_f32_32x32x16_bf16 v[64:79],v[192:195],a[20:23],v[64:79]
ds_read_b64_tr_b16 v[220:221],v225 offset:17920
ds_read_b64_tr_b16 v[222:223],v225 offset:18176
s_waitcnt lgkmcnt(12)
v_mfma_f32_32x32x16_bf16 v[80:95],v[196:199],a[20:23],v[80:95]
s_waitcnt vmcnt(44)
s_barrier
ds_read_b64_tr_b16 v[192:193],v225 offset:24576
ds_read_b64_tr_b16 v[194:195],v225 offset:24832
s_waitcnt lgkmcnt(12)
v_mfma_f32_32x32x16_bf16 v[96:111],v[200:203],a[20:23],v[96:111]
ds_read_b64_tr_b16 v[196:197],v225 offset:25088
ds_read_b64_tr_b16 v[198:199],v225 offset:25344
s_waitcnt lgkmcnt(12)
v_mfma_f32_32x32x16_bf16 v[112:127],v[204:207],a[20:23],v[112:127]
ds_read_b64_tr_b16 v[200:201],v225 offset:25600
ds_read_b64_tr_b16 v[202:203],v225 offset:25856
s_waitcnt lgkmcnt(12)
v_mfma_f32_32x32x16_bf16 v[128:143],v[208:211],a[20:23],v[128:143]
ds_read_b64_tr_b16 v[204:205],v225 offset:26112
ds_read_b64_tr_b16 v[206:207],v225 offset:26368
s_waitcnt lgkmcnt(12)
v_mfma_f32_32x32x16_bf16 v[144:159],v[212:215],a[20:23],v[144:159]
ds_read_b64_tr_b16 v[208:209],v225 offset:26624
ds_read_b64_tr_b16 v[210:211],v225 offset:26880
s_waitcnt lgkmcnt(12)
v_mfma_f32_32x32x16_bf16 v[160:175],v[216:219],a[20:23],v[160:175]
ds_read_b64_tr_b16 v[212:213],v225 offset:27136
ds_read_b64_tr_b16 v[214:215],v225 offset:27392
s_waitcnt lgkmcnt(12)
v_mfma_f32_32x32x16_bf16 v[176:191],v[220:223],a[20:23],v[176:191]
s_cmp_eq_u32 s91, s61
s_cbranch_scc1 XL0_4
s_add_u32 s57, s91, 4096
buffer_load_dwordx4 a[16:19],v233,s[8:11],s57 offen
buffer_load_dwordx4 a[20:23],v233,s[8:11],s57 offen offset:1024
XL0_4:
ds_read_b64_tr_b16 v[216:217],v225 offset:27648
ds_read_b64_tr_b16 v[218:219],v225 offset:27904
s_waitcnt lgkmcnt(12)
v_mfma_f32_32x32x16_bf16 v[0:15],v[192:195],a[24:27],v[0:15]
ds_read_b64_tr_b16 v[220:221],v225 offset:28160
ds_read_b64_tr_b16 v[222:223],v225 offset:28416
s_waitcnt lgkmcnt(12)
v_mfma_f32_32x32x16_bf16 v[16:31],v[196:199],a[24:27],v[16:31]
s_add_u32 m0, s58, 49152
s_add_u32 s57, s59, 2752512
buffer_load_dwordx4 v230,s[24:27],s57 offen lds
ds_read_b64_tr_b16 v[192:193],v225 offset:28672
ds_read_b64_tr_b16 v[194:195],v225 offset:28928
s_waitcnt lgkmcnt(12)
v_mfma_f32_32x32x16_bf16 v[32:47],v[200:203],a[24:27],v[32:47]
ds_read_b64_tr_b16 v[196:197],v225 offset:29184
ds_read_b64_tr_b16 v[198:199],v225 offset:29440
s_waitcnt lgkmcnt(12)
v_mfma_f32_32x32x16_bf16 v[48:63],v[204:207],a[24:27],v[48:63]
s_add_u32 m0, s58, 50176
s_add_u32 s57, s59, 2752640
buffer_load_dwordx4 v230,s[24:27],s57 offen lds
ds_read_b64_tr_b16 v[200:201],v225 offset:29696
ds_read_b64_tr_b16 v[202:203],v225 offset:29952
s_waitcnt lgkmcnt(12)
v_mfma_f32_32x32x16_bf16 v[64:79],v[208:211],a[24:27],v[64:79]
ds_read_b64_tr_b16 v[204:205],v225 offset:30208
ds_read_b64_tr_b16 v[206:207],v225 offset:30464
s_waitcnt lgkmcnt(12)
v_mfma_f32_32x32x16_bf16 v[80:95],v[212:215],a[24:27],v[80:95]
s_add_u32 m0, s58, 51200
s_add_u32 s57, s59, 2752768
buffer_load_dwordx4 v230,s[24:27],s57 offen lds
ds_read_b64_tr_b16 v[208:209],v225 offset:36864
ds_read_b64_tr_b16 v[210:211],v225 offset:37120
s_waitcnt lgkmcnt(12)
v_mfma_f32_32x32x16_bf16 v[96:111],v[216:219],a[24:27],v[96:111]
ds_read_b64_tr_b16 v[212:213],v225 offset:37376
ds_read_b64_tr_b16 v[214:215],v225 offset:37632
s_waitcnt lgkmcnt(12)
v_mfma_f32_32x32x16_bf16 v[112:127],v[220:223],a[24:27],v[112:127]
s_add_u32 m0, s58, 52224
s_add_u32 s57, s59, 2752512
buffer_load_dwordx4 v230,s[28:31],s57 offen lds
ds_read_b64_tr_b16 v[216:217],v225 offset:37888
ds_read_b64_tr_b16 v[218:219],v225 offset:38144
s_waitcnt lgkmcnt(12)
v_mfma_f32_32x32x16_bf16 v[128:143],v[192:195],a[24:27],v[128:143]
ds_read_b64_tr_b16 v[220:221],v225 offset:38400
ds_read_b64_tr_b16 v[222:223],v225 offset:38656
s_waitcnt lgkmcnt(12)
v_mfma_f32_32x32x16_bf16 v[144:159],v[196:199],a[24:27],v[144:159]
s_add_u32 m0, s58, 53248
s_add_u32 s57, s59, 2752640
buffer_load_dwordx4 v230,s[28:31],s57 offen lds
ds_read_b64_tr_b16 v[192:193],v225 offset:38912
ds_read_b64_tr_b16 v[194:195],v225 offset:39168
s_waitcnt lgkmcnt(12)
v_mfma_f32_32x32x16_bf16 v[160:175],v[200:203],a[24:27],v[160:175]
ds_read_b64_tr_b16 v[196:197],v225 offset:39424
ds_read_b64_tr_b16 v[198:199],v225 offset:39680
s_waitcnt lgkmcnt(12)
v_mfma_f32_32x32x16_bf16 v[176:191],v[204:207],a[24:27],v[176:191]
s_add_u32 m0, s58, 54272
s_add_u32 s57, s59, 2752768
buffer_load_dwordx4 v230,s[28:31],s57 offen lds
ds_read_b64_tr_b16 v[200:201],v225 offset:39936
ds_read_b64_tr_b16 v[202:203],v225 offset:40192
s_waitcnt lgkmcnt(12)
v_mfma_f32_32x32x16_bf16 v[0:15],v[208:211],a[28:31],v[0:15]
ds_read_b64_tr_b16 v[204:205],v225 offset:40448
ds_read_b64_tr_b16 v[206:207],v225 offset:40704
s_waitcnt lgkmcnt(12)
v_mfma_f32_32x32x16_bf16 v[16:31],v[212:215],a[28:31],v[16:31]
ds_read_b64_tr_b16 v[208:209],v225 offset:40960
ds_read_b64_tr_b16 v[210:211],v225 offset:41216
s_waitcnt lgkmcnt(12)
v_mfma_f32_32x32x16_bf16 v[32:47],v[216:219],a[28:31],v[32:47]
ds_read_b64_tr_b16 v[212:213],v225 offset:41472
ds_read_b64_tr_b16 v[214:215],v225 offset:41728
s_waitcnt lgkmcnt(12)
v_mfma_f32_32x32x16_bf16 v[48:63],v[220:223],a[28:31],v[48:63]
ds_read_b64_tr_b16 v[216:217],v225 offset:41984
ds_read_b64_tr_b16 v[218:219],v225 offset:42240
s_waitcnt lgkmcnt(12)
v_mfma_f32_32x32x16_bf16 v[64:79],v[192:195],a[28:31],v[64:79]
ds_read_b64_tr_b16 v[220:221],v225 offset:42496
ds_read_b64_tr_b16 v[222:223],v225 offset:42752
s_waitcnt lgkmcnt(12)
v_mfma_f32_32x32x16_bf16 v[80:95],v[196:199],a[28:31],v[80:95]
s_waitcnt vmcnt(18)
s_barrier
ds_read_b64_tr_b16 v[192:193],v226 offset:0
ds_read_b64_tr_b16 v[194:195],v226 offset:256
s_waitcnt lgkmcnt(12)
v_mfma_f32_32x32x16_bf16 v[96:111],v[200:203],a[28:31],v[96:111]
ds_read_b64_tr_b16 v[196:197],v226 offset:512
ds_read_b64_tr_b16 v[198:199],v226 offset:768
s_waitcnt lgkmcnt(12)
v_mfma_f32_32x32x16_bf16 v[112:127],v[204:207],a[28:31],v[112:127]
buffer_atomic_add v239,v238,s[8:11],s93 offen sc1
ds_read_b64_tr_b16 v[200:201],v226 offset:1024
ds_read_b64_tr_b16 v[202:203],v226 offset:1280
s_waitcnt lgkmcnt(12)
v_mfma_f32_32x32x16_bf16 v[128:143],v[208:211],a[28:31],v[128:143]
ds_read_b64_tr_b16 v[204:205],v226 offset:1536
ds_read_b64_tr_b16 v[206:207],v226 offset:1792
s_waitcnt lgkmcnt(12)
v_mfma_f32_32x32x16_bf16 v[144:159],v[212:215],a[28:31],v[144:159]
ds_read_b64_tr_b16 v[208:209],v226 offset:2048
ds_read_b64_tr_b16 v[210:211],v226 offset:2304
s_waitcnt lgkmcnt(12)
v_mfma_f32_32x32x16_bf16 v[160:175],v[216:219],a[28:31],v[160:175]
ds_read_b64_tr_b16 v[212:213],v226 offset:2560
ds_read_b64_tr_b16 v[214:215],v226 offset:2816
s_waitcnt lgkmcnt(12)
v_mfma_f32_32x32x16_bf16 v[176:191],v[220:223],a[28:31],v[176:191]
s_cmp_eq_u32 s91, s61
s_cbranch_scc1 XL0_6
s_add_u32 s57, s91, 6144
buffer_load_dwordx4 a[24:27],v233,s[8:11],s57 offen
buffer_load_dwordx4 a[28:31],v233,s[8:11],s57 offen offset:1024
XL0_6:
ds_read_b64_tr_b16 v[216:217],v226 offset:3072
ds_read_b64_tr_b16 v[218:219],v226 offset:3328
s_waitcnt lgkmcnt(12)
v_mfma_f32_32x32x16_bf16 v[0:15],v[192:195],a[32:35],v[0:15]
ds_read_b64_tr_b16 v[220:221],v226 offset:3584
ds_read_b64_tr_b16 v[222:223],v226 offset:3840
s_waitcnt lgkmcnt(12)
v_mfma_f32_32x32x16_bf16 v[16:31],v[196:199],a[32:35],v[16:31]
s_add_u32 m0, s58, 73728
s_add_u32 s57, s59, 3145728
buffer_load_dwordx4 v230,s[24:27],s57 offen lds
ds_read_b64_tr_b16 v[192:193],v226 offset:4096
ds_read_b64_tr_b16 v[194:195],v226 offset:4352
s_waitcnt lgkmcnt(12)
v_mfma_f32_32x32x16_bf16 v[32:47],v[200:203],a[32:35],v[32:47]
ds_read_b64_tr_b16 v[196:197],v226 offset:4608
ds_read_b64_tr_b16 v[198:199],v226 offset:4864
s_waitcnt lgkmcnt(12)
v_mfma_f32_32x32x16_bf16 v[48:63],v[204:207],a[32:35],v[48:63]
s_add_u32 m0, s58, 74752
s_add_u32 s57, s59, 3145856
buffer_load_dwordx4 v230,s[24:27],s57 offen lds
ds_read_b64_tr_b16 v[200:201],v226 offset:5120
ds_read_b64_tr_b16 v[202:203],v226 offset:5376
s_waitcnt lgkmcnt(12)
v_mfma_f32_32x32x16_bf16 v[64:79],v[208:211],a[32:35],v[64:79]
ds_read_b64_tr_b16 v[204:205],v226 offset:5632
ds_read_b64_tr_b16 v[206:207],v226 offset:5888
s_waitcnt lgkmcnt(12)
v_mfma_f32_32x32x16_bf16 v[80:95],v[212:215],a[32:35],v[80:95]
s_add_u32 m0, s58, 75776
s_add_u32 s57, s59, 3145984
buffer_load_dwordx4 v230,s[24:27],s57 offen lds
ds_read_b64_tr_b16 v[208:209],v226 offset:12288
ds_read_b64_tr_b16 v[210:211],v226 offset:12544
s_waitcnt lgkmcnt(12)
v_mfma_f32_32x32x16_bf16 v[96:111],v[216:219],a[32:35],v[96:111]
ds_read_b64_tr_b16 v[212:213],v226 offset:12800
ds_read_b64_tr_b16 v[214:215],v226 offset:13056
s_waitcnt lgkmcnt(12)
v_mfma_f32_32x32x16_bf16 v[112:127],v[220:223],a[32:35],v[112:127]
s_add_u32 m0, s58, 76800
s_add_u32 s57, s59, 3145728
buffer_load_dwordx4 v230,s[28:31],s57 offen lds
ds_read_b64_tr_b16 v[216:217],v226 offset:13312
ds_read_b64_tr_b16 v[218:219],v226 offset:13568
s_waitcnt lgkmcnt(12)
v_mfma_f32_32x32x16_bf16 v[128:143],v[192:195],a[32:35],v[128:143]
ds_read_b64_tr_b16 v[220:221],v226 offset:13824
ds_read_b64_tr_b16 v[222:223],v226 offset:14080
s_waitcnt lgkmcnt(12)
v_mfma_f32_32x32x16_bf16 v[144:159],v[196:199],a[32:35],v[144:159]
s_add_u32 m0, s58, 77824
s_add_u32 s57, s59, 3145856
buffer_load_dwordx4 v230,s[28:31],s57 offen lds
ds_read_b64_tr_b16 v[192:193],v226 offset:14336
ds_read_b64_tr_b16 v[194:195],v226 offset:14592
s_waitcnt lgkmcnt(12)
v_mfma_f32_32x32x16_bf16 v[160:175],v[200:203],a[32:35],v[160:175]
ds_read_b64_tr_b16 v[196:197],v226 offset:14848
ds_read_b64_tr_b16 v[198:199],v226 offset:15104
s_waitcnt lgkmcnt(12)
v_mfma_f32_32x32x16_bf16 v[176:191],v[204:207],a[32:35],v[176:191]
s_add_u32 m0, s58, 78848
s_add_u32 s57, s59, 3145984
buffer_load_dwordx4 v230,s[28:31],s57 offen lds
ds_read_b64_tr_b16 v[200:201],v226 offset:15360
ds_read_b64_tr_b16 v[202:203],v226 offset:15616
s_waitcnt lgkmcnt(12)
v_mfma_f32_32x32x16_bf16 v[0:15],v[208:211],a[36:39],v[0:15]
ds_read_b64_tr_b16 v[204:205],v226 offset:15872
ds_read_b64_tr_b16 v[206:207],v226 offset:16128
s_waitcnt lgkmcnt(12)
v_mfma_f32_32x32x16_bf16 v[16:31],v[212:215],a[36:39],v[16:31]
ds_read_b64_tr_b16 v[208:209],v226 offset:16384
ds_read_b64_tr_b16 v[210:211],v226 offset:16640
s_waitcnt lgkmcnt(12)
v_mfma_f32_32x32x16_bf16 v[32:47],v[216:219],a[36:39],v[32:47]
ds_read_b64_tr_b16 v[212:213],v226 offset:16896
ds_read_b64_tr_b16 v[214:215],v226 offset:17152
s_waitcnt lgkmcnt(12)
v_mfma_f32_32x32x16_bf16 v[48:63],v[220:223],a[36:39],v[48:63]
ds_read_b64_tr_b16 v[216:217],v226 offset:17408
ds_read_b64_tr_b16 v[218:219],v226 offset:17664
s_waitcnt lgkmcnt(12)
v_mfma_f32_32x32x16_bf16 v[64:79],v[192:195],a[36:39],v[64:79]
ds_read_b64_tr_b16 v[220:221],v226 offset:17920
ds_read_b64_tr_b16 v[222:223],v226 offset:18176
s_waitcnt lgkmcnt(12)
v_mfma_f32_32x32x16_bf16 v[80:95],v[196:199],a[36:39],v[80:95]
s_waitcnt vmcnt(19)
s_barrier
ds_read_b64_tr_b16 v[192:193],v224 offset:0
ds_read_b64_tr_b16 v[194:195],v224 offset:256
s_waitcnt lgkmcnt(12)
v_mfma_f32_32x32x16_bf16 v[96:111],v[200:203],a[36:39],v[96:111]
ds_read_b64_tr_b16 v[196:197],v224 offset:512
ds_read_b64_tr_b16 v[198:199],v224 offset:768
s_waitcnt lgkmcnt(12)
v_mfma_f32_32x32x16_bf16 v[112:127],v[204:207],a[36:39],v[112:127]
ds_read_b64_tr_b16 v[200:201],v224 offset:1024
ds_read_b64_tr_b16 v[202:203],v224 offset:1280
s_waitcnt lgkmcnt(12)
v_mfma_f32_32x32x16_bf16 v[128:143],v[208:211],a[36:39],v[128:143]
ds_read_b64_tr_b16 v[204:205],v224 offset:1536
ds_read_b64_tr_b16 v[206:207],v224 offset:1792
s_waitcnt lgkmcnt(12)
v_mfma_f32_32x32x16_bf16 v[144:159],v[212:215],a[36:39],v[144:159]
ds_read_b64_tr_b16 v[208:209],v224 offset:2048
ds_read_b64_tr_b16 v[210:211],v224 offset:2304
s_waitcnt lgkmcnt(12)
v_mfma_f32_32x32x16_bf16 v[160:175],v[216:219],a[36:39],v[160:175]
ds_read_b64_tr_b16 v[212:213],v224 offset:2560
ds_read_b64_tr_b16 v[214:215],v224 offset:2816
s_waitcnt lgkmcnt(12)
v_mfma_f32_32x32x16_bf16 v[176:191],v[220:223],a[36:39],v[176:191]
s_cmp_eq_u32 s91, s61
s_cbranch_scc1 XL0_8
s_add_u32 s57, s91, 8192
buffer_load_dwordx4 a[32:35],v233,s[8:11],s57 offen
buffer_load_dwordx4 a[36:39],v233,s[8:11],s57 offen offset:1024
XL0_8:
ds_read_b64_tr_b16 v[216:217],v224 offset:3072
ds_read_b64_tr_b16 v[218:219],v224 offset:3328
s_waitcnt lgkmcnt(12)
v_mfma_f32_32x32x16_bf16 v[0:15],v[192:195],a[40:43],v[0:15]
ds_read_b64_tr_b16 v[220:221],v224 offset:3584
ds_read_b64_tr_b16 v[222:223],v224 offset:3840
s_waitcnt lgkmcnt(12)
v_mfma_f32_32x32x16_bf16 v[16:31],v[196:199],a[40:43],v[16:31]
s_add_u32 m0, s58, 98304
s_add_u32 s57, s59, 3538944
buffer_load_dwordx4 v230,s[24:27],s57 offen lds
ds_read_b64_tr_b16 v[192:193],v224 offset:4096
ds_read_b64_tr_b16 v[194:195],v224 offset:4352
s_waitcnt lgkmcnt(12)
v_mfma_f32_32x32x16_bf16 v[32:47],v[200:203],a[40:43],v[32:47]
ds_read_b64_tr_b16 v[196:197],v224 offset:4608
ds_read_b64_tr_b16 v[198:199],v224 offset:4864
s_waitcnt lgkmcnt(12)
v_mfma_f32_32x32x16_bf16 v[48:63],v[204:207],a[40:43],v[48:63]
s_add_u32 m0, s58, 99328
s_add_u32 s57, s59, 3539072
buffer_load_dwordx4 v230,s[24:27],s57 offen lds
ds_read_b64_tr_b16 v[200:201],v224 offset:5120
ds_read_b64_tr_b16 v[202:203],v224 offset:5376
s_waitcnt lgkmcnt(12)
v_mfma_f32_32x32x16_bf16 v[64:79],v[208:211],a[40:43],v[64:79]
ds_read_b64_tr_b16 v[204:205],v224 offset:5632
ds_read_b64_tr_b16 v[206:207],v224 offset:5888
s_waitcnt lgkmcnt(12)
v_mfma_f32_32x32x16_bf16 v[80:95],v[212:215],a[40:43],v[80:95]
s_add_u32 m0, s58, 100352
s_add_u32 s57, s59, 3539200
buffer_load_dwordx4 v230,s[24:27],s57 offen lds
ds_read_b64_tr_b16 v[208:209],v224 offset:12288
ds_read_b64_tr_b16 v[210:211],v224 offset:12544
s_waitcnt lgkmcnt(12)
v_mfma_f32_32x32x16_bf16 v[96:111],v[216:219],a[40:43],v[96:111]
ds_read_b64_tr_b16 v[212:213],v224 offset:12800
ds_read_b64_tr_b16 v[214:215],v224 offset:13056
s_waitcnt lgkmcnt(12)
v_mfma_f32_32x32x16_bf16 v[112:127],v[220:223],a[40:43],v[112:127]
s_add_u32 m0, s58, 101376
s_add_u32 s57, s59, 3538944
buffer_load_dwordx4 v230,s[28:31],s57 offen lds
ds_read_b64_tr_b16 v[216:217],v224 offset:13312
ds_read_b64_tr_b16 v[218:219],v224 offset:13568
s_waitcnt lgkmcnt(12)
v_mfma_f32_32x32x16_bf16 v[128:143],v[192:195],a[40:43],v[128:143]
ds_read_b64_tr_b16 v[220:221],v224 offset:13824
ds_read_b64_tr_b16 v[222:223],v224 offset:14080
s_waitcnt lgkmcnt(12)
v_mfma_f32_32x32x16_bf16 v[144:159],v[196:199],a[40:43],v[144:159]
s_add_u32 m0, s58, 102400
s_add_u32 s57, s59, 3539072
buffer_load_dwordx4 v230,s[28:31],s57 offen lds
ds_read_b64_tr_b16 v[192:193],v224 offset:14336
ds_read_b64_tr_b16 v[194:195],v224 offset:14592
s_waitcnt lgkmcnt(12)
v_mfma_f32_32x32x16_bf16 v[160:175],v[200:203],a[40:43],v[160:175]
ds_read_b64_tr_b16 v[196:197],v224 offset:14848
ds_read_b64_tr_b16 v[198:199],v224 offset:15104
s_waitcnt lgkmcnt(12)
v_mfma_f32_32x32x16_bf16 v[176:191],v[204:207],a[40:43],v[176:191]
s_add_u32 m0, s58, 103424
s_add_u32 s57, s59, 3539200
buffer_load_dwordx4 v230,s[28:31],s57 offen lds
ds_read_b64_tr_b16 v[200:201],v224 offset:15360
ds_read_b64_tr_b16 v[202:203],v224 offset:15616
s_waitcnt lgkmcnt(12)
v_mfma_f32_32x32x16_bf16 v[0:15],v[208:211],a[44:47],v[0:15]
ds_read_b64_tr_b16 v[204:205],v224 offset:15872
ds_read_b64_tr_b16 v[206:207],v224 offset:16128
s_waitcnt lgkmcnt(12)
v_mfma_f32_32x32x16_bf16 v[16:31],v[212:215],a[44:47],v[16:31]
ds_read_b64_tr_b16 v[208:209],v224 offset:16384
ds_read_b64_tr_b16 v[210:211],v224 offset:16640
s_waitcnt lgkmcnt(12)
v_mfma_f32_32x32x16_bf16 v[32:47],v[216:219],a[44:47],v[32:47]
ds_read_b64_tr_b16 v[212:213],v224 offset:16896
ds_read_b64_tr_b16 v[214:215],v224 offset:17152
s_waitcnt lgkmcnt(12)
v_mfma_f32_32x32x16_bf16 v[48:63],v[220:223],a[44:47],v[48:63]
ds_read_b64_tr_b16 v[216:217],v224 offset:17408
ds_read_b64_tr_b16 v[218:219],v224 offset:17664
s_waitcnt lgkmcnt(12)
v_mfma_f32_32x32x16_bf16 v[64:79],v[192:195],a[44:47],v[64:79]
ds_read_b64_tr_b16 v[220:221],v224 offset:17920
ds_read_b64_tr_b16 v[222:223],v224 offset:18176
s_waitcnt lgkmcnt(12)
v_mfma_f32_32x32x16_bf16 v[80:95],v[196:199],a[44:47],v[80:95]
s_waitcnt vmcnt(19)
s_barrier
ds_read_b64_tr_b16 v[192:193],v224 offset:24576
ds_read_b64_tr_b16 v[194:195],v224 offset:24832
s_waitcnt lgkmcnt(12)
v_mfma_f32_32x32x16_bf16 v[96:111],v[200:203],a[44:47],v[96:111]
ds_read_b64_tr_b16 v[196:197],v224 offset:25088
ds_read_b64_tr_b16 v[198:199],v224 offset:25344
s_waitcnt lgkmcnt(12)
v_mfma_f32_32x32x16_bf16 v[112:127],v[204:207],a[44:47],v[112:127]
ds_read_b64_tr_b16 v[200:201],v224 offset:25600
ds_read_b64_tr_b16 v[202:203],v224 offset:25856
s_waitcnt lgkmcnt(12)
v_mfma_f32_32x32x16_bf16 v[128:143],v[208:211],a[44:47],v[128:143]
ds_read_b64_tr_b16 v[204:205],v224 offset:26112
ds_read_b64_tr_b16 v[206:207],v224 offset:26368
s_waitcnt lgkmcnt(12)
v_mfma_f32_32x32x16_bf16 v[144:159],v[212:215],a[44:47],v[144:159]
ds_read_b64_tr_b16 v[208:209],v224 offset:26624
ds_read_b64_tr_b16 v[210:211],v224 offset:26880
s_waitcnt lgkmcnt(12)
v_mfma_f32_32x32x16_bf16 v[160:175],v[216:219],a[44:47],v[160:175]
ds_read_b64_tr_b16 v[212:213],v224 offset:27136
ds_read_b64_tr_b16 v[214:215],v224 offset:27392
s_waitcnt lgkmcnt(12)
v_mfma_f32_32x32x16_bf16 v[176:191],v[220:223],a[44:47],v[176:191]
s_cmp_eq_u32 s91, s61
s_cbranch_scc1 XL0_10
s_add_u32 s57, s91, 10240
buffer_load_dwordx4 a[40:43],v233,s[8:11],s57 offen
buffer_load_dwordx4 a[44:47],v233,s[8:11],s57 offen offset:1024
XL0_10:
ds_read_b64_tr_b16 v[216:217],v224 offset:27648
ds_read_b64_tr_b16 v[218:219],v224 offset:27904
s_waitcnt lgkmcnt(12)
v_mfma_f32_32x32x16_bf16 v[0:15],v[192:195],a[48:51],v[0:15]
ds_read_b64_tr_b16 v[220:221],v224 offset:28160
ds_read_b64_tr_b16 v[222:223],v224 offset:28416
s_waitcnt lgkmcnt(12)
v_mfma_f32_32x32x16_bf16 v[16:31],v[196:199],a[48:51],v[16:31]
s_add_u32 m0, s58, 0
s_add_u32 s57, s59, 3932160
buffer_load_dwordx4 v230,s[24:27],s57 offen lds
ds_read_b64_tr_b16 v[192:193],v224 offset:28672
ds_read_b64_tr_b16 v[194:195],v224 offset:28928
s_waitcnt lgkmcnt(12)
v_mfma_f32_32x32x16_bf16 v[32:47],v[200:203],a[48:51],v[32:47]
ds_read_b64_tr_b16 v[196:197],v224 offset:29184
ds_read_b64_tr_b16 v[198:199],v224 offset:29440
s_waitcnt lgkmcnt(12)
v_mfma_f32_32x32x16_bf16 v[48:63],v[204:207],a[48:51],v[48:63]
s_add_u32 m0, s58, 1024
s_add_u32 s57, s59, 3932288
buffer_load_dwordx4 v230,s[24:27],s57 offen lds
ds_read_b64_tr_b16 v[200:201],v224 offset:29696
ds_read_b64_tr_b16 v[202:203],v224 offset:29952
s_waitcnt lgkmcnt(12)
v_mfma_f32_32x32x16_bf16 v[64:79],v[208:211],a[48:51],v[64:79]
ds_read_b64_tr_b16 v[204:205],v224 offset:30208
ds_read_b64_tr_b16 v[206:207],v224 offset:30464
s_waitcnt lgkmcnt(12)
v_mfma_f32_32x32x16_bf16 v[80:95],v[212:215],a[48:51],v[80:95]
s_add_u32 m0, s58, 2048
s_add_u32 s57, s59, 3932416
buffer_load_dwordx4 v230,s[24:27],s57 offen lds
ds_read_b64_tr_b16 v[208:209],v224 offset:36864
ds_read_b64_tr_b16 v[210:211],v224 offset:37120
s_waitcnt lgkmcnt(12)
v_mfma_f32_32x32x16_bf16 v[96:111],v[216:219],a[48:51],v[96:111]
ds_read_b64_tr_b16 v[212:213],v224 offset:37376
ds_read_b64_tr_b16 v[214:215],v224 offset:37632
s_waitcnt lgkmcnt(12)
v_mfma_f32_32x32x16_bf16 v[112:127],v[220:223],a[48:51],v[112:127]
s_add_u32 m0, s58, 3072
s_add_u32 s57, s59, 3932160
buffer_load_dwordx4 v230,s[28:31],s57 offen lds
ds_read_b64_tr_b16 v[216:217],v224 offset:37888
ds_read_b64_tr_b16 v[218:219],v224 offset:38144
s_waitcnt lgkmcnt(12)
v_mfma_f32_32x32x16_bf16 v[128:143],v[192:195],a[48:51],v[128:143]
ds_read_b64_tr_b16 v[220:221],v224 offset:38400
ds_read_b64_tr_b16 v[222:223],v224 offset:38656
s_waitcnt lgkmcnt(12)
v_mfma_f32_32x32x16_bf16 v[144:159],v[196:199],a[48:51],v[144:159]
s_add_u32 m0, s58, 4096
s_add_u32 s57, s59, 3932288
buffer_load_dwordx4 v230,s[28:31],s57 offen lds
ds_read_b64_tr_b16 v[192:193],v224 offset:38912
ds_read_b64_tr_b16 v[194:195],v224 offset:39168
s_waitcnt lgkmcnt(12)
v_mfma_f32_32x32x16_bf16 v[160:175],v[200:203],a[48:51],v[160:175]
ds_read_b64_tr_b16 v[196:197],v224 offset:39424
ds_read_b64_tr_b16 v[198:199],v224 offset:39680
s_waitcnt lgkmcnt(12)
v_mfma_f32_32x32x16_bf16 v[176:191],v[204:207],a[48:51],v[176:191]
s_add_u32 m0, s58, 5120
s_add_u32 s57, s59, 3932416
buffer_load_dwordx4 v230,s[28:31],s57 offen lds
ds_read_b64_tr_b16 v[200:201],v224 offset:39936
ds_read_b64_tr_b16 v[202:203],v224 offset:40192
s_waitcnt lgkmcnt(12)
v_mfma_f32_32x32x16_bf16 v[0:15],v[208:211],a[52:55],v[0:15]
ds_read_b64_tr_b16 v[204:205],v224 offset:40448
ds_read_b64_tr_b16 v[206:207],v224 offset:40704
s_waitcnt lgkmcnt(12)
v_mfma_f32_32x32x16_bf16 v[16:31],v[212:215],a[52:55],v[16:31]
ds_read_b64_tr_b16 v[208:209],v224 offset:40960
ds_read_b64_tr_b16 v[210:211],v224 offset:41216
s_waitcnt lgkmcnt(12)
v_mfma_f32_32x32x16_bf16 v[32:47],v[216:219],a[52:55],v[32:47]
ds_read_b64_tr_b16 v[212:213],v224 offset:41472
ds_read_b64_tr_b16 v[214:215],v224 offset:41728
s_waitcnt lgkmcnt(12)
v_mfma_f32_32x32x16_bf16 v[48:63],v[220:223],a[52:55],v[48:63]
ds_read_b64_tr_b16 v[216:217],v224 offset:41984
ds_read_b64_tr_b16 v[218:219],v224 offset:42240
s_waitcnt lgkmcnt(12)
v_mfma_f32_32x32x16_bf16 v[64:79],v[192:195],a[52:55],v[64:79]
ds_read_b64_tr_b16 v[220:221],v224 offset:42496
ds_read_b64_tr_b16 v[222:223],v224 offset:42752
s_waitcnt lgkmcnt(12)
v_mfma_f32_32x32x16_bf16 v[80:95],v[196:199],a[52:55],v[80:95]
s_waitcnt vmcnt(19)
s_barrier
ds_read_b64_tr_b16 v[192:193],v225 offset:0
ds_read_b64_tr_b16 v[194:195],v225 offset:256
s_waitcnt lgkmcnt(12)
v_mfma_f32_32x32x16_bf16 v[96:111],v[200:203],a[52:55],v[96:111]
ds_read_b64_tr_b16 v[196:197],v225 offset:512
ds_read_b64_tr_b16 v[198:199],v225 offset:768
s_waitcnt lgkmcnt(12)
v_mfma_f32_32x32x16_bf16 v[112:127],v[204:207],a[52:55],v[112:127]
ds_read_b64_tr_b16 v[200:201],v225 offset:1024
ds_read_b64_tr_b16 v[202:203],v225 offset:1280
s_waitcnt lgkmcnt(12)
v_mfma_f32_32x32x16_bf16 v[128:143],v[208:211],a[52:55],v[128:143]
ds_read_b64_tr_b16 v[204:205],v225 offset:1536
ds_read_b64_tr_b16 v[206:207],v225 offset:1792
s_waitcnt lgkmcnt(12)
v_mfma_f32_32x32x16_bf16 v[144:159],v[212:215],a[52:55],v[144:159]
ds_read_b64_tr_b16 v[208:209],v225 offset:2048
ds_read_b64_tr_b16 v[210:211],v225 offset:2304
s_waitcnt lgkmcnt(12)
v_mfma_f32_32x32x16_bf16 v[160:175],v[216:219],a[52:55],v[160:175]
ds_read_b64_tr_b16 v[212:213],v225 offset:2560
ds_read_b64_tr_b16 v[214:215],v225 offset:2816
s_waitcnt lgkmcnt(12)
v_mfma_f32_32x32x16_bf16 v[176:191],v[220:223],a[52:55],v[176:191]
s_cmp_eq_u32 s91, s61
s_cbranch_scc1 XL0_12
s_add_u32 s57, s91, 12288
buffer_load_dwordx4 a[48:51],v233,s[8:11],s57 offen
buffer_load_dwordx4 a[52:55],v233,s[8:11],s57 offen offset:1024
XL0_12:
ds_read_b64_tr_b16 v[216:217],v225 offset:3072
ds_read_b64_tr_b16 v[218:219],v225 offset:3328
s_waitcnt lgkmcnt(12)
v_mfma_f32_32x32x16_bf16 v[0:15],v[192:195],a[56:59],v[0:15]
ds_read_b64_tr_b16 v[220:221],v225 offset:3584
ds_read_b64_tr_b16 v[222:223],v225 offset:3840
s_waitcnt lgkmcnt(12)
v_mfma_f32_32x32x16_bf16 v[16:31],v[196:199],a[56:59],v[16:31]
s_add_u32 m0, s58, 24576
s_add_u32 s57, s59, 4325376
buffer_load_dwordx4 v230,s[24:27],s57 offen lds
ds_read_b64_tr_b16 v[192:193],v225 offset:4096
ds_read_b64_tr_b16 v[194:195],v225 offset:4352
s_waitcnt lgkmcnt(12)
v_mfma_f32_32x32x16_bf16 v[32:47],v[200:203],a[56:59],v[32:47]
ds_read_b64_tr_b16 v[196:197],v225 offset:4608
ds_read_b64_tr_b16 v[198:199],v225 offset:4864
s_waitcnt lgkmcnt(12)
v_mfma_f32_32x32x16_bf16 v[48:63],v[204:207],a[56:59],v[48:63]
s_add_u32 m0, s58, 25600
s_add_u32 s57, s59, 4325504
buffer_load_dwordx4 v230,s[24:27],s57 offen lds
ds_read_b64_tr_b16 v[200:201],v225 offset:5120
ds_read_b64_tr_b16 v[202:203],v225 offset:5376
s_waitcnt lgkmcnt(12)
v_mfma_f32_32x32x16_bf16 v[64:79],v[208:211],a[56:59],v[64:79]
ds_read_b64_tr_b16 v[204:205],v225 offset:5632
ds_read_b64_tr_b16 v[206:207],v225 offset:5888
s_waitcnt lgkmcnt(12)
v_mfma_f32_32x32x16_bf16 v[80:95],v[212:215],a[56:59],v[80:95]
s_add_u32 m0, s58, 26624
s_add_u32 s57, s59, 4325632
buffer_load_dwordx4 v230,s[24:27],s57 offen lds
ds_read_b64_tr_b16 v[208:209],v225 offset:12288
ds_read_b64_tr_b16 v[210:211],v225 offset:12544
s_waitcnt lgkmcnt(12)
v_mfma_f32_32x32x16_bf16 v[96:111],v[216:219],a[56:59],v[96:111]
ds_read_b64_tr_b16 v[212:213],v225 offset:12800
ds_read_b64_tr_b16 v[214:215],v225 offset:13056
s_waitcnt lgkmcnt(12)
v_mfma_f32_32x32x16_bf16 v[112:127],v[220:223],a[56:59],v[112:127]
s_add_u32 m0, s58, 27648
s_add_u32 s57, s59, 4325376
buffer_load_dwordx4 v230,s[28:31],s57 offen lds
ds_read_b64_tr_b16 v[216:217],v225 offset:13312
ds_read_b64_tr_b16 v[218:219],v225 offset:13568
s_waitcnt lgkmcnt(12)
v_mfma_f32_32x32x16_bf16 v[128:143],v[192:195],a[56:59],v[128:143]
ds_read_b64_tr_b16 v[220:221],v225 offset:13824
ds_read_b64_tr_b16 v[222:223],v225 offset:14080
s_waitcnt lgkmcnt(12)
v_mfma_f32_32x32x16_bf16 v[144:159],v[196:199],a[56:59],v[144:159]
s_add_u32 m0, s58, 28672
s_add_u32 s57, s59, 4325504
buffer_load_dwordx4 v230,s[28:31],s57 offen lds
ds_read_b64_tr_b16 v[192:193],v225 offset:14336
ds_read_b64_tr_b16 v[194:195],v225 offset:14592
s_waitcnt lgkmcnt(12)
v_mfma_f32_32x32x16_bf16 v[160:175],v[200:203],a[56:59],v[160:175]
ds_read_b64_tr_b16 v[196:197],v225 offset:14848
ds_read_b64_tr_b16 v[198:199],v225 offset:15104
s_waitcnt lgkmcnt(12)
v_mfma_f32_32x32x16_bf16 v[176:191],v[204:207],a[56:59],v[176:191]
s_add_u32 m0, s58, 29696
s_add_u32 s57, s59, 4325632
buffer_load_dwordx4 v230,s[28:31],s57 offen lds
ds_read_b64_tr_b16 v[200:201],v225 offset:15360
ds_read_b64_tr_b16 v[202:203],v225 offset:15616
s_waitcnt lgkmcnt(12)
v_mfma_f32_32x32x16_bf16 v[0:15],v[208:211],a[60:63],v[0:15]
ds_read_b64_tr_b16 v[204:205],v225 offset:15872
ds_read_b64_tr_b16 v[206:207],v225 offset:16128
s_waitcnt lgkmcnt(12)
v_mfma_f32_32x32x16_bf16 v[16:31],v[212:215],a[60:63],v[16:31]
ds_read_b64_tr_b16 v[208:209],v225 offset:16384
ds_read_b64_tr_b16 v[210:211],v225 offset:16640
s_waitcnt lgkmcnt(12)
v_mfma_f32_32x32x16_bf16 v[32:47],v[216:219],a[60:63],v[32:47]
ds_read_b64_tr_b16 v[212:213],v225 offset:16896
ds_read_b64_tr_b16 v[214:215],v225 offset:17152
s_waitcnt lgkmcnt(12)
v_mfma_f32_32x32x16_bf16 v[48:63],v[220:223],a[60:63],v[48:63]
ds_read_b64_tr_b16 v[216:217],v225 offset:17408
ds_read_b64_tr_b16 v[218:219],v225 offset:17664
s_waitcnt lgkmcnt(12)
v_mfma_f32_32x32x16_bf16 v[64:79],v[192:195],a[60:63],v[64:79]
ds_read_b64_tr_b16 v[220:221],v225 offset:17920
ds_read_b64_tr_b16 v[222:223],v225 offset:18176
s_waitcnt lgkmcnt(12)
v_mfma_f32_32x32x16_bf16 v[80:95],v[196:199],a[60:63],v[80:95]
s_waitcnt vmcnt(18)
s_barrier
ds_read_b64_tr_b16 v[192:193],v225 offset:24576
ds_read_b64_tr_b16 v[194:195],v225 offset:24832
s_waitcnt lgkmcnt(12)
v_mfma_f32_32x32x16_bf16 v[96:111],v[200:203],a[60:63],v[96:111]
ds_read_b64_tr_b16 v[196:197],v225 offset:25088
ds_read_b64_tr_b16 v[198:199],v225 offset:25344
s_waitcnt lgkmcnt(12)
v_mfma_f32_32x32x16_bf16 v[112:127],v[204:207],a[60:63],v[112:127]
ds_read_b64_tr_b16 v[200:201],v225 offset:25600
ds_read_b64_tr_b16 v[202:203],v225 offset:25856
s_waitcnt lgkmcnt(12)
v_mfma_f32_32x32x16_bf16 v[128:143],v[208:211],a[60:63],v[128:143]
ds_read_b64_tr_b16 v[204:205],v225 offset:26112
ds_read_b64_tr_b16 v[206:207],v225 offset:26368
s_waitcnt lgkmcnt(12)
v_mfma_f32_32x32x16_bf16 v[144:159],v[212:215],a[60:63],v[144:159]
ds_read_b64_tr_b16 v[208:209],v225 offset:26624
ds_read_b64_tr_b16 v[210:211],v225 offset:26880
s_waitcnt lgkmcnt(12)
v_mfma_f32_32x32x16_bf16 v[160:175],v[216:219],a[60:63],v[160:175]
ds_read_b64_tr_b16 v[212:213],v225 offset:27136
ds_read_b64_tr_b16 v[214:215],v225 offset:27392
s_waitcnt lgkmcnt(12)
v_mfma_f32_32x32x16_bf16 v[176:191],v[220:223],a[60:63],v[176:191]
s_cmp_eq_u32 s91, s61
s_cbranch_scc1 XL0_14
s_add_u32 s57, s91, 14336
buffer_load_dwordx4 a[56:59],v233,s[8:11],s57 offen
buffer_load_dwordx4 a[60:63],v233,s[8:11],s57 offen offset:1024
XL0_14:
ds_read_b64_tr_b16 v[216:217],v225 offset:27648
ds_read_b64_tr_b16 v[218:219],v225 offset:27904
s_waitcnt lgkmcnt(12)
v_mfma_f32_32x32x16_bf16 v[0:15],v[192:195],a[64:67],v[0:15]
ds_read_b64_tr_b16 v[220:221],v225 offset:28160
ds_read_b64_tr_b16 v[222:223],v225 offset:28416
s_waitcnt lgkmcnt(12)
v_mfma_f32_32x32x16_bf16 v[16:31],v[196:199],a[64:67],v[16:31]
s_add_u32 m0, s58, 49152
s_add_u32 s57, s59, 4718592
buffer_load_dwordx4 v230,s[24:27],s57 offen lds
ds_read_b64_tr_b16 v[192:193],v225 offset:28672
ds_read_b64_tr_b16 v[194:195],v225 offset:28928
s_waitcnt lgkmcnt(12)
v_mfma_f32_32x32x16_bf16 v[32:47],v[200:203],a[64:67],v[32:47]
ds_read_b64_tr_b16 v[196:197],v225 offset:29184
ds_read_b64_tr_b16 v[198:199],v225 offset:29440
s_waitcnt lgkmcnt(12)
v_mfma_f32_32x32x16_bf16 v[48:63],v[204:207],a[64:67],v[48:63]
s_add_u32 m0, s58, 50176
s_add_u32 s57, s59, 4718720
buffer_load_dwordx4 v230,s[24:27],s57 offen lds
ds_read_b64_tr_b16 v[200:201],v225 offset:29696
ds_read_b64_tr_b16 v[202:203],v225 offset:29952
s_waitcnt lgkmcnt(12)
v_mfma_f32_32x32x16_bf16 v[64:79],v[208:211],a[64:67],v[64:79]
ds_read_b64_tr_b16 v[204:205],v225 offset:30208
ds_read_b64_tr_b16 v[206:207],v225 offset:30464
s_waitcnt lgkmcnt(12)
v_mfma_f32_32x32x16_bf16 v[80:95],v[212:215],a[64:67],v[80:95]
s_add_u32 m0, s58, 51200
s_add_u32 s57, s59, 4718848
buffer_load_dwordx4 v230,s[24:27],s57 offen lds
ds_read_b64_tr_b16 v[208:209],v225 offset:36864
ds_read_b64_tr_b16 v[210:211],v225 offset:37120
s_waitcnt lgkmcnt(12)
v_mfma_f32_32x32x16_bf16 v[96:111],v[216:219],a[64:67],v[96:111]
ds_read_b64_tr_b16 v[212:213],v225 offset:37376
ds_read_b64_tr_b16 v[214:215],v225 offset:37632
s_waitcnt lgkmcnt(12)
v_mfma_f32_32x32x16_bf16 v[112:127],v[220:223],a[64:67],v[112:127]
s_add_u32 m0, s58, 52224
s_add_u32 s57, s59, 4718592
buffer_load_dwordx4 v230,s[28:31],s57 offen lds
ds_read_b64_tr_b16 v[216:217],v225 offset:37888
ds_read_b64_tr_b16 v[218:219],v225 offset:38144
s_waitcnt lgkmcnt(12)
v_mfma_f32_32x32x16_bf16 v[128:143],v[192:195],a[64:67],v[128:143]
ds_read_b64_tr_b16 v[220:221],v225 offset:38400
ds_read_b64_tr_b16 v[222:223],v225 offset:38656
s_waitcnt lgkmcnt(12)
v_mfma_f32_32x32x16_bf16 v[144:159],v[196:199],a[64:67],v[144:159]
s_add_u32 m0, s58, 53248
s_add_u32 s57, s59, 4718720
buffer_load_dwordx4 v230,s[28:31],s57 offen lds
ds_read_b64_tr_b16 v[192:193],v225 offset:38912
ds_read_b64_tr_b16 v[194:195],v225 offset:39168
s_waitcnt lgkmcnt(12)
v_mfma_f32_32x32x16_bf16 v[160:175],v[200:203],a[64:67],v[160:175]
ds_read_b64_tr_b16 v[196:197],v225 offset:39424
ds_read_b64_tr_b16 v[198:199],v225 offset:39680
s_waitcnt lgkmcnt(12)
v_mfma_f32_32x32x16_bf16 v[176:191],v[204:207],a[64:67],v[176:191]
s_add_u32 m0, s58, 54272
s_add_u32 s57, s59, 4718848
buffer_load_dwordx4 v230,s[28:31],s57 offen lds
ds_read_b64_tr_b16 v[200:201],v225 offset:39936
ds_read_b64_tr_b16 v[202:203],v225 offset:40192
s_waitcnt lgkmcnt(12)
v_mfma_f32_32x32x16_bf16 v[0:15],v[208:211],a[68:71],v[0:15]
ds_read_b64_tr_b16 v[204:205],v225 offset:40448
ds_read_b64_tr_b16 v[206:207],v225 offset:40704
s_waitcnt lgkmcnt(12)
v_mfma_f32_32x32x16_bf16 v[16:31],v[212:215],a[68:71],v[16:31]
ds_read_b64_tr_b16 v[208:209],v225 offset:40960
ds_read_b64_tr_b16 v[210:211],v225 offset:41216
s_waitcnt lgkmcnt(12)
v_mfma_f32_32x32x16_bf16 v[32:47],v[216:219],a[68:71],v[32:47]
ds_read_b64_tr_b16 v[212:213],v225 offset:41472
ds_read_b64_tr_b16 v[214:215],v225 offset:41728
s_waitcnt lgkmcnt(12)
v_mfma_f32_32x32x16_bf16 v[48:63],v[220:223],a[68:71],v[48:63]
ds_read_b64_tr_b16 v[216:217],v225 offset:41984
ds_read_b64_tr_b16 v[218:219],v225 offset:42240
s_waitcnt lgkmcnt(12)
v_mfma_f32_32x32x16_bf16 v[64:79],v[192:195],a[68:71],v[64:79]
ds_read_b64_tr_b16 v[220:221],v225 offset:42496
ds_read_b64_tr_b16 v[222:223],v225 offset:42752
s_waitcnt lgkmcnt(12)
v_mfma_f32_32x32x16_bf16 v[80:95],v[196:199],a[68:71],v[80:95]
s_waitcnt vmcnt(18)
s_barrier
ds_read_b64_tr_b16 v[192:193],v226 offset:0
ds_read_b64_tr_b16 v[194:195],v226 offset:256
s_waitcnt lgkmcnt(12)
v_mfma_f32_32x32x16_bf16 v[96:111],v[200:203],a[68:71],v[96:111]
ds_read_b64_tr_b16 v[196:197],v226 offset:512
ds_read_b64_tr_b16 v[198:199],v226 offset:768
s_waitcnt lgkmcnt(12)
v_mfma_f32_32x32x16_bf16 v[112:127],v[204:207],a[68:71],v[112:127]
ds_read_b64_tr_b16 v[200:201],v226 offset:1024
ds_read_b64_tr_b16 v[202:203],v226 offset:1280
s_waitcnt lgkmcnt(12)
v_mfma_f32_32x32x16_bf16 v[128:143],v[208:211],a[68:71],v[128:143]
ds_read_b64_tr_b16 v[204:205],v226 offset:1536
ds_read_b64_tr_b16 v[206:207],v226 offset:1792
s_waitcnt lgkmcnt(12)
v_mfma_f32_32x32x16_bf16 v[144:159],v[212:215],a[68:71],v[144:159]
ds_read_b64_tr_b16 v[208:209],v226 offset:2048
ds_read_b64_tr_b16 v[210:211],v226 offset:2304
s_waitcnt lgkmcnt(12)
v_mfma_f32_32x32x16_bf16 v[160:175],v[216:219],a[68:71],v[160:175]
ds_read_b64_tr_b16 v[212:213],v226 offset:2560
ds_read_b64_tr_b16 v[214:215],v226 offset:2816
s_waitcnt lgkmcnt(12)
v_mfma_f32_32x32x16_bf16 v[176:191],v[220:223],a[68:71],v[176:191]
s_cmp_eq_u32 s91, s61
s_cbranch_scc1 XL0_16
s_add_u32 s57, s91, 16384
buffer_load_dwordx4 a[64:67],v233,s[8:11],s57 offen
buffer_load_dwordx4 a[68:71],v233,s[8:11],s57 offen offset:1024
XL0_16:
ds_read_b64_tr_b16 v[216:217],v226 offset:3072
ds_read_b64_tr_b16 v[218:219],v226 offset:3328
s_waitcnt lgkmcnt(12)
v_mfma_f32_32x32x16_bf16 v[0:15],v[192:195],a[72:75],v[0:15]
ds_read_b64_tr_b16 v[220:221],v226 offset:3584
ds_read_b64_tr_b16 v[222:223],v226 offset:3840
s_waitcnt lgkmcnt(12)
v_mfma_f32_32x32x16_bf16 v[16:31],v[196:199],a[72:75],v[16:31]
s_add_u32 m0, s58, 73728
s_add_u32 s57, s59, 5111808
buffer_load_dwordx4 v230,s[24:27],s57 offen lds
ds_read_b64_tr_b16 v[192:193],v226 offset:4096
ds_read_b64_tr_b16 v[194:195],v226 offset:4352
s_waitcnt lgkmcnt(12)
v_mfma_f32_32x32x16_bf16 v[32:47],v[200:203],a[72:75],v[32:47]
ds_read_b64_tr_b16 v[196:197],v226 offset:4608
ds_read_b64_tr_b16 v[198:199],v226 offset:4864
s_waitcnt lgkmcnt(12)
v_mfma_f32_32x32x16_bf16 v[48:63],v[204:207],a[72:75],v[48:63]
s_add_u32 m0, s58, 74752
s_add_u32 s57, s59, 5111936
buffer_load_dwordx4 v230,s[24:27],s57 offen lds
ds_read_b64_tr_b16 v[200:201],v226 offset:5120
ds_read_b64_tr_b16 v[202:203],v226 offset:5376
s_waitcnt lgkmcnt(12)
v_mfma_f32_32x32x16_bf16 v[64:79],v[208:211],a[72:75],v[64:79]
ds_read_b64_tr_b16 v[204:205],v226 offset:5632
ds_read_b64_tr_b16 v[206:207],v226 offset:5888
s_waitcnt lgkmcnt(12)
v_mfma_f32_32x32x16_bf16 v[80:95],v[212:215],a[72:75],v[80:95]
s_add_u32 m0, s58, 75776
s_add_u32 s57, s59, 5112064
buffer_load_dwordx4 v230,s[24:27],s57 offen lds
ds_read_b64_tr_b16 v[208:209],v226 offset:12288
ds_read_b64_tr_b16 v[210:211],v226 offset:12544
s_waitcnt lgkmcnt(12)
v_mfma_f32_32x32x16_bf16 v[96:111],v[216:219],a[72:75],v[96:111]
ds_read_b64_tr_b16 v[212:213],v226 offset:12800
ds_read_b64_tr_b16 v[214:215],v226 offset:13056
s_waitcnt lgkmcnt(12)
v_mfma_f32_32x32x16_bf16 v[112:127],v[220:223],a[72:75],v[112:127]
s_add_u32 m0, s58, 76800
s_add_u32 s57, s59, 5111808
buffer_load_dwordx4 v230,s[28:31],s57 offen lds
ds_read_b64_tr_b16 v[216:217],v226 offset:13312
ds_read_b64_tr_b16 v[218:219],v226 offset:13568
s_waitcnt lgkmcnt(12)
v_mfma_f32_32x32x16_bf16 v[128:143],v[192:195],a[72:75],v[128:143]
ds_read_b64_tr_b16 v[220:221],v226 offset:13824
ds_read_b64_tr_b16 v[222:223],v226 offset:14080
s_waitcnt lgkmcnt(12)
v_mfma_f32_32x32x16_bf16 v[144:159],v[196:199],a[72:75],v[144:159]
s_add_u32 m0, s58, 77824
s_add_u32 s57, s59, 5111936
buffer_load_dwordx4 v230,s[28:31],s57 offen lds
ds_read_b64_tr_b16 v[192:193],v226 offset:14336
ds_read_b64_tr_b16 v[194:195],v226 offset:14592
s_waitcnt lgkmcnt(12)
v_mfma_f32_32x32x16_bf16 v[160:175],v[200:203],a[72:75],v[160:175]
ds_read_b64_tr_b16 v[196:197],v226 offset:14848
ds_read_b64_tr_b16 v[198:199],v226 offset:15104
s_waitcnt lgkmcnt(12)
v_mfma_f32_32x32x16_bf16 v[176:191],v[204:207],a[72:75],v[176:191]
s_add_u32 m0, s58, 78848
s_add_u32 s57, s59, 5112064
buffer_load_dwordx4 v230,s[28:31],s57 offen lds
ds_read_b64_tr_b16 v[200:201],v226 offset:15360
ds_read_b64_tr_b16 v[202:203],v226 offset:15616
s_waitcnt lgkmcnt(12)
v_mfma_f32_32x32x16_bf16 v[0:15],v[208:211],a[76:79],v[0:15]
ds_read_b64_tr_b16 v[204:205],v226 offset:15872
ds_read_b64_tr_b16 v[206:207],v226 offset:16128
s_waitcnt lgkmcnt(12)
v_mfma_f32_32x32x16_bf16 v[16:31],v[212:215],a[76:79],v[16:31]
ds_read_b64_tr_b16 v[208:209],v226 offset:16384
ds_read_b64_tr_b16 v[210:211],v226 offset:16640
s_waitcnt lgkmcnt(12)
v_mfma_f32_32x32x16_bf16 v[32:47],v[216:219],a[76:79],v[32:47]
ds_read_b64_tr_b16 v[212:213],v226 offset:16896
ds_read_b64_tr_b16 v[214:215],v226 offset:17152
s_waitcnt lgkmcnt(12)
v_mfma_f32_32x32x16_bf16 v[48:63],v[220:223],a[76:79],v[48:63]
ds_read_b64_tr_b16 v[216:217],v226 offset:17408
ds_read_b64_tr_b16 v[218:219],v226 offset:17664
s_waitcnt lgkmcnt(12)
v_mfma_f32_32x32x16_bf16 v[64:79],v[192:195],a[76:79],v[64:79]
ds_read_b64_tr_b16 v[220:221],v226 offset:17920
ds_read_b64_tr_b16 v[222:223],v226 offset:18176
s_waitcnt lgkmcnt(12)
v_mfma_f32_32x32x16_bf16 v[80:95],v[196:199],a[76:79],v[80:95]
s_waitcnt vmcnt(18)
s_barrier
ds_read_b64_tr_b16 v[192:193],v224 offset:0
ds_read_b64_tr_b16 v[194:195],v224 offset:256
s_waitcnt lgkmcnt(12)
v_mfma_f32_32x32x16_bf16 v[96:111],v[200:203],a[76:79],v[96:111]
ds_read_b64_tr_b16 v[196:197],v224 offset:512
ds_read_b64_tr_b16 v[198:199],v224 offset:768
s_waitcnt lgkmcnt(12)
v_mfma_f32_32x32x16_bf16 v[112:127],v[204:207],a[76:79],v[112:127]
ds_read_b64_tr_b16 v[200:201],v224 offset:1024
ds_read_b64_tr_b16 v[202:203],v224 offset:1280
s_waitcnt lgkmcnt(12)
v_mfma_f32_32x32x16_bf16 v[128:143],v[208:211],a[76:79],v[128:143]
ds_read_b64_tr_b16 v[204:205],v224 offset:1536
ds_read_b64_tr_b16 v[206:207],v224 offset:1792
s_waitcnt lgkmcnt(12)
v_mfma_f32_32x32x16_bf16 v[144:159],v[212:215],a[76:79],v[144:159]
ds_read_b64_tr_b16 v[208:209],v224 offset:2048
ds_read_b64_tr_b16 v[210:211],v224 offset:2304
s_waitcnt lgkmcnt(12)
v_mfma_f32_32x32x16_bf16 v[160:175],v[216:219],a[76:79],v[160:175]
ds_read_b64_tr_b16 v[212:213],v224 offset:2560
ds_read_b64_tr_b16 v[214:215],v224 offset:2816
s_waitcnt lgkmcnt(12)
v_mfma_f32_32x32x16_bf16 v[176:191],v[220:223],a[76:79],v[176:191]
s_cmp_eq_u32 s91, s61
s_cbranch_scc1 XL0_18
s_add_u32 s57, s91, 18432
buffer_load_dwordx4 a[72:75],v233,s[8:11],s57 offen
buffer_load_dwordx4 a[76:79],v233,s[8:11],s57 offen offset:1024
XL0_18:
ds_read_b64_tr_b16 v[216:217],v224 offset:3072
ds_read_b64_tr_b16 v[218:219],v224 offset:3328
s_waitcnt lgkmcnt(12)
v_mfma_f32_32x32x16_bf16 v[0:15],v[192:195],a[80:83],v[0:15]
ds_read_b64_tr_b16 v[220:221],v224 offset:3584
ds_read_b64_tr_b16 v[222:223],v224 offset:3840
s_waitcnt lgkmcnt(12)
v_mfma_f32_32x32x16_bf16 v[16:31],v[196:199],a[80:83],v[16:31]
s_add_u32 m0, s58, 98304
s_add_u32 s57, s59, 5505024
buffer_load_dwordx4 v230,s[24:27],s57 offen lds
ds_read_b64_tr_b16 v[192:193],v224 offset:4096
ds_read_b64_tr_b16 v[194:195],v224 offset:4352
s_waitcnt lgkmcnt(12)
v_mfma_f32_32x32x16_bf16 v[32:47],v[200:203],a[80:83],v[32:47]
ds_read_b64_tr_b16 v[196:197],v224 offset:4608
ds_read_b64_tr_b16 v[198:199],v224 offset:4864
s_waitcnt lgkmcnt(12)
v_mfma_f32_32x32x16_bf16 v[48:63],v[204:207],a[80:83],v[48:63]
s_add_u32 m0, s58, 99328
s_add_u32 s57, s59, 5505152
buffer_load_dwordx4 v230,s[24:27],s57 offen lds
ds_read_b64_tr_b16 v[200:201],v224 offset:5120
ds_read_b64_tr_b16 v[202:203],v224 offset:5376
s_waitcnt lgkmcnt(12)
v_mfma_f32_32x32x16_bf16 v[64:79],v[208:211],a[80:83],v[64:79]
ds_read_b64_tr_b16 v[204:205],v224 offset:5632
ds_read_b64_tr_b16 v[206:207],v224 offset:5888
s_waitcnt lgkmcnt(12)
v_mfma_f32_32x32x16_bf16 v[80:95],v[212:215],a[80:83],v[80:95]
s_add_u32 m0, s58, 100352
s_add_u32 s57, s59, 5505280
buffer_load_dwordx4 v230,s[24:27],s57 offen lds
ds_read_b64_tr_b16 v[208:209],v224 offset:12288
ds_read_b64_tr_b16 v[210:211],v224 offset:12544
s_waitcnt lgkmcnt(12)
v_mfma_f32_32x32x16_bf16 v[96:111],v[216:219],a[80:83],v[96:111]
ds_read_b64_tr_b16 v[212:213],v224 offset:12800
ds_read_b64_tr_b16 v[214:215],v224 offset:13056
s_waitcnt lgkmcnt(12)
v_mfma_f32_32x32x16_bf16 v[112:127],v[220:223],a[80:83],v[112:127]
s_add_u32 m0, s58, 101376
s_add_u32 s57, s59, 5505024
buffer_load_dwordx4 v230,s[28:31],s57 offen lds
ds_read_b64_tr_b16 v[216:217],v224 offset:13312
ds_read_b64_tr_b16 v[218:219],v224 offset:13568
s_waitcnt lgkmcnt(12)
v_mfma_f32_32x32x16_bf16 v[128:143],v[192:195],a[80:83],v[128:143]
ds_read_b64_tr_b16 v[220:221],v224 offset:13824
ds_read_b64_tr_b16 v[222:223],v224 offset:14080
s_waitcnt lgkmcnt(12)
v_mfma_f32_32x32x16_bf16 v[144:159],v[196:199],a[80:83],v[144:159]
s_add_u32 m0, s58, 102400
s_add_u32 s57, s59, 5505152
buffer_load_dwordx4 v230,s[28:31],s57 offen lds
ds_read_b64_tr_b16 v[192:193],v224 offset:14336
ds_read_b64_tr_b16 v[194:195],v224 offset:14592
s_waitcnt lgkmcnt(12)
v_mfma_f32_32x32x16_bf16 v[160:175],v[200:203],a[80:83],v[160:175]
ds_read_b64_tr_b16 v[196:197],v224 offset:14848
ds_read_b64_tr_b16 v[198:199],v224 offset:15104
s_waitcnt lgkmcnt(12)
v_mfma_f32_32x32x16_bf16 v[176:191],v[204:207],a[80:83],v[176:191]
s_add_u32 m0, s58, 103424
s_add_u32 s57, s59, 5505280
buffer_load_dwordx4 v230,s[28:31],s57 offen lds
ds_read_b64_tr_b16 v[200:201],v224 offset:15360
ds_read_b64_tr_b16 v[202:203],v224 offset:15616
s_waitcnt lgkmcnt(12)
v_mfma_f32_32x32x16_bf16 v[0:15],v[208:211],a[84:87],v[0:15]
ds_read_b64_tr_b16 v[204:205],v224 offset:15872
ds_read_b64_tr_b16 v[206:207],v224 offset:16128
s_waitcnt lgkmcnt(12)
v_mfma_f32_32x32x16_bf16 v[16:31],v[212:215],a[84:87],v[16:31]
ds_read_b64_tr_b16 v[208:209],v224 offset:16384
ds_read_b64_tr_b16 v[210:211],v224 offset:16640
s_waitcnt lgkmcnt(12)
v_mfma_f32_32x32x16_bf16 v[32:47],v[216:219],a[84:87],v[32:47]
ds_read_b64_tr_b16 v[212:213],v224 offset:16896
ds_read_b64_tr_b16 v[214:215],v224 offset:17152
s_waitcnt lgkmcnt(12)
v_mfma_f32_32x32x16_bf16 v[48:63],v[220:223],a[84:87],v[48:63]
ds_read_b64_tr_b16 v[216:217],v224 offset:17408
ds_read_b64_tr_b16 v[218:219],v224 offset:17664
s_waitcnt lgkmcnt(12)
v_mfma_f32_32x32x16_bf16 v[64:79],v[192:195],a[84:87],v[64:79]
ds_read_b64_tr_b16 v[220:221],v224 offset:17920
ds_read_b64_tr_b16 v[222:223],v224 offset:18176
s_waitcnt lgkmcnt(12)
v_mfma_f32_32x32x16_bf16 v[80:95],v[196:199],a[84:87],v[80:95]
s_waitcnt vmcnt(18)
s_barrier
ds_read_b64_tr_b16 v[192:193],v224 offset:24576
ds_read_b64_tr_b16 v[194:195],v224 offset:24832
s_waitcnt lgkmcnt(12)
v_mfma_f32_32x32x16_bf16 v[96:111],v[200:203],a[84:87],v[96:111]
ds_read_b64_tr_b16 v[196:197],v224 offset:25088
ds_read_b64_tr_b16 v[198:199],v224 offset:25344
s_waitcnt lgkmcnt(12)
v_mfma_f32_32x32x16_bf16 v[112:127],v[204:207],a[84:87],v[112:127]
ds_read_b64_tr_b16 v[200:201],v224 offset:25600
ds_read_b64_tr_b16 v[202:203],v224 offset:25856
s_waitcnt lgkmcnt(12)
v_mfma_f32_32x32x16_bf16 v[128:143],v[208:211],a[84:87],v[128:143]
ds_read_b64_tr_b16 v[204:205],v224 offset:26112
ds_read_b64_tr_b16 v[206:207],v224 offset:26368
s_waitcnt lgkmcnt(12)
v_mfma_f32_32x32x16_bf16 v[144:159],v[212:215],a[84:87],v[144:159]
ds_read_b64_tr_b16 v[208:209],v224 offset:26624
ds_read_b64_tr_b16 v[210:211],v224 offset:26880
s_waitcnt lgkmcnt(12)
v_mfma_f32_32x32x16_bf16 v[160:175],v[216:219],a[84:87],v[160:175]
ds_read_b64_tr_b16 v[212:213],v224 offset:27136
ds_read_b64_tr_b16 v[214:215],v224 offset:27392
s_waitcnt lgkmcnt(12)
v_mfma_f32_32x32x16_bf16 v[176:191],v[220:223],a[84:87],v[176:191]
s_cmp_eq_u32 s91, s61
s_cbranch_scc1 XL0_20
s_add_u32 s57, s91, 20480
buffer_load_dwordx4 a[80:83],v233,s[8:11],s57 offen
buffer_load_dwordx4 a[84:87],v233,s[8:11],s57 offen offset:1024
XL0_20:
ds_read_b64_tr_b16 v[216:217],v224 offset:27648
ds_read_b64_tr_b16 v[218:219],v224 offset:27904
s_waitcnt lgkmcnt(12)
v_mfma_f32_32x32x16_bf16 v[0:15],v[192:195],a[88:91],v[0:15]
ds_read_b64_tr_b16 v[220:221],v224 offset:28160
ds_read_b64_tr_b16 v[222:223],v224 offset:28416
s_waitcnt lgkmcnt(12)
v_mfma_f32_32x32x16_bf16 v[16:31],v[196:199],a[88:91],v[16:31]
s_add_u32 m0, s58, 0
s_add_u32 s57, s59, 5898240
buffer_load_dwordx4 v230,s[24:27],s57 offen lds
ds_read_b64_tr_b16 v[192:193],v224 offset:28672
ds_read_b64_tr_b16 v[194:195],v224 offset:28928
s_waitcnt lgkmcnt(12)
v_mfma_f32_32x32x16_bf16 v[32:47],v[200:203],a[88:91],v[32:47]
ds_read_b64_tr_b16 v[196:197],v224 offset:29184
ds_read_b64_tr_b16 v[198:199],v224 offset:29440
s_waitcnt lgkmcnt(12)
v_mfma_f32_32x32x16_bf16 v[48:63],v[204:207],a[88:91],v[48:63]
s_add_u32 m0, s58, 1024
s_add_u32 s57, s59, 5898368
buffer_load_dwordx4 v230,s[24:27],s57 offen lds
ds_read_b64_tr_b16 v[200:201],v224 offset:29696
ds_read_b64_tr_b16 v[202:203],v224 offset:29952
s_waitcnt lgkmcnt(12)
v_mfma_f32_32x32x16_bf16 v[64:79],v[208:211],a[88:91],v[64:79]
ds_read_b64_tr_b16 v[204:205],v224 offset:30208
ds_read_b64_tr_b16 v[206:207],v224 offset:30464
s_waitcnt lgkmcnt(12)
v_mfma_f32_32x32x16_bf16 v[80:95],v[212:215],a[88:91],v[80:95]
s_add_u32 m0, s58, 2048
s_add_u32 s57, s59, 5898496
buffer_load_dwordx4 v230,s[24:27],s57 offen lds
ds_read_b64_tr_b16 v[208:209],v224 offset:36864
ds_read_b64_tr_b16 v[210:211],v224 offset:37120
s_waitcnt lgkmcnt(12)
v_mfma_f32_32x32x16_bf16 v[96:111],v[216:219],a[88:91],v[96:111]
ds_read_b64_tr_b16 v[212:213],v224 offset:37376
ds_read_b64_tr_b16 v[214:215],v224 offset:37632
s_waitcnt lgkmcnt(12)
v_mfma_f32_32x32x16_bf16 v[112:127],v[220:223],a[88:91],v[112:127]
s_add_u32 m0, s58, 3072
s_add_u32 s57, s59, 5898240
buffer_load_dwordx4 v230,s[28:31],s57 offen lds
ds_read_b64_tr_b16 v[216:217],v224 offset:37888
ds_read_b64_tr_b16 v[218:219],v224 offset:38144
s_waitcnt lgkmcnt(12)
v_mfma_f32_32x32x16_bf16 v[128:143],v[192:195],a[88:91],v[128:143]
ds_read_b64_tr_b16 v[220:221],v224 offset:38400
ds_read_b64_tr_b16 v[222:223],v224 offset:38656
s_waitcnt lgkmcnt(12)
v_mfma_f32_32x32x16_bf16 v[144:159],v[196:199],a[88:91],v[144:159]
s_add_u32 m0, s58, 4096
s_add_u32 s57, s59, 5898368
buffer_load_dwordx4 v230,s[28:31],s57 offen lds
ds_read_b64_tr_b16 v[192:193],v224 offset:38912
ds_read_b64_tr_b16 v[194:195],v224 offset:39168
s_waitcnt lgkmcnt(12)
v_mfma_f32_32x32x16_bf16 v[160:175],v[200:203],a[88:91],v[160:175]
ds_read_b64_tr_b16 v[196:197],v224 offset:39424
ds_read_b64_tr_b16 v[198:199],v224 offset:39680
s_waitcnt lgkmcnt(12)
v_mfma_f32_32x32x16_bf16 v[176:191],v[204:207],a[88:91],v[176:191]
s_add_u32 m0, s58, 5120
s_add_u32 s57, s59, 5898496
buffer_load_dwordx4 v230,s[28:31],s57 offen lds
ds_read_b64_tr_b16 v[200:201],v224 offset:39936
ds_read_b64_tr_b16 v[202:203],v224 offset:40192
s_waitcnt lgkmcnt(12)
v_mfma_f32_32x32x16_bf16 v[0:15],v[208:211],a[92:95],v[0:15]
ds_read_b64_tr_b16 v[204:205],v224 offset:40448
ds_read_b64_tr_b16 v[206:207],v224 offset:40704
s_waitcnt lgkmcnt(12)
v_mfma_f32_32x32x16_bf16 v[16:31],v[212:215],a[92:95],v[16:31]
ds_read_b64_tr_b16 v[208:209],v224 offset:40960
ds_read_b64_tr_b16 v[210:211],v224 offset:41216
s_waitcnt lgkmcnt(12)
v_mfma_f32_32x32x16_bf16 v[32:47],v[216:219],a[92:95],v[32:47]
ds_read_b64_tr_b16 v[212:213],v224 offset:41472
ds_read_b64_tr_b16 v[214:215],v224 offset:41728
s_waitcnt lgkmcnt(12)
v_mfma_f32_32x32x16_bf16 v[48:63],v[220:223],a[92:95],v[48:63]
ds_read_b64_tr_b16 v[216:217],v224 offset:41984
ds_read_b64_tr_b16 v[218:219],v224 offset:42240
s_waitcnt lgkmcnt(12)
v_mfma_f32_32x32x16_bf16 v[64:79],v[192:195],a[92:95],v[64:79]
ds_read_b64_tr_b16 v[220:221],v224 offset:42496
ds_read_b64_tr_b16 v[222:223],v224 offset:42752
s_waitcnt lgkmcnt(12)
v_mfma_f32_32x32x16_bf16 v[80:95],v[196:199],a[92:95],v[80:95]
s_waitcnt vmcnt(18)
s_barrier
ds_read_b64_tr_b16 v[192:193],v225 offset:0
ds_read_b64_tr_b16 v[194:195],v225 offset:256
s_waitcnt lgkmcnt(12)
v_mfma_f32_32x32x16_bf16 v[96:111],v[200:203],a[92:95],v[96:111]
ds_read_b64_tr_b16 v[196:197],v225 offset:512
ds_read_b64_tr_b16 v[198:199],v225 offset:768
s_waitcnt lgkmcnt(12)
v_mfma_f32_32x32x16_bf16 v[112:127],v[204:207],a[92:95],v[112:127]
ds_read_b64_tr_b16 v[200:201],v225 offset:1024
ds_read_b64_tr_b16 v[202:203],v225 offset:1280
s_waitcnt lgkmcnt(12)
v_mfma_f32_32x32x16_bf16 v[128:143],v[208:211],a[92:95],v[128:143]
ds_read_b64_tr_b16 v[204:205],v225 offset:1536
ds_read_b64_tr_b16 v[206:207],v225 offset:1792
s_waitcnt lgkmcnt(12)
v_mfma_f32_32x32x16_bf16 v[144:159],v[212:215],a[92:95],v[144:159]
ds_read_b64_tr_b16 v[208:209],v225 offset:2048
ds_read_b64_tr_b16 v[210:211],v225 offset:2304
s_waitcnt lgkmcnt(12)
v_mfma_f32_32x32x16_bf16 v[160:175],v[216:219],a[92:95],v[160:175]
ds_read_b64_tr_b16 v[212:213],v225 offset:2560
ds_read_b64_tr_b16 v[214:215],v225 offset:2816
s_waitcnt lgkmcnt(12)
v_mfma_f32_32x32x16_bf16 v[176:191],v[220:223],a[92:95],v[176:191]
s_cmp_eq_u32 s91, s61
s_cbranch_scc1 XL0_22
s_add_u32 s57, s91, 22528
buffer_load_dwordx4 a[88:91],v233,s[8:11],s57 offen
buffer_load_dwordx4 a[92:95],v233,s[8:11],s57 offen offset:1024
XL0_22:
ds_read_b64_tr_b16 v[216:217],v225 offset:3072
ds_read_b64_tr_b16 v[218:219],v225 offset:3328
s_waitcnt lgkmcnt(12)
v_mfma_f32_32x32x16_bf16 v[0:15],v[192:195],a[96:99],v[0:15]
ds_read_b64_tr_b16 v[220:221],v225 offset:3584
ds_read_b64_tr_b16 v[222:223],v225 offset:3840
s_waitcnt lgkmcnt(12)
v_mfma_f32_32x32x16_bf16 v[16:31],v[196:199],a[96:99],v[16:31]
s_add_u32 m0, s58, 24576
s_add_u32 s57, s59, 6291456
buffer_load_dwordx4 v230,s[24:27],s57 offen lds
ds_read_b64_tr_b16 v[192:193],v225 offset:4096
ds_read_b64_tr_b16 v[194:195],v225 offset:4352
s_waitcnt lgkmcnt(12)
v_mfma_f32_32x32x16_bf16 v[32:47],v[200:203],a[96:99],v[32:47]
ds_read_b64_tr_b16 v[196:197],v225 offset:4608
ds_read_b64_tr_b16 v[198:199],v225 offset:4864
s_waitcnt lgkmcnt(12)
v_mfma_f32_32x32x16_bf16 v[48:63],v[204:207],a[96:99],v[48:63]
s_add_u32 m0, s58, 25600
s_add_u32 s57, s59, 6291584
buffer_load_dwordx4 v230,s[24:27],s57 offen lds
ds_read_b64_tr_b16 v[200:201],v225 offset:5120
ds_read_b64_tr_b16 v[202:203],v225 offset:5376
s_waitcnt lgkmcnt(12)
v_mfma_f32_32x32x16_bf16 v[64:79],v[208:211],a[96:99],v[64:79]
ds_read_b64_tr_b16 v[204:205],v225 offset:5632
ds_read_b64_tr_b16 v[206:207],v225 offset:5888
s_waitcnt lgkmcnt(12)
v_mfma_f32_32x32x16_bf16 v[80:95],v[212:215],a[96:99],v[80:95]
s_add_u32 m0, s58, 26624
s_add_u32 s57, s59, 6291712
buffer_load_dwordx4 v230,s[24:27],s57 offen lds
ds_read_b64_tr_b16 v[208:209],v225 offset:12288
ds_read_b64_tr_b16 v[210:211],v225 offset:12544
s_waitcnt lgkmcnt(12)
v_mfma_f32_32x32x16_bf16 v[96:111],v[216:219],a[96:99],v[96:111]
ds_read_b64_tr_b16 v[212:213],v225 offset:12800
ds_read_b64_tr_b16 v[214:215],v225 offset:13056
s_waitcnt lgkmcnt(12)
v_mfma_f32_32x32x16_bf16 v[112:127],v[220:223],a[96:99],v[112:127]
s_add_u32 m0, s58, 27648
s_add_u32 s57, s59, 6291456
buffer_load_dwordx4 v230,s[28:31],s57 offen lds
ds_read_b64_tr_b16 v[216:217],v225 offset:13312
ds_read_b64_tr_b16 v[218:219],v225 offset:13568
s_waitcnt lgkmcnt(12)
v_mfma_f32_32x32x16_bf16 v[128:143],v[192:195],a[96:99],v[128:143]
ds_read_b64_tr_b16 v[220:221],v225 offset:13824
ds_read_b64_tr_b16 v[222:223],v225 offset:14080
s_waitcnt lgkmcnt(12)
v_mfma_f32_32x32x16_bf16 v[144:159],v[196:199],a[96:99],v[144:159]
s_add_u32 m0, s58, 28672
s_add_u32 s57, s59, 6291584
buffer_load_dwordx4 v230,s[28:31],s57 offen lds
ds_read_b64_tr_b16 v[192:193],v225 offset:14336
ds_read_b64_tr_b16 v[194:195],v225 offset:14592
s_waitcnt lgkmcnt(12)
v_mfma_f32_32x32x16_bf16 v[160:175],v[200:203],a[96:99],v[160:175]
ds_read_b64_tr_b16 v[196:197],v225 offset:14848
ds_read_b64_tr_b16 v[198:199],v225 offset:15104
s_waitcnt lgkmcnt(12)
v_mfma_f32_32x32x16_bf16 v[176:191],v[204:207],a[96:99],v[176:191]
s_add_u32 m0, s58, 29696
s_add_u32 s57, s59, 6291712
buffer_load_dwordx4 v230,s[28:31],s57 offen lds
ds_read_b64_tr_b16 v[200:201],v225 offset:15360
ds_read_b64_tr_b16 v[202:203],v225 offset:15616
s_waitcnt lgkmcnt(12)
v_mfma_f32_32x32x16_bf16 v[0:15],v[208:211],a[100:103],v[0:15]
ds_read_b64_tr_b16 v[204:205],v225 offset:15872
ds_read_b64_tr_b16 v[206:207],v225 offset:16128
s_waitcnt lgkmcnt(12)
v_mfma_f32_32x32x16_bf16 v[16:31],v[212:215],a[100:103],v[16:31]
ds_read_b64_tr_b16 v[208:209],v225 offset:16384
ds_read_b64_tr_b16 v[210:211],v225 offset:16640
s_waitcnt lgkmcnt(12)
v_mfma_f32_32x32x16_bf16 v[32:47],v[216:219],a[100:103],v[32:47]
ds_read_b64_tr_b16 v[212:213],v225 offset:16896
ds_read_b64_tr_b16 v[214:215],v225 offset:17152
s_waitcnt lgkmcnt(12)
v_mfma_f32_32x32x16_bf16 v[48:63],v[220:223],a[100:103],v[48:63]
ds_read_b64_tr_b16 v[216:217],v225 offset:17408
ds_read_b64_tr_b16 v[218:219],v225 offset:17664
s_waitcnt lgkmcnt(12)
v_mfma_f32_32x32x16_bf16 v[64:79],v[192:195],a[100:103],v[64:79]
ds_read_b64_tr_b16 v[220:221],v225 offset:17920
ds_read_b64_tr_b16 v[222:223],v225 offset:18176
s_waitcnt lgkmcnt(12)
v_mfma_f32_32x32x16_bf16 v[80:95],v[196:199],a[100:103],v[80:95]
s_waitcnt vmcnt(18)
s_barrier
ds_read_b64_tr_b16 v[192:193],v225 offset:24576
ds_read_b64_tr_b16 v[194:195],v225 offset:24832
s_waitcnt lgkmcnt(12)
v_mfma_f32_32x32x16_bf16 v[96:111],v[200:203],a[100:103],v[96:111]
ds_read_b64_tr_b16 v[196:197],v225 offset:25088
ds_read_b64_tr_b16 v[198:199],v225 offset:25344
s_waitcnt lgkmcnt(12)
v_mfma_f32_32x32x16_bf16 v[112:127],v[204:207],a[100:103],v[112:127]
ds_read_b64_tr_b16 v[200:201],v225 offset:25600
ds_read_b64_tr_b16 v[202:203],v225 offset:25856
s_waitcnt lgkmcnt(12)
v_mfma_f32_32x32x16_bf16 v[128:143],v[208:211],a[100:103],v[128:143]
ds_read_b64_tr_b16 v[204:205],v225 offset:26112
ds_read_b64_tr_b16 v[206:207],v225 offset:26368
s_waitcnt lgkmcnt(12)
v_mfma_f32_32x32x16_bf16 v[144:159],v[212:215],a[100:103],v[144:159]
ds_read_b64_tr_b16 v[208:209],v225 offset:26624
ds_read_b64_tr_b16 v[210:211],v225 offset:26880
s_waitcnt lgkmcnt(12)
v_mfma_f32_32x32x16_bf16 v[160:175],v[216:219],a[100:103],v[160:175]
ds_read_b64_tr_b16 v[212:213],v225 offset:27136
ds_read_b64_tr_b16 v[214:215],v225 offset:27392
s_waitcnt lgkmcnt(12)
v_mfma_f32_32x32x16_bf16 v[176:191],v[220:223],a[100:103],v[176:191]
s_cmp_eq_u32 s91, s61
s_cbranch_scc1 XL0_24
s_add_u32 s57, s91, 24576
buffer_load_dwordx4 a[96:99],v233,s[8:11],s57 offen
buffer_load_dwordx4 a[100:103],v233,s[8:11],s57 offen offset:1024
XL0_24:
ds_read_b64_tr_b16 v[216:217],v225 offset:27648
ds_read_b64_tr_b16 v[218:219],v225 offset:27904
s_waitcnt lgkmcnt(12)
v_mfma_f32_32x32x16_bf16 v[0:15],v[192:195],a[104:107],v[0:15]
ds_read_b64_tr_b16 v[220:221],v225 offset:28160
ds_read_b64_tr_b16 v[222:223],v225 offset:28416
s_waitcnt lgkmcnt(12)
v_mfma_f32_32x32x16_bf16 v[16:31],v[196:199],a[104:107],v[16:31]
s_add_u32 m0, s58, 49152
s_add_u32 s57, s59, 6684672
buffer_load_dwordx4 v230,s[24:27],s57 offen lds
ds_read_b64_tr_b16 v[192:193],v225 offset:28672
ds_read_b64_tr_b16 v[194:195],v225 offset:28928
s_waitcnt lgkmcnt(12)
v_mfma_f32_32x32x16_bf16 v[32:47],v[200:203],a[104:107],v[32:47]
ds_read_b64_tr_b16 v[196:197],v225 offset:29184
ds_read_b64_tr_b16 v[198:199],v225 offset:29440
s_waitcnt lgkmcnt(12)
v_mfma_f32_32x32x16_bf16 v[48:63],v[204:207],a[104:107],v[48:63]
s_add_u32 m0, s58, 50176
s_add_u32 s57, s59, 6684800
buffer_load_dwordx4 v230,s[24:27],s57 offen lds
ds_read_b64_tr_b16 v[200:201],v225 offset:29696
ds_read_b64_tr_b16 v[202:203],v225 offset:29952
s_waitcnt lgkmcnt(12)
v_mfma_f32_32x32x16_bf16 v[64:79],v[208:211],a[104:107],v[64:79]
ds_read_b64_tr_b16 v[204:205],v225 offset:30208
ds_read_b64_tr_b16 v[206:207],v225 offset:30464
s_waitcnt lgkmcnt(12)
v_mfma_f32_32x32x16_bf16 v[80:95],v[212:215],a[104:107],v[80:95]
s_add_u32 m0, s58, 51200
s_add_u32 s57, s59, 6684928
buffer_load_dwordx4 v230,s[24:27],s57 offen lds
ds_read_b64_tr_b16 v[208:209],v225 offset:36864
ds_read_b64_tr_b16 v[210:211],v225 offset:37120
s_waitcnt lgkmcnt(12)
v_mfma_f32_32x32x16_bf16 v[96:111],v[216:219],a[104:107],v[96:111]
ds_read_b64_tr_b16 v[212:213],v225 offset:37376
ds_read_b64_tr_b16 v[214:215],v225 offset:37632
s_waitcnt lgkmcnt(12)
v_mfma_f32_32x32x16_bf16 v[112:127],v[220:223],a[104:107],v[112:127]
s_add_u32 m0, s58, 52224
s_add_u32 s57, s59, 6684672
buffer_load_dwordx4 v230,s[28:31],s57 offen lds
ds_read_b64_tr_b16 v[216:217],v225 offset:37888
ds_read_b64_tr_b16 v[218:219],v225 offset:38144
s_waitcnt lgkmcnt(12)
v_mfma_f32_32x32x16_bf16 v[128:143],v[192:195],a[104:107],v[128:143]
ds_read_b64_tr_b16 v[220:221],v225 offset:38400
ds_read_b64_tr_b16 v[222:223],v225 offset:38656
s_waitcnt lgkmcnt(12)
v_mfma_f32_32x32x16_bf16 v[144:159],v[196:199],a[104:107],v[144:159]
s_add_u32 m0, s58, 53248
s_add_u32 s57, s59, 6684800
buffer_load_dwordx4 v230,s[28:31],s57 offen lds
ds_read_b64_tr_b16 v[192:193],v225 offset:38912
ds_read_b64_tr_b16 v[194:195],v225 offset:39168
s_waitcnt lgkmcnt(12)
v_mfma_f32_32x32x16_bf16 v[160:175],v[200:203],a[104:107],v[160:175]
ds_read_b64_tr_b16 v[196:197],v225 offset:39424
ds_read_b64_tr_b16 v[198:199],v225 offset:39680
s_waitcnt lgkmcnt(12)
v_mfma_f32_32x32x16_bf16 v[176:191],v[204:207],a[104:107],v[176:191]
s_add_u32 m0, s58, 54272
s_add_u32 s57, s59, 6684928
buffer_load_dwordx4 v230,s[28:31],s57 offen lds
ds_read_b64_tr_b16 v[200:201],v225 offset:39936
ds_read_b64_tr_b16 v[202:203],v225 offset:40192
s_waitcnt lgkmcnt(12)
v_mfma_f32_32x32x16_bf16 v[0:15],v[208:211],a[108:111],v[0:15]
ds_read_b64_tr_b16 v[204:205],v225 offset:40448
ds_read_b64_tr_b16 v[206:207],v225 offset:40704
s_waitcnt lgkmcnt(12)
v_mfma_f32_32x32x16_bf16 v[16:31],v[212:215],a[108:111],v[16:31]
ds_read_b64_tr_b16 v[208:209],v225 offset:40960
ds_read_b64_tr_b16 v[210:211],v225 offset:41216
s_waitcnt lgkmcnt(12)
v_mfma_f32_32x32x16_bf16 v[32:47],v[216:219],a[108:111],v[32:47]
ds_read_b64_tr_b16 v[212:213],v225 offset:41472
ds_read_b64_tr_b16 v[214:215],v225 offset:41728
s_waitcnt lgkmcnt(12)
v_mfma_f32_32x32x16_bf16 v[48:63],v[220:223],a[108:111],v[48:63]
ds_read_b64_tr_b16 v[216:217],v225 offset:41984
ds_read_b64_tr_b16 v[218:219],v225 offset:42240
s_waitcnt lgkmcnt(12)
v_mfma_f32_32x32x16_bf16 v[64:79],v[192:195],a[108:111],v[64:79]
ds_read_b64_tr_b16 v[220:221],v225 offset:42496
ds_read_b64_tr_b16 v[222:223],v225 offset:42752
s_waitcnt lgkmcnt(12)
v_mfma_f32_32x32x16_bf16 v[80:95],v[196:199],a[108:111],v[80:95]
s_waitcnt vmcnt(18)
s_barrier
ds_read_b64_tr_b16 v[192:193],v226 offset:0
ds_read_b64_tr_b16 v[194:195],v226 offset:256
s_waitcnt lgkmcnt(12)
v_mfma_f32_32x32x16_bf16 v[96:111],v[200:203],a[108:111],v[96:111]
ds_read_b64_tr_b16 v[196:197],v226 offset:512
ds_read_b64_tr_b16 v[198:199],v226 offset:768
s_waitcnt lgkmcnt(12)
v_mfma_f32_32x32x16_bf16 v[112:127],v[204:207],a[108:111],v[112:127]
ds_read_b64_tr_b16 v[200:201],v226 offset:1024
ds_read_b64_tr_b16 v[202:203],v226 offset:1280
s_waitcnt lgkmcnt(12)
v_mfma_f32_32x32x16_bf16 v[128:143],v[208:211],a[108:111],v[128:143]
ds_read_b64_tr_b16 v[204:205],v226 offset:1536
ds_read_b64_tr_b16 v[206:207],v226 offset:1792
s_waitcnt lgkmcnt(12)
v_mfma_f32_32x32x16_bf16 v[144:159],v[212:215],a[108:111],v[144:159]
ds_read_b64_tr_b16 v[208:209],v226 offset:2048
ds_read_b64_tr_b16 v[210:211],v226 offset:2304
s_waitcnt lgkmcnt(12)
v_mfma_f32_32x32x16_bf16 v[160:175],v[216:219],a[108:111],v[160:175]
ds_read_b64_tr_b16 v[212:213],v226 offset:2560
ds_read_b64_tr_b16 v[214:215],v226 offset:2816
s_waitcnt lgkmcnt(12)
v_mfma_f32_32x32x16_bf16 v[176:191],v[220:223],a[108:111],v[176:191]
s_cmp_eq_u32 s91, s61
s_cbranch_scc1 XL0_26
s_add_u32 s57, s91, 26624
buffer_load_dwordx4 a[104:107],v233,s[8:11],s57 offen
buffer_load_dwordx4 a[108:111],v233,s[8:11],s57 offen offset:1024
XL0_26:
ds_read_b64_tr_b16 v[216:217],v226 offset:3072
ds_read_b64_tr_b16 v[218:219],v226 offset:3328
s_waitcnt lgkmcnt(12)
v_mfma_f32_32x32x16_bf16 v[0:15],v[192:195],a[112:115],v[0:15]
ds_read_b64_tr_b16 v[220:221],v226 offset:3584
ds_read_b64_tr_b16 v[222:223],v226 offset:3840
s_waitcnt lgkmcnt(12)
v_mfma_f32_32x32x16_bf16 v[16:31],v[196:199],a[112:115],v[16:31]
s_add_u32 m0, s58, 73728
s_add_u32 s57, s59, 7077888
buffer_load_dwordx4 v230,s[24:27],s57 offen lds
ds_read_b64_tr_b16 v[192:193],v226 offset:4096
ds_read_b64_tr_b16 v[194:195],v226 offset:4352
s_waitcnt lgkmcnt(12)
v_mfma_f32_32x32x16_bf16 v[32:47],v[200:203],a[112:115],v[32:47]
ds_read_b64_tr_b16 v[196:197],v226 offset:4608
ds_read_b64_tr_b16 v[198:199],v226 offset:4864
s_waitcnt lgkmcnt(12)
v_mfma_f32_32x32x16_bf16 v[48:63],v[204:207],a[112:115],v[48:63]
s_add_u32 m0, s58, 74752
s_add_u32 s57, s59, 7078016
buffer_load_dwordx4 v230,s[24:27],s57 offen lds
ds_read_b64_tr_b16 v[200:201],v226 offset:5120
ds_read_b64_tr_b16 v[202:203],v226 offset:5376
s_waitcnt lgkmcnt(12)
v_mfma_f32_32x32x16_bf16 v[64:79],v[208:211],a[112:115],v[64:79]
ds_read_b64_tr_b16 v[204:205],v226 offset:5632
ds_read_b64_tr_b16 v[206:207],v226 offset:5888
s_waitcnt lgkmcnt(12)
v_mfma_f32_32x32x16_bf16 v[80:95],v[212:215],a[112:115],v[80:95]
s_add_u32 m0, s58, 75776
s_add_u32 s57, s59, 7078144
buffer_load_dwordx4 v230,s[24:27],s57 offen lds
ds_read_b64_tr_b16 v[208:209],v226 offset:12288
ds_read_b64_tr_b16 v[210:211],v226 offset:12544
s_waitcnt lgkmcnt(12)
v_mfma_f32_32x32x16_bf16 v[96:111],v[216:219],a[112:115],v[96:111]
ds_read_b64_tr_b16 v[212:213],v226 offset:12800
ds_read_b64_tr_b16 v[214:215],v226 offset:13056
s_waitcnt lgkmcnt(12)
v_mfma_f32_32x32x16_bf16 v[112:127],v[220:223],a[112:115],v[112:127]
s_add_u32 m0, s58, 76800
s_add_u32 s57, s59, 7077888
buffer_load_dwordx4 v230,s[28:31],s57 offen lds
ds_read_b64_tr_b16 v[216:217],v226 offset:13312
ds_read_b64_tr_b16 v[218:219],v226 offset:13568
s_waitcnt lgkmcnt(12)
v_mfma_f32_32x32x16_bf16 v[128:143],v[192:195],a[112:115],v[128:143]
ds_read_b64_tr_b16 v[220:221],v226 offset:13824
ds_read_b64_tr_b16 v[222:223],v226 offset:14080
s_waitcnt lgkmcnt(12)
v_mfma_f32_32x32x16_bf16 v[144:159],v[196:199],a[112:115],v[144:159]
s_add_u32 m0, s58, 77824
s_add_u32 s57, s59, 7078016
buffer_load_dwordx4 v230,s[28:31],s57 offen lds
ds_read_b64_tr_b16 v[192:193],v226 offset:14336
ds_read_b64_tr_b16 v[194:195],v226 offset:14592
s_waitcnt lgkmcnt(12)
v_mfma_f32_32x32x16_bf16 v[160:175],v[200:203],a[112:115],v[160:175]
ds_read_b64_tr_b16 v[196:197],v226 offset:14848
ds_read_b64_tr_b16 v[198:199],v226 offset:15104
s_waitcnt lgkmcnt(12)
v_mfma_f32_32x32x16_bf16 v[176:191],v[204:207],a[112:115],v[176:191]
s_add_u32 m0, s58, 78848
s_add_u32 s57, s59, 7078144
buffer_load_dwordx4 v230,s[28:31],s57 offen lds
ds_read_b64_tr_b16 v[200:201],v226 offset:15360
ds_read_b64_tr_b16 v[202:203],v226 offset:15616
s_waitcnt lgkmcnt(12)
v_mfma_f32_32x32x16_bf16 v[0:15],v[208:211],a[116:119],v[0:15]
ds_read_b64_tr_b16 v[204:205],v226 offset:15872
ds_read_b64_tr_b16 v[206:207],v226 offset:16128
s_waitcnt lgkmcnt(12)
v_mfma_f32_32x32x16_bf16 v[16:31],v[212:215],a[116:119],v[16:31]
ds_read_b64_tr_b16 v[208:209],v226 offset:16384
ds_read_b64_tr_b16 v[210:211],v226 offset:16640
s_waitcnt lgkmcnt(12)
v_mfma_f32_32x32x16_bf16 v[32:47],v[216:219],a[116:119],v[32:47]
ds_read_b64_tr_b16 v[212:213],v226 offset:16896
ds_read_b64_tr_b16 v[214:215],v226 offset:17152
s_waitcnt lgkmcnt(12)
v_mfma_f32_32x32x16_bf16 v[48:63],v[220:223],a[116:119],v[48:63]
ds_read_b64_tr_b16 v[216:217],v226 offset:17408
ds_read_b64_tr_b16 v[218:219],v226 offset:17664
s_waitcnt lgkmcnt(12)
v_mfma_f32_32x32x16_bf16 v[64:79],v[192:195],a[116:119],v[64:79]
ds_read_b64_tr_b16 v[220:221],v226 offset:17920
ds_read_b64_tr_b16 v[222:223],v226 offset:18176
s_waitcnt lgkmcnt(12)
v_mfma_f32_32x32x16_bf16 v[80:95],v[196:199],a[116:119],v[80:95]
s_waitcnt vmcnt(18)
s_barrier
ds_read_b64_tr_b16 v[192:193],v224 offset:0
ds_read_b64_tr_b16 v[194:195],v224 offset:256
s_waitcnt lgkmcnt(12)
v_mfma_f32_32x32x16_bf16 v[96:111],v[200:203],a[116:119],v[96:111]
ds_read_b64_tr_b16 v[196:197],v224 offset:512
ds_read_b64_tr_b16 v[198:199],v224 offset:768
s_waitcnt lgkmcnt(12)
v_mfma_f32_32x32x16_bf16 v[112:127],v[204:207],a[116:119],v[112:127]
ds_read_b64_tr_b16 v[200:201],v224 offset:1024
ds_read_b64_tr_b16 v[202:203],v224 offset:1280
s_waitcnt lgkmcnt(12)
v_mfma_f32_32x32x16_bf16 v[128:143],v[208:211],a[116:119],v[128:143]
ds_read_b64_tr_b16 v[204:205],v224 offset:1536
ds_read_b64_tr_b16 v[206:207],v224 offset:1792
s_waitcnt lgkmcnt(12)
v_mfma_f32_32x32x16_bf16 v[144:159],v[212:215],a[116:119],v[144:159]
ds_read_b64_tr_b16 v[208:209],v224 offset:2048
ds_read_b64_tr_b16 v[210:211],v224 offset:2304
s_waitcnt lgkmcnt(12)
v_mfma_f32_32x32x16_bf16 v[160:175],v[216:219],a[116:119],v[160:175]
ds_read_b64_tr_b16 v[212:213],v224 offset:2560
ds_read_b64_tr_b16 v[214:215],v224 offset:2816
s_waitcnt lgkmcnt(12)
v_mfma_f32_32x32x16_bf16 v[176:191],v[220:223],a[116:119],v[176:191]
s_cmp_eq_u32 s91, s61
s_cbranch_scc1 XL0_28
s_add_u32 s57, s91, 28672
buffer_load_dwordx4 a[112:115],v233,s[8:11],s57 offen
buffer_load_dwordx4 a[116:119],v233,s[8:11],s57 offen offset:1024
XL0_28:
ds_read_b64_tr_b16 v[216:217],v224 offset:3072
ds_read_b64_tr_b16 v[218:219],v224 offset:3328
s_waitcnt lgkmcnt(12)
v_mfma_f32_32x32x16_bf16 v[0:15],v[192:195],a[120:123],v[0:15]
ds_read_b64_tr_b16 v[220:221],v224 offset:3584
ds_read_b64_tr_b16 v[222:223],v224 offset:3840
s_waitcnt lgkmcnt(12)
v_mfma_f32_32x32x16_bf16 v[16:31],v[196:199],a[120:123],v[16:31]
s_add_u32 m0, s58, 98304
s_add_u32 s57, s59, 7471104
buffer_load_dwordx4 v230,s[24:27],s57 offen lds
ds_read_b64_tr_b16 v[192:193],v224 offset:4096
ds_read_b64_tr_b16 v[194:195],v224 offset:4352
s_waitcnt lgkmcnt(12)
v_mfma_f32_32x32x16_bf16 v[32:47],v[200:203],a[120:123],v[32:47]
ds_read_b64_tr_b16 v[196:197],v224 offset:4608
ds_read_b64_tr_b16 v[198:199],v224 offset:4864
s_waitcnt lgkmcnt(12)
v_mfma_f32_32x32x16_bf16 v[48:63],v[204:207],a[120:123],v[48:63]
s_add_u32 m0, s58, 99328
s_add_u32 s57, s59, 7471232
buffer_load_dwordx4 v230,s[24:27],s57 offen lds
ds_read_b64_tr_b16 v[200:201],v224 offset:5120
ds_read_b64_tr_b16 v[202:203],v224 offset:5376
s_waitcnt lgkmcnt(12)
v_mfma_f32_32x32x16_bf16 v[64:79],v[208:211],a[120:123],v[64:79]
ds_read_b64_tr_b16 v[204:205],v224 offset:5632
ds_read_b64_tr_b16 v[206:207],v224 offset:5888
s_waitcnt lgkmcnt(12)
v_mfma_f32_32x32x16_bf16 v[80:95],v[212:215],a[120:123],v[80:95]
s_add_u32 m0, s58, 100352
s_add_u32 s57, s59, 7471360
buffer_load_dwordx4 v230,s[24:27],s57 offen lds
ds_read_b64_tr_b16 v[208:209],v224 offset:12288
ds_read_b64_tr_b16 v[210:211],v224 offset:12544
s_waitcnt lgkmcnt(12)
v_mfma_f32_32x32x16_bf16 v[96:111],v[216:219],a[120:123],v[96:111]
ds_read_b64_tr_b16 v[212:213],v224 offset:12800
ds_read_b64_tr_b16 v[214:215],v224 offset:13056
s_waitcnt lgkmcnt(12)
v_mfma_f32_32x32x16_bf16 v[112:127],v[220:223],a[120:123],v[112:127]
s_add_u32 m0, s58, 101376
s_add_u32 s57, s59, 7471104
buffer_load_dwordx4 v230,s[28:31],s57 offen lds
ds_read_b64_tr_b16 v[216:217],v224 offset:13312
ds_read_b64_tr_b16 v[218:219],v224 offset:13568
s_waitcnt lgkmcnt(12)
v_mfma_f32_32x32x16_bf16 v[128:143],v[192:195],a[120:123],v[128:143]
ds_read_b64_tr_b16 v[220:221],v224 offset:13824
ds_read_b64_tr_b16 v[222:223],v224 offset:14080
s_waitcnt lgkmcnt(12)
v_mfma_f32_32x32x16_bf16 v[144:159],v[196:199],a[120:123],v[144:159]
s_add_u32 m0, s58, 102400
s_add_u32 s57, s59, 7471232
buffer_load_dwordx4 v230,s[28:31],s57 offen lds
ds_read_b64_tr_b16 v[192:193],v224 offset:14336
ds_read_b64_tr_b16 v[194:195],v224 offset:14592
s_waitcnt lgkmcnt(12)
v_mfma_f32_32x32x16_bf16 v[160:175],v[200:203],a[120:123],v[160:175]
ds_read_b64_tr_b16 v[196:197],v224 offset:14848
ds_read_b64_tr_b16 v[198:199],v224 offset:15104
s_waitcnt lgkmcnt(12)
v_mfma_f32_32x32x16_bf16 v[176:191],v[204:207],a[120:123],v[176:191]
s_add_u32 m0, s58, 103424
s_add_u32 s57, s59, 7471360
buffer_load_dwordx4 v230,s[28:31],s57 offen lds
ds_read_b64_tr_b16 v[200:201],v224 offset:15360
ds_read_b64_tr_b16 v[202:203],v224 offset:15616
s_waitcnt lgkmcnt(12)
v_mfma_f32_32x32x16_bf16 v[0:15],v[208:211],a[124:127],v[0:15]
ds_read_b64_tr_b16 v[204:205],v224 offset:15872
ds_read_b64_tr_b16 v[206:207],v224 offset:16128
s_waitcnt lgkmcnt(12)
v_mfma_f32_32x32x16_bf16 v[16:31],v[212:215],a[124:127],v[16:31]
ds_read_b64_tr_b16 v[208:209],v224 offset:16384
ds_read_b64_tr_b16 v[210:211],v224 offset:16640
s_waitcnt lgkmcnt(12)
v_mfma_f32_32x32x16_bf16 v[32:47],v[216:219],a[124:127],v[32:47]
ds_read_b64_tr_b16 v[212:213],v224 offset:16896
ds_read_b64_tr_b16 v[214:215],v224 offset:17152
s_waitcnt lgkmcnt(12)
v_mfma_f32_32x32x16_bf16 v[48:63],v[220:223],a[124:127],v[48:63]
ds_read_b64_tr_b16 v[216:217],v224 offset:17408
ds_read_b64_tr_b16 v[218:219],v224 offset:17664
s_waitcnt lgkmcnt(12)
v_mfma_f32_32x32x16_bf16 v[64:79],v[192:195],a[124:127],v[64:79]
ds_read_b64_tr_b16 v[220:221],v224 offset:17920
ds_read_b64_tr_b16 v[222:223],v224 offset:18176
s_waitcnt lgkmcnt(12)
v_mfma_f32_32x32x16_bf16 v[80:95],v[196:199],a[124:127],v[80:95]
s_waitcnt vmcnt(18)
s_barrier
ds_read_b64_tr_b16 v[192:193],v224 offset:24576
ds_read_b64_tr_b16 v[194:195],v224 offset:24832
s_waitcnt lgkmcnt(12)
v_mfma_f32_32x32x16_bf16 v[96:111],v[200:203],a[124:127],v[96:111]
ds_read_b64_tr_b16 v[196:197],v224 offset:25088
ds_read_b64_tr_b16 v[198:199],v224 offset:25344
s_waitcnt lgkmcnt(12)
v_mfma_f32_32x32x16_bf16 v[112:127],v[204:207],a[124:127],v[112:127]
ds_read_b64_tr_b16 v[200:201],v224 offset:25600
ds_read_b64_tr_b16 v[202:203],v224 offset:25856
s_waitcnt lgkmcnt(12)
v_mfma_f32_32x32x16_bf16 v[128:143],v[208:211],a[124:127],v[128:143]
ds_read_b64_tr_b16 v[204:205],v224 offset:26112
ds_read_b64_tr_b16 v[206:207],v224 offset:26368
s_waitcnt lgkmcnt(12)
v_mfma_f32_32x32x16_bf16 v[144:159],v[212:215],a[124:127],v[144:159]
ds_read_b64_tr_b16 v[208:209],v224 offset:26624
ds_read_b64_tr_b16 v[210:211],v224 offset:26880
s_waitcnt lgkmcnt(12)
v_mfma_f32_32x32x16_bf16 v[160:175],v[216:219],a[124:127],v[160:175]
ds_read_b64_tr_b16 v[212:213],v224 offset:27136
ds_read_b64_tr_b16 v[214:215],v224 offset:27392
s_waitcnt lgkmcnt(12)
v_mfma_f32_32x32x16_bf16 v[176:191],v[220:223],a[124:127],v[176:191]
s_cmp_eq_u32 s91, s61
s_cbranch_scc1 XL0_30
s_add_u32 s57, s91, 30720
buffer_load_dwordx4 a[120:123],v233,s[8:11],s57 offen
buffer_load_dwordx4 a[124:127],v233,s[8:11],s57 offen offset:1024
XL0_30:
s_mul_i32 s59, s86, 384
ds_read_b64_tr_b16 v[216:217],v224 offset:27648
ds_read_b64_tr_b16 v[218:219],v224 offset:27904
s_waitcnt lgkmcnt(12)
v_mfma_f32_32x32x16_bf16 v[0:15],v[192:195],a[128:131],v[0:15]
ds_read_b64_tr_b16 v[220:221],v224 offset:28160
ds_read_b64_tr_b16 v[222:223],v224 offset:28416
s_waitcnt lgkmcnt(12)
v_mfma_f32_32x32x16_bf16 v[16:31],v[196:199],a[128:131],v[16:31]
s_add_u32 m0, s58, 0
s_add_u32 s57, s59, 0
buffer_load_dwordx4 v230,s[24:27],s57 offen lds
ds_read_b64_tr_b16 v[192:193],v224 offset:28672
ds_read_b64_tr_b16 v[194:195],v224 offset:28928
s_waitcnt lgkmcnt(12)
v_mfma_f32_32x32x16_bf16 v[32:47],v[200:203],a[128:131],v[32:47]
ds_read_b64_tr_b16 v[196:197],v224 offset:29184
ds_read_b64_tr_b16 v[198:199],v224 offset:29440
s_waitcnt lgkmcnt(12)
v_mfma_f32_32x32x16_bf16 v[48:63],v[204:207],a[128:131],v[48:63]
s_add_u32 m0, s58, 1024
s_add_u32 s57, s59, 128
buffer_load_dwordx4 v230,s[24:27],s57 offen lds
ds_read_b64_tr_b16 v[200:201],v224 offset:29696
ds_read_b64_tr_b16 v[202:203],v224 offset:29952
s_waitcnt lgkmcnt(12)
v_mfma_f32_32x32x16_bf16 v[64:79],v[208:211],a[128:131],v[64:79]
ds_read_b64_tr_b16 v[204:205],v224 offset:30208
ds_read_b64_tr_b16 v[206:207],v224 offset:30464
s_waitcnt lgkmcnt(12)
v_mfma_f32_32x32x16_bf16 v[80:95],v[212:215],a[128:131],v[80:95]
s_add_u32 m0, s58, 2048
s_add_u32 s57, s59, 256
buffer_load_dwordx4 v230,s[24:27],s57 offen lds
ds_read_b64_tr_b16 v[208:209],v224 offset:36864
ds_read_b64_tr_b16 v[210:211],v224 offset:37120
s_waitcnt lgkmcnt(12)
v_mfma_f32_32x32x16_bf16 v[96:111],v[216:219],a[128:131],v[96:111]
ds_read_b64_tr_b16 v[212:213],v224 offset:37376
ds_read_b64_tr_b16 v[214:215],v224 offset:37632
s_waitcnt lgkmcnt(12)
v_mfma_f32_32x32x16_bf16 v[112:127],v[220:223],a[128:131],v[112:127]
s_add_u32 m0, s58, 3072
s_add_u32 s57, s59, 0
buffer_load_dwordx4 v230,s[28:31],s57 offen lds
ds_read_b64_tr_b16 v[216:217],v224 offset:37888
ds_read_b64_tr_b16 v[218:219],v224 offset:38144
s_waitcnt lgkmcnt(12)
v_mfma_f32_32x32x16_bf16 v[128:143],v[192:195],a[128:131],v[128:143]
ds_read_b64_tr_b16 v[220:221],v224 offset:38400
ds_read_b64_tr_b16 v[222:223],v224 offset:38656
s_waitcnt lgkmcnt(12)
v_mfma_f32_32x32x16_bf16 v[144:159],v[196:199],a[128:131],v[144:159]
s_add_u32 m0, s58, 4096
s_add_u32 s57, s59, 128
buffer_load_dwordx4 v230,s[28:31],s57 offen lds
ds_read_b64_tr_b16 v[192:193],v224 offset:38912
ds_read_b64_tr_b16 v[194:195],v224 offset:39168
s_waitcnt lgkmcnt(12)
v_mfma_f32_32x32x16_bf16 v[160:175],v[200:203],a[128:131],v[160:175]
ds_read_b64_tr_b16 v[196:197],v224 offset:39424
ds_read_b64_tr_b16 v[198:199],v224 offset:39680
s_waitcnt lgkmcnt(12)
v_mfma_f32_32x32x16_bf16 v[176:191],v[204:207],a[128:131],v[176:191]
s_add_u32 m0, s58, 5120
s_add_u32 s57, s59, 256
buffer_load_dwordx4 v230,s[28:31],s57 offen lds
ds_read_b64_tr_b16 v[200:201],v224 offset:39936
ds_read_b64_tr_b16 v[202:203],v224 offset:40192
s_waitcnt lgkmcnt(12)
v_mfma_f32_32x32x16_bf16 v[0:15],v[208:211],a[132:135],v[0:15]
ds_read_b64_tr_b16 v[204:205],v224 offset:40448
ds_read_b64_tr_b16 v[206:207],v224 offset:40704
s_waitcnt lgkmcnt(12)
v_mfma_f32_32x32x16_bf16 v[16:31],v[212:215],a[132:135],v[16:31]
ds_read_b64_tr_b16 v[208:209],v224 offset:40960
ds_read_b64_tr_b16 v[210:211],v224 offset:41216
s_waitcnt lgkmcnt(12)
v_mfma_f32_32x32x16_bf16 v[32:47],v[216:219],a[132:135],v[32:47]
ds_read_b64_tr_b16 v[212:213],v224 offset:41472
ds_read_b64_tr_b16 v[214:215],v224 offset:41728
s_waitcnt lgkmcnt(12)
v_mfma_f32_32x32x16_bf16 v[48:63],v[220:223],a[132:135],v[48:63]
ds_read_b64_tr_b16 v[216:217],v224 offset:41984
ds_read_b64_tr_b16 v[218:219],v224 offset:42240
s_waitcnt lgkmcnt(12)
v_mfma_f32_32x32x16_bf16 v[64:79],v[192:195],a[132:135],v[64:79]
ds_read_b64_tr_b16 v[220:221],v224 offset:42496
ds_read_b64_tr_b16 v[222:223],v224 offset:42752
s_waitcnt lgkmcnt(12)
v_mfma_f32_32x32x16_bf16 v[80:95],v[196:199],a[132:135],v[80:95]
s_waitcnt vmcnt(18)
s_barrier
ds_read_b64_tr_b16 v[192:193],v225 offset:0
ds_read_b64_tr_b16 v[194:195],v225 offset:256
s_waitcnt lgkmcnt(12)
v_mfma_f32_32x32x16_bf16 v[96:111],v[200:203],a[132:135],v[96:111]
ds_read_b64_tr_b16 v[196:197],v225 offset:512
ds_read_b64_tr_b16 v[198:199],v225 offset:768
s_waitcnt lgkmcnt(12)
v_mfma_f32_32x32x16_bf16 v[112:127],v[204:207],a[132:135],v[112:127]
ds_read_b64_tr_b16 v[200:201],v225 offset:1024
ds_read_b64_tr_b16 v[202:203],v225 offset:1280
s_waitcnt lgkmcnt(12)
v_mfma_f32_32x32x16_bf16 v[128:143],v[208:211],a[132:135],v[128:143]
ds_read_b64_tr_b16 v[204:205],v225 offset:1536
ds_read_b64_tr_b16 v[206:207],v225 offset:1792
s_waitcnt lgkmcnt(12)
v_mfma_f32_32x32x16_bf16 v[144:159],v[212:215],a[132:135],v[144:159]
ds_read_b64_tr_b16 v[208:209],v225 offset:2048
ds_read_b64_tr_b16 v[210:211],v225 offset:2304
s_waitcnt lgkmcnt(12)
v_mfma_f32_32x32x16_bf16 v[160:175],v[216:219],a[132:135],v[160:175]
ds_read_b64_tr_b16 v[212:213],v225 offset:2560
ds_read_b64_tr_b16 v[214:215],v225 offset:2816
s_waitcnt lgkmcnt(12)
v_mfma_f32_32x32x16_bf16 v[176:191],v[220:223],a[132:135],v[176:191]
s_cmp_eq_u32 s91, s61
s_cbranch_scc1 XL0_32
s_add_u32 s57, s91, 32768
buffer_load_dwordx4 a[128:131],v233,s[8:11],s57 offen
buffer_load_dwordx4 a[132:135],v233,s[8:11],s57 offen offset:1024
XL0_32:
ds_read_b64_tr_b16 v[216:217],v225 offset:3072
ds_read_b64_tr_b16 v[218:219],v225 offset:3328
s_waitcnt lgkmcnt(12)
v_mfma_f32_32x32x16_bf16 v[0:15],v[192:195],a[136:139],v[0:15]
ds_read_b64_tr_b16 v[220:221],v225 offset:3584
ds_read_b64_tr_b16 v[222:223],v225 offset:3840
s_waitcnt lgkmcnt(12)
v_mfma_f32_32x32x16_bf16 v[16:31],v[196:199],a[136:139],v[16:31]
s_add_u32 m0, s58, 24576
s_add_u32 s57, s59, 393216
buffer_load_dwordx4 v230,s[24:27],s57 offen lds
ds_read_b64_tr_b16 v[192:193],v225 offset:4096
ds_read_b64_tr_b16 v[194:195],v225 offset:4352
s_waitcnt lgkmcnt(12)
v_mfma_f32_32x32x16_bf16 v[32:47],v[200:203],a[136:139],v[32:47]
ds_read_b64_tr_b16 v[196:197],v225 offset:4608
ds_read_b64_tr_b16 v[198:199],v225 offset:4864
s_waitcnt lgkmcnt(12)
v_mfma_f32_32x32x16_bf16 v[48:63],v[204:207],a[136:139],v[48:63]
s_add_u32 m0, s58, 25600
s_add_u32 s57, s59, 393344
buffer_load_dwordx4 v230,s[24:27],s57 offen lds
ds_read_b64_tr_b16 v[200:201],v225 offset:5120
ds_read_b64_tr_b16 v[202:203],v225 offset:5376
s_waitcnt lgkmcnt(12)
v_mfma_f32_32x32x16_bf16 v[64:79],v[208:211],a[136:139],v[64:79]
ds_read_b64_tr_b16 v[204:205],v225 offset:5632
ds_read_b64_tr_b16 v[206:207],v225 offset:5888
s_waitcnt lgkmcnt(12)
v_mfma_f32_32x32x16_bf16 v[80:95],v[212:215],a[136:139],v[80:95]
s_add_u32 m0, s58, 26624
s_add_u32 s57, s59, 393472
buffer_load_dwordx4 v230,s[24:27],s57 offen lds
ds_read_b64_tr_b16 v[208:209],v225 offset:12288
ds_read_b64_tr_b16 v[210:211],v225 offset:12544
s_waitcnt lgkmcnt(12)
v_mfma_f32_32x32x16_bf16 v[96:111],v[216:219],a[136:139],v[96:111]
ds_read_b64_tr_b16 v[212:213],v225 offset:12800
ds_read_b64_tr_b16 v[214:215],v225 offset:13056
s_waitcnt lgkmcnt(12)
v_mfma_f32_32x32x16_bf16 v[112:127],v[220:223],a[136:139],v[112:127]
s_add_u32 m0, s58, 27648
s_add_u32 s57, s59, 393216
buffer_load_dwordx4 v230,s[28:31],s57 offen lds
ds_read_b64_tr_b16 v[216:217],v225 offset:13312
ds_read_b64_tr_b16 v[218:219],v225 offset:13568
s_waitcnt lgkmcnt(12)
v_mfma_f32_32x32x16_bf16 v[128:143],v[192:195],a[136:139],v[128:143]
ds_read_b64_tr_b16 v[220:221],v225 offset:13824
ds_read_b64_tr_b16 v[222:223],v225 offset:14080
s_waitcnt lgkmcnt(12)
v_mfma_f32_32x32x16_bf16 v[144:159],v[196:199],a[136:139],v[144:159]
s_add_u32 m0, s58, 28672
s_add_u32 s57, s59, 393344
buffer_load_dwordx4 v230,s[28:31],s57 offen lds
ds_read_b64_tr_b16 v[192:193],v225 offset:14336
ds_read_b64_tr_b16 v[194:195],v225 offset:14592
s_waitcnt lgkmcnt(12)
v_mfma_f32_32x32x16_bf16 v[160:175],v[200:203],a[136:139],v[160:175]
ds_read_b64_tr_b16 v[196:197],v225 offset:14848
ds_read_b64_tr_b16 v[198:199],v225 offset:15104
s_waitcnt lgkmcnt(12)
v_mfma_f32_32x32x16_bf16 v[176:191],v[204:207],a[136:139],v[176:191]
s_add_u32 m0, s58, 29696
s_add_u32 s57, s59, 393472
buffer_load_dwordx4 v230,s[28:31],s57 offen lds
ds_read_b64_tr_b16 v[200:201],v225 offset:15360
ds_read_b64_tr_b16 v[202:203],v225 offset:15616
s_waitcnt lgkmcnt(12)
v_mfma_f32_32x32x16_bf16 v[0:15],v[208:211],a[140:143],v[0:15]
ds_read_b64_tr_b16 v[204:205],v225 offset:15872
ds_read_b64_tr_b16 v[206:207],v225 offset:16128
s_waitcnt lgkmcnt(12)
v_mfma_f32_32x32x16_bf16 v[16:31],v[212:215],a[140:143],v[16:31]
ds_read_b64_tr_b16 v[208:209],v225 offset:16384
ds_read_b64_tr_b16 v[210:211],v225 offset:16640
s_waitcnt lgkmcnt(12)
v_mfma_f32_32x32x16_bf16 v[32:47],v[216:219],a[140:143],v[32:47]
ds_read_b64_tr_b16 v[212:213],v225 offset:16896
ds_read_b64_tr_b16 v[214:215],v225 offset:17152
s_waitcnt lgkmcnt(12)
v_mfma_f32_32x32x16_bf16 v[48:63],v[220:223],a[140:143],v[48:63]
ds_read_b64_tr_b16 v[216:217],v225 offset:17408
ds_read_b64_tr_b16 v[218:219],v225 offset:17664
s_waitcnt lgkmcnt(12)
v_mfma_f32_32x32x16_bf16 v[64:79],v[192:195],a[140:143],v[64:79]
ds_read_b64_tr_b16 v[220:221],v225 offset:17920
ds_read_b64_tr_b16 v[222:223],v225 offset:18176
s_waitcnt lgkmcnt(12)
v_mfma_f32_32x32x16_bf16 v[80:95],v[196:199],a[140:143],v[80:95]
s_waitcnt vmcnt(18)
s_barrier
ds_read_b64_tr_b16 v[192:193],v225 offset:24576
ds_read_b64_tr_b16 v[194:195],v225 offset:24832
s_waitcnt lgkmcnt(12)
v_mfma_f32_32x32x16_bf16 v[96:111],v[200:203],a[140:143],v[96:111]
ds_read_b64_tr_b16 v[196:197],v225 offset:25088
ds_read_b64_tr_b16 v[198:199],v225 offset:25344
s_waitcnt lgkmcnt(12)
v_mfma_f32_32x32x16_bf16 v[112:127],v[204:207],a[140:143],v[112:127]
ds_read_b64_tr_b16 v[200:201],v225 offset:25600
ds_read_b64_tr_b16 v[202:203],v225 offset:25856
s_waitcnt lgkmcnt(12)
v_mfma_f32_32x32x16_bf16 v[128:143],v[208:211],a[140:143],v[128:143]
ds_read_b64_tr_b16 v[204:205],v225 offset:26112
ds_read_b64_tr_b16 v[206:207],v225 offset:26368
s_waitcnt lgkmcnt(12)
v_mfma_f32_32x32x16_bf16 v[144:159],v[212:215],a[140:143],v[144:159]
ds_read_b64_tr_b16 v[208:209],v225 offset:26624
ds_read_b64_tr_b16 v[210:211],v225 offset:26880
s_waitcnt lgkmcnt(12)
v_mfma_f32_32x32x16_bf16 v[160:175],v[216:219],a[140:143],v[160:175]
ds_read_b64_tr_b16 v[212:213],v225 offset:27136
ds_read_b64_tr_b16 v[214:215],v225 offset:27392
s_waitcnt lgkmcnt(12)
v_mfma_f32_32x32x16_bf16 v[176:191],v[220:223],a[140:143],v[176:191]
s_cmp_eq_u32 s91, s61
s_cbranch_scc1 XL0_34
s_add_u32 s57, s91, 34816
buffer_load_dwordx4 a[136:139],v233,s[8:11],s57 offen
buffer_load_dwordx4 a[140:143],v233,s[8:11],s57 offen offset:1024
XL0_34:
ds_read_b64_tr_b16 v[216:217],v225 offset:27648
ds_read_b64_tr_b16 v[218:219],v225 offset:27904
s_waitcnt lgkmcnt(12)
v_mfma_f32_32x32x16_bf16 v[0:15],v[192:195],a[144:147],v[0:15]
ds_read_b64_tr_b16 v[220:221],v225 offset:28160
ds_read_b64_tr_b16 v[222:223],v225 offset:28416
s_waitcnt lgkmcnt(12)
v_mfma_f32_32x32x16_bf16 v[16:31],v[196:199],a[144:147],v[16:31]
s_add_u32 m0, s58, 49152
s_add_u32 s57, s59, 786432
buffer_load_dwordx4 v230,s[24:27],s57 offen lds
ds_read_b64_tr_b16 v[192:193],v225 offset:28672
ds_read_b64_tr_b16 v[194:195],v225 offset:28928
s_waitcnt lgkmcnt(12)
v_mfma_f32_32x32x16_bf16 v[32:47],v[200:203],a[144:147],v[32:47]
ds_read_b64_tr_b16 v[196:197],v225 offset:29184
ds_read_b64_tr_b16 v[198:199],v225 offset:29440
s_waitcnt lgkmcnt(12)
v_mfma_f32_32x32x16_bf16 v[48:63],v[204:207],a[144:147],v[48:63]
s_add_u32 m0, s58, 50176
s_add_u32 s57, s59, 786560
buffer_load_dwordx4 v230,s[24:27],s57 offen lds
ds_read_b64_tr_b16 v[200:201],v225 offset:29696
ds_read_b64_tr_b16 v[202:203],v225 offset:29952
s_waitcnt lgkmcnt(12)
v_mfma_f32_32x32x16_bf16 v[64:79],v[208:211],a[144:147],v[64:79]
ds_read_b64_tr_b16 v[204:205],v225 offset:30208
ds_read_b64_tr_b16 v[206:207],v225 offset:30464
s_waitcnt lgkmcnt(12)
v_mfma_f32_32x32x16_bf16 v[80:95],v[212:215],a[144:147],v[80:95]
s_add_u32 m0, s58, 51200
s_add_u32 s57, s59, 786688
buffer_load_dwordx4 v230,s[24:27],s57 offen lds
ds_read_b64_tr_b16 v[208:209],v225 offset:36864
ds_read_b64_tr_b16 v[210:211],v225 offset:37120
s_waitcnt lgkmcnt(12)
v_mfma_f32_32x32x16_bf16 v[96:111],v[216:219],a[144:147],v[96:111]
ds_read_b64_tr_b16 v[212:213],v225 offset:37376
ds_read_b64_tr_b16 v[214:215],v225 offset:37632
s_waitcnt lgkmcnt(12)
v_mfma_f32_32x32x16_bf16 v[112:127],v[220:223],a[144:147],v[112:127]
s_add_u32 m0, s58, 52224
s_add_u32 s57, s59, 786432
buffer_load_dwordx4 v230,s[28:31],s57 offen lds
ds_read_b64_tr_b16 v[216:217],v225 offset:37888
ds_read_b64_tr_b16 v[218:219],v225 offset:38144
s_waitcnt lgkmcnt(12)
v_mfma_f32_32x32x16_bf16 v[128:143],v[192:195],a[144:147],v[128:143]
ds_read_b64_tr_b16 v[220:221],v225 offset:38400
ds_read_b64_tr_b16 v[222:223],v225 offset:38656
s_waitcnt lgkmcnt(12)
v_mfma_f32_32x32x16_bf16 v[144:159],v[196:199],a[144:147],v[144:159]
s_add_u32 m0, s58, 53248
s_add_u32 s57, s59, 786560
buffer_load_dwordx4 v230,s[28:31],s57 offen lds
ds_read_b64_tr_b16 v[192:193],v225 offset:38912
ds_read_b64_tr_b16 v[194:195],v225 offset:39168
s_waitcnt lgkmcnt(12)
v_mfma_f32_32x32x16_bf16 v[160:175],v[200:203],a[144:147],v[160:175]
ds_read_b64_tr_b16 v[196:197],v225 offset:39424
ds_read_b64_tr_b16 v[198:199],v225 offset:39680
s_waitcnt lgkmcnt(12)
v_mfma_f32_32x32x16_bf16 v[176:191],v[204:207],a[144:147],v[176:191]
s_add_u32 m0, s58, 54272
s_add_u32 s57, s59, 786688
buffer_load_dwordx4 v230,s[28:31],s57 offen lds
ds_read_b64_tr_b16 v[200:201],v225 offset:39936
ds_read_b64_tr_b16 v[202:203],v225 offset:40192
s_waitcnt lgkmcnt(12)
v_mfma_f32_32x32x16_bf16 v[0:15],v[208:211],a[148:151],v[0:15]
ds_read_b64_tr_b16 v[204:205],v225 offset:40448
ds_read_b64_tr_b16 v[206:207],v225 offset:40704
s_waitcnt lgkmcnt(12)
v_mfma_f32_32x32x16_bf16 v[16:31],v[212:215],a[148:151],v[16:31]
ds_read_b64_tr_b16 v[208:209],v225 offset:40960
ds_read_b64_tr_b16 v[210:211],v225 offset:41216
s_waitcnt lgkmcnt(12)
v_mfma_f32_32x32x16_bf16 v[32:47],v[216:219],a[148:151],v[32:47]
ds_read_b64_tr_b16 v[212:213],v225 offset:41472
ds_read_b64_tr_b16 v[214:215],v225 offset:41728
s_waitcnt lgkmcnt(12)
v_mfma_f32_32x32x16_bf16 v[48:63],v[220:223],a[148:151],v[48:63]
ds_read_b64_tr_b16 v[216:217],v225 offset:41984
ds_read_b64_tr_b16 v[218:219],v225 offset:42240
s_waitcnt lgkmcnt(12)
v_mfma_f32_32x32x16_bf16 v[64:79],v[192:195],a[148:151],v[64:79]
ds_read_b64_tr_b16 v[220:221],v225 offset:42496
ds_read_b64_tr_b16 v[222:223],v225 offset:42752
s_waitcnt lgkmcnt(12)
v_mfma_f32_32x32x16_bf16 v[80:95],v[196:199],a[148:151],v[80:95]
s_waitcnt vmcnt(18)
s_barrier
ds_read_b64_tr_b16 v[192:193],v226 offset:0
ds_read_b64_tr_b16 v[194:195],v226 offset:256
s_waitcnt lgkmcnt(12)
v_mfma_f32_32x32x16_bf16 v[96:111],v[200:203],a[148:151],v[96:111]
ds_read_b64_tr_b16 v[196:197],v226 offset:512
ds_read_b64_tr_b16 v[198:199],v226 offset:768
s_waitcnt lgkmcnt(12)
v_mfma_f32_32x32x16_bf16 v[112:127],v[204:207],a[148:151],v[112:127]
ds_read_b64_tr_b16 v[200:201],v226 offset:1024
ds_read_b64_tr_b16 v[202:203],v226 offset:1280
s_waitcnt lgkmcnt(12)
v_mfma_f32_32x32x16_bf16 v[128:143],v[208:211],a[148:151],v[128:143]
ds_read_b64_tr_b16 v[204:205],v226 offset:1536
ds_read_b64_tr_b16 v[206:207],v226 offset:1792
s_waitcnt lgkmcnt(12)
v_mfma_f32_32x32x16_bf16 v[144:159],v[212:215],a[148:151],v[144:159]
ds_read_b64_tr_b16 v[208:209],v226 offset:2048
ds_read_b64_tr_b16 v[210:211],v226 offset:2304
s_waitcnt lgkmcnt(12)
v_mfma_f32_32x32x16_bf16 v[160:175],v[216:219],a[148:151],v[160:175]
ds_read_b64_tr_b16 v[212:213],v226 offset:2560
ds_read_b64_tr_b16 v[214:215],v226 offset:2816
s_waitcnt lgkmcnt(12)
v_mfma_f32_32x32x16_bf16 v[176:191],v[220:223],a[148:151],v[176:191]
s_cmp_eq_u32 s91, s61
s_cbranch_scc1 XL0_36
s_add_u32 s57, s91, 36864
buffer_load_dwordx4 a[144:147],v233,s[8:11],s57 offen
buffer_load_dwordx4 a[148:151],v233,s[8:11],s57 offen offset:1024
XL0_36:
ds_read_b64_tr_b16 v[216:217],v226 offset:3072
ds_read_b64_tr_b16 v[218:219],v226 offset:3328
s_waitcnt lgkmcnt(12)
v_mfma_f32_32x32x16_bf16 v[0:15],v[192:195],a[152:155],v[0:15]
ds_read_b64_tr_b16 v[220:221],v226 offset:3584
ds_read_b64_tr_b16 v[222:223],v226 offset:3840
s_waitcnt lgkmcnt(12)
v_mfma_f32_32x32x16_bf16 v[16:31],v[196:199],a[152:155],v[16:31]
s_add_u32 m0, s58, 73728
s_add_u32 s57, s59, 1179648
buffer_load_dwordx4 v230,s[24:27],s57 offen lds
ds_read_b64_tr_b16 v[192:193],v226 offset:4096
ds_read_b64_tr_b16 v[194:195],v226 offset:4352
s_waitcnt lgkmcnt(12)
v_mfma_f32_32x32x16_bf16 v[32:47],v[200:203],a[152:155],v[32:47]
ds_read_b64_tr_b16 v[196:197],v226 offset:4608
ds_read_b64_tr_b16 v[198:199],v226 offset:4864
s_waitcnt lgkmcnt(12)
v_mfma_f32_32x32x16_bf16 v[48:63],v[204:207],a[152:155],v[48:63]
s_add_u32 m0, s58, 74752
s_add_u32 s57, s59, 1179776
buffer_load_dwordx4 v230,s[24:27],s57 offen lds
ds_read_b64_tr_b16 v[200:201],v226 offset:5120
ds_read_b64_tr_b16 v[202:203],v226 offset:5376
s_waitcnt lgkmcnt(12)
v_mfma_f32_32x32x16_bf16 v[64:79],v[208:211],a[152:155],v[64:79]
ds_read_b64_tr_b16 v[204:205],v226 offset:5632
ds_read_b64_tr_b16 v[206:207],v226 offset:5888
s_waitcnt lgkmcnt(12)
v_mfma_f32_32x32x16_bf16 v[80:95],v[212:215],a[152:155],v[80:95]
s_add_u32 m0, s58, 75776
s_add_u32 s57, s59, 1179904
buffer_load_dwordx4 v230,s[24:27],s57 offen lds
ds_read_b64_tr_b16 v[208:209],v226 offset:12288
ds_read_b64_tr_b16 v[210:211],v226 offset:12544
s_waitcnt lgkmcnt(12)
v_mfma_f32_32x32x16_bf16 v[96:111],v[216:219],a[152:155],v[96:111]
ds_read_b64_tr_b16 v[212:213],v226 offset:12800
ds_read_b64_tr_b16 v[214:215],v226 offset:13056
s_waitcnt lgkmcnt(12)
v_mfma_f32_32x32x16_bf16 v[112:127],v[220:223],a[152:155],v[112:127]
s_add_u32 m0, s58, 76800
s_add_u32 s57, s59, 1179648
buffer_load_dwordx4 v230,s[28:31],s57 offen lds
ds_read_b64_tr_b16 v[216:217],v226 offset:13312
ds_read_b64_tr_b16 v[218:219],v226 offset:13568
s_waitcnt lgkmcnt(12)
v_mfma_f32_32x32x16_bf16 v[128:143],v[192:195],a[152:155],v[128:143]
ds_read_b64_tr_b16 v[220:221],v226 offset:13824
ds_read_b64_tr_b16 v[222:223],v226 offset:14080
s_waitcnt lgkmcnt(12)
v_mfma_f32_32x32x16_bf16 v[144:159],v[196:199],a[152:155],v[144:159]
s_add_u32 m0, s58, 77824
s_add_u32 s57, s59, 1179776
buffer_load_dwordx4 v230,s[28:31],s57 offen lds
ds_read_b64_tr_b16 v[192:193],v226 offset:14336
ds_read_b64_tr_b16 v[194:195],v226 offset:14592
s_waitcnt lgkmcnt(12)
v_mfma_f32_32x32x16_bf16 v[160:175],v[200:203],a[152:155],v[160:175]
ds_read_b64_tr_b16 v[196:197],v226 offset:14848
ds_read_b64_tr_b16 v[198:199],v226 offset:15104
s_waitcnt lgkmcnt(12)
v_mfma_f32_32x32x16_bf16 v[176:191],v[204:207],a[152:155],v[176:191]
s_add_u32 m0, s58, 78848
s_add_u32 s57, s59, 1179904
buffer_load_dwordx4 v230,s[28:31],s57 offen lds
ds_read_b64_tr_b16 v[200:201],v226 offset:15360
ds_read_b64_tr_b16 v[202:203],v226 offset:15616
s_waitcnt lgkmcnt(12)
v_mfma_f32_32x32x16_bf16 v[0:15],v[208:211],a[156:159],v[0:15]
ds_read_b64_tr_b16 v[204:205],v226 offset:15872
ds_read_b64_tr_b16 v[206:207],v226 offset:16128
s_waitcnt lgkmcnt(12)
v_mfma_f32_32x32x16_bf16 v[16:31],v[212:215],a[156:159],v[16:31]
ds_read_b64_tr_b16 v[208:209],v226 offset:16384
ds_read_b64_tr_b16 v[210:211],v226 offset:16640
s_waitcnt lgkmcnt(12)
v_mfma_f32_32x32x16_bf16 v[32:47],v[216:219],a[156:159],v[32:47]
ds_read_b64_tr_b16 v[212:213],v226 offset:16896
ds_read_b64_tr_b16 v[214:215],v226 offset:17152
s_waitcnt lgkmcnt(12)
v_mfma_f32_32x32x16_bf16 v[48:63],v[220:223],a[156:159],v[48:63]
ds_read_b64_tr_b16 v[216:217],v226 offset:17408
ds_read_b64_tr_b16 v[218:219],v226 offset:17664
s_waitcnt lgkmcnt(12)
v_mfma_f32_32x32x16_bf16 v[64:79],v[192:195],a[156:159],v[64:79]
ds_read_b64_tr_b16 v[220:221],v226 offset:17920
ds_read_b64_tr_b16 v[222:223],v226 offset:18176
s_waitcnt lgkmcnt(12)
v_mfma_f32_32x32x16_bf16 v[80:95],v[196:199],a[156:159],v[80:95]
s_waitcnt vmcnt(18)
s_barrier
ds_read_b64_tr_b16 v[192:193],v224 offset:0
ds_read_b64_tr_b16 v[194:195],v224 offset:256
s_waitcnt lgkmcnt(12)
v_mfma_f32_32x32x16_bf16 v[96:111],v[200:203],a[156:159],v[96:111]
ds_read_b64_tr_b16 v[196:197],v224 offset:512
ds_read_b64_tr_b16 v[198:199],v224 offset:768
s_waitcnt lgkmcnt(12)
v_mfma_f32_32x32x16_bf16 v[112:127],v[204:207],a[156:159],v[112:127]
ds_read_b64_tr_b16 v[200:201],v224 offset:1024
ds_read_b64_tr_b16 v[202:203],v224 offset:1280
s_waitcnt lgkmcnt(12)
v_mfma_f32_32x32x16_bf16 v[128:143],v[208:211],a[156:159],v[128:143]
ds_read_b64_tr_b16 v[204:205],v224 offset:1536
ds_read_b64_tr_b16 v[206:207],v224 offset:1792
s_waitcnt lgkmcnt(12)
v_mfma_f32_32x32x16_bf16 v[144:159],v[212:215],a[156:159],v[144:159]
ds_read_b64_tr_b16 v[208:209],v224 offset:2048
ds_read_b64_tr_b16 v[210:211],v224 offset:2304
s_waitcnt lgkmcnt(12)
v_mfma_f32_32x32x16_bf16 v[160:175],v[216:219],a[156:159],v[160:175]
ds_read_b64_tr_b16 v[212:213],v224 offset:2560
ds_read_b64_tr_b16 v[214:215],v224 offset:2816
s_waitcnt lgkmcnt(12)
v_mfma_f32_32x32x16_bf16 v[176:191],v[220:223],a[156:159],v[176:191]
s_cmp_eq_u32 s91, s61
s_cbranch_scc1 XL0_38
s_add_u32 s57, s91, 38912
buffer_load_dwordx4 a[152:155],v233,s[8:11],s57 offen
buffer_load_dwordx4 a[156:159],v233,s[8:11],s57 offen offset:1024
XL0_38:
s_nop 11
v_cvt_pk_bf16_f32 v0, v0, v1
v_cvt_pk_bf16_f32 v1, v2, v3
v_cvt_pk_bf16_f32 v2, v4, v5
v_cvt_pk_bf16_f32 v3, v6, v7
v_cvt_pk_bf16_f32 v4, v8, v9
v_cvt_pk_bf16_f32 v5, v10, v11
v_cvt_pk_bf16_f32 v6, v12, v13
v_cvt_pk_bf16_f32 v7, v14, v15
v_cvt_pk_bf16_f32 v8, v16, v17
v_cvt_pk_bf16_f32 v9, v18, v19
v_cvt_pk_bf16_f32 v10, v20, v21
v_cvt_pk_bf16_f32 v11, v22, v23
v_cvt_pk_bf16_f32 v12, v24, v25
v_cvt_pk_bf16_f32 v13, v26, v27
v_cvt_pk_bf16_f32 v14, v28, v29
v_cvt_pk_bf16_f32 v15, v30, v31
v_cvt_pk_bf16_f32 v16, v32, v33
v_cvt_pk_bf16_f32 v17, v34, v35
v_cvt_pk_bf16_f32 v18, v36, v37
v_cvt_pk_bf16_f32 v19, v38, v39
v_cvt_pk_bf16_f32 v20, v40, v41
v_cvt_pk_bf16_f32 v21, v42, v43
v_cvt_pk_bf16_f32 v22, v44, v45
v_cvt_pk_bf16_f32 v23, v46, v47
v_cvt_pk_bf16_f32 v24, v48, v49
v_cvt_pk_bf16_f32 v25, v50, v51
v_cvt_pk_bf16_f32 v26, v52, v53
v_cvt_pk_bf16_f32 v27, v54, v55
v_cvt_pk_bf16_f32 v28, v56, v57
v_cvt_pk_bf16_f32 v29, v58, v59
v_cvt_pk_bf16_f32 v30, v60, v61
v_cvt_pk_bf16_f32 v31, v62, v63
v_cvt_pk_bf16_f32 v32, v64, v65
v_cvt_pk_bf16_f32 v33, v66, v67
v_cvt_pk_bf16_f32 v34, v68, v69
v_cvt_pk_bf16_f32 v35, v70, v71
v_cvt_pk_bf16_f32 v36, v72, v73
v_cvt_pk_bf16_f32 v37, v74, v75
v_cvt_pk_bf16_f32 v38, v76, v77
v_cvt_pk_bf16_f32 v39, v78, v79
v_cvt_pk_bf16_f32 v40, v80, v81
v_cvt_pk_bf16_f32 v41, v82, v83
v_cvt_pk_bf16_f32 v42, v84, v85
v_cvt_pk_bf16_f32 v43, v86, v87
v_cvt_pk_bf16_f32 v44, v88, v89
v_cvt_pk_bf16_f32 v45, v90, v91
v_cvt_pk_bf16_f32 v46, v92, v93
v_cvt_pk_bf16_f32 v47, v94, v95
v_cvt_pk_bf16_f32 v48, v96, v97
v_cvt_pk_bf16_f32 v49, v98, v99
v_cvt_pk_bf16_f32 v50, v100, v101
v_cvt_pk_bf16_f32 v51, v102, v103
v_cvt_pk_bf16_f32 v52, v104, v105
v_cvt_pk_bf16_f32 v53, v106, v107
v_cvt_pk_bf16_f32 v54, v108, v109
v_cvt_pk_bf16_f32 v55, v110, v111
v_cvt_pk_bf16_f32 v56, v112, v113
v_cvt_pk_bf16_f32 v57, v114, v115
v_cvt_pk_bf16_f32 v58, v116, v117
v_cvt_pk_bf16_f32 v59, v118, v119
v_cvt_pk_bf16_f32 v60, v120, v121
v_cvt_pk_bf16_f32 v61, v122, v123
v_cvt_pk_bf16_f32 v62, v124, v125
v_cvt_pk_bf16_f32 v63, v126, v127
v_cvt_pk_bf16_f32 v64, v128, v129
v_cvt_pk_bf16_f32 v65, v130, v131
v_cvt_pk_bf16_f32 v66, v132, v133
v_cvt_pk_bf16_f32 v67, v134, v135
v_cvt_pk_bf16_f32 v68, v136, v137
v_cvt_pk_bf16_f32 v69, v138, v139
v_cvt_pk_bf16_f32 v70, v140, v141
v_cvt_pk_bf16_f32 v71, v142, v143
v_cvt_pk_bf16_f32 v72, v144, v145
v_cvt_pk_bf16_f32 v73, v146, v147
v_cvt_pk_bf16_f32 v74, v148, v149
v_cvt_pk_bf16_f32 v75, v150, v151
v_cvt_pk_bf16_f32 v76, v152, v153
v_cvt_pk_bf16_f32 v77, v154, v155
v_cvt_pk_bf16_f32 v78, v156, v157
v_cvt_pk_bf16_f32 v79, v158, v159
v_cvt_pk_bf16_f32 v80, v160, v161
v_cvt_pk_bf16_f32 v81, v162, v163
v_cvt_pk_bf16_f32 v82, v164, v165
v_cvt_pk_bf16_f32 v83, v166, v167
v_cvt_pk_bf16_f32 v84, v168, v169
v_cvt_pk_bf16_f32 v85, v170, v171
v_cvt_pk_bf16_f32 v86, v172, v173
v_cvt_pk_bf16_f32 v87, v174, v175
v_cvt_pk_bf16_f32 v88, v176, v177
v_cvt_pk_bf16_f32 v89, v178, v179
v_cvt_pk_bf16_f32 v90, v180, v181
v_cvt_pk_bf16_f32 v91, v182, v183
v_cvt_pk_bf16_f32 v92, v184, v185
v_cvt_pk_bf16_f32 v93, v186, v187
v_cvt_pk_bf16_f32 v94, v188, v189
v_cvt_pk_bf16_f32 v95, v190, v191
s_nop 1
v_mfma_f32_32x32x16_bf16 v[96:111],v[48:51],v[0:3],0
v_mfma_f32_32x32x16_bf16 v[96:111],v[52:55],v[4:7],v[96:111]
v_mfma_f32_32x32x16_bf16 v[96:111],v[56:59],v[8:11],v[96:111]
v_mfma_f32_32x32x16_bf16 v[96:111],v[60:63],v[12:15],v[96:111]
v_mfma_f32_32x32x16_bf16 v[96:111],v[64:67],v[16:19],v[96:111]
v_mfma_f32_32x32x16_bf16 v[96:111],v[68:71],v[20:23],v[96:111]
v_mfma_f32_32x32x16_bf16 v[96:111],v[72:75],v[24:27],v[96:111]
v_mfma_f32_32x32x16_bf16 v[96:111],v[76:79],v[28:31],v[96:111]
v_mfma_f32_32x32x16_bf16 v[96:111],v[80:83],v[32:35],v[96:111]
v_mfma_f32_32x32x16_bf16 v[96:111],v[84:87],v[36:39],v[96:111]
v_mfma_f32_32x32x16_bf16 v[96:111],v[88:91],v[40:43],v[96:111]
v_mfma_f32_32x32x16_bf16 v[96:111],v[92:95],v[44:47],v[96:111]
s_lshl_b32 s68, s66, 5
s_add_u32 s68, s68, s62
s_mul_i32 s67, s68, 12288
v_lshrrev_b32 v236, 3, v255
v_and_b32 v236, 1, v236
v_mul_u32_u24 v236, 1024, v236
v_lshrrev_b32 v254, 5, v255
v_and_b32 v254, 1, v254
v_mul_u32_u24 v254, 256, v254
v_add_u32 v236, v254, v236
v_lshrrev_b32 v254, 4, v255
v_and_b32 v254, 1, v254
v_mul_u32_u24 v254, 128, v254
v_add_u32 v236, v254, v236
v_and_b32 v254, 7, v255
v_mul_u32_u24 v254, 16, v254
v_add_u32 v236, v254, v236
s_add_u32 s57, s67, 132792320
buffer_store_dwordx4 v[48:51],v236,s[8:11],s57 offen sc1
buffer_store_dwordx4 v[52:55],v236,s[8:11],s57 offen offset:512 sc1
buffer_store_dwordx4 v[56:59],v236,s[8:11],s57 offen offset:2048 sc1
buffer_store_dwordx4 v[60:63],v236,s[8:11],s57 offen offset:2560 sc1
s_add_u32 s57, s67, 132796416
buffer_store_dwordx4 v[64:67],v236,s[8:11],s57 offen sc1
buffer_store_dwordx4 v[68:71],v236,s[8:11],s57 offen offset:512 sc1
buffer_store_dwordx4 v[72:75],v236,s[8:11],s57 offen offset:2048 sc1
buffer_store_dwordx4 v[76:79],v236,s[8:11],s57 offen offset:2560 sc1
s_add_u32 s57, s67, 132800512
buffer_store_dwordx4 v[80:83],v236,s[8:11],s57 offen sc1
buffer_store_dwordx4 v[84:87],v236,s[8:11],s57 offen offset:512 sc1
buffer_store_dwordx4 v[88:91],v236,s[8:11],s57 offen offset:2048 sc1
buffer_store_dwordx4 v[92:95],v236,s[8:11],s57 offen offset:2560 sc1
s_add_u32 s57, s67, 157958144
buffer_store_dwordx4 v[0:3],v233,s[8:11],s57 offen sc1
buffer_store_dwordx4 v[4:7],v233,s[8:11],s57 offen offset:1024 sc1
buffer_store_dwordx4 v[8:11],v233,s[8:11],s57 offen offset:2048 sc1
buffer_store_dwordx4 v[12:15],v233,s[8:11],s57 offen offset:3072 sc1
s_add_u32 s57, s67, 157962240
buffer_store_dwordx4 v[16:19],v233,s[8:11],s57 offen sc1
buffer_store_dwordx4 v[20:23],v233,s[8:11],s57 offen offset:1024 sc1
buffer_store_dwordx4 v[24:27],v233,s[8:11],s57 offen offset:2048 sc1
buffer_store_dwordx4 v[28:31],v233,s[8:11],s57 offen offset:3072 sc1
s_add_u32 s57, s67, 157966336
buffer_store_dwordx4 v[32:35],v233,s[8:11],s57 offen sc1
buffer_store_dwordx4 v[36:39],v233,s[8:11],s57 offen offset:1024 sc1
buffer_store_dwordx4 v[40:43],v233,s[8:11],s57 offen offset:2048 sc1
buffer_store_dwordx4 v[44:47],v233,s[8:11],s57 offen offset:3072 sc1
s_lshl_b32 s57, s68, 11
s_add_u32 s57, s57, 183123968
v_lshrrev_b32 v236, 5, v255
v_and_b32 v236, 1, v236
v_mul_u32_u24 v236, 4, v236
v_and_b32 v237, 31, v255
v_sub_u32 v236, v237, v236
v_mov_b32 v237, 0xff800000
v_cmp_le_i32 vcc, 0, v236
s_nop 1
v_cndmask_b32 v96, v237, v96, vcc
v_cmp_le_i32 vcc, 1, v236
s_nop 1
v_cndmask_b32 v97, v237, v97, vcc
v_cmp_le_i32 vcc, 2, v236
s_nop 1
v_cndmask_b32 v98, v237, v98, vcc
v_cmp_le_i32 vcc, 3, v236
s_nop 1
v_cndmask_b32 v99, v237, v99, vcc
v_cmp_le_i32 vcc, 8, v236
s_nop 1
v_cndmask_b32 v100, v237, v100, vcc
v_cmp_le_i32 vcc, 9, v236
s_nop 1
v_cndmask_b32 v101, v237, v101, vcc
v_cmp_le_i32 vcc, 10, v236
s_nop 1
v_cndmask_b32 v102, v237, v102, vcc
v_cmp_le_i32 vcc, 11, v236
s_nop 1
v_cndmask_b32 v103, v237, v103, vcc
v_cmp_le_i32 vcc, 16, v236
s_nop 1
v_cndmask_b32 v104, v237, v104, vcc
v_cmp_le_i32 vcc, 17, v236
s_nop 1
v_cndmask_b32 v105, v237, v105, vcc
v_cmp_le_i32 vcc, 18, v236
s_nop 1
v_cndmask_b32 v106, v237, v106, vcc
v_cmp_le_i32 vcc, 19, v236
s_nop 1
v_cndmask_b32 v107, v237, v107, vcc
v_cmp_le_i32 vcc, 24, v236
s_nop 1
v_cndmask_b32 v108, v237, v108, vcc
v_cmp_le_i32 vcc, 25, v236
s_nop 1
v_cndmask_b32 v109, v237, v109, vcc
v_cmp_le_i32 vcc, 26, v236
s_nop 1
v_cndmask_b32 v110, v237, v110, vcc
v_cmp_le_i32 vcc, 27, v236
s_nop 1
v_cndmask_b32 v111, v237, v111, vcc
v_cvt_pk_bf16_f32 v96, v96, v97
v_cvt_pk_bf16_f32 v97, v98, v99
v_cvt_pk_bf16_f32 v98, v100, v101
v_cvt_pk_bf16_f32 v99, v102, v103
v_cvt_pk_bf16_f32 v100, v104, v105
v_cvt_pk_bf16_f32 v101, v106, v107
v_cvt_pk_bf16_f32 v102, v108, v109
v_cvt_pk_bf16_f32 v103, v110, v111
buffer_store_dwordx4 v[96:99],v233,s[8:11],s57 offen sc1
buffer_store_dwordx4 v[100:103],v233,s[8:11],s57 offen offset:1024 sc1
s_lshl_b32 s93, s63, 7
s_add_u32 s93, s93, s92
s_mov_b32 s62, s86
s_mov_b32 s63, s87
s_mov_b32 s61, s91
s_lshl_b32 s66, s63, 2
s_add_u32 s66, s66, s56
s_cmp_lt_u32 s65, 2
s_cbranch_scc0 TL0n
s_waitcnt vmcnt(0)
s_barrier
buffer_atomic_add v239,v238,s[8:11],s93 offen sc1
s_mov_b32 s93, 244486016
TL0n:
s_add_u32 s65, s65, 1
s_cmp_lt_u32 s65, 8
s_cbranch_scc1 TL0
s_waitcnt vmcnt(0)
s_barrier
buffer_atomic_add v239,v238,s[8:11],s93 offen sc1
s_branch W_A
W_VO:
s_add_u32 s92, s92, 8192
v_lshrrev_b32 v230, 2, v255
v_and_b32 v230, 7, v230
v_mul_u32_u24 v230, 12288, v230
v_lshrrev_b32 v254, 5, v255
v_and_b32 v254, 1, v254
v_mul_u32_u24 v254, 64, v254
v_add_u32 v230, v254, v230
v_and_b32 v254, 3, v255
v_mul_u32_u24 v254, 16, v254
v_add_u32 v230, v254, v230
s_mul_i32 s57, s56, 98304
v_add_u32 v230, s57, v230
s_lshl_b32 s66, s63, 2
s_add_u32 s66, s66, s56
s_mul_i32 s61, s66, 40960
s_add_u32 s61, s61, 236535808
s_mul_i32 s59, s62, 384
s_mov_b32 s93, 244486016
v_lshrrev_b32 v234, 3, v255
v_and_b32 v234, 3, v234
v_mul_u32_u24 v234, 20736, v234
v_lshrrev_b32 v254, 5, v255
v_and_b32 v254, 1, v254
v_mul_u32_u24 v254, 128, v254
v_add_u32 v234, v254, v234
v_and_b32 v254, 7, v255
v_mul_u32_u24 v254, 16, v254
v_add_u32 v234, v254, v234
v_lshlrev_b32 v246, 7, v255
v_lshrrev_b32 v247, 2, v255
v_and_b32 v247, 15, v247
v_mul_u32_u24 v247, 20736, v247
v_and_b32 v254, 3, v255
v_mul_u32_u24 v254, 128, v254
v_add_u32 v247, v254, v247
s_barrier
s_add_u32 m0, s58, 0
s_add_u32 s57, s59, 0
buffer_load_dwordx4 v230,s[32:35],s57 offen lds
s_add_u32 m0, s58, 1024
s_add_u32 s57, s59, 128
buffer_load_dwordx4 v230,s[32:35],s57 offen lds
s_add_u32 m0, s58, 2048
s_add_u32 s57, s59, 256
buffer_load_dwordx4 v230,s[32:35],s57 offen lds
s_add_u32 m0, s58, 3072
s_add_u32 s57, s59, 393216
buffer_load_dwordx4 v230,s[32:35],s57 offen lds
s_add_u32 m0, s58, 4096
s_add_u32 s57, s59, 393344
buffer_load_dwordx4 v230,s[32:35],s57 offen lds
s_add_u32 m0, s58, 5120
s_add_u32 s57, s59, 393472
buffer_load_dwordx4 v230,s[32:35],s57 offen lds
s_add_u32 m0, s58, 24576
s_add_u32 s57, s59, 786432
buffer_load_dwordx4 v230,s[32:35],s57 offen lds
s_add_u32 m0, s58, 25600
s_add_u32 s57, s59, 786560
buffer_load_dwordx4 v230,s[32:35],s57 offen lds
s_add_u32 m0, s58, 26624
s_add_u32 s57, s59, 786688
buffer_load_dwordx4 v230,s[32:35],s57 offen lds
s_add_u32 m0, s58, 27648
s_add_u32 s57, s59, 1179648
buffer_load_dwordx4 v230,s[32:35],s57 offen lds
s_add_u32 m0, s58, 28672
s_add_u32 s57, s59, 1179776
buffer_load_dwordx4 v230,s[32:35],s57 offen lds
s_add_u32 m0, s58, 29696
s_add_u32 s57, s59, 1179904
buffer_load_dwordx4 v230,s[32:35],s57 offen lds
s_bitcmp1_b32 s7, 3
s_cbranch_scc1 TL1x
s_add_u32 s57, s61, 0
buffer_load_dwordx4 a[0:3],v233,s[8:11],s57 offen
buffer_load_dwordx4 a[4:7],v233,s[8:11],s57 offen offset:1024
buffer_load_dwordx4 a[8:11],v233,s[8:11],s57 offen offset:2048
buffer_load_dwordx4 a[12:15],v233,s[8:11],s57 offen offset:3072
s_add_u32 s57, s61, 4096
buffer_load_dwordx4 a[16:19],v233,s[8:11],s57 offen
buffer_load_dwordx4 a[20:23],v233,s[8:11],s57 offen offset:1024
buffer_load_dwordx4 a[24:27],v233,s[8:11],s57 offen offset:2048
buffer_load_dwordx4 a[28:31],v233,s[8:11],s57 offen offset:3072
s_add_u32 s57, s61, 8192
buffer_load_dwordx4 a[32:35],v233,s[8:11],s57 offen
buffer_load_dwordx4 a[36:39],v233,s[8:11],s57 offen offset:1024
buffer_load_dwordx4 a[40:43],v233,s[8:11],s57 offen offset:2048
buffer_load_dwordx4 a[44:47],v233,s[8:11],s57 offen offset:3072
s_add_u32 s57, s61, 12288
buffer_load_dwordx4 a[48:51],v233,s[8:11],s57 offen
buffer_load_dwordx4 a[52:55],v233,s[8:11],s57 offen offset:1024
buffer_load_dwordx4 a[56:59],v233,s[8:11],s57 offen offset:2048
buffer_load_dwordx4 a[60:63],v233,s[8:11],s57 offen offset:3072
s_add_u32 s57, s61, 16384
buffer_load_dwordx4 a[64:67],v233,s[8:11],s57 offen
buffer_load_dwordx4 a[68:71],v233,s[8:11],s57 offen offset:1024
buffer_load_dwordx4 a[72:75],v233,s[8:11],s57 offen offset:2048
buffer_load_dwordx4 a[76:79],v233,s[8:11],s57 offen offset:3072
s_add_u32 s57, s61, 20480
buffer_load_dwordx4 a[80:83],v233,s[8:11],s57 offen
buffer_load_dwordx4 a[84:87],v233,s[8:11],s57 offen offset:1024
buffer_load_dwordx4 a[88:91],v233,s[8:11],s57 offen offset:2048
buffer_load_dwordx4 a[92:95],v233,s[8:11],s57 offen offset:3072
s_add_u32 s57, s61, 24576
buffer_load_dwordx4 a[96:99],v233,s[8:11],s57 offen
buffer_load_dwordx4 a[100:103],v233,s[8:11],s57 offen offset:1024
buffer_load_dwordx4 a[104:107],v233,s[8:11],s57 offen offset:2048
buffer_load_dwordx4 a[108:111],v233,s[8:11],s57 offen offset:3072
s_add_u32 s57, s61, 28672
buffer_load_dwordx4 a[112:115],v233,s[8:11],s57 offen
buffer_load_dwordx4 a[116:119],v233,s[8:11],s57 offen offset:1024
buffer_load_dwordx4 a[120:123],v233,s[8:11],s57 offen offset:2048
buffer_load_dwordx4 a[124:127],v233,s[8:11],s57 offen offset:3072
s_add_u32 s57, s61, 32768
buffer_load_dwordx4 a[128:131],v233,s[8:11],s57 offen
buffer_load_dwordx4 a[132:135],v233,s[8:11],s57 offen offset:1024
buffer_load_dwordx4 a[136:139],v233,s[8:11],s57 offen offset:2048
buffer_load_dwordx4 a[140:143],v233,s[8:11],s57 offen offset:3072
s_add_u32 s57, s61, 36864
buffer_load_dwordx4 a[144:147],v233,s[8:11],s57 offen
buffer_load_dwordx4 a[148:151],v233,s[8:11],s57 offen offset:1024
buffer_load_dwordx4 a[152:155],v233,s[8:11],s57 offen offset:2048
buffer_load_dwordx4 a[156:159],v233,s[8:11],s57 offen offset:3072
TL1x:
s_add_u32 m0, s58, 49152
s_add_u32 s57, s59, 1572864
buffer_load_dwordx4 v230,s[32:35],s57 offen lds
s_add_u32 m0, s58, 50176
s_add_u32 s57, s59, 1572992
buffer_load_dwordx4 v230,s[32:35],s57 offen lds
s_add_u32 m0, s58, 51200
s_add_u32 s57, s59, 1573120
buffer_load_dwordx4 v230,s[32:35],s57 offen lds
s_add_u32 m0, s58, 52224
s_add_u32 s57, s59, 1966080
buffer_load_dwordx4 v230,s[32:35],s57 offen lds
s_add_u32 m0, s58, 53248
s_add_u32 s57, s59, 1966208
buffer_load_dwordx4 v230,s[32:35],s57 offen lds
s_add_u32 m0, s58, 54272
s_add_u32 s57, s59, 1966336
buffer_load_dwordx4 v230,s[32:35],s57 offen lds
s_add_u32 m0, s58, 73728
s_add_u32 s57, s59, 2359296
buffer_load_dwordx4 v230,s[32:35],s57 offen lds
s_add_u32 m0, s58, 74752
s_add_u32 s57, s59, 2359424
buffer_load_dwordx4 v230,s[32:35],s57 offen lds
s_add_u32 m0, s58, 75776
s_add_u32 s57, s59, 2359552
buffer_load_dwordx4 v230,s[32:35],s57 offen lds
s_add_u32 m0, s58, 76800
s_add_u32 s57, s59, 2752512
buffer_load_dwordx4 v230,s[32:35],s57 offen lds
s_add_u32 m0, s58, 77824
s_add_u32 s57, s59, 2752640
buffer_load_dwordx4 v230,s[32:35],s57 offen lds
s_add_u32 m0, s58, 78848
s_add_u32 s57, s59, 2752768
buffer_load_dwordx4 v230,s[32:35],s57 offen lds
s_waitcnt vmcnt(0)
s_barrier
s_mov_b32 s65, 0
ds_read_b64_tr_b16 v[192:193],v224 offset:0
ds_read_b64_tr_b16 v[194:195],v224 offset:256
ds_read_b64_tr_b16 v[196:197],v224 offset:512
ds_read_b64_tr_b16 v[198:199],v224 offset:768
ds_read_b64_tr_b16 v[200:201],v224 offset:1024
ds_read_b64_tr_b16 v[202:203],v224 offset:1280
ds_read_b64_tr_b16 v[204:205],v224 offset:1536
ds_read_b64_tr_b16 v[206:207],v224 offset:1792
ds_read_b64_tr_b16 v[208:209],v224 offset:2048
ds_read_b64_tr_b16 v[210:211],v224 offset:2304
ds_read_b64_tr_b16 v[212:213],v224 offset:2560
ds_read_b64_tr_b16 v[214:215],v224 offset:2816
s_waitcnt vmcnt(0)
TL1:
ds_read_b64_tr_b16 v[216:217],v224 offset:12288
ds_read_b64_tr_b16 v[218:219],v224 offset:12544
s_waitcnt lgkmcnt(12)
v_mfma_f32_32x32x16_bf16 v[0:15],v[192:195],a[0:3],0
s_add_u32 s57, s65, 1
s_min_u32 s57, s57, 7
s_and_b32 s86, s57, 6
s_lshl_b32 s86, s86, 1
s_lshr_b32 s87, s7, 2
s_add_u32 s87, s87, s86
s_and_b32 s57, s57, 1
s_lshl_b32 s57, s57, 2
s_and_b32 s86, s62, 27
s_or_b32 s86, s86, s57
s_bitcmp1_b32 s65, 0
s_cselect_b32 s57, 3, 1
s_add_u32 s57, s63, s57
s_cmp_lt_u32 s65, 3
s_cselect_b32 s86, s62, s86
s_cselect_b32 s87, s57, s87
s_sub_u32 s57, s87, s63
s_mul_i32 s57, s57, 163840
s_add_u32 s91, s61, s57
s_mul_i32 s67, s66, 1658880
s_mul_i32 s90, s62, 640
s_add_u32 s67, s67, s90
s_mul_i32 s60, s62, 245760
ds_read_b64_tr_b16 v[220:221],v224 offset:12800
ds_read_b64_tr_b16 v[222:223],v224 offset:13056
s_waitcnt lgkmcnt(12)
v_mfma_f32_32x32x16_bf16 v[16:31],v[196:199],a[0:3],0
s_add_u32 m0, s58, 98304
s_add_u32 s57, s59, 3145728
buffer_load_dwordx4 v230,s[32:35],s57 offen lds
ds_read_b64_tr_b16 v[192:193],v224 offset:13312
ds_read_b64_tr_b16 v[194:195],v224 offset:13568
s_waitcnt lgkmcnt(12)
v_mfma_f32_32x32x16_bf16 v[32:47],v[200:203],a[0:3],0
ds_read_b64_tr_b16 v[196:197],v224 offset:13824
ds_read_b64_tr_b16 v[198:199],v224 offset:14080
s_waitcnt lgkmcnt(12)
v_mfma_f32_32x32x16_bf16 v[48:63],v[204:207],a[0:3],0
s_add_u32 m0, s58, 99328
s_add_u32 s57, s59, 3145856
buffer_load_dwordx4 v230,s[32:35],s57 offen lds
ds_read_b64_tr_b16 v[200:201],v224 offset:14336
ds_read_b64_tr_b16 v[202:203],v224 offset:14592
s_waitcnt lgkmcnt(12)
v_mfma_f32_32x32x16_bf16 v[64:79],v[208:211],a[0:3],0
ds_read_b64_tr_b16 v[204:205],v224 offset:14848
ds_read_b64_tr_b16 v[206:207],v224 offset:15104
s_waitcnt lgkmcnt(12)
v_mfma_f32_32x32x16_bf16 v[80:95],v[212:215],a[0:3],0
s_add_u32 m0, s58, 100352
s_add_u32 s57, s59, 3145984
buffer_load_dwordx4 v230,s[32:35],s57 offen lds
ds_read_b64_tr_b16 v[208:209],v224 offset:3072
ds_read_b64_tr_b16 v[210:211],v224 offset:3328
s_waitcnt lgkmcnt(12)
v_mfma_f32_32x32x16_bf16 v[0:15],v[216:219],a[4:7],v[0:15]
ds_read_b64_tr_b16 v[212:213],v224 offset:3584
ds_read_b64_tr_b16 v[214:215],v224 offset:3840
s_waitcnt lgkmcnt(12)
v_mfma_f32_32x32x16_bf16 v[16:31],v[220:223],a[4:7],v[16:31]
s_add_u32 m0, s58, 101376
s_add_u32 s57, s59, 3538944
buffer_load_dwordx4 v230,s[32:35],s57 offen lds
ds_read_b64_tr_b16 v[216:217],v224 offset:4096
ds_read_b64_tr_b16 v[218:219],v224 offset:4352
s_waitcnt lgkmcnt(12)
v_mfma_f32_32x32x16_bf16 v[32:47],v[192:195],a[4:7],v[32:47]
ds_read_b64_tr_b16 v[220:221],v224 offset:4608
ds_read_b64_tr_b16 v[222:223],v224 offset:4864
s_waitcnt lgkmcnt(12)
v_mfma_f32_32x32x16_bf16 v[48:63],v[196:199],a[4:7],v[48:63]
s_add_u32 m0, s58, 102400
s_add_u32 s57, s59, 3539072
buffer_load_dwordx4 v230,s[32:35],s57 offen lds
ds_read_b64_tr_b16 v[192:193],v224 offset:5120
ds_read_b64_tr_b16 v[194:195],v224 offset:5376
s_waitcnt lgkmcnt(12)
v_mfma_f32_32x32x16_bf16 v[64:79],v[200:203],a[4:7],v[64:79]
ds_read_b64_tr_b16 v[196:197],v224 offset:5632
ds_read_b64_tr_b16 v[198:199],v224 offset:5888
s_waitcnt lgkmcnt(12)
v_mfma_f32_32x32x16_bf16 v[80:95],v[204:207],a[4:7],v[80:95]
s_add_u32 m0, s58, 103424
s_add_u32 s57, s59, 3539200
buffer_load_dwordx4 v230,s[32:35],s57 offen lds
ds_read_b64_tr_b16 v[200:201],v224 offset:15360
ds_read_b64_tr_b16 v[202:203],v224 offset:15616
s_waitcnt lgkmcnt(12)
v_mfma_f32_32x32x16_bf16 v[0:15],v[208:211],a[8:11],v[0:15]
ds_read_b64_tr_b16 v[204:205],v224 offset:15872
ds_read_b64_tr_b16 v[206:207],v224 offset:16128
s_waitcnt lgkmcnt(12)
v_mfma_f32_32x32x16_bf16 v[16:31],v[212:215],a[8:11],v[16:31]
ds_read_b64_tr_b16 v[208:209],v224 offset:16384
ds_read_b64_tr_b16 v[210:211],v224 offset:16640
s_waitcnt lgkmcnt(12)
v_mfma_f32_32x32x16_bf16 v[32:47],v[216:219],a[8:11],v[32:47]
ds_read_b64_tr_b16 v[212:213],v224 offset:16896
ds_read_b64_tr_b16 v[214:215],v224 offset:17152
s_waitcnt lgkmcnt(12)
v_mfma_f32_32x32x16_bf16 v[48:63],v[220:223],a[8:11],v[48:63]
ds_read_b64_tr_b16 v[216:217],v224 offset:17408
ds_read_b64_tr_b16 v[218:219],v224 offset:17664
s_waitcnt lgkmcnt(12)
v_mfma_f32_32x32x16_bf16 v[64:79],v[192:195],a[8:11],v[64:79]
ds_read_b64_tr_b16 v[220:221],v224 offset:17920
ds_read_b64_tr_b16 v[222:223],v224 offset:18176
s_waitcnt lgkmcnt(12)
v_mfma_f32_32x32x16_bf16 v[80:95],v[196:199],a[8:11],v[80:95]
s_waitcnt vmcnt(30)
s_barrier
ds_read_b64_tr_b16 v[192:193],v224 offset:24576
ds_read_b64_tr_b16 v[194:195],v224 offset:24832
s_waitcnt lgkmcnt(12)
v_mfma_f32_32x32x16_bf16 v[0:15],v[200:203],a[12:15],v[0:15]
ds_read_b64_tr_b16 v[196:197],v224 offset:25088
ds_read_b64_tr_b16 v[198:199],v224 offset:25344
s_waitcnt lgkmcnt(12)
v_mfma_f32_32x32x16_bf16 v[16:31],v[204:207],a[12:15],v[16:31]
ds_read_b64_tr_b16 v[200:201],v224 offset:25600
ds_read_b64_tr_b16 v[202:203],v224 offset:25856
s_waitcnt lgkmcnt(12)
v_mfma_f32_32x32x16_bf16 v[32:47],v[208:211],a[12:15],v[32:47]
ds_read_b64_tr_b16 v[204:205],v224 offset:26112
ds_read_b64_tr_b16 v[206:207],v224 offset:26368
s_waitcnt lgkmcnt(12)
v_mfma_f32_32x32x16_bf16 v[48:63],v[212:215],a[12:15],v[48:63]
ds_read_b64_tr_b16 v[208:209],v224 offset:26624
ds_read_b64_tr_b16 v[210:211],v224 offset:26880
s_waitcnt lgkmcnt(12)
v_mfma_f32_32x32x16_bf16 v[64:79],v[216:219],a[12:15],v[64:79]
ds_read_b64_tr_b16 v[212:213],v224 offset:27136
ds_read_b64_tr_b16 v[214:215],v224 offset:27392
s_waitcnt lgkmcnt(12)
v_mfma_f32_32x32x16_bf16 v[80:95],v[220:223],a[12:15],v[80:95]
ds_read_b64_tr_b16 v[216:217],v224 offset:36864
ds_read_b64_tr_b16 v[218:219],v224 offset:37120
s_waitcnt lgkmcnt(12)
v_mfma_f32_32x32x16_bf16 v[0:15],v[192:195],a[16:19],v[0:15]
ds_read_b64_tr_b16 v[220:221],v224 offset:37376
ds_read_b64_tr_b16 v[222:223],v224 offset:37632
s_waitcnt lgkmcnt(12)
v_mfma_f32_32x32x16_bf16 v[16:31],v[196:199],a[16:19],v[16:31]
s_add_u32 m0, s58, 0
s_add_u32 s57, s59, 3932160
buffer_load_dwordx4 v230,s[32:35],s57 offen lds
ds_read_b64_tr_b16 v[192:193],v224 offset:37888
ds_read_b64_tr_b16 v[194:195],v224 offset:38144
s_waitcnt lgkmcnt(12)
v_mfma_f32_32x32x16_bf16 v[32:47],v[200:203],a[16:19],v[32:47]
ds_read_b64_tr_b16 v[196:197],v224 offset:38400
ds_read_b64_tr_b16 v[198:199],v224 offset:38656
s_waitcnt lgkmcnt(12)
v_mfma_f32_32x32x16_bf16 v[48:63],v[204:207],a[16:19],v[48:63]
s_add_u32 m0, s58, 1024
s_add_u32 s57, s59, 3932288
buffer_load_dwordx4 v230,s[32:35],s57 offen lds
ds_read_b64_tr_b16 v[200:201],v224 offset:38912
ds_read_b64_tr_b16 v[202:203],v224 offset:39168
s_waitcnt lgkmcnt(12)
v_mfma_f32_32x32x16_bf16 v[64:79],v[208:211],a[16:19],v[64:79]
ds_read_b64_tr_b16 v[204:205],v224 offset:39424
ds_read_b64_tr_b16 v[206:207],v224 offset:39680
s_waitcnt lgkmcnt(12)
v_mfma_f32_32x32x16_bf16 v[80:95],v[212:215],a[16:19],v[80:95]
s_add_u32 m0, s58, 2048
s_add_u32 s57, s59, 3932416
buffer_load_dwordx4 v230,s[32:35],s57 offen lds
ds_read_b64_tr_b16 v[208:209],v224 offset:27648
ds_read_b64_tr_b16 v[210:211],v224 offset:27904
s_waitcnt lgkmcnt(12)
v_mfma_f32_32x32x16_bf16 v[0:15],v[216:219],a[20:23],v[0:15]
ds_read_b64_tr_b16 v[212:213],v224 offset:28160
ds_read_b64_tr_b16 v[214:215],v224 offset:28416
s_waitcnt lgkmcnt(12)
v_mfma_f32_32x32x16_bf16 v[16:31],v[220:223],a[20:23],v[16:31]
s_add_u32 m0, s58, 3072
s_add_u32 s57, s59, 4325376
buffer_load_dwordx4 v230,s[32:35],s57 offen lds
ds_read_b64_tr_b16 v[216:217],v224 offset:28672
ds_read_b64_tr_b16 v[218:219],v224 offset:28928
s_waitcnt lgkmcnt(12)
v_mfma_f32_32x32x16_bf16 v[32:47],v[192:195],a[20:23],v[32:47]
ds_read_b64_tr_b16 v[220:221],v224 offset:29184
ds_read_b64_tr_b16 v[222:223],v224 offset:29440
s_waitcnt lgkmcnt(12)
v_mfma_f32_32x32x16_bf16 v[48:63],v[196:199],a[20:23],v[48:63]
s_add_u32 m0, s58, 4096
s_add_u32 s57, s59, 4325504
buffer_load_dwordx4 v230,s[32:35],s57 offen lds
ds_read_b64_tr_b16 v[192:193],v224 offset:29696
ds_read_b64_tr_b16 v[194:195],v224 offset:29952
s_waitcnt lgkmcnt(12)
v_mfma_f32_32x32x16_bf16 v[64:79],v[200:203],a[20:23],v[64:79]
ds_read_b64_tr_b16 v[196:197],v224 offset:30208
ds_read_b64_tr_b16 v[198:199],v224 offset:30464
s_waitcnt lgkmcnt(12)
v_mfma_f32_32x32x16_bf16 v[80:95],v[204:207],a[20:23],v[80:95]
s_add_u32 m0, s58, 5120
s_add_u32 s57, s59, 4325632
buffer_load_dwordx4 v230,s[32:35],s57 offen lds
ds_read_b64_tr_b16 v[200:201],v224 offset:39936
ds_read_b64_tr_b16 v[202:203],v224 offset:40192
s_waitcnt lgkmcnt(12)
v_mfma_f32_32x32x16_bf16 v[0:15],v[208:211],a[24:27],v[0:15]
ds_read_b64_tr_b16 v[204:205],v224 offset:40448
ds_read_b64_tr_b16 v[206:207],v224 offset:40704
s_waitcnt lgkmcnt(12)
v_mfma_f32_32x32x16_bf16 v[16:31],v[212:215],a[24:27],v[16:31]
ds_read_b64_tr_b16 v[208:209],v224 offset:40960
ds_read_b64_tr_b16 v[210:211],v224 offset:41216
s_waitcnt lgkmcnt(12)
v_mfma_f32_32x32x16_bf16 v[32:47],v[216:219],a[24:27],v[32:47]
s_cmp_eq_u32 s91, s61
s_cbranch_scc1 XL1_0
s_add_u32 s57, s91, 0
buffer_load_dwordx4 a[0:3],v233,s[8:11],s57 offen
buffer_load_dwordx4 a[4:7],v233,s[8:11],s57 offen offset:1024
XL1_0:
ds_read_b64_tr_b16 v[212:213],v224 offset:41472
ds_read_b64_tr_b16 v[214:215],v224 offset:41728
s_waitcnt lgkmcnt(12)
v_mfma_f32_32x32x16_bf16 v[48:63],v[220:223],a[24:27],v[48:63]
ds_read_b64_tr_b16 v[216:217],v224 offset:41984
ds_read_b64_tr_b16 v[218:219],v224 offset:42240
s_waitcnt lgkmcnt(12)
v_mfma_f32_32x32x16_bf16 v[64:79],v[192:195],a[24:27],v[64:79]
ds_read_b64_tr_b16 v[220:221],v224 offset:42496
ds_read_b64_tr_b16 v[222:223],v224 offset:42752
s_waitcnt lgkmcnt(12)
v_mfma_f32_32x32x16_bf16 v[80:95],v[196:199],a[24:27],v[80:95]
s_waitcnt vmcnt(26)
s_barrier
ds_read_b64_tr_b16 v[192:193],v225 offset:0
ds_read_b64_tr_b16 v[194:195],v225 offset:256
s_waitcnt lgkmcnt(12)
v_mfma_f32_32x32x16_bf16 v[0:15],v[200:203],a[28:31],v[0:15]
s_cmp_eq_u32 s91, s61
s_cbranch_scc1 XL1_2
s_add_u32 s57, s91, 2048
buffer_load_dwordx4 a[8:11],v233,s[8:11],s57 offen
buffer_load_dwordx4 a[12:15],v233,s[8:11],s57 offen offset:1024
XL1_2:
ds_read_b64_tr_b16 v[196:197],v225 offset:512
ds_read_b64_tr_b16 v[198:199],v225 offset:768
s_waitcnt lgkmcnt(12)
v_mfma_f32_32x32x16_bf16 v[16:31],v[204:207],a[28:31],v[16:31]
ds_read_b64_tr_b16 v[200:201],v225 offset:1024
ds_read_b64_tr_b16 v[202:203],v225 offset:1280
s_waitcnt lgkmcnt(12)
v_mfma_f32_32x32x16_bf16 v[32:47],v[208:211],a[28:31],v[32:47]
ds_read_b64_tr_b16 v[204:205],v225 offset:1536
ds_read_b64_tr_b16 v[206:207],v225 offset:1792
s_waitcnt lgkmcnt(12)
v_mfma_f32_32x32x16_bf16 v[48:63],v[212:215],a[28:31],v[48:63]
ds_read_b64_tr_b16 v[208:209],v225 offset:2048
ds_read_b64_tr_b16 v[210:211],v225 offset:2304
s_waitcnt lgkmcnt(12)
v_mfma_f32_32x32x16_bf16 v[64:79],v[216:219],a[28:31],v[64:79]
ds_read_b64_tr_b16 v[212:213],v225 offset:2560
ds_read_b64_tr_b16 v[214:215],v225 offset:2816
s_waitcnt lgkmcnt(12)
v_mfma_f32_32x32x16_bf16 v[80:95],v[220:223],a[28:31],v[80:95]
ds_read_b64_tr_b16 v[216:217],v225 offset:12288
ds_read_b64_tr_b16 v[218:219],v225 offset:12544
s_waitcnt lgkmcnt(12)
v_mfma_f32_32x32x16_bf16 v[0:15],v[192:195],a[32:35],v[0:15]
ds_read_b64_tr_b16 v[220:221],v225 offset:12800
ds_read_b64_tr_b16 v[222:223],v225 offset:13056
s_waitcnt lgkmcnt(12)
v_mfma_f32_32x32x16_bf16 v[16:31],v[196:199],a[32:35],v[16:31]
s_add_u32 m0, s58, 24576
s_add_u32 s57, s59, 4718592
buffer_load_dwordx4 v230,s[32:35],s57 offen lds
ds_read_b64_tr_b16 v[192:193],v225 offset:13312
ds_read_b64_tr_b16 v[194:195],v225 offset:13568
s_waitcnt lgkmcnt(12)
v_mfma_f32_32x32x16_bf16 v[32:47],v[200:203],a[32:35],v[32:47]
ds_read_b64_tr_b16 v[196:197],v225 offset:13824
ds_read_b64_tr_b16 v[198:199],v225 offset:14080
s_waitcnt lgkmcnt(12)
v_mfma_f32_32x32x16_bf16 v[48:63],v[204:207],a[32:35],v[48:63]
s_add_u32 m0, s58, 25600
s_add_u32 s57, s59, 4718720
buffer_load_dwordx4 v230,s[32:35],s57 offen lds
ds_read_b64_tr_b16 v[200:201],v225 offset:14336
ds_read_b64_tr_b16 v[202:203],v225 offset:14592
s_waitcnt lgkmcnt(12)
v_mfma_f32_32x32x16_bf16 v[64:79],v[208:211],a[32:35],v[64:79]
ds_read_b64_tr_b16 v[204:205],v225 offset:14848
ds_read_b64_tr_b16 v[206:207],v225 offset:15104
s_waitcnt lgkmcnt(12)
v_mfma_f32_32x32x16_bf16 v[80:95],v[212:215],a[32:35],v[80:95]
s_add_u32 m0, s58, 26624
s_add_u32 s57, s59, 4718848
buffer_load_dwordx4 v230,s[32:35],s57 offen lds
ds_read_b64_tr_b16 v[208:209],v225 offset:3072
ds_read_b64_tr_b16 v[210:211],v225 offset:3328
s_waitcnt lgkmcnt(12)
v_mfma_f32_32x32x16_bf16 v[0:15],v[216:219],a[36:39],v[0:15]
ds_read_b64_tr_b16 v[212:213],v225 offset:3584
ds_read_b64_tr_b16 v[214:215],v225 offset:3840
s_waitcnt lgkmcnt(12)
v_mfma_f32_32x32x16_bf16 v[16:31],v[220:223],a[36:39],v[16:31]
s_add_u32 m0, s58, 27648
s_add_u32 s57, s59, 5111808
buffer_load_dwordx4 v230,s[32:35],s57 offen lds
ds_read_b64_tr_b16 v[216:217],v225 offset:4096
ds_read_b64_tr_b16 v[218:219],v225 offset:4352
s_waitcnt lgkmcnt(12)
v_mfma_f32_32x32x16_bf16 v[32:47],v[192:195],a[36:39],v[32:47]
ds_read_b64_tr_b16 v[220:221],v225 offset:4608
ds_read_b64_tr_b16 v[222:223],v225 offset:4864
s_waitcnt lgkmcnt(12)
v_mfma_f32_32x32x16_bf16 v[48:63],v[196:199],a[36:39],v[48:63]
s_add_u32 m0, s58, 28672
s_add_u32 s57, s59, 5111936
buffer_load_dwordx4 v230,s[32:35],s57 offen lds
ds_read_b64_tr_b16 v[192:193],v225 offset:5120
ds_read_b64_tr_b16 v[194:195],v225 offset:5376
s_waitcnt lgkmcnt(12)
v_mfma_f32_32x32x16_bf16 v[64:79],v[200:203],a[36:39],v[64:79]
ds_read_b64_tr_b16 v[196:197],v225 offset:5632
ds_read_b64_tr_b16 v[198:199],v225 offset:5888
s_waitcnt lgkmcnt(12)
v_mfma_f32_32x32x16_bf16 v[80:95],v[204:207],a[36:39],v[80:95]
s_add_u32 m0, s58, 29696
s_add_u32 s57, s59, 5112064
buffer_load_dwordx4 v230,s[32:35],s57 offen lds
ds_read_b64_tr_b16 v[200:201],v225 offset:15360
ds_read_b64_tr_b16 v[202:203],v225 offset:15616
s_waitcnt lgkmcnt(12)
v_mfma_f32_32x32x16_bf16 v[0:15],v[208:211],a[40:43],v[0:15]
ds_read_b64_tr_b16 v[204:205],v225 offset:15872
ds_read_b64_tr_b16 v[206:207],v225 offset:16128
s_waitcnt lgkmcnt(12)
v_mfma_f32_32x32x16_bf16 v[16:31],v[212:215],a[40:43],v[16:31]
ds_read_b64_tr_b16 v[208:209],v225 offset:16384
ds_read_b64_tr_b16 v[210:211],v225 offset:16640
s_waitcnt lgkmcnt(12)
v_mfma_f32_32x32x16_bf16 v[32:47],v[216:219],a[40:43],v[32:47]
s_cmp_eq_u32 s91, s61
s_cbranch_scc1 XL1_4
s_add_u32 s57, s91, 4096
buffer_load_dwordx4 a[16:19],v233,s[8:11],s57 offen
buffer_load_dwordx4 a[20:23],v233,s[8:11],s57 offen offset:1024
XL1_4:
ds_read_b64_tr_b16 v[212:213],v225 offset:16896
ds_read_b64_tr_b16 v[214:215],v225 offset:17152
s_waitcnt lgkmcnt(12)
v_mfma_f32_32x32x16_bf16 v[48:63],v[220:223],a[40:43],v[48:63]
ds_read_b64_tr_b16 v[216:217],v225 offset:17408
ds_read_b64_tr_b16 v[218:219],v225 offset:17664
s_waitcnt lgkmcnt(12)
v_mfma_f32_32x32x16_bf16 v[64:79],v[192:195],a[40:43],v[64:79]
ds_read_b64_tr_b16 v[220:221],v225 offset:17920
ds_read_b64_tr_b16 v[222:223],v225 offset:18176
s_waitcnt lgkmcnt(12)
v_mfma_f32_32x32x16_bf16 v[80:95],v[196:199],a[40:43],v[80:95]
s_waitcnt vmcnt(22)
s_barrier
ds_read_b64_tr_b16 v[192:193],v225 offset:24576
ds_read_b64_tr_b16 v[194:195],v225 offset:24832
s_waitcnt lgkmcnt(12)
v_mfma_f32_32x32x16_bf16 v[0:15],v[200:203],a[44:47],v[0:15]
s_cmp_eq_u32 s91, s61
s_cbranch_scc1 XL1_6
s_add_u32 s57, s91, 6144
buffer_load_dwordx4 a[24:27],v233,s[8:11],s57 offen
buffer_load_dwordx4 a[28:31],v233,s[8:11],s57 offen offset:1024
XL1_6:
ds_read_b64_tr_b16 v[196:197],v225 offset:25088
ds_read_b64_tr_b16 v[198:199],v225 offset:25344
s_waitcnt lgkmcnt(12)
v_mfma_f32_32x32x16_bf16 v[16:31],v[204:207],a[44:47],v[16:31]
ds_read_b64_tr_b16 v[200:201],v225 offset:25600
ds_read_b64_tr_b16 v[202:203],v225 offset:25856
s_waitcnt lgkmcnt(12)
v_mfma_f32_32x32x16_bf16 v[32:47],v[208:211],a[44:47],v[32:47]
ds_read_b64_tr_b16 v[204:205],v225 offset:26112
ds_read_b64_tr_b16 v[206:207],v225 offset:26368
s_waitcnt lgkmcnt(12)
v_mfma_f32_32x32x16_bf16 v[48:63],v[212:215],a[44:47],v[48:63]
ds_read_b64_tr_b16 v[208:209],v225 offset:26624
ds_read_b64_tr_b16 v[210:211],v225 offset:26880
s_waitcnt lgkmcnt(12)
v_mfma_f32_32x32x16_bf16 v[64:79],v[216:219],a[44:47],v[64:79]
ds_read_b64_tr_b16 v[212:213],v225 offset:27136
ds_read_b64_tr_b16 v[214:215],v225 offset:27392
s_waitcnt lgkmcnt(12)
v_mfma_f32_32x32x16_bf16 v[80:95],v[220:223],a[44:47],v[80:95]
ds_read_b64_tr_b16 v[216:217],v225 offset:36864
ds_read_b64_tr_b16 v[218:219],v225 offset:37120
s_waitcnt lgkmcnt(12)
v_mfma_f32_32x32x16_bf16 v[0:15],v[192:195],a[48:51],v[0:15]
ds_read_b64_tr_b16 v[220:221],v225 offset:37376
ds_read_b64_tr_b16 v[222:223],v225 offset:37632
s_waitcnt lgkmcnt(12)
v_mfma_f32_32x32x16_bf16 v[16:31],v[196:199],a[48:51],v[16:31]
s_add_u32 m0, s58, 49152
s_add_u32 s57, s59, 5505024
buffer_load_dwordx4 v230,s[32:35],s57 offen lds
ds_read_b64_tr_b16 v[192:193],v225 offset:37888
ds_read_b64_tr_b16 v[194:195],v225 offset:38144
s_waitcnt lgkmcnt(12)
v_mfma_f32_32x32x16_bf16 v[32:47],v[200:203],a[48:51],v[32:47]
ds_read_b64_tr_b16 v[196:197],v225 offset:38400
ds_read_b64_tr_b16 v[198:199],v225 offset:38656
s_waitcnt lgkmcnt(12)
v_mfma_f32_32x32x16_bf16 v[48:63],v[204:207],a[48:51],v[48:63]
s_add_u32 m0, s58, 50176
s_add_u32 s57, s59, 5505152
buffer_load_dwordx4 v230,s[32:35],s57 offen lds
ds_read_b64_tr_b16 v[200:201],v225 offset:38912
ds_read_b64_tr_b16 v[202:203],v225 offset:39168
s_waitcnt lgkmcnt(12)
v_mfma_f32_32x32x16_bf16 v[64:79],v[208:211],a[48:51],v[64:79]
ds_read_b64_tr_b16 v[204:205],v225 offset:39424
ds_read_b64_tr_b16 v[206:207],v225 offset:39680
s_waitcnt lgkmcnt(12)
v_mfma_f32_32x32x16_bf16 v[80:95],v[212:215],a[48:51],v[80:95]
s_add_u32 m0, s58, 51200
s_add_u32 s57, s59, 5505280
buffer_load_dwordx4 v230,s[32:35],s57 offen lds
ds_read_b64_tr_b16 v[208:209],v225 offset:27648
ds_read_b64_tr_b16 v[210:211],v225 offset:27904
s_waitcnt lgkmcnt(12)
v_mfma_f32_32x32x16_bf16 v[0:15],v[216:219],a[52:55],v[0:15]
ds_read_b64_tr_b16 v[212:213],v225 offset:28160
ds_read_b64_tr_b16 v[214:215],v225 offset:28416
s_waitcnt lgkmcnt(12)
v_mfma_f32_32x32x16_bf16 v[16:31],v[220:223],a[52:55],v[16:31]
s_add_u32 m0, s58, 52224
s_add_u32 s57, s59, 5898240
buffer_load_dwordx4 v230,s[32:35],s57 offen lds
ds_read_b64_tr_b16 v[216:217],v225 offset:28672
ds_read_b64_tr_b16 v[218:219],v225 offset:28928
s_waitcnt lgkmcnt(12)
v_mfma_f32_32x32x16_bf16 v[32:47],v[192:195],a[52:55],v[32:47]
ds_read_b64_tr_b16 v[220:221],v225 offset:29184
ds_read_b64_tr_b16 v[222:223],v225 offset:29440
s_waitcnt lgkmcnt(12)
v_mfma_f32_32x32x16_bf16 v[48:63],v[196:199],a[52:55],v[48:63]
s_add_u32 m0, s58, 53248
s_add_u32 s57, s59, 5898368
buffer_load_dwordx4 v230,s[32:35],s57 offen lds
ds_read_b64_tr_b16 v[192:193],v225 offset:29696
ds_read_b64_tr_b16 v[194:195],v225 offset:29952
s_waitcnt lgkmcnt(12)
v_mfma_f32_32x32x16_bf16 v[64:79],v[200:203],a[52:55],v[64:79]
ds_read_b64_tr_b16 v[196:197],v225 offset:30208
ds_read_b64_tr_b16 v[198:199],v225 offset:30464
s_waitcnt lgkmcnt(12)
v_mfma_f32_32x32x16_bf16 v[80:95],v[204:207],a[52:55],v[80:95]
s_add_u32 m0, s58, 54272
s_add_u32 s57, s59, 5898496
buffer_load_dwordx4 v230,s[32:35],s57 offen lds
ds_read_b64_tr_b16 v[200:201],v225 offset:39936
ds_read_b64_tr_b16 v[202:203],v225 offset:40192
s_waitcnt lgkmcnt(12)
v_mfma_f32_32x32x16_bf16 v[0:15],v[208:211],a[56:59],v[0:15]
ds_read_b64_tr_b16 v[204:205],v225 offset:40448
ds_read_b64_tr_b16 v[206:207],v225 offset:40704
s_waitcnt lgkmcnt(12)
v_mfma_f32_32x32x16_bf16 v[16:31],v[212:215],a[56:59],v[16:31]
ds_read_b64_tr_b16 v[208:209],v225 offset:40960
ds_read_b64_tr_b16 v[210:211],v225 offset:41216
s_waitcnt lgkmcnt(12)
v_mfma_f32_32x32x16_bf16 v[32:47],v[216:219],a[56:59],v[32:47]
s_cmp_eq_u32 s91, s61
s_cbranch_scc1 XL1_8
s_add_u32 s57, s91, 8192
buffer_load_dwordx4 a[32:35],v233,s[8:11],s57 offen
buffer_load_dwordx4 a[36:39],v233,s[8:11],s57 offen offset:1024
XL1_8:
ds_read_b64_tr_b16 v[212:213],v225 offset:41472
ds_read_b64_tr_b16 v[214:215],v225 offset:41728
s_waitcnt lgkmcnt(12)
v_mfma_f32_32x32x16_bf16 v[48:63],v[220:223],a[56:59],v[48:63]
ds_read_b64_tr_b16 v[216:217],v225 offset:41984
ds_read_b64_tr_b16 v[218:219],v225 offset:42240
s_waitcnt lgkmcnt(12)
v_mfma_f32_32x32x16_bf16 v[64:79],v[192:195],a[56:59],v[64:79]
ds_read_b64_tr_b16 v[220:221],v225 offset:42496
ds_read_b64_tr_b16 v[222:223],v225 offset:42752
s_waitcnt lgkmcnt(12)
v_mfma_f32_32x32x16_bf16 v[80:95],v[196:199],a[56:59],v[80:95]
s_waitcnt vmcnt(18)
s_barrier
ds_read_b64_tr_b16 v[192:193],v226 offset:0
ds_read_b64_tr_b16 v[194:195],v226 offset:256
s_waitcnt lgkmcnt(12)
v_mfma_f32_32x32x16_bf16 v[0:15],v[200:203],a[60:63],v[0:15]
s_cmp_eq_u32 s91, s61
s_cbranch_scc1 XL1_10
s_add_u32 s57, s91, 10240
buffer_load_dwordx4 a[40:43],v233,s[8:11],s57 offen
buffer_load_dwordx4 a[44:47],v233,s[8:11],s57 offen offset:1024
XL1_10:
ds_read_b64_tr_b16 v[196:197],v226 offset:512
ds_read_b64_tr_b16 v[198:199],v226 offset:768
s_waitcnt lgkmcnt(12)
v_mfma_f32_32x32x16_bf16 v[16:31],v[204:207],a[60:63],v[16:31]
buffer_atomic_add v239,v238,s[8:11],s93 offen sc1
ds_read_b64_tr_b16 v[200:201],v226 offset:1024
ds_read_b64_tr_b16 v[202:203],v226 offset:1280
s_waitcnt lgkmcnt(12)
v_mfma_f32_32x32x16_bf16 v[32:47],v[208:211],a[60:63],v[32:47]
ds_read_b64_tr_b16 v[204:205],v226 offset:1536
ds_read_b64_tr_b16 v[206:207],v226 offset:1792
s_waitcnt lgkmcnt(12)
v_mfma_f32_32x32x16_bf16 v[48:63],v[212:215],a[60:63],v[48:63]
ds_read_b64_tr_b16 v[208:209],v226 offset:2048
ds_read_b64_tr_b16 v[210:211],v226 offset:2304
s_waitcnt lgkmcnt(12)
v_mfma_f32_32x32x16_bf16 v[64:79],v[216:219],a[60:63],v[64:79]
ds_read_b64_tr_b16 v[212:213],v226 offset:2560
ds_read_b64_tr_b16 v[214:215],v226 offset:2816
s_waitcnt lgkmcnt(12)
v_mfma_f32_32x32x16_bf16 v[80:95],v[220:223],a[60:63],v[80:95]
ds_read_b64_tr_b16 v[216:217],v226 offset:12288
ds_read_b64_tr_b16 v[218:219],v226 offset:12544
s_waitcnt lgkmcnt(12)
v_mfma_f32_32x32x16_bf16 v[0:15],v[192:195],a[64:67],v[0:15]
ds_read_b64_tr_b16 v[220:221],v226 offset:12800
ds_read_b64_tr_b16 v[222:223],v226 offset:13056
s_waitcnt lgkmcnt(12)
v_mfma_f32_32x32x16_bf16 v[16:31],v[196:199],a[64:67],v[16:31]
s_add_u32 m0, s58, 73728
s_add_u32 s57, s59, 6291456
buffer_load_dwordx4 v230,s[32:35],s57 offen lds
ds_read_b64_tr_b16 v[192:193],v226 offset:13312
ds_read_b64_tr_b16 v[194:195],v226 offset:13568
s_waitcnt lgkmcnt(12)
v_mfma_f32_32x32x16_bf16 v[32:47],v[200:203],a[64:67],v[32:47]
ds_read_b64_tr_b16 v[196:197],v226 offset:13824
ds_read_b64_tr_b16 v[198:199],v226 offset:14080
s_waitcnt lgkmcnt(12)
v_mfma_f32_32x32x16_bf16 v[48:63],v[204:207],a[64:67],v[48:63]
s_add_u32 m0, s58, 74752
s_add_u32 s57, s59, 6291584
buffer_load_dwordx4 v230,s[32:35],s57 offen lds
ds_read_b64_tr_b16 v[200:201],v226 offset:14336
ds_read_b64_tr_b16 v[202:203],v226 offset:14592
s_waitcnt lgkmcnt(12)
v_mfma_f32_32x32x16_bf16 v[64:79],v[208:211],a[64:67],v[64:79]
ds_read_b64_tr_b16 v[204:205],v226 offset:14848
ds_read_b64_tr_b16 v[206:207],v226 offset:15104
s_waitcnt lgkmcnt(12)
v_mfma_f32_32x32x16_bf16 v[80:95],v[212:215],a[64:67],v[80:95]
s_add_u32 m0, s58, 75776
s_add_u32 s57, s59, 6291712
buffer_load_dwordx4 v230,s[32:35],s57 offen lds
ds_read_b64_tr_b16 v[208:209],v226 offset:3072
ds_read_b64_tr_b16 v[210:211],v226 offset:3328
s_waitcnt lgkmcnt(12)
v_mfma_f32_32x32x16_bf16 v[0:15],v[216:219],a[68:71],v[0:15]
ds_read_b64_tr_b16 v[212:213],v226 offset:3584
ds_read_b64_tr_b16 v[214:215],v226 offset:3840
s_waitcnt lgkmcnt(12)
v_mfma_f32_32x32x16_bf16 v[16:31],v[220:223],a[68:71],v[16:31]
s_add_u32 m0, s58, 76800
s_add_u32 s57, s59, 6684672
buffer_load_dwordx4 v230,s[32:35],s57 offen lds
ds_read_b64_tr_b16 v[216:217],v226 offset:4096
ds_read_b64_tr_b16 v[218:219],v226 offset:4352
s_waitcnt lgkmcnt(12)
v_mfma_f32_32x32x16_bf16 v[32:47],v[192:195],a[68:71],v[32:47]
ds_read_b64_tr_b16 v[220:221],v226 offset:4608
ds_read_b64_tr_b16 v[222:223],v226 offset:4864
s_waitcnt lgkmcnt(12)
v_mfma_f32_32x32x16_bf16 v[48:63],v[196:199],a[68:71],v[48:63]
s_add_u32 m0, s58, 77824
s_add_u32 s57, s59, 6684800
buffer_load_dwordx4 v230,s[32:35],s57 offen lds
ds_read_b64_tr_b16 v[192:193],v226 offset:5120
ds_read_b64_tr_b16 v[194:195],v226 offset:5376
s_waitcnt lgkmcnt(12)
v_mfma_f32_32x32x16_bf16 v[64:79],v[200:203],a[68:71],v[64:79]
ds_read_b64_tr_b16 v[196:197],v226 offset:5632
ds_read_b64_tr_b16 v[198:199],v226 offset:5888
s_waitcnt lgkmcnt(12)
v_mfma_f32_32x32x16_bf16 v[80:95],v[204:207],a[68:71],v[80:95]
s_add_u32 m0, s58, 78848
s_add_u32 s57, s59, 6684928
buffer_load_dwordx4 v230,s[32:35],s57 offen lds
ds_read_b64_tr_b16 v[200:201],v226 offset:15360
ds_read_b64_tr_b16 v[202:203],v226 offset:15616
s_waitcnt lgkmcnt(12)
v_mfma_f32_32x32x16_bf16 v[0:15],v[208:211],a[72:75],v[0:15]
ds_read_b64_tr_b16 v[204:205],v226 offset:15872
ds_read_b64_tr_b16 v[206:207],v226 offset:16128
s_waitcnt lgkmcnt(12)
v_mfma_f32_32x32x16_bf16 v[16:31],v[212:215],a[72:75],v[16:31]
ds_read_b64_tr_b16 v[208:209],v226 offset:16384
ds_read_b64_tr_b16 v[210:211],v226 offset:16640
s_waitcnt lgkmcnt(12)
v_mfma_f32_32x32x16_bf16 v[32:47],v[216:219],a[72:75],v[32:47]
s_cmp_eq_u32 s91, s61
s_cbranch_scc1 XL1_12
s_add_u32 s57, s91, 12288
buffer_load_dwordx4 a[48:51],v233,s[8:11],s57 offen
buffer_load_dwordx4 a[52:55],v233,s[8:11],s57 offen offset:1024
XL1_12:
ds_read_b64_tr_b16 v[212:213],v226 offset:16896
ds_read_b64_tr_b16 v[214:215],v226 offset:17152
s_waitcnt lgkmcnt(12)
v_mfma_f32_32x32x16_bf16 v[48:63],v[220:223],a[72:75],v[48:63]
ds_read_b64_tr_b16 v[216:217],v226 offset:17408
ds_read_b64_tr_b16 v[218:219],v226 offset:17664
s_waitcnt lgkmcnt(12)
v_mfma_f32_32x32x16_bf16 v[64:79],v[192:195],a[72:75],v[64:79]
ds_read_b64_tr_b16 v[220:221],v226 offset:17920
ds_read_b64_tr_b16 v[222:223],v226 offset:18176
s_waitcnt lgkmcnt(12)
v_mfma_f32_32x32x16_bf16 v[80:95],v[196:199],a[72:75],v[80:95]
s_waitcnt vmcnt(19)
s_barrier
ds_read_b64_tr_b16 v[192:193],v224 offset:0
ds_read_b64_tr_b16 v[194:195],v224 offset:256
s_waitcnt lgkmcnt(12)
v_mfma_f32_32x32x16_bf16 v[0:15],v[200:203],a[76:79],v[0:15]
s_cmp_eq_u32 s91, s61
s_cbranch_scc1 XL1_14
s_add_u32 s57, s91, 14336
buffer_load_dwordx4 a[56:59],v233,s[8:11],s57 offen
buffer_load_dwordx4 a[60:63],v233,s[8:11],s57 offen offset:1024
XL1_14:
ds_read_b64_tr_b16 v[196:197],v224 offset:512
ds_read_b64_tr_b16 v[198:199],v224 offset:768
s_waitcnt lgkmcnt(12)
v_mfma_f32_32x32x16_bf16 v[16:31],v[204:207],a[76:79],v[16:31]
ds_read_b64_tr_b16 v[200:201],v224 offset:1024
ds_read_b64_tr_b16 v[202:203],v224 offset:1280
s_waitcnt lgkmcnt(12)
v_mfma_f32_32x32x16_bf16 v[32:47],v[208:211],a[76:79],v[32:47]
ds_read_b64_tr_b16 v[204:205],v224 offset:1536
ds_read_b64_tr_b16 v[206:207],v224 offset:1792
s_waitcnt lgkmcnt(12)
v_mfma_f32_32x32x16_bf16 v[48:63],v[212:215],a[76:79],v[48:63]
ds_read_b64_tr_b16 v[208:209],v224 offset:2048
ds_read_b64_tr_b16 v[210:211],v224 offset:2304
s_waitcnt lgkmcnt(12)
v_mfma_f32_32x32x16_bf16 v[64:79],v[216:219],a[76:79],v[64:79]
ds_read_b64_tr_b16 v[212:213],v224 offset:2560
ds_read_b64_tr_b16 v[214:215],v224 offset:2816
s_waitcnt lgkmcnt(12)
v_mfma_f32_32x32x16_bf16 v[80:95],v[220:223],a[76:79],v[80:95]
ds_read_b64_tr_b16 v[216:217],v224 offset:12288
ds_read_b64_tr_b16 v[218:219],v224 offset:12544
s_waitcnt lgkmcnt(12)
v_mfma_f32_32x32x16_bf16 v[0:15],v[192:195],a[80:83],v[0:15]
ds_read_b64_tr_b16 v[220:221],v224 offset:12800
ds_read_b64_tr_b16 v[222:223],v224 offset:13056
s_waitcnt lgkmcnt(12)
v_mfma_f32_32x32x16_bf16 v[16:31],v[196:199],a[80:83],v[16:31]
s_add_u32 m0, s58, 98304
s_add_u32 s57, s59, 7077888
buffer_load_dwordx4 v230,s[32:35],s57 offen lds
ds_read_b64_tr_b16 v[192:193],v224 offset:13312
ds_read_b64_tr_b16 v[194:195],v224 offset:13568
s_waitcnt lgkmcnt(12)
v_mfma_f32_32x32x16_bf16 v[32:47],v[200:203],a[80:83],v[32:47]
ds_read_b64_tr_b16 v[196:197],v224 offset:13824
ds_read_b64_tr_b16 v[198:199],v224 offset:14080
s_waitcnt lgkmcnt(12)
v_mfma_f32_32x32x16_bf16 v[48:63],v[204:207],a[80:83],v[48:63]
s_add_u32 m0, s58, 99328
s_add_u32 s57, s59, 7078016
buffer_load_dwordx4 v230,s[32:35],s57 offen lds
ds_read_b64_tr_b16 v[200:201],v224 offset:14336
ds_read_b64_tr_b16 v[202:203],v224 offset:14592
s_waitcnt lgkmcnt(12)
v_mfma_f32_32x32x16_bf16 v[64:79],v[208:211],a[80:83],v[64:79]
ds_read_b64_tr_b16 v[204:205],v224 offset:14848
ds_read_b64_tr_b16 v[206:207],v224 offset:15104
s_waitcnt lgkmcnt(12)
v_mfma_f32_32x32x16_bf16 v[80:95],v[212:215],a[80:83],v[80:95]
s_add_u32 m0, s58, 100352
s_add_u32 s57, s59, 7078144
buffer_load_dwordx4 v230,s[32:35],s57 offen lds
ds_read_b64_tr_b16 v[208:209],v224 offset:3072
ds_read_b64_tr_b16 v[210:211],v224 offset:3328
s_waitcnt lgkmcnt(12)
v_mfma_f32_32x32x16_bf16 v[0:15],v[216:219],a[84:87],v[0:15]
ds_read_b64_tr_b16 v[212:213],v224 offset:3584
ds_read_b64_tr_b16 v[214:215],v224 offset:3840
s_waitcnt lgkmcnt(12)
v_mfma_f32_32x32x16_bf16 v[16:31],v[220:223],a[84:87],v[16:31]
s_add_u32 m0, s58, 101376
s_add_u32 s57, s59, 7471104
buffer_load_dwordx4 v230,s[32:35],s57 offen lds
ds_read_b64_tr_b16 v[216:217],v224 offset:4096
ds_read_b64_tr_b16 v[218:219],v224 offset:4352
s_waitcnt lgkmcnt(12)
v_mfma_f32_32x32x16_bf16 v[32:47],v[192:195],a[84:87],v[32:47]
ds_read_b64_tr_b16 v[220:221],v224 offset:4608
ds_read_b64_tr_b16 v[222:223],v224 offset:4864
s_waitcnt lgkmcnt(12)
v_mfma_f32_32x32x16_bf16 v[48:63],v[196:199],a[84:87],v[48:63]
s_add_u32 m0, s58, 102400
s_add_u32 s57, s59, 7471232
buffer_load_dwordx4 v230,s[32:35],s57 offen lds
ds_read_b64_tr_b16 v[192:193],v224 offset:5120
ds_read_b64_tr_b16 v[194:195],v224 offset:5376
s_waitcnt lgkmcnt(12)
v_mfma_f32_32x32x16_bf16 v[64:79],v[200:203],a[84:87],v[64:79]
ds_read_b64_tr_b16 v[196:197],v224 offset:5632
ds_read_b64_tr_b16 v[198:199],v224 offset:5888
s_waitcnt lgkmcnt(12)
v_mfma_f32_32x32x16_bf16 v[80:95],v[204:207],a[84:87],v[80:95]
s_add_u32 m0, s58, 103424
s_add_u32 s57, s59, 7471360
buffer_load_dwordx4 v230,s[32:35],s57 offen lds
ds_read_b64_tr_b16 v[200:201],v224 offset:15360
ds_read_b64_tr_b16 v[202:203],v224 offset:15616
s_waitcnt lgkmcnt(12)
v_mfma_f32_32x32x16_bf16 v[0:15],v[208:211],a[88:91],v[0:15]
ds_read_b64_tr_b16 v[204:205],v224 offset:15872
ds_read_b64_tr_b16 v[206:207],v224 offset:16128
s_waitcnt lgkmcnt(12)
v_mfma_f32_32x32x16_bf16 v[16:31],v[212:215],a[88:91],v[16:31]
ds_read_b64_tr_b16 v[208:209],v224 offset:16384
ds_read_b64_tr_b16 v[210:211],v224 offset:16640
s_waitcnt lgkmcnt(12)
v_mfma_f32_32x32x16_bf16 v[32:47],v[216:219],a[88:91],v[32:47]
s_cmp_eq_u32 s91, s61
s_cbranch_scc1 XL1_16
s_add_u32 s57, s91, 16384
buffer_load_dwordx4 a[64:67],v233,s[8:11],s57 offen
buffer_load_dwordx4 a[68:71],v233,s[8:11],s57 offen offset:1024
XL1_16:
ds_read_b64_tr_b16 v[212:213],v224 offset:16896
ds_read_b64_tr_b16 v[214:215],v224 offset:17152
s_waitcnt lgkmcnt(12)
v_mfma_f32_32x32x16_bf16 v[48:63],v[220:223],a[88:91],v[48:63]
ds_read_b64_tr_b16 v[216:217],v224 offset:17408
ds_read_b64_tr_b16 v[218:219],v224 offset:17664
s_waitcnt lgkmcnt(12)
v_mfma_f32_32x32x16_bf16 v[64:79],v[192:195],a[88:91],v[64:79]
ds_read_b64_tr_b16 v[220:221],v224 offset:17920
ds_read_b64_tr_b16 v[222:223],v224 offset:18176
s_waitcnt lgkmcnt(12)
v_mfma_f32_32x32x16_bf16 v[80:95],v[196:199],a[88:91],v[80:95]
s_waitcnt vmcnt(19)
s_barrier
ds_read_b64_tr_b16 v[192:193],v224 offset:24576
ds_read_b64_tr_b16 v[194:195],v224 offset:24832
s_waitcnt lgkmcnt(12)
v_mfma_f32_32x32x16_bf16 v[0:15],v[200:203],a[92:95],v[0:15]
s_cmp_eq_u32 s91, s61
s_cbranch_scc1 XL1_18
s_add_u32 s57, s91, 18432
buffer_load_dwordx4 a[72:75],v233,s[8:11],s57 offen
buffer_load_dwordx4 a[76:79],v233,s[8:11],s57 offen offset:1024
XL1_18:
ds_read_b64_tr_b16 v[196:197],v224 offset:25088
ds_read_b64_tr_b16 v[198:199],v224 offset:25344
s_waitcnt lgkmcnt(12)
v_mfma_f32_32x32x16_bf16 v[16:31],v[204:207],a[92:95],v[16:31]
ds_read_b64_tr_b16 v[200:201],v224 offset:25600
ds_read_b64_tr_b16 v[202:203],v224 offset:25856
s_waitcnt lgkmcnt(12)
v_mfma_f32_32x32x16_bf16 v[32:47],v[208:211],a[92:95],v[32:47]
ds_read_b64_tr_b16 v[204:205],v224 offset:26112
ds_read_b64_tr_b16 v[206:207],v224 offset:26368
s_waitcnt lgkmcnt(12)
v_mfma_f32_32x32x16_bf16 v[48:63],v[212:215],a[92:95],v[48:63]
ds_read_b64_tr_b16 v[208:209],v224 offset:26624
ds_read_b64_tr_b16 v[210:211],v224 offset:26880
s_waitcnt lgkmcnt(12)
v_mfma_f32_32x32x16_bf16 v[64:79],v[216:219],a[92:95],v[64:79]
ds_read_b64_tr_b16 v[212:213],v224 offset:27136
ds_read_b64_tr_b16 v[214:215],v224 offset:27392
s_waitcnt lgkmcnt(12)
v_mfma_f32_32x32x16_bf16 v[80:95],v[220:223],a[92:95],v[80:95]
ds_read_b64_tr_b16 v[216:217],v224 offset:36864
ds_read_b64_tr_b16 v[218:219],v224 offset:37120
s_waitcnt lgkmcnt(12)
v_mfma_f32_32x32x16_bf16 v[0:15],v[192:195],a[96:99],v[0:15]
ds_read_b64_tr_b16 v[220:221],v224 offset:37376
ds_read_b64_tr_b16 v[222:223],v224 offset:37632
s_waitcnt lgkmcnt(12)
v_mfma_f32_32x32x16_bf16 v[16:31],v[196:199],a[96:99],v[16:31]
s_add_u32 m0, s58, 0
s_add_u32 s57, s60, 0
buffer_load_dwordx4 v231,s[36:39],s57 offen lds
ds_read_b64_tr_b16 v[192:193],v224 offset:37888
ds_read_b64_tr_b16 v[194:195],v224 offset:38144
s_waitcnt lgkmcnt(12)
v_mfma_f32_32x32x16_bf16 v[32:47],v[200:203],a[96:99],v[32:47]
ds_read_b64_tr_b16 v[196:197],v224 offset:38400
ds_read_b64_tr_b16 v[198:199],v224 offset:38656
s_waitcnt lgkmcnt(12)
v_mfma_f32_32x32x16_bf16 v[48:63],v[204:207],a[96:99],v[48:63]
s_add_u32 m0, s58, 1024
s_add_u32 s57, s60, 40960
buffer_load_dwordx4 v231,s[36:39],s57 offen lds
ds_read_b64_tr_b16 v[200:201],v224 offset:38912
ds_read_b64_tr_b16 v[202:203],v224 offset:39168
s_waitcnt lgkmcnt(12)
v_mfma_f32_32x32x16_bf16 v[64:79],v[208:211],a[96:99],v[64:79]
ds_read_b64_tr_b16 v[204:205],v224 offset:39424
ds_read_b64_tr_b16 v[206:207],v224 offset:39680
s_waitcnt lgkmcnt(12)
v_mfma_f32_32x32x16_bf16 v[80:95],v[212:215],a[96:99],v[80:95]
s_add_u32 m0, s58, 2048
s_add_u32 s57, s60, 81920
buffer_load_dwordx4 v231,s[36:39],s57 offen lds
ds_read_b64_tr_b16 v[208:209],v224 offset:27648
ds_read_b64_tr_b16 v[210:211],v224 offset:27904
s_waitcnt lgkmcnt(12)
v_mfma_f32_32x32x16_bf16 v[0:15],v[216:219],a[100:103],v[0:15]
ds_read_b64_tr_b16 v[212:213],v224 offset:28160
ds_read_b64_tr_b16 v[214:215],v224 offset:28416
s_waitcnt lgkmcnt(12)
v_mfma_f32_32x32x16_bf16 v[16:31],v[220:223],a[100:103],v[16:31]
s_add_u32 m0, s58, 3072
s_add_u32 s57, s60, 122880
buffer_load_dwordx4 v231,s[36:39],s57 offen lds
ds_read_b64_tr_b16 v[216:217],v224 offset:28672
ds_read_b64_tr_b16 v[218:219],v224 offset:28928
s_waitcnt lgkmcnt(12)
v_mfma_f32_32x32x16_bf16 v[32:47],v[192:195],a[100:103],v[32:47]
ds_read_b64_tr_b16 v[220:221],v224 offset:29184
ds_read_b64_tr_b16 v[222:223],v224 offset:29440
s_waitcnt lgkmcnt(12)
v_mfma_f32_32x32x16_bf16 v[48:63],v[196:199],a[100:103],v[48:63]
s_add_u32 m0, s58, 4096
s_add_u32 s57, s60, 163840
buffer_load_dwordx4 v231,s[36:39],s57 offen lds
ds_read_b64_tr_b16 v[192:193],v224 offset:29696
ds_read_b64_tr_b16 v[194:195],v224 offset:29952
s_waitcnt lgkmcnt(12)
v_mfma_f32_32x32x16_bf16 v[64:79],v[200:203],a[100:103],v[64:79]
ds_read_b64_tr_b16 v[196:197],v224 offset:30208
ds_read_b64_tr_b16 v[198:199],v224 offset:30464
s_waitcnt lgkmcnt(12)
v_mfma_f32_32x32x16_bf16 v[80:95],v[204:207],a[100:103],v[80:95]
s_add_u32 m0, s58, 5120
s_add_u32 s57, s60, 204800
buffer_load_dwordx4 v231,s[36:39],s57 offen lds
ds_read_b64_tr_b16 v[200:201],v224 offset:39936
ds_read_b64_tr_b16 v[202:203],v224 offset:40192
s_waitcnt lgkmcnt(12)
v_mfma_f32_32x32x16_bf16 v[0:15],v[208:211],a[104:107],v[0:15]
ds_read_b64_tr_b16 v[204:205],v224 offset:40448
ds_read_b64_tr_b16 v[206:207],v224 offset:40704
s_waitcnt lgkmcnt(12)
v_mfma_f32_32x32x16_bf16 v[16:31],v[212:215],a[104:107],v[16:31]
ds_read_b64_tr_b16 v[208:209],v224 offset:40960
ds_read_b64_tr_b16 v[210:211],v224 offset:41216
s_waitcnt lgkmcnt(12)
v_mfma_f32_32x32x16_bf16 v[32:47],v[216:219],a[104:107],v[32:47]
s_cmp_eq_u32 s91, s61
s_cbranch_scc1 XL1_20
s_add_u32 s57, s91, 20480
buffer_load_dwordx4 a[80:83],v233,s[8:11],s57 offen
buffer_load_dwordx4 a[84:87],v233,s[8:11],s57 offen offset:1024
XL1_20:
ds_read_b64_tr_b16 v[212:213],v224 offset:41472
ds_read_b64_tr_b16 v[214:215],v224 offset:41728
s_waitcnt lgkmcnt(12)
v_mfma_f32_32x32x16_bf16 v[48:63],v[220:223],a[104:107],v[48:63]
ds_read_b64_tr_b16 v[216:217],v224 offset:41984
ds_read_b64_tr_b16 v[218:219],v224 offset:42240
s_waitcnt lgkmcnt(12)
v_mfma_f32_32x32x16_bf16 v[64:79],v[192:195],a[104:107],v[64:79]
ds_read_b64_tr_b16 v[220:221],v224 offset:42496
ds_read_b64_tr_b16 v[222:223],v224 offset:42752
s_waitcnt lgkmcnt(12)
v_mfma_f32_32x32x16_bf16 v[80:95],v[196:199],a[104:107],v[80:95]
s_waitcnt vmcnt(19)
s_barrier
ds_read_b64_tr_b16 v[192:193],v225 offset:0
ds_read_b64_tr_b16 v[194:195],v225 offset:256
s_waitcnt lgkmcnt(12)
v_mfma_f32_32x32x16_bf16 v[0:15],v[200:203],a[108:111],v[0:15]
s_cmp_eq_u32 s91, s61
s_cbranch_scc1 XL1_22
s_add_u32 s57, s91, 22528
buffer_load_dwordx4 a[88:91],v233,s[8:11],s57 offen
buffer_load_dwordx4 a[92:95],v233,s[8:11],s57 offen offset:1024
XL1_22:
ds_read_b64_tr_b16 v[196:197],v225 offset:512
ds_read_b64_tr_b16 v[198:199],v225 offset:768
s_waitcnt lgkmcnt(12)
v_mfma_f32_32x32x16_bf16 v[16:31],v[204:207],a[108:111],v[16:31]
ds_read_b64_tr_b16 v[200:201],v225 offset:1024
ds_read_b64_tr_b16 v[202:203],v225 offset:1280
s_waitcnt lgkmcnt(12)
v_mfma_f32_32x32x16_bf16 v[32:47],v[208:211],a[108:111],v[32:47]
ds_read_b64_tr_b16 v[204:205],v225 offset:1536
ds_read_b64_tr_b16 v[206:207],v225 offset:1792
s_waitcnt lgkmcnt(12)
v_mfma_f32_32x32x16_bf16 v[48:63],v[212:215],a[108:111],v[48:63]
ds_read_b64_tr_b16 v[208:209],v225 offset:2048
ds_read_b64_tr_b16 v[210:211],v225 offset:2304
s_waitcnt lgkmcnt(12)
v_mfma_f32_32x32x16_bf16 v[64:79],v[216:219],a[108:111],v[64:79]
ds_read_b64_tr_b16 v[212:213],v225 offset:2560
ds_read_b64_tr_b16 v[214:215],v225 offset:2816
s_waitcnt lgkmcnt(12)
v_mfma_f32_32x32x16_bf16 v[80:95],v[220:223],a[108:111],v[80:95]
ds_read_b64_tr_b16 v[216:217],v225 offset:12288
ds_read_b64_tr_b16 v[218:219],v225 offset:12544
s_waitcnt lgkmcnt(12)
v_mfma_f32_32x32x16_bf16 v[0:15],v[192:195],a[112:115],v[0:15]
ds_read_b64_tr_b16 v[220:221],v225 offset:12800
ds_read_b64_tr_b16 v[222:223],v225 offset:13056
s_waitcnt lgkmcnt(12)
v_mfma_f32_32x32x16_bf16 v[16:31],v[196:199],a[112:115],v[16:31]
s_add_u32 m0, s58, 24576
s_add_u32 s57, s60, 128
buffer_load_dwordx4 v231,s[36:39],s57 offen lds
ds_read_b64_tr_b16 v[192:193],v225 offset:13312
ds_read_b64_tr_b16 v[194:195],v225 offset:13568
s_waitcnt lgkmcnt(12)
v_mfma_f32_32x32x16_bf16 v[32:47],v[200:203],a[112:115],v[32:47]
ds_read_b64_tr_b16 v[196:197],v225 offset:13824
ds_read_b64_tr_b16 v[198:199],v225 offset:14080
s_waitcnt lgkmcnt(12)
v_mfma_f32_32x32x16_bf16 v[48:63],v[204:207],a[112:115],v[48:63]
s_add_u32 m0, s58, 25600
s_add_u32 s57, s60, 41088
buffer_load_dwordx4 v231,s[36:39],s57 offen lds
ds_read_b64_tr_b16 v[200:201],v225 offset:14336
ds_read_b64_tr_b16 v[202:203],v225 offset:14592
s_waitcnt lgkmcnt(12)
v_mfma_f32_32x32x16_bf16 v[64:79],v[208:211],a[112:115],v[64:79]
ds_read_b64_tr_b16 v[204:205],v225 offset:14848
ds_read_b64_tr_b16 v[206:207],v225 offset:15104
s_waitcnt lgkmcnt(12)
v_mfma_f32_32x32x16_bf16 v[80:95],v[212:215],a[112:115],v[80:95]
s_add_u32 m0, s58, 26624
s_add_u32 s57, s60, 82048
buffer_load_dwordx4 v231,s[36:39],s57 offen lds
ds_read_b64_tr_b16 v[208:209],v225 offset:3072
ds_read_b64_tr_b16 v[210:211],v225 offset:3328
s_waitcnt lgkmcnt(12)
v_mfma_f32_32x32x16_bf16 v[0:15],v[216:219],a[116:119],v[0:15]
ds_read_b64_tr_b16 v[212:213],v225 offset:3584
ds_read_b64_tr_b16 v[214:215],v225 offset:3840
s_waitcnt lgkmcnt(12)
v_mfma_f32_32x32x16_bf16 v[16:31],v[220:223],a[116:119],v[16:31]
s_add_u32 m0, s58, 27648
s_add_u32 s57, s60, 123008
buffer_load_dwordx4 v231,s[36:39],s57 offen lds
ds_read_b64_tr_b16 v[216:217],v225 offset:4096
ds_read_b64_tr_b16 v[218:219],v225 offset:4352
s_waitcnt lgkmcnt(12)
v_mfma_f32_32x32x16_bf16 v[32:47],v[192:195],a[116:119],v[32:47]
ds_read_b64_tr_b16 v[220:221],v225 offset:4608
ds_read_b64_tr_b16 v[222:223],v225 offset:4864
s_waitcnt lgkmcnt(12)
v_mfma_f32_32x32x16_bf16 v[48:63],v[196:199],a[116:119],v[48:63]
s_add_u32 m0, s58, 28672
s_add_u32 s57, s60, 163968
buffer_load_dwordx4 v231,s[36:39],s57 offen lds
ds_read_b64_tr_b16 v[192:193],v225 offset:5120
ds_read_b64_tr_b16 v[194:195],v225 offset:5376
s_waitcnt lgkmcnt(12)
v_mfma_f32_32x32x16_bf16 v[64:79],v[200:203],a[116:119],v[64:79]
ds_read_b64_tr_b16 v[196:197],v225 offset:5632
ds_read_b64_tr_b16 v[198:199],v225 offset:5888
s_waitcnt lgkmcnt(12)
v_mfma_f32_32x32x16_bf16 v[80:95],v[204:207],a[116:119],v[80:95]
s_add_u32 m0, s58, 29696
s_add_u32 s57, s60, 204928
buffer_load_dwordx4 v231,s[36:39],s57 offen lds
ds_read_b64_tr_b16 v[200:201],v225 offset:15360
ds_read_b64_tr_b16 v[202:203],v225 offset:15616
s_waitcnt lgkmcnt(12)
v_mfma_f32_32x32x16_bf16 v[0:15],v[208:211],a[120:123],v[0:15]
ds_read_b64_tr_b16 v[204:205],v225 offset:15872
ds_read_b64_tr_b16 v[206:207],v225 offset:16128
s_waitcnt lgkmcnt(12)
v_mfma_f32_32x32x16_bf16 v[16:31],v[212:215],a[120:123],v[16:31]
ds_read_b64_tr_b16 v[208:209],v225 offset:16384
ds_read_b64_tr_b16 v[210:211],v225 offset:16640
s_waitcnt lgkmcnt(12)
v_mfma_f32_32x32x16_bf16 v[32:47],v[216:219],a[120:123],v[32:47]
s_cmp_eq_u32 s91, s61
s_cbranch_scc1 XL1_24
s_add_u32 s57, s91, 24576
buffer_load_dwordx4 a[96:99],v233,s[8:11],s57 offen
buffer_load_dwordx4 a[100:103],v233,s[8:11],s57 offen offset:1024
XL1_24:
ds_read_b64_tr_b16 v[212:213],v225 offset:16896
ds_read_b64_tr_b16 v[214:215],v225 offset:17152
s_waitcnt lgkmcnt(12)
v_mfma_f32_32x32x16_bf16 v[48:63],v[220:223],a[120:123],v[48:63]
ds_read_b64_tr_b16 v[216:217],v225 offset:17408
ds_read_b64_tr_b16 v[218:219],v225 offset:17664
s_waitcnt lgkmcnt(12)
v_mfma_f32_32x32x16_bf16 v[64:79],v[192:195],a[120:123],v[64:79]
ds_read_b64_tr_b16 v[220:221],v225 offset:17920
ds_read_b64_tr_b16 v[222:223],v225 offset:18176
s_waitcnt lgkmcnt(12)
v_mfma_f32_32x32x16_bf16 v[80:95],v[196:199],a[120:123],v[80:95]
s_waitcnt vmcnt(18)
s_barrier
ds_read_b64_tr_b16 v[192:193],v225 offset:24576
ds_read_b64_tr_b16 v[194:195],v225 offset:24832
s_waitcnt lgkmcnt(12)
v_mfma_f32_32x32x16_bf16 v[0:15],v[200:203],a[124:127],v[0:15]
s_cmp_eq_u32 s91, s61
s_cbranch_scc1 XL1_26
s_add_u32 s57, s91, 26624
buffer_load_dwordx4 a[104:107],v233,s[8:11],s57 offen
buffer_load_dwordx4 a[108:111],v233,s[8:11],s57 offen offset:1024
XL1_26:
ds_read_b64_tr_b16 v[196:197],v225 offset:25088
ds_read_b64_tr_b16 v[198:199],v225 offset:25344
s_waitcnt lgkmcnt(12)
v_mfma_f32_32x32x16_bf16 v[16:31],v[204:207],a[124:127],v[16:31]
ds_read_b64_tr_b16 v[200:201],v225 offset:25600
ds_read_b64_tr_b16 v[202:203],v225 offset:25856
s_waitcnt lgkmcnt(12)
v_mfma_f32_32x32x16_bf16 v[32:47],v[208:211],a[124:127],v[32:47]
ds_read_b64_tr_b16 v[204:205],v225 offset:26112
ds_read_b64_tr_b16 v[206:207],v225 offset:26368
s_waitcnt lgkmcnt(12)
v_mfma_f32_32x32x16_bf16 v[48:63],v[212:215],a[124:127],v[48:63]
ds_read_b64_tr_b16 v[208:209],v225 offset:26624
ds_read_b64_tr_b16 v[210:211],v225 offset:26880
s_waitcnt lgkmcnt(12)
v_mfma_f32_32x32x16_bf16 v[64:79],v[216:219],a[124:127],v[64:79]
ds_read_b64_tr_b16 v[212:213],v225 offset:27136
ds_read_b64_tr_b16 v[214:215],v225 offset:27392
s_waitcnt lgkmcnt(12)
v_mfma_f32_32x32x16_bf16 v[80:95],v[220:223],a[124:127],v[80:95]
ds_read_b64_tr_b16 v[216:217],v225 offset:36864
ds_read_b64_tr_b16 v[218:219],v225 offset:37120
s_waitcnt lgkmcnt(12)
v_mfma_f32_32x32x16_bf16 v[0:15],v[192:195],a[128:131],v[0:15]
ds_read_b64_tr_b16 v[220:221],v225 offset:37376
ds_read_b64_tr_b16 v[222:223],v225 offset:37632
s_waitcnt lgkmcnt(12)
v_mfma_f32_32x32x16_bf16 v[16:31],v[196:199],a[128:131],v[16:31]
s_add_u32 m0, s58, 49152
s_add_u32 s57, s60, 256
buffer_load_dwordx4 v231,s[36:39],s57 offen lds
ds_read_b64_tr_b16 v[192:193],v225 offset:37888
ds_read_b64_tr_b16 v[194:195],v225 offset:38144
s_waitcnt lgkmcnt(12)
v_mfma_f32_32x32x16_bf16 v[32:47],v[200:203],a[128:131],v[32:47]
ds_read_b64_tr_b16 v[196:197],v225 offset:38400
ds_read_b64_tr_b16 v[198:199],v225 offset:38656
s_waitcnt lgkmcnt(12)
v_mfma_f32_32x32x16_bf16 v[48:63],v[204:207],a[128:131],v[48:63]
s_add_u32 m0, s58, 50176
s_add_u32 s57, s60, 41216
buffer_load_dwordx4 v231,s[36:39],s57 offen lds
ds_read_b64_tr_b16 v[200:201],v225 offset:38912
ds_read_b64_tr_b16 v[202:203],v225 offset:39168
s_waitcnt lgkmcnt(12)
v_mfma_f32_32x32x16_bf16 v[64:79],v[208:211],a[128:131],v[64:79]
ds_read_b64_tr_b16 v[204:205],v225 offset:39424
ds_read_b64_tr_b16 v[206:207],v225 offset:39680
s_waitcnt lgkmcnt(12)
v_mfma_f32_32x32x16_bf16 v[80:95],v[212:215],a[128:131],v[80:95]
s_add_u32 m0, s58, 51200
s_add_u32 s57, s60, 82176
buffer_load_dwordx4 v231,s[36:39],s57 offen lds
ds_read_b64_tr_b16 v[208:209],v225 offset:27648
ds_read_b64_tr_b16 v[210:211],v225 offset:27904
s_waitcnt lgkmcnt(12)
v_mfma_f32_32x32x16_bf16 v[0:15],v[216:219],a[132:135],v[0:15]
ds_read_b64_tr_b16 v[212:213],v225 offset:28160
ds_read_b64_tr_b16 v[214:215],v225 offset:28416
s_waitcnt lgkmcnt(12)
v_mfma_f32_32x32x16_bf16 v[16:31],v[220:223],a[132:135],v[16:31]
s_add_u32 m0, s58, 52224
s_add_u32 s57, s60, 123136
buffer_load_dwordx4 v231,s[36:39],s57 offen lds
ds_read_b64_tr_b16 v[216:217],v225 offset:28672
ds_read_b64_tr_b16 v[218:219],v225 offset:28928
s_waitcnt lgkmcnt(12)
v_mfma_f32_32x32x16_bf16 v[32:47],v[192:195],a[132:135],v[32:47]
ds_read_b64_tr_b16 v[220:221],v225 offset:29184
ds_read_b64_tr_b16 v[222:223],v225 offset:29440
s_waitcnt lgkmcnt(12)
v_mfma_f32_32x32x16_bf16 v[48:63],v[196:199],a[132:135],v[48:63]
s_add_u32 m0, s58, 53248
s_add_u32 s57, s60, 164096
buffer_load_dwordx4 v231,s[36:39],s57 offen lds
ds_read_b64_tr_b16 v[192:193],v225 offset:29696
ds_read_b64_tr_b16 v[194:195],v225 offset:29952
s_waitcnt lgkmcnt(12)
v_mfma_f32_32x32x16_bf16 v[64:79],v[200:203],a[132:135],v[64:79]
ds_read_b64_tr_b16 v[196:197],v225 offset:30208
ds_read_b64_tr_b16 v[198:199],v225 offset:30464
s_waitcnt lgkmcnt(12)
v_mfma_f32_32x32x16_bf16 v[80:95],v[204:207],a[132:135],v[80:95]
s_add_u32 m0, s58, 54272
s_add_u32 s57, s60, 205056
buffer_load_dwordx4 v231,s[36:39],s57 offen lds
ds_read_b64_tr_b16 v[200:201],v225 offset:39936
ds_read_b64_tr_b16 v[202:203],v225 offset:40192
s_waitcnt lgkmcnt(12)
v_mfma_f32_32x32x16_bf16 v[0:15],v[208:211],a[136:139],v[0:15]
ds_read_b64_tr_b16 v[204:205],v225 offset:40448
ds_read_b64_tr_b16 v[206:207],v225 offset:40704
s_waitcnt lgkmcnt(12)
v_mfma_f32_32x32x16_bf16 v[16:31],v[212:215],a[136:139],v[16:31]
ds_read_b64_tr_b16 v[208:209],v225 offset:40960
ds_read_b64_tr_b16 v[210:211],v225 offset:41216
s_waitcnt lgkmcnt(12)
v_mfma_f32_32x32x16_bf16 v[32:47],v[216:219],a[136:139],v[32:47]
s_cmp_eq_u32 s91, s61
s_cbranch_scc1 XL1_28
s_add_u32 s57, s91, 28672
buffer_load_dwordx4 a[112:115],v233,s[8:11],s57 offen
buffer_load_dwordx4 a[116:119],v233,s[8:11],s57 offen offset:1024
XL1_28:
ds_read_b64_tr_b16 v[212:213],v225 offset:41472
ds_read_b64_tr_b16 v[214:215],v225 offset:41728
s_waitcnt lgkmcnt(12)
v_mfma_f32_32x32x16_bf16 v[48:63],v[220:223],a[136:139],v[48:63]
ds_read_b64_tr_b16 v[216:217],v225 offset:41984
ds_read_b64_tr_b16 v[218:219],v225 offset:42240
s_waitcnt lgkmcnt(12)
v_mfma_f32_32x32x16_bf16 v[64:79],v[192:195],a[136:139],v[64:79]
ds_read_b64_tr_b16 v[220:221],v225 offset:42496
ds_read_b64_tr_b16 v[222:223],v225 offset:42752
s_waitcnt lgkmcnt(12)
v_mfma_f32_32x32x16_bf16 v[80:95],v[196:199],a[136:139],v[80:95]
s_waitcnt vmcnt(18)
s_barrier
ds_read_b64_tr_b16 v[192:193],v226 offset:0
ds_read_b64_tr_b16 v[194:195],v226 offset:256
s_waitcnt lgkmcnt(12)
v_mfma_f32_32x32x16_bf16 v[0:15],v[200:203],a[140:143],v[0:15]
s_cmp_eq_u32 s91, s61
s_cbranch_scc1 XL1_30
s_add_u32 s57, s91, 30720
buffer_load_dwordx4 a[120:123],v233,s[8:11],s57 offen
buffer_load_dwordx4 a[124:127],v233,s[8:11],s57 offen offset:1024
XL1_30:
ds_read_b64_tr_b16 v[196:197],v226 offset:512
ds_read_b64_tr_b16 v[198:199],v226 offset:768
s_waitcnt lgkmcnt(12)
v_mfma_f32_32x32x16_bf16 v[16:31],v[204:207],a[140:143],v[16:31]
ds_read_b64_tr_b16 v[200:201],v226 offset:1024
ds_read_b64_tr_b16 v[202:203],v226 offset:1280
s_waitcnt lgkmcnt(12)
v_mfma_f32_32x32x16_bf16 v[32:47],v[208:211],a[140:143],v[32:47]
ds_read_b64_tr_b16 v[204:205],v226 offset:1536
ds_read_b64_tr_b16 v[206:207],v226 offset:1792
s_waitcnt lgkmcnt(12)
v_mfma_f32_32x32x16_bf16 v[48:63],v[212:215],a[140:143],v[48:63]
ds_read_b64_tr_b16 v[208:209],v226 offset:2048
ds_read_b64_tr_b16 v[210:211],v226 offset:2304
s_waitcnt lgkmcnt(12)
v_mfma_f32_32x32x16_bf16 v[64:79],v[216:219],a[140:143],v[64:79]
ds_read_b64_tr_b16 v[212:213],v226 offset:2560
ds_read_b64_tr_b16 v[214:215],v226 offset:2816
s_waitcnt lgkmcnt(12)
v_mfma_f32_32x32x16_bf16 v[80:95],v[220:223],a[140:143],v[80:95]
ds_read_b64_tr_b16 v[216:217],v226 offset:12288
ds_read_b64_tr_b16 v[218:219],v226 offset:12544
s_waitcnt lgkmcnt(12)
v_mfma_f32_32x32x16_bf16 v[0:15],v[192:195],a[144:147],v[0:15]
ds_read_b64_tr_b16 v[220:221],v226 offset:12800
ds_read_b64_tr_b16 v[222:223],v226 offset:13056
s_waitcnt lgkmcnt(12)
v_mfma_f32_32x32x16_bf16 v[16:31],v[196:199],a[144:147],v[16:31]
s_add_u32 m0, s58, 73728
s_add_u32 s57, s60, 384
buffer_load_dwordx4 v231,s[36:39],s57 offen lds
ds_read_b64_tr_b16 v[192:193],v226 offset:13312
ds_read_b64_tr_b16 v[194:195],v226 offset:13568
s_waitcnt lgkmcnt(12)
v_mfma_f32_32x32x16_bf16 v[32:47],v[200:203],a[144:147],v[32:47]
ds_read_b64_tr_b16 v[196:197],v226 offset:13824
ds_read_b64_tr_b16 v[198:199],v226 offset:14080
s_waitcnt lgkmcnt(12)
v_mfma_f32_32x32x16_bf16 v[48:63],v[204:207],a[144:147],v[48:63]
s_add_u32 m0, s58, 74752
s_add_u32 s57, s60, 41344
buffer_load_dwordx4 v231,s[36:39],s57 offen lds
ds_read_b64_tr_b16 v[200:201],v226 offset:14336
ds_read_b64_tr_b16 v[202:203],v226 offset:14592
s_waitcnt lgkmcnt(12)
v_mfma_f32_32x32x16_bf16 v[64:79],v[208:211],a[144:147],v[64:79]
ds_read_b64_tr_b16 v[204:205],v226 offset:14848
ds_read_b64_tr_b16 v[206:207],v226 offset:15104
s_waitcnt lgkmcnt(12)
v_mfma_f32_32x32x16_bf16 v[80:95],v[212:215],a[144:147],v[80:95]
s_add_u32 m0, s58, 75776
s_add_u32 s57, s60, 82304
buffer_load_dwordx4 v231,s[36:39],s57 offen lds
ds_read_b64_tr_b16 v[208:209],v226 offset:3072
ds_read_b64_tr_b16 v[210:211],v226 offset:3328
s_waitcnt lgkmcnt(12)
v_mfma_f32_32x32x16_bf16 v[0:15],v[216:219],a[148:151],v[0:15]
ds_read_b64_tr_b16 v[212:213],v226 offset:3584
ds_read_b64_tr_b16 v[214:215],v226 offset:3840
s_waitcnt lgkmcnt(12)
v_mfma_f32_32x32x16_bf16 v[16:31],v[220:223],a[148:151],v[16:31]
s_add_u32 m0, s58, 76800
s_add_u32 s57, s60, 123264
buffer_load_dwordx4 v231,s[36:39],s57 offen lds
ds_read_b64_tr_b16 v[216:217],v226 offset:4096
ds_read_b64_tr_b16 v[218:219],v226 offset:4352
s_waitcnt lgkmcnt(12)
v_mfma_f32_32x32x16_bf16 v[32:47],v[192:195],a[148:151],v[32:47]
ds_read_b64_tr_b16 v[220:221],v226 offset:4608
ds_read_b64_tr_b16 v[222:223],v226 offset:4864
s_waitcnt lgkmcnt(12)
v_mfma_f32_32x32x16_bf16 v[48:63],v[196:199],a[148:151],v[48:63]
s_add_u32 m0, s58, 77824
s_add_u32 s57, s60, 164224
buffer_load_dwordx4 v231,s[36:39],s57 offen lds
ds_read_b64_tr_b16 v[192:193],v226 offset:5120
ds_read_b64_tr_b16 v[194:195],v226 offset:5376
s_waitcnt lgkmcnt(12)
v_mfma_f32_32x32x16_bf16 v[64:79],v[200:203],a[148:151],v[64:79]
ds_read_b64_tr_b16 v[196:197],v226 offset:5632
ds_read_b64_tr_b16 v[198:199],v226 offset:5888
s_waitcnt lgkmcnt(12)
v_mfma_f32_32x32x16_bf16 v[80:95],v[204:207],a[148:151],v[80:95]
s_add_u32 m0, s58, 78848
s_add_u32 s57, s60, 205184
buffer_load_dwordx4 v231,s[36:39],s57 offen lds
ds_read_b64_tr_b16 v[200:201],v226 offset:15360
ds_read_b64_tr_b16 v[202:203],v226 offset:15616
s_waitcnt lgkmcnt(12)
v_mfma_f32_32x32x16_bf16 v[0:15],v[208:211],a[152:155],v[0:15]
ds_read_b64_tr_b16 v[204:205],v226 offset:15872
ds_read_b64_tr_b16 v[206:207],v226 offset:16128
s_waitcnt lgkmcnt(12)
v_mfma_f32_32x32x16_bf16 v[16:31],v[212:215],a[152:155],v[16:31]
ds_read_b64_tr_b16 v[208:209],v226 offset:16384
ds_read_b64_tr_b16 v[210:211],v226 offset:16640
s_waitcnt lgkmcnt(12)
v_mfma_f32_32x32x16_bf16 v[32:47],v[216:219],a[152:155],v[32:47]
s_cmp_eq_u32 s91, s61
s_cbranch_scc1 XL1_32
s_add_u32 s57, s91, 32768
buffer_load_dwordx4 a[128:131],v233,s[8:11],s57 offen
buffer_load_dwordx4 a[132:135],v233,s[8:11],s57 offen offset:1024
XL1_32:
ds_read_b64_tr_b16 v[212:213],v226 offset:16896
ds_read_b64_tr_b16 v[214:215],v226 offset:17152
s_waitcnt lgkmcnt(12)
v_mfma_f32_32x32x16_bf16 v[48:63],v[220:223],a[152:155],v[48:63]
ds_read_b64_tr_b16 v[216:217],v226 offset:17408
ds_read_b64_tr_b16 v[218:219],v226 offset:17664
s_waitcnt lgkmcnt(12)
v_mfma_f32_32x32x16_bf16 v[64:79],v[192:195],a[152:155],v[64:79]
ds_read_b64_tr_b16 v[220:221],v226 offset:17920
ds_read_b64_tr_b16 v[222:223],v226 offset:18176
s_waitcnt lgkmcnt(12)
v_mfma_f32_32x32x16_bf16 v[80:95],v[196:199],a[152:155],v[80:95]
s_waitcnt vmcnt(18)
s_barrier
ds_read_b64_tr_b16 v[192:193],v227 offset:0
ds_read_b64_tr_b16 v[194:195],v227 offset:6144
s_waitcnt lgkmcnt(12)
v_mfma_f32_32x32x16_bf16 v[0:15],v[200:203],a[156:159],v[0:15]
s_cmp_eq_u32 s91, s61
s_cbranch_scc1 XL1_34
s_add_u32 s57, s91, 34816
buffer_load_dwordx4 a[136:139],v233,s[8:11],s57 offen
buffer_load_dwordx4 a[140:143],v233,s[8:11],s57 offen offset:1024
XL1_34:
ds_read_b64_tr_b16 v[196:197],v227 offset:512
ds_read_b64_tr_b16 v[198:199],v227 offset:6656
s_waitcnt lgkmcnt(12)
v_mfma_f32_32x32x16_bf16 v[16:31],v[204:207],a[156:159],v[16:31]
ds_read_b64_tr_b16 v[200:201],v227 offset:12288
ds_read_b64_tr_b16 v[202:203],v227 offset:18432
s_waitcnt lgkmcnt(12)
v_mfma_f32_32x32x16_bf16 v[32:47],v[208:211],a[156:159],v[32:47]
ds_read_b64_tr_b16 v[204:205],v227 offset:12800
ds_read_b64_tr_b16 v[206:207],v227 offset:18944
s_waitcnt lgkmcnt(12)
v_mfma_f32_32x32x16_bf16 v[48:63],v[212:215],a[156:159],v[48:63]
ds_read_b64_tr_b16 v[208:209],v227 offset:1024
ds_read_b64_tr_b16 v[210:211],v227 offset:7168
s_waitcnt lgkmcnt(12)
v_mfma_f32_32x32x16_bf16 v[64:79],v[216:219],a[156:159],v[64:79]
ds_read_b64_tr_b16 v[212:213],v227 offset:1536
ds_read_b64_tr_b16 v[214:215],v227 offset:7680
s_waitcnt lgkmcnt(12)
v_mfma_f32_32x32x16_bf16 v[80:95],v[220:223],a[156:159],v[80:95]
s_nop 11
v_cvt_pk_bf16_f32 v96, v0, v1
v_cvt_pk_bf16_f32 v97, v2, v3
v_cvt_pk_bf16_f32 v98, v4, v5
v_cvt_pk_bf16_f32 v99, v6, v7
v_cvt_pk_bf16_f32 v100, v8, v9
v_cvt_pk_bf16_f32 v101, v10, v11
v_cvt_pk_bf16_f32 v102, v12, v13
v_cvt_pk_bf16_f32 v103, v14, v15
v_cvt_pk_bf16_f32 v104, v16, v17
v_cvt_pk_bf16_f32 v105, v18, v19
v_cvt_pk_bf16_f32 v106, v20, v21
v_cvt_pk_bf16_f32 v107, v22, v23
v_cvt_pk_bf16_f32 v108, v24, v25
v_cvt_pk_bf16_f32 v109, v26, v27
v_cvt_pk_bf16_f32 v110, v28, v29
v_cvt_pk_bf16_f32 v111, v30, v31
v_cvt_pk_bf16_f32 v112, v32, v33
v_cvt_pk_bf16_f32 v113, v34, v35
v_cvt_pk_bf16_f32 v114, v36, v37
v_cvt_pk_bf16_f32 v115, v38, v39
v_cvt_pk_bf16_f32 v116, v40, v41
v_cvt_pk_bf16_f32 v117, v42, v43
v_cvt_pk_bf16_f32 v118, v44, v45
v_cvt_pk_bf16_f32 v119, v46, v47
v_cvt_pk_bf16_f32 v120, v48, v49
v_cvt_pk_bf16_f32 v121, v50, v51
v_cvt_pk_bf16_f32 v122, v52, v53
v_cvt_pk_bf16_f32 v123, v54, v55
v_cvt_pk_bf16_f32 v124, v56, v57
v_cvt_pk_bf16_f32 v125, v58, v59
v_cvt_pk_bf16_f32 v126, v60, v61
v_cvt_pk_bf16_f32 v127, v62, v63
v_cvt_pk_bf16_f32 v128, v64, v65
v_cvt_pk_bf16_f32 v129, v66, v67
v_cvt_pk_bf16_f32 v130, v68, v69
v_cvt_pk_bf16_f32 v131, v70, v71
v_cvt_pk_bf16_f32 v132, v72, v73
v_cvt_pk_bf16_f32 v133, v74, v75
v_cvt_pk_bf16_f32 v134, v76, v77
v_cvt_pk_bf16_f32 v135, v78, v79
v_cvt_pk_bf16_f32 v136, v80, v81
v_cvt_pk_bf16_f32 v137, v82, v83
v_cvt_pk_bf16_f32 v138, v84, v85
v_cvt_pk_bf16_f32 v139, v86, v87
v_cvt_pk_bf16_f32 v140, v88, v89
v_cvt_pk_bf16_f32 v141, v90, v91
v_cvt_pk_bf16_f32 v142, v92, v93
v_cvt_pk_bf16_f32 v143, v94, v95
ds_read_b64_tr_b16 v[216:217],v227 offset:13312
ds_read_b64_tr_b16 v[218:219],v227 offset:19456
s_waitcnt lgkmcnt(12)
v_mfma_f32_32x32x16_bf16 v[0:15],v[96:99],v[192:195],0
ds_read_b64_tr_b16 v[220:221],v227 offset:13824
ds_read_b64_tr_b16 v[222:223],v227 offset:19968
s_waitcnt lgkmcnt(12)
v_mfma_f32_32x32x16_bf16 v[16:31],v[96:99],v[196:199],0
s_add_u32 m0, s58, 98304
s_add_u32 s57, s60, 512
buffer_load_dwordx4 v231,s[36:39],s57 offen lds
ds_read_b64_tr_b16 v[192:193],v227 offset:2048
ds_read_b64_tr_b16 v[194:195],v227 offset:8192
s_waitcnt lgkmcnt(12)
v_mfma_f32_32x32x16_bf16 v[0:15],v[100:103],v[200:203],v[0:15]
ds_read_b64_tr_b16 v[196:197],v227 offset:2560
ds_read_b64_tr_b16 v[198:199],v227 offset:8704
s_waitcnt lgkmcnt(12)
v_mfma_f32_32x32x16_bf16 v[16:31],v[100:103],v[204:207],v[16:31]
s_add_u32 m0, s58, 99328
s_add_u32 s57, s60, 41472
buffer_load_dwordx4 v231,s[36:39],s57 offen lds
ds_read_b64_tr_b16 v[200:201],v227 offset:14336
ds_read_b64_tr_b16 v[202:203],v227 offset:20480
s_waitcnt lgkmcnt(12)
v_mfma_f32_32x32x16_bf16 v[0:15],v[104:107],v[208:211],v[0:15]
ds_read_b64_tr_b16 v[204:205],v227 offset:14848
ds_read_b64_tr_b16 v[206:207],v227 offset:20992
s_waitcnt lgkmcnt(12)
v_mfma_f32_32x32x16_bf16 v[16:31],v[104:107],v[212:215],v[16:31]
s_add_u32 m0, s58, 100352
s_add_u32 s57, s60, 82432
buffer_load_dwordx4 v231,s[36:39],s57 offen lds
ds_read_b64_tr_b16 v[208:209],v227 offset:3072
ds_read_b64_tr_b16 v[210:211],v227 offset:9216
s_waitcnt lgkmcnt(12)
v_mfma_f32_32x32x16_bf16 v[0:15],v[108:111],v[216:219],v[0:15]
ds_read_b64_tr_b16 v[212:213],v227 offset:3584
ds_read_b64_tr_b16 v[214:215],v227 offset:9728
s_waitcnt lgkmcnt(12)
v_mfma_f32_32x32x16_bf16 v[16:31],v[108:111],v[220:223],v[16:31]
s_add_u32 m0, s58, 101376
s_add_u32 s57, s60, 123392
buffer_load_dwordx4 v231,s[36:39],s57 offen lds
ds_read_b64_tr_b16 v[216:217],v227 offset:15360
ds_read_b64_tr_b16 v[218:219],v227 offset:21504
s_waitcnt lgkmcnt(12)
v_mfma_f32_32x32x16_bf16 v[0:15],v[112:115],v[192:195],v[0:15]
ds_read_b64_tr_b16 v[220:221],v227 offset:15872
ds_read_b64_tr_b16 v[222:223],v227 offset:22016
s_waitcnt lgkmcnt(12)
v_mfma_f32_32x32x16_bf16 v[16:31],v[112:115],v[196:199],v[16:31]
s_add_u32 m0, s58, 102400
s_add_u32 s57, s60, 164352
buffer_load_dwordx4 v231,s[36:39],s57 offen lds
ds_read_b64_tr_b16 v[192:193],v227 offset:4096
ds_read_b64_tr_b16 v[194:195],v227 offset:10240
s_waitcnt lgkmcnt(12)
v_mfma_f32_32x32x16_bf16 v[0:15],v[116:119],v[200:203],v[0:15]
ds_read_b64_tr_b16 v[196:197],v227 offset:4608
ds_read_b64_tr_b16 v[198:199],v227 offset:10752
s_waitcnt lgkmcnt(12)
v_mfma_f32_32x32x16_bf16 v[16:31],v[116:119],v[204:207],v[16:31]
s_add_u32 m0, s58, 103424
s_add_u32 s57, s60, 205312
buffer_load_dwordx4 v231,s[36:39],s57 offen lds
ds_read_b64_tr_b16 v[200:201],v227 offset:16384
ds_read_b64_tr_b16 v[202:203],v227 offset:22528
s_waitcnt lgkmcnt(12)
v_mfma_f32_32x32x16_bf16 v[0:15],v[120:123],v[208:211],v[0:15]
ds_read_b64_tr_b16 v[204:205],v227 offset:16896
ds_read_b64_tr_b16 v[206:207],v227 offset:23040
s_waitcnt lgkmcnt(12)
v_mfma_f32_32x32x16_bf16 v[16:31],v[120:123],v[212:215],v[16:31]
ds_read_b64_tr_b16 v[208:209],v227 offset:5120
ds_read_b64_tr_b16 v[210:211],v227 offset:11264
s_waitcnt lgkmcnt(12)
v_mfma_f32_32x32x16_bf16 v[0:15],v[124:127],v[216:219],v[0:15]
s_cmp_eq_u32 s91, s61
s_cbranch_scc1 XL1_36
s_add_u32 s57, s91, 36864
buffer_load_dwordx4 a[144:147],v233,s[8:11],s57 offen
buffer_load_dwordx4 a[148:151],v233,s[8:11],s57 offen offset:1024
XL1_36:
ds_read_b64_tr_b16 v[212:213],v227 offset:5632
ds_read_b64_tr_b16 v[214:215],v227 offset:11776
s_waitcnt lgkmcnt(12)
v_mfma_f32_32x32x16_bf16 v[16:31],v[124:127],v[220:223],v[16:31]
ds_read_b64_tr_b16 v[216:217],v227 offset:17408
ds_read_b64_tr_b16 v[218:219],v227 offset:23552
s_waitcnt lgkmcnt(12)
v_mfma_f32_32x32x16_bf16 v[0:15],v[128:131],v[192:195],v[0:15]
ds_read_b64_tr_b16 v[220:221],v227 offset:17920
ds_read_b64_tr_b16 v[222:223],v227 offset:24064
s_waitcnt lgkmcnt(12)
v_mfma_f32_32x32x16_bf16 v[16:31],v[128:131],v[196:199],v[16:31]
s_waitcnt vmcnt(18)
s_barrier
ds_read_b64_tr_b16 v[192:193],v227 offset:24576
ds_read_b64_tr_b16 v[194:195],v227 offset:30720
s_waitcnt lgkmcnt(12)
v_mfma_f32_32x32x16_bf16 v[0:15],v[132:135],v[200:203],v[0:15]
s_cmp_eq_u32 s91, s61
s_cbranch_scc1 XL1_38
s_add_u32 s57, s91, 38912
buffer_load_dwordx4 a[152:155],v233,s[8:11],s57 offen
buffer_load_dwordx4 a[156:159],v233,s[8:11],s57 offen offset:1024
XL1_38:
ds_read_b64_tr_b16 v[196:197],v227 offset:25088
ds_read_b64_tr_b16 v[198:199],v227 offset:31232
s_waitcnt lgkmcnt(12)
v_mfma_f32_32x32x16_bf16 v[16:31],v[132:135],v[204:207],v[16:31]
ds_read_b64_tr_b16 v[200:201],v227 offset:36864
ds_read_b64_tr_b16 v[202:203],v227 offset:43008
s_waitcnt lgkmcnt(12)
v_mfma_f32_32x32x16_bf16 v[0:15],v[136:139],v[208:211],v[0:15]
ds_read_b64_tr_b16 v[204:205],v227 offset:37376
ds_read_b64_tr_b16 v[206:207],v227 offset:43520
s_waitcnt lgkmcnt(12)
v_mfma_f32_32x32x16_bf16 v[16:31],v[136:139],v[212:215],v[16:31]
ds_read_b64_tr_b16 v[208:209],v227 offset:25600
ds_read_b64_tr_b16 v[210:211],v227 offset:31744
s_waitcnt lgkmcnt(12)
v_mfma_f32_32x32x16_bf16 v[0:15],v[140:143],v[216:219],v[0:15]
ds_read_b64_tr_b16 v[212:213],v227 offset:26112
ds_read_b64_tr_b16 v[214:215],v227 offset:32256
s_waitcnt lgkmcnt(12)
v_mfma_f32_32x32x16_bf16 v[16:31],v[140:143],v[220:223],v[16:31]
ds_read_b64_tr_b16 v[216:217],v227 offset:37888
ds_read_b64_tr_b16 v[218:219],v227 offset:44032
s_waitcnt lgkmcnt(12)
v_mfma_f32_32x32x16_bf16 v[32:47],v[96:99],v[192:195],0
ds_read_b64_tr_b16 v[220:221],v227 offset:38400
ds_read_b64_tr_b16 v[222:223],v227 offset:44544
s_waitcnt lgkmcnt(12)
v_mfma_f32_32x32x16_bf16 v[48:63],v[96:99],v[196:199],0
s_add_u32 m0, s58, 0
s_add_u32 s57, s60, 640
buffer_load_dwordx4 v231,s[36:39],s57 offen lds
ds_read_b64_tr_b16 v[192:193],v227 offset:26624
ds_read_b64_tr_b16 v[194:195],v227 offset:32768
s_waitcnt lgkmcnt(12)
v_mfma_f32_32x32x16_bf16 v[32:47],v[100:103],v[200:203],v[32:47]
ds_read_b64_tr_b16 v[196:197],v227 offset:27136
ds_read_b64_tr_b16 v[198:199],v227 offset:33280
s_waitcnt lgkmcnt(12)
v_mfma_f32_32x32x16_bf16 v[48:63],v[100:103],v[204:207],v[48:63]
s_add_u32 m0, s58, 1024
s_add_u32 s57, s60, 41600
buffer_load_dwordx4 v231,s[36:39],s57 offen lds
ds_read_b64_tr_b16 v[200:201],v227 offset:38912
ds_read_b64_tr_b16 v[202:203],v227 offset:45056
s_waitcnt lgkmcnt(12)
v_mfma_f32_32x32x16_bf16 v[32:47],v[104:107],v[208:211],v[32:47]
ds_read_b64_tr_b16 v[204:205],v227 offset:39424
ds_read_b64_tr_b16 v[206:207],v227 offset:45568
s_waitcnt lgkmcnt(12)
v_mfma_f32_32x32x16_bf16 v[48:63],v[104:107],v[212:215],v[48:63]
s_add_u32 m0, s58, 2048
s_add_u32 s57, s60, 82560
buffer_load_dwordx4 v231,s[36:39],s57 offen lds
ds_read_b64_tr_b16 v[208:209],v227 offset:27648
ds_read_b64_tr_b16 v[210:211],v227 offset:33792
s_waitcnt lgkmcnt(12)
v_mfma_f32_32x32x16_bf16 v[32:47],v[108:111],v[216:219],v[32:47]
ds_read_b64_tr_b16 v[212:213],v227 offset:28160
ds_read_b64_tr_b16 v[214:215],v227 offset:34304
s_waitcnt lgkmcnt(12)
v_mfma_f32_32x32x16_bf16 v[48:63],v[108:111],v[220:223],v[48:63]
s_add_u32 m0, s58, 3072
s_add_u32 s57, s60, 123520
buffer_load_dwordx4 v231,s[36:39],s57 offen lds
ds_read_b64_tr_b16 v[216:217],v227 offset:39936
ds_read_b64_tr_b16 v[218:219],v227 offset:46080
s_waitcnt lgkmcnt(12)
v_mfma_f32_32x32x16_bf16 v[32:47],v[112:115],v[192:195],v[32:47]
v_cvt_pk_bf16_f32 v144, v0, v1
v_cvt_pk_bf16_f32 v145, v2, v3
v_cvt_pk_bf16_f32 v146, v4, v5
v_cvt_pk_bf16_f32 v147, v6, v7
v_cvt_pk_bf16_f32 v148, v8, v9
v_cvt_pk_bf16_f32 v149, v10, v11
v_cvt_pk_bf16_f32 v150, v12, v13
v_cvt_pk_bf16_f32 v151, v14, v15
s_add_u32 s57, s67, 0
buffer_store_dwordx4 v[144:147],v234,s[8:11],s57 offen sc1
buffer_store_dwordx4 v[148:151],v234,s[8:11],s57 offen offset:256 sc1
v_cvt_pk_bf16_f32 v152, v16, v17
v_cvt_pk_bf16_f32 v153, v18, v19
v_cvt_pk_bf16_f32 v154, v20, v21
v_cvt_pk_bf16_f32 v155, v22, v23
v_cvt_pk_bf16_f32 v156, v24, v25
v_cvt_pk_bf16_f32 v157, v26, v27
v_cvt_pk_bf16_f32 v158, v28, v29
v_cvt_pk_bf16_f32 v159, v30, v31
s_add_u32 s57, s67, 82944
buffer_store_dwordx4 v[152:155],v234,s[8:11],s57 offen sc1
buffer_store_dwordx4 v[156:159],v234,s[8:11],s57 offen offset:256 sc1
ds_read_b64_tr_b16 v[220:221],v227 offset:40448
ds_read_b64_tr_b16 v[222:223],v227 offset:46592
s_waitcnt lgkmcnt(12)
v_mfma_f32_32x32x16_bf16 v[48:63],v[112:115],v[196:199],v[48:63]
s_add_u32 m0, s58, 4096
s_add_u32 s57, s60, 164480
buffer_load_dwordx4 v231,s[36:39],s57 offen lds
ds_read_b64_tr_b16 v[192:193],v227 offset:28672
ds_read_b64_tr_b16 v[194:195],v227 offset:34816
s_waitcnt lgkmcnt(12)
v_mfma_f32_32x32x16_bf16 v[32:47],v[116:119],v[200:203],v[32:47]
ds_read_b64_tr_b16 v[196:197],v227 offset:29184
ds_read_b64_tr_b16 v[198:199],v227 offset:35328
s_waitcnt lgkmcnt(12)
v_mfma_f32_32x32x16_bf16 v[48:63],v[116:119],v[204:207],v[48:63]
s_add_u32 m0, s58, 5120
s_add_u32 s57, s60, 205440
buffer_load_dwordx4 v231,s[36:39],s57 offen lds
ds_read_b64_tr_b16 v[200:201],v227 offset:40960
ds_read_b64_tr_b16 v[202:203],v227 offset:47104
s_waitcnt lgkmcnt(12)
v_mfma_f32_32x32x16_bf16 v[32:47],v[120:123],v[208:211],v[32:47]
ds_read_b64_tr_b16 v[204:205],v227 offset:41472
ds_read_b64_tr_b16 v[206:207],v227 offset:47616
s_waitcnt lgkmcnt(12)
v_mfma_f32_32x32x16_bf16 v[48:63],v[120:123],v[212:215],v[48:63]
ds_read_b64_tr_b16 v[208:209],v227 offset:29696
ds_read_b64_tr_b16 v[210:211],v227 offset:35840
s_waitcnt lgkmcnt(12)
v_mfma_f32_32x32x16_bf16 v[32:47],v[124:127],v[216:219],v[32:47]
ds_read_b64_tr_b16 v[212:213],v227 offset:30208
ds_read_b64_tr_b16 v[214:215],v227 offset:36352
s_waitcnt lgkmcnt(12)
v_mfma_f32_32x32x16_bf16 v[48:63],v[124:127],v[220:223],v[48:63]
ds_read_b64_tr_b16 v[216:217],v227 offset:41984
ds_read_b64_tr_b16 v[218:219],v227 offset:48128
s_waitcnt lgkmcnt(12)
v_mfma_f32_32x32x16_bf16 v[32:47],v[128:131],v[192:195],v[32:47]
ds_read_b64_tr_b16 v[220:221],v227 offset:42496
ds_read_b64_tr_b16 v[222:223],v227 offset:48640
s_waitcnt lgkmcnt(12)
v_mfma_f32_32x32x16_bf16 v[48:63],v[128:131],v[196:199],v[48:63]
s_waitcnt vmcnt(22)
s_barrier
ds_read_b64_tr_b16 v[192:193],v228 offset:0
ds_read_b64_tr_b16 v[194:195],v228 offset:6144
s_waitcnt lgkmcnt(12)
v_mfma_f32_32x32x16_bf16 v[32:47],v[132:135],v[200:203],v[32:47]
ds_read_b64_tr_b16 v[196:197],v228 offset:512
ds_read_b64_tr_b16 v[198:199],v228 offset:6656
s_waitcnt lgkmcnt(12)
v_mfma_f32_32x32x16_bf16 v[48:63],v[132:135],v[204:207],v[48:63]
ds_read_b64_tr_b16 v[200:201],v228 offset:12288
ds_read_b64_tr_b16 v[202:203],v228 offset:18432
s_waitcnt lgkmcnt(12)
v_mfma_f32_32x32x16_bf16 v[32:47],v[136:139],v[208:211],v[32:47]
ds_read_b64_tr_b16 v[204:205],v228 offset:12800
ds_read_b64_tr_b16 v[206:207],v228 offset:18944
s_waitcnt lgkmcnt(12)
v_mfma_f32_32x32x16_bf16 v[48:63],v[136:139],v[212:215],v[48:63]
ds_read_b64_tr_b16 v[208:209],v228 offset:1024
ds_read_b64_tr_b16 v[210:211],v228 offset:7168
s_waitcnt lgkmcnt(12)
v_mfma_f32_32x32x16_bf16 v[32:47],v[140:143],v[216:219],v[32:47]
ds_read_b64_tr_b16 v[212:213],v228 offset:1536
ds_read_b64_tr_b16 v[214:215],v228 offset:7680
s_waitcnt lgkmcnt(12)
v_mfma_f32_32x32x16_bf16 v[48:63],v[140:143],v[220:223],v[48:63]
ds_read_b64_tr_b16 v[216:217],v228 offset:13312
ds_read_b64_tr_b16 v[218:219],v228 offset:19456
s_waitcnt lgkmcnt(12)
v_mfma_f32_32x32x16_bf16 v[0:15],v[96:99],v[192:195],0
ds_read_b64_tr_b16 v[220:221],v228 offset:13824
ds_read_b64_tr_b16 v[222:223],v228 offset:19968
s_waitcnt lgkmcnt(12)
v_mfma_f32_32x32x16_bf16 v[16:31],v[96:99],v[196:199],0
s_add_u32 m0, s58, 24576
s_add_u32 s57, s60, 768
buffer_load_dwordx4 v231,s[36:39],s57 offen lds
ds_read_b64_tr_b16 v[192:193],v228 offset:2048
ds_read_b64_tr_b16 v[194:195],v228 offset:8192
s_waitcnt lgkmcnt(12)
v_mfma_f32_32x32x16_bf16 v[0:15],v[100:103],v[200:203],v[0:15]
ds_read_b64_tr_b16 v[196:197],v228 offset:2560
ds_read_b64_tr_b16 v[198:199],v228 offset:8704
s_waitcnt lgkmcnt(12)
v_mfma_f32_32x32x16_bf16 v[16:31],v[100:103],v[204:207],v[16:31]
s_add_u32 m0, s58, 25600
s_add_u32 s57, s60, 41728
buffer_load_dwordx4 v231,s[36:39],s57 offen lds
ds_read_b64_tr_b16 v[200:201],v228 offset:14336
ds_read_b64_tr_b16 v[202:203],v228 offset:20480
s_waitcnt lgkmcnt(12)
v_mfma_f32_32x32x16_bf16 v[0:15],v[104:107],v[208:211],v[0:15]
ds_read_b64_tr_b16 v[204:205],v228 offset:14848
ds_read_b64_tr_b16 v[206:207],v228 offset:20992
s_waitcnt lgkmcnt(12)
v_mfma_f32_32x32x16_bf16 v[16:31],v[104:107],v[212:215],v[16:31]
s_add_u32 m0, s58, 26624
s_add_u32 s57, s60, 82688
buffer_load_dwordx4 v231,s[36:39],s57 offen lds
ds_read_b64_tr_b16 v[208:209],v228 offset:3072
ds_read_b64_tr_b16 v[210:211],v228 offset:9216
s_waitcnt lgkmcnt(12)
v_mfma_f32_32x32x16_bf16 v[0:15],v[108:111],v[216:219],v[0:15]
ds_read_b64_tr_b16 v[212:213],v228 offset:3584
ds_read_b64_tr_b16 v[214:215],v228 offset:9728
s_waitcnt lgkmcnt(12)
v_mfma_f32_32x32x16_bf16 v[16:31],v[108:111],v[220:223],v[16:31]
s_add_u32 m0, s58, 27648
s_add_u32 s57, s60, 123648
buffer_load_dwordx4 v231,s[36:39],s57 offen lds
ds_read_b64_tr_b16 v[216:217],v228 offset:15360
ds_read_b64_tr_b16 v[218:219],v228 offset:21504
s_waitcnt lgkmcnt(12)
v_mfma_f32_32x32x16_bf16 v[0:15],v[112:115],v[192:195],v[0:15]
v_cvt_pk_bf16_f32 v144, v32, v33
v_cvt_pk_bf16_f32 v145, v34, v35
v_cvt_pk_bf16_f32 v146, v36, v37
v_cvt_pk_bf16_f32 v147, v38, v39
v_cvt_pk_bf16_f32 v148, v40, v41
v_cvt_pk_bf16_f32 v149, v42, v43
v_cvt_pk_bf16_f32 v150, v44, v45
v_cvt_pk_bf16_f32 v151, v46, v47
s_add_u32 s57, s67, 165888
buffer_store_dwordx4 v[144:147],v234,s[8:11],s57 offen sc1
buffer_store_dwordx4 v[148:151],v234,s[8:11],s57 offen offset:256 sc1
v_cvt_pk_bf16_f32 v152, v48, v49
v_cvt_pk_bf16_f32 v153, v50, v51
v_cvt_pk_bf16_f32 v154, v52, v53
v_cvt_pk_bf16_f32 v155, v54, v55
v_cvt_pk_bf16_f32 v156, v56, v57
v_cvt_pk_bf16_f32 v157, v58, v59
v_cvt_pk_bf16_f32 v158, v60, v61
v_cvt_pk_bf16_f32 v159, v62, v63
s_add_u32 s57, s67, 248832
buffer_store_dwordx4 v[152:155],v234,s[8:11],s57 offen sc1
buffer_store_dwordx4 v[156:159],v234,s[8:11],s57 offen offset:256 sc1
ds_read_b64_tr_b16 v[220:221],v228 offset:15872
ds_read_b64_tr_b16 v[222:223],v228 offset:22016
s_waitcnt lgkmcnt(12)
v_mfma_f32_32x32x16_bf16 v[16:31],v[112:115],v[196:199],v[16:31]
s_add_u32 m0, s58, 28672
s_add_u32 s57, s60, 164608
buffer_load_dwordx4 v231,s[36:39],s57 offen lds
ds_read_b64_tr_b16 v[192:193],v228 offset:4096
ds_read_b64_tr_b16 v[194:195],v228 offset:10240
s_waitcnt lgkmcnt(12)
v_mfma_f32_32x32x16_bf16 v[0:15],v[116:119],v[200:203],v[0:15]
ds_read_b64_tr_b16 v[196:197],v228 offset:4608
ds_read_b64_tr_b16 v[198:199],v228 offset:10752
s_waitcnt lgkmcnt(12)
v_mfma_f32_32x32x16_bf16 v[16:31],v[116:119],v[204:207],v[16:31]
s_add_u32 m0, s58, 29696
s_add_u32 s57, s60, 205568
buffer_load_dwordx4 v231,s[36:39],s57 offen lds
ds_read_b64_tr_b16 v[200:201],v228 offset:16384
ds_read_b64_tr_b16 v[202:203],v228 offset:22528
s_waitcnt lgkmcnt(12)
v_mfma_f32_32x32x16_bf16 v[0:15],v[120:123],v[208:211],v[0:15]
ds_read_b64_tr_b16 v[204:205],v228 offset:16896
ds_read_b64_tr_b16 v[206:207],v228 offset:23040
s_waitcnt lgkmcnt(12)
v_mfma_f32_32x32x16_bf16 v[16:31],v[120:123],v[212:215],v[16:31]
ds_read_b64_tr_b16 v[208:209],v228 offset:5120
ds_read_b64_tr_b16 v[210:211],v228 offset:11264
s_waitcnt lgkmcnt(12)
v_mfma_f32_32x32x16_bf16 v[0:15],v[124:127],v[216:219],v[0:15]
ds_read_b64_tr_b16 v[212:213],v228 offset:5632
ds_read_b64_tr_b16 v[214:215],v228 offset:11776
s_waitcnt lgkmcnt(12)
v_mfma_f32_32x32x16_bf16 v[16:31],v[124:127],v[220:223],v[16:31]
ds_read_b64_tr_b16 v[216:217],v228 offset:17408
ds_read_b64_tr_b16 v[218:219],v228 offset:23552
s_waitcnt lgkmcnt(12)
v_mfma_f32_32x32x16_bf16 v[0:15],v[128:131],v[192:195],v[0:15]
ds_read_b64_tr_b16 v[220:221],v228 offset:17920
ds_read_b64_tr_b16 v[222:223],v228 offset:24064
s_waitcnt lgkmcnt(12)
v_mfma_f32_32x32x16_bf16 v[16:31],v[128:131],v[196:199],v[16:31]
s_waitcnt vmcnt(26)
s_barrier
ds_read_b64_tr_b16 v[192:193],v228 offset:24576
ds_read_b64_tr_b16 v[194:195],v228 offset:30720
s_waitcnt lgkmcnt(12)
v_mfma_f32_32x32x16_bf16 v[0:15],v[132:135],v[200:203],v[0:15]
ds_read_b64_tr_b16 v[196:197],v228 offset:25088
ds_read_b64_tr_b16 v[198:199],v228 offset:31232
s_waitcnt lgkmcnt(12)
v_mfma_f32_32x32x16_bf16 v[16:31],v[132:135],v[204:207],v[16:31]
ds_read_b64_tr_b16 v[200:201],v228 offset:36864
ds_read_b64_tr_b16 v[202:203],v228 offset:43008
s_waitcnt lgkmcnt(12)
v_mfma_f32_32x32x16_bf16 v[0:15],v[136:139],v[208:211],v[0:15]
ds_read_b64_tr_b16 v[204:205],v228 offset:37376
ds_read_b64_tr_b16 v[206:207],v228 offset:43520
s_waitcnt lgkmcnt(12)
v_mfma_f32_32x32x16_bf16 v[16:31],v[136:139],v[212:215],v[16:31]
ds_read_b64_tr_b16 v[208:209],v228 offset:25600
ds_read_b64_tr_b16 v[210:211],v228 offset:31744
s_waitcnt lgkmcnt(12)
v_mfma_f32_32x32x16_bf16 v[0:15],v[140:143],v[216:219],v[0:15]
ds_read_b64_tr_b16 v[212:213],v228 offset:26112
ds_read_b64_tr_b16 v[214:215],v228 offset:32256
s_waitcnt lgkmcnt(12)
v_mfma_f32_32x32x16_bf16 v[16:31],v[140:143],v[220:223],v[16:31]
ds_read_b64_tr_b16 v[216:217],v228 offset:37888
ds_read_b64_tr_b16 v[218:219],v228 offset:44032
s_waitcnt lgkmcnt(12)
v_mfma_f32_32x32x16_bf16 v[32:47],v[96:99],v[192:195],0
ds_read_b64_tr_b16 v[220:221],v228 offset:38400
ds_read_b64_tr_b16 v[222:223],v228 offset:44544
s_waitcnt lgkmcnt(12)
v_mfma_f32_32x32x16_bf16 v[48:63],v[96:99],v[196:199],0
s_add_u32 m0, s58, 49152
s_add_u32 s57, s60, 896
buffer_load_dwordx4 v231,s[36:39],s57 offen lds
ds_read_b64_tr_b16 v[192:193],v228 offset:26624
ds_read_b64_tr_b16 v[194:195],v228 offset:32768
s_waitcnt lgkmcnt(12)
v_mfma_f32_32x32x16_bf16 v[32:47],v[100:103],v[200:203],v[32:47]
ds_read_b64_tr_b16 v[196:197],v228 offset:27136
ds_read_b64_tr_b16 v[198:199],v228 offset:33280
s_waitcnt lgkmcnt(12)
v_mfma_f32_32x32x16_bf16 v[48:63],v[100:103],v[204:207],v[48:63]
s_add_u32 m0, s58, 50176
s_add_u32 s57, s60, 41856
buffer_load_dwordx4 v231,s[36:39],s57 offen lds
ds_read_b64_tr_b16 v[200:201],v228 offset:38912
ds_read_b64_tr_b16 v[202:203],v228 offset:45056
s_waitcnt lgkmcnt(12)
v_mfma_f32_32x32x16_bf16 v[32:47],v[104:107],v[208:211],v[32:47]
ds_read_b64_tr_b16 v[204:205],v228 offset:39424
ds_read_b64_tr_b16 v[206:207],v228 offset:45568
s_waitcnt lgkmcnt(12)
v_mfma_f32_32x32x16_bf16 v[48:63],v[104:107],v[212:215],v[48:63]
s_add_u32 m0, s58, 51200
s_add_u32 s57, s60, 82816
buffer_load_dwordx4 v231,s[36:39],s57 offen lds
ds_read_b64_tr_b16 v[208:209],v228 offset:27648
ds_read_b64_tr_b16 v[210:211],v228 offset:33792
s_waitcnt lgkmcnt(12)
v_mfma_f32_32x32x16_bf16 v[32:47],v[108:111],v[216:219],v[32:47]
ds_read_b64_tr_b16 v[212:213],v228 offset:28160
ds_read_b64_tr_b16 v[214:215],v228 offset:34304
s_waitcnt lgkmcnt(12)
v_mfma_f32_32x32x16_bf16 v[48:63],v[108:111],v[220:223],v[48:63]
s_add_u32 m0, s58, 52224
s_add_u32 s57, s60, 123776
buffer_load_dwordx4 v231,s[36:39],s57 offen lds
ds_read_b64_tr_b16 v[216:217],v228 offset:39936
ds_read_b64_tr_b16 v[218:219],v228 offset:46080
s_waitcnt lgkmcnt(12)
v_mfma_f32_32x32x16_bf16 v[32:47],v[112:115],v[192:195],v[32:47]
v_cvt_pk_bf16_f32 v144, v0, v1
v_cvt_pk_bf16_f32 v145, v2, v3
v_cvt_pk_bf16_f32 v146, v4, v5
v_cvt_pk_bf16_f32 v147, v6, v7
v_cvt_pk_bf16_f32 v148, v8, v9
v_cvt_pk_bf16_f32 v149, v10, v11
v_cvt_pk_bf16_f32 v150, v12, v13
v_cvt_pk_bf16_f32 v151, v14, v15
s_add_u32 s57, s67, 331776
buffer_store_dwordx4 v[144:147],v234,s[8:11],s57 offen sc1
buffer_store_dwordx4 v[148:151],v234,s[8:11],s57 offen offset:256 sc1
v_cvt_pk_bf16_f32 v152, v16, v17
v_cvt_pk_bf16_f32 v153, v18, v19
v_cvt_pk_bf16_f32 v154, v20, v21
v_cvt_pk_bf16_f32 v155, v22, v23
v_cvt_pk_bf16_f32 v156, v24, v25
v_cvt_pk_bf16_f32 v157, v26, v27
v_cvt_pk_bf16_f32 v158, v28, v29
v_cvt_pk_bf16_f32 v159, v30, v31
s_add_u32 s57, s67, 414720
buffer_store_dwordx4 v[152:155],v234,s[8:11],s57 offen sc1
buffer_store_dwordx4 v[156:159],v234,s[8:11],s57 offen offset:256 sc1
ds_read_b64_tr_b16 v[220:221],v228 offset:40448
ds_read_b64_tr_b16 v[222:223],v228 offset:46592
s_waitcnt lgkmcnt(12)
v_mfma_f32_32x32x16_bf16 v[48:63],v[112:115],v[196:199],v[48:63]
s_add_u32 m0, s58, 53248
s_add_u32 s57, s60, 164736
buffer_load_dwordx4 v231,s[36:39],s57 offen lds
ds_read_b64_tr_b16 v[192:193],v228 offset:28672
ds_read_b64_tr_b16 v[194:195],v228 offset:34816
s_waitcnt lgkmcnt(12)
v_mfma_f32_32x32x16_bf16 v[32:47],v[116:119],v[200:203],v[32:47]
ds_read_b64_tr_b16 v[196:197],v228 offset:29184
ds_read_b64_tr_b16 v[198:199],v228 offset:35328
s_waitcnt lgkmcnt(12)
v_mfma_f32_32x32x16_bf16 v[48:63],v[116:119],v[204:207],v[48:63]
s_add_u32 m0, s58, 54272
s_add_u32 s57, s60, 205696
buffer_load_dwordx4 v231,s[36:39],s57 offen lds
ds_read_b64_tr_b16 v[200:201],v228 offset:40960
ds_read_b64_tr_b16 v[202:203],v228 offset:47104
s_waitcnt lgkmcnt(12)
v_mfma_f32_32x32x16_bf16 v[32:47],v[120:123],v[208:211],v[32:47]
ds_read_b64_tr_b16 v[204:205],v228 offset:41472
ds_read_b64_tr_b16 v[206:207],v228 offset:47616
s_waitcnt lgkmcnt(12)
v_mfma_f32_32x32x16_bf16 v[48:63],v[120:123],v[212:215],v[48:63]
ds_read_b64_tr_b16 v[208:209],v228 offset:29696
ds_read_b64_tr_b16 v[210:211],v228 offset:35840
s_waitcnt lgkmcnt(12)
v_mfma_f32_32x32x16_bf16 v[32:47],v[124:127],v[216:219],v[32:47]
ds_read_b64_tr_b16 v[212:213],v228 offset:30208
ds_read_b64_tr_b16 v[214:215],v228 offset:36352
s_waitcnt lgkmcnt(12)
v_mfma_f32_32x32x16_bf16 v[48:63],v[124:127],v[220:223],v[48:63]
ds_read_b64_tr_b16 v[216:217],v228 offset:41984
ds_read_b64_tr_b16 v[218:219],v228 offset:48128
s_waitcnt lgkmcnt(12)
v_mfma_f32_32x32x16_bf16 v[32:47],v[128:131],v[192:195],v[32:47]
ds_read_b64_tr_b16 v[220:221],v228 offset:42496
ds_read_b64_tr_b16 v[222:223],v228 offset:48640
s_waitcnt lgkmcnt(12)
v_mfma_f32_32x32x16_bf16 v[48:63],v[128:131],v[196:199],v[48:63]
s_waitcnt vmcnt(30)
s_barrier
ds_read_b64_tr_b16 v[192:193],v229 offset:0
ds_read_b64_tr_b16 v[194:195],v229 offset:6144
s_waitcnt lgkmcnt(12)
v_mfma_f32_32x32x16_bf16 v[32:47],v[132:135],v[200:203],v[32:47]
ds_read_b64_tr_b16 v[196:197],v229 offset:512
ds_read_b64_tr_b16 v[198:199],v229 offset:6656
s_waitcnt lgkmcnt(12)
v_mfma_f32_32x32x16_bf16 v[48:63],v[132:135],v[204:207],v[48:63]
ds_read_b64_tr_b16 v[200:201],v229 offset:12288
ds_read_b64_tr_b16 v[202:203],v229 offset:18432
s_waitcnt lgkmcnt(12)
v_mfma_f32_32x32x16_bf16 v[32:47],v[136:139],v[208:211],v[32:47]
ds_read_b64_tr_b16 v[204:205],v229 offset:12800
ds_read_b64_tr_b16 v[206:207],v229 offset:18944
s_waitcnt lgkmcnt(12)
v_mfma_f32_32x32x16_bf16 v[48:63],v[136:139],v[212:215],v[48:63]
ds_read_b64_tr_b16 v[208:209],v229 offset:1024
ds_read_b64_tr_b16 v[210:211],v229 offset:7168
s_waitcnt lgkmcnt(12)
v_mfma_f32_32x32x16_bf16 v[32:47],v[140:143],v[216:219],v[32:47]
ds_read_b64_tr_b16 v[212:213],v229 offset:1536
ds_read_b64_tr_b16 v[214:215],v229 offset:7680
s_waitcnt lgkmcnt(12)
v_mfma_f32_32x32x16_bf16 v[48:63],v[140:143],v[220:223],v[48:63]
ds_read_b64_tr_b16 v[216:217],v229 offset:13312
ds_read_b64_tr_b16 v[218:219],v229 offset:19456
s_waitcnt lgkmcnt(12)
v_mfma_f32_32x32x16_bf16 v[0:15],v[96:99],v[192:195],0
ds_read_b64_tr_b16 v[220:221],v229 offset:13824
ds_read_b64_tr_b16 v[222:223],v229 offset:19968
s_waitcnt lgkmcnt(12)
v_mfma_f32_32x32x16_bf16 v[16:31],v[96:99],v[196:199],0
s_add_u32 m0, s58, 73728
s_add_u32 s57, s60, 1024
buffer_load_dwordx4 v231,s[36:39],s57 offen lds
ds_read_b64_tr_b16 v[192:193],v229 offset:2048
ds_read_b64_tr_b16 v[194:195],v229 offset:8192
s_waitcnt lgkmcnt(12)
v_mfma_f32_32x32x16_bf16 v[0:15],v[100:103],v[200:203],v[0:15]
ds_read_b64_tr_b16 v[196:197],v229 offset:2560
ds_read_b64_tr_b16 v[198:199],v229 offset:8704
s_waitcnt lgkmcnt(12)
v_mfma_f32_32x32x16_bf16 v[16:31],v[100:103],v[204:207],v[16:31]
s_add_u32 m0, s58, 74752
s_add_u32 s57, s60, 41984
buffer_load_dwordx4 v231,s[36:39],s57 offen lds
ds_read_b64_tr_b16 v[200:201],v229 offset:14336
ds_read_b64_tr_b16 v[202:203],v229 offset:20480
s_waitcnt lgkmcnt(12)
v_mfma_f32_32x32x16_bf16 v[0:15],v[104:107],v[208:211],v[0:15]
ds_read_b64_tr_b16 v[204:205],v229 offset:14848
ds_read_b64_tr_b16 v[206:207],v229 offset:20992
s_waitcnt lgkmcnt(12)
v_mfma_f32_32x32x16_bf16 v[16:31],v[104:107],v[212:215],v[16:31]
s_add_u32 m0, s58, 75776
s_add_u32 s57, s60, 82944
buffer_load_dwordx4 v231,s[36:39],s57 offen lds
ds_read_b64_tr_b16 v[208:209],v229 offset:3072
ds_read_b64_tr_b16 v[210:211],v229 offset:9216
s_waitcnt lgkmcnt(12)
v_mfma_f32_32x32x16_bf16 v[0:15],v[108:111],v[216:219],v[0:15]
ds_read_b64_tr_b16 v[212:213],v229 offset:3584
ds_read_b64_tr_b16 v[214:215],v229 offset:9728
s_waitcnt lgkmcnt(12)
v_mfma_f32_32x32x16_bf16 v[16:31],v[108:111],v[220:223],v[16:31]
s_add_u32 m0, s58, 76800
s_add_u32 s57, s60, 123904
buffer_load_dwordx4 v231,s[36:39],s57 offen lds
ds_read_b64_tr_b16 v[216:217],v229 offset:15360
ds_read_b64_tr_b16 v[218:219],v229 offset:21504
s_waitcnt lgkmcnt(12)
v_mfma_f32_32x32x16_bf16 v[0:15],v[112:115],v[192:195],v[0:15]
v_cvt_pk_bf16_f32 v144, v32, v33
v_cvt_pk_bf16_f32 v145, v34, v35
v_cvt_pk_bf16_f32 v146, v36, v37
v_cvt_pk_bf16_f32 v147, v38, v39
v_cvt_pk_bf16_f32 v148, v40, v41
v_cvt_pk_bf16_f32 v149, v42, v43
v_cvt_pk_bf16_f32 v150, v44, v45
v_cvt_pk_bf16_f32 v151, v46, v47
s_add_u32 s57, s67, 497664
buffer_store_dwordx4 v[144:147],v234,s[8:11],s57 offen sc1
buffer_store_dwordx4 v[148:151],v234,s[8:11],s57 offen offset:256 sc1
v_cvt_pk_bf16_f32 v152, v48, v49
v_cvt_pk_bf16_f32 v153, v50, v51
v_cvt_pk_bf16_f32 v154, v52, v53
v_cvt_pk_bf16_f32 v155, v54, v55
v_cvt_pk_bf16_f32 v156, v56, v57
v_cvt_pk_bf16_f32 v157, v58, v59
v_cvt_pk_bf16_f32 v158, v60, v61
v_cvt_pk_bf16_f32 v159, v62, v63
s_add_u32 s57, s67, 580608
buffer_store_dwordx4 v[152:155],v234,s[8:11],s57 offen sc1
buffer_store_dwordx4 v[156:159],v234,s[8:11],s57 offen offset:256 sc1
ds_read_b64_tr_b16 v[220:221],v229 offset:15872
ds_read_b64_tr_b16 v[222:223],v229 offset:22016
s_waitcnt lgkmcnt(12)
v_mfma_f32_32x32x16_bf16 v[16:31],v[112:115],v[196:199],v[16:31]
s_add_u32 m0, s58, 77824
s_add_u32 s57, s60, 164864
buffer_load_dwordx4 v231,s[36:39],s57 offen lds
ds_read_b64_tr_b16 v[192:193],v229 offset:4096
ds_read_b64_tr_b16 v[194:195],v229 offset:10240
s_waitcnt lgkmcnt(12)
v_mfma_f32_32x32x16_bf16 v[0:15],v[116:119],v[200:203],v[0:15]
ds_read_b64_tr_b16 v[196:197],v229 offset:4608
ds_read_b64_tr_b16 v[198:199],v229 offset:10752
s_waitcnt lgkmcnt(12)
v_mfma_f32_32x32x16_bf16 v[16:31],v[116:119],v[204:207],v[16:31]
s_add_u32 m0, s58, 78848
s_add_u32 s57, s60, 205824
buffer_load_dwordx4 v231,s[36:39],s57 offen lds
ds_read_b64_tr_b16 v[200:201],v229 offset:16384
ds_read_b64_tr_b16 v[202:203],v229 offset:22528
s_waitcnt lgkmcnt(12)
v_mfma_f32_32x32x16_bf16 v[0:15],v[120:123],v[208:211],v[0:15]
ds_read_b64_tr_b16 v[204:205],v229 offset:16896
ds_read_b64_tr_b16 v[206:207],v229 offset:23040
s_waitcnt lgkmcnt(12)
v_mfma_f32_32x32x16_bf16 v[16:31],v[120:123],v[212:215],v[16:31]
ds_read_b64_tr_b16 v[208:209],v229 offset:5120
ds_read_b64_tr_b16 v[210:211],v229 offset:11264
s_waitcnt lgkmcnt(12)
v_mfma_f32_32x32x16_bf16 v[0:15],v[124:127],v[216:219],v[0:15]
ds_read_b64_tr_b16 v[212:213],v229 offset:5632
ds_read_b64_tr_b16 v[214:215],v229 offset:11776
s_waitcnt lgkmcnt(12)
v_mfma_f32_32x32x16_bf16 v[16:31],v[124:127],v[220:223],v[16:31]
ds_read_b64_tr_b16 v[216:217],v229 offset:17408
ds_read_b64_tr_b16 v[218:219],v229 offset:23552
s_waitcnt lgkmcnt(12)
v_mfma_f32_32x32x16_bf16 v[0:15],v[128:131],v[192:195],v[0:15]
ds_read_b64_tr_b16 v[220:221],v229 offset:17920
ds_read_b64_tr_b16 v[222:223],v229 offset:24064
s_waitcnt lgkmcnt(12)
v_mfma_f32_32x32x16_bf16 v[16:31],v[128:131],v[196:199],v[16:31]
s_waitcnt vmcnt(30)
s_barrier
ds_read_b64_tr_b16 v[192:193],v227 offset:0
ds_read_b64_tr_b16 v[194:195],v227 offset:6144
s_waitcnt lgkmcnt(12)
v_mfma_f32_32x32x16_bf16 v[0:15],v[132:135],v[200:203],v[0:15]
ds_read_b64_tr_b16 v[196:197],v227 offset:512
ds_read_b64_tr_b16 v[198:199],v227 offset:6656
s_waitcnt lgkmcnt(12)
v_mfma_f32_32x32x16_bf16 v[16:31],v[132:135],v[204:207],v[16:31]
ds_read_b64_tr_b16 v[200:201],v227 offset:12288
ds_read_b64_tr_b16 v[202:203],v227 offset:18432
s_waitcnt lgkmcnt(12)
v_mfma_f32_32x32x16_bf16 v[0:15],v[136:139],v[208:211],v[0:15]
ds_read_b64_tr_b16 v[204:205],v227 offset:12800
ds_read_b64_tr_b16 v[206:207],v227 offset:18944
s_waitcnt lgkmcnt(12)
v_mfma_f32_32x32x16_bf16 v[16:31],v[136:139],v[212:215],v[16:31]
ds_read_b64_tr_b16 v[208:209],v227 offset:1024
ds_read_b64_tr_b16 v[210:211],v227 offset:7168
s_waitcnt lgkmcnt(12)
v_mfma_f32_32x32x16_bf16 v[0:15],v[140:143],v[216:219],v[0:15]
ds_read_b64_tr_b16 v[212:213],v227 offset:1536
ds_read_b64_tr_b16 v[214:215],v227 offset:7680
s_waitcnt lgkmcnt(12)
v_mfma_f32_32x32x16_bf16 v[16:31],v[140:143],v[220:223],v[16:31]
ds_read_b64_tr_b16 v[216:217],v227 offset:13312
ds_read_b64_tr_b16 v[218:219],v227 offset:19456
s_waitcnt lgkmcnt(12)
v_mfma_f32_32x32x16_bf16 v[32:47],v[96:99],v[192:195],0
ds_read_b64_tr_b16 v[220:221],v227 offset:13824
ds_read_b64_tr_b16 v[222:223],v227 offset:19968
s_waitcnt lgkmcnt(12)
v_mfma_f32_32x32x16_bf16 v[48:63],v[96:99],v[196:199],0
s_add_u32 m0, s58, 98304
s_add_u32 s57, s60, 1152
buffer_load_dwordx4 v231,s[36:39],s57 offen lds
ds_read_b64_tr_b16 v[192:193],v227 offset:2048
ds_read_b64_tr_b16 v[194:195],v227 offset:8192
s_waitcnt lgkmcnt(12)
v_mfma_f32_32x32x16_bf16 v[32:47],v[100:103],v[200:203],v[32:47]
ds_read_b64_tr_b16 v[196:197],v227 offset:2560
ds_read_b64_tr_b16 v[198:199],v227 offset:8704
s_waitcnt lgkmcnt(12)
v_mfma_f32_32x32x16_bf16 v[48:63],v[100:103],v[204:207],v[48:63]
s_add_u32 m0, s58, 99328
s_add_u32 s57, s60, 42112
buffer_load_dwordx4 v231,s[36:39],s57 offen lds
ds_read_b64_tr_b16 v[200:201],v227 offset:14336
ds_read_b64_tr_b16 v[202:203],v227 offset:20480
s_waitcnt lgkmcnt(12)
v_mfma_f32_32x32x16_bf16 v[32:47],v[104:107],v[208:211],v[32:47]
ds_read_b64_tr_b16 v[204:205],v227 offset:14848
ds_read_b64_tr_b16 v[206:207],v227 offset:20992
s_waitcnt lgkmcnt(12)
v_mfma_f32_32x32x16_bf16 v[48:63],v[104:107],v[212:215],v[48:63]
s_add_u32 m0, s58, 100352
s_add_u32 s57, s60, 83072
buffer_load_dwordx4 v231,s[36:39],s57 offen lds
ds_read_b64_tr_b16 v[208:209],v227 offset:3072
ds_read_b64_tr_b16 v[210:211],v227 offset:9216
s_waitcnt lgkmcnt(12)
v_mfma_f32_32x32x16_bf16 v[32:47],v[108:111],v[216:219],v[32:47]
ds_read_b64_tr_b16 v[212:213],v227 offset:3584
ds_read_b64_tr_b16 v[214:215],v227 offset:9728
s_waitcnt lgkmcnt(12)
v_mfma_f32_32x32x16_bf16 v[48:63],v[108:111],v[220:223],v[48:63]
s_add_u32 m0, s58, 101376
s_add_u32 s57, s60, 124032
buffer_load_dwordx4 v231,s[36:39],s57 offen lds
ds_read_b64_tr_b16 v[216:217],v227 offset:15360
ds_read_b64_tr_b16 v[218:219],v227 offset:21504
s_waitcnt lgkmcnt(12)
v_mfma_f32_32x32x16_bf16 v[32:47],v[112:115],v[192:195],v[32:47]
v_cvt_pk_bf16_f32 v144, v0, v1
v_cvt_pk_bf16_f32 v145, v2, v3
v_cvt_pk_bf16_f32 v146, v4, v5
v_cvt_pk_bf16_f32 v147, v6, v7
v_cvt_pk_bf16_f32 v148, v8, v9
v_cvt_pk_bf16_f32 v149, v10, v11
v_cvt_pk_bf16_f32 v150, v12, v13
v_cvt_pk_bf16_f32 v151, v14, v15
s_add_u32 s57, s67, 663552
buffer_store_dwordx4 v[144:147],v234,s[8:11],s57 offen sc1
buffer_store_dwordx4 v[148:151],v234,s[8:11],s57 offen offset:256 sc1
v_cvt_pk_bf16_f32 v152, v16, v17
v_cvt_pk_bf16_f32 v153, v18, v19
v_cvt_pk_bf16_f32 v154, v20, v21
v_cvt_pk_bf16_f32 v155, v22, v23
v_cvt_pk_bf16_f32 v156, v24, v25
v_cvt_pk_bf16_f32 v157, v26, v27
v_cvt_pk_bf16_f32 v158, v28, v29
v_cvt_pk_bf16_f32 v159, v30, v31
s_add_u32 s57, s67, 746496
buffer_store_dwordx4 v[152:155],v234,s[8:11],s57 offen sc1
buffer_store_dwordx4 v[156:159],v234,s[8:11],s57 offen offset:256 sc1
ds_read_b64_tr_b16 v[220:221],v227 offset:15872
ds_read_b64_tr_b16 v[222:223],v227 offset:22016
s_waitcnt lgkmcnt(12)
v_mfma_f32_32x32x16_bf16 v[48:63],v[112:115],v[196:199],v[48:63]
s_add_u32 m0, s58, 102400
s_add_u32 s57, s60, 164992
buffer_load_dwordx4 v231,s[36:39],s57 offen lds
ds_read_b64_tr_b16 v[192:193],v227 offset:4096
ds_read_b64_tr_b16 v[194:195],v227 offset:10240
s_waitcnt lgkmcnt(12)
v_mfma_f32_32x32x16_bf16 v[32:47],v[116:119],v[200:203],v[32:47]
ds_read_b64_tr_b16 v[196:197],v227 offset:4608
ds_read_b64_tr_b16 v[198:199],v227 offset:10752
s_waitcnt lgkmcnt(12)
v_mfma_f32_32x32x16_bf16 v[48:63],v[116:119],v[204:207],v[48:63]
s_add_u32 m0, s58, 103424
s_add_u32 s57, s60, 205952
buffer_load_dwordx4 v231,s[36:39],s57 offen lds
ds_read_b64_tr_b16 v[200:201],v227 offset:16384
ds_read_b64_tr_b16 v[202:203],v227 offset:22528
s_waitcnt lgkmcnt(12)
v_mfma_f32_32x32x16_bf16 v[32:47],v[120:123],v[208:211],v[32:47]
ds_read_b64_tr_b16 v[204:205],v227 offset:16896
ds_read_b64_tr_b16 v[206:207],v227 offset:23040
s_waitcnt lgkmcnt(12)
v_mfma_f32_32x32x16_bf16 v[48:63],v[120:123],v[212:215],v[48:63]
ds_read_b64_tr_b16 v[208:209],v227 offset:5120
ds_read_b64_tr_b16 v[210:211],v227 offset:11264
s_waitcnt lgkmcnt(12)
v_mfma_f32_32x32x16_bf16 v[32:47],v[124:127],v[216:219],v[32:47]
ds_read_b64_tr_b16 v[212:213],v227 offset:5632
ds_read_b64_tr_b16 v[214:215],v227 offset:11776
s_waitcnt lgkmcnt(12)
v_mfma_f32_32x32x16_bf16 v[48:63],v[124:127],v[220:223],v[48:63]
ds_read_b64_tr_b16 v[216:217],v227 offset:17408
ds_read_b64_tr_b16 v[218:219],v227 offset:23552
s_waitcnt lgkmcnt(12)
v_mfma_f32_32x32x16_bf16 v[32:47],v[128:131],v[192:195],v[32:47]
ds_read_b64_tr_b16 v[220:221],v227 offset:17920
ds_read_b64_tr_b16 v[222:223],v227 offset:24064
s_waitcnt lgkmcnt(12)
v_mfma_f32_32x32x16_bf16 v[48:63],v[128:131],v[196:199],v[48:63]
s_waitcnt vmcnt(30)
s_barrier
ds_read_b64_tr_b16 v[192:193],v227 offset:24576
ds_read_b64_tr_b16 v[194:195],v227 offset:30720
s_waitcnt lgkmcnt(12)
v_mfma_f32_32x32x16_bf16 v[32:47],v[132:135],v[200:203],v[32:47]
ds_read_b64_tr_b16 v[196:197],v227 offset:25088
ds_read_b64_tr_b16 v[198:199],v227 offset:31232
s_waitcnt lgkmcnt(12)
v_mfma_f32_32x32x16_bf16 v[48:63],v[132:135],v[204:207],v[48:63]
ds_read_b64_tr_b16 v[200:201],v227 offset:36864
ds_read_b64_tr_b16 v[202:203],v227 offset:43008
s_waitcnt lgkmcnt(12)
v_mfma_f32_32x32x16_bf16 v[32:47],v[136:139],v[208:211],v[32:47]
ds_read_b64_tr_b16 v[204:205],v227 offset:37376
ds_read_b64_tr_b16 v[206:207],v227 offset:43520
s_waitcnt lgkmcnt(12)
v_mfma_f32_32x32x16_bf16 v[48:63],v[136:139],v[212:215],v[48:63]
ds_read_b64_tr_b16 v[208:209],v227 offset:25600
ds_read_b64_tr_b16 v[210:211],v227 offset:31744
s_waitcnt lgkmcnt(12)
v_mfma_f32_32x32x16_bf16 v[32:47],v[140:143],v[216:219],v[32:47]
ds_read_b64_tr_b16 v[212:213],v227 offset:26112
ds_read_b64_tr_b16 v[214:215],v227 offset:32256
s_waitcnt lgkmcnt(12)
v_mfma_f32_32x32x16_bf16 v[48:63],v[140:143],v[220:223],v[48:63]
s_mul_i32 s59, s86, 384
ds_read_b64_tr_b16 v[216:217],v227 offset:37888
ds_read_b64_tr_b16 v[218:219],v227 offset:44032
s_waitcnt lgkmcnt(12)
v_mfma_f32_32x32x16_bf16 v[0:15],v[96:99],v[192:195],0
ds_read_b64_tr_b16 v[220:221],v227 offset:38400
ds_read_b64_tr_b16 v[222:223],v227 offset:44544
s_waitcnt lgkmcnt(12)
v_mfma_f32_32x32x16_bf16 v[16:31],v[96:99],v[196:199],0
s_add_u32 m0, s58, 0
s_add_u32 s57, s59, 0
buffer_load_dwordx4 v230,s[32:35],s57 offen lds
ds_read_b64_tr_b16 v[192:193],v227 offset:26624
ds_read_b64_tr_b16 v[194:195],v227 offset:32768
s_waitcnt lgkmcnt(12)
v_mfma_f32_32x32x16_bf16 v[0:15],v[100:103],v[200:203],v[0:15]
ds_read_b64_tr_b16 v[196:197],v227 offset:27136
ds_read_b64_tr_b16 v[198:199],v227 offset:33280
s_waitcnt lgkmcnt(12)
v_mfma_f32_32x32x16_bf16 v[16:31],v[100:103],v[204:207],v[16:31]
s_add_u32 m0, s58, 1024
s_add_u32 s57, s59, 128
buffer_load_dwordx4 v230,s[32:35],s57 offen lds
ds_read_b64_tr_b16 v[200:201],v227 offset:38912
ds_read_b64_tr_b16 v[202:203],v227 offset:45056
s_waitcnt lgkmcnt(12)
v_mfma_f32_32x32x16_bf16 v[0:15],v[104:107],v[208:211],v[0:15]
ds_read_b64_tr_b16 v[204:205],v227 offset:39424
ds_read_b64_tr_b16 v[206:207],v227 offset:45568
s_waitcnt lgkmcnt(12)
v_mfma_f32_32x32x16_bf16 v[16:31],v[104:107],v[212:215],v[16:31]
s_add_u32 m0, s58, 2048
s_add_u32 s57, s59, 256
buffer_load_dwordx4 v230,s[32:35],s57 offen lds
ds_read_b64_tr_b16 v[208:209],v227 offset:27648
ds_read_b64_tr_b16 v[210:211],v227 offset:33792
s_waitcnt lgkmcnt(12)
v_mfma_f32_32x32x16_bf16 v[0:15],v[108:111],v[216:219],v[0:15]
ds_read_b64_tr_b16 v[212:213],v227 offset:28160
ds_read_b64_tr_b16 v[214:215],v227 offset:34304
s_waitcnt lgkmcnt(12)
v_mfma_f32_32x32x16_bf16 v[16:31],v[108:111],v[220:223],v[16:31]
s_add_u32 m0, s58, 3072
s_add_u32 s57, s59, 393216
buffer_load_dwordx4 v230,s[32:35],s57 offen lds
ds_read_b64_tr_b16 v[216:217],v227 offset:39936
ds_read_b64_tr_b16 v[218:219],v227 offset:46080
s_waitcnt lgkmcnt(12)
v_mfma_f32_32x32x16_bf16 v[0:15],v[112:115],v[192:195],v[0:15]
v_cvt_pk_bf16_f32 v144, v32, v33
v_cvt_pk_bf16_f32 v145, v34, v35
v_cvt_pk_bf16_f32 v146, v36, v37
v_cvt_pk_bf16_f32 v147, v38, v39
v_cvt_pk_bf16_f32 v148, v40, v41
v_cvt_pk_bf16_f32 v149, v42, v43
v_cvt_pk_bf16_f32 v150, v44, v45
v_cvt_pk_bf16_f32 v151, v46, v47
s_add_u32 s57, s67, 829440
buffer_store_dwordx4 v[144:147],v234,s[8:11],s57 offen sc1
buffer_store_dwordx4 v[148:151],v234,s[8:11],s57 offen offset:256 sc1
v_cvt_pk_bf16_f32 v152, v48, v49
v_cvt_pk_bf16_f32 v153, v50, v51
v_cvt_pk_bf16_f32 v154, v52, v53
v_cvt_pk_bf16_f32 v155, v54, v55
v_cvt_pk_bf16_f32 v156, v56, v57
v_cvt_pk_bf16_f32 v157, v58, v59
v_cvt_pk_bf16_f32 v158, v60, v61
v_cvt_pk_bf16_f32 v159, v62, v63
s_add_u32 s57, s67, 912384
buffer_store_dwordx4 v[152:155],v234,s[8:11],s57 offen sc1
buffer_store_dwordx4 v[156:159],v234,s[8:11],s57 offen offset:256 sc1
ds_read_b64_tr_b16 v[220:221],v227 offset:40448
ds_read_b64_tr_b16 v[222:223],v227 offset:46592
s_waitcnt lgkmcnt(12)
v_mfma_f32_32x32x16_bf16 v[16:31],v[112:115],v[196:199],v[16:31]
s_add_u32 m0, s58, 4096
s_add_u32 s57, s59, 393344
buffer_load_dwordx4 v230,s[32:35],s57 offen lds
ds_read_b64_tr_b16 v[192:193],v227 offset:28672
ds_read_b64_tr_b16 v[194:195],v227 offset:34816
s_waitcnt lgkmcnt(12)
v_mfma_f32_32x32x16_bf16 v[0:15],v[116:119],v[200:203],v[0:15]
ds_read_b64_tr_b16 v[196:197],v227 offset:29184
ds_read_b64_tr_b16 v[198:199],v227 offset:35328
s_waitcnt lgkmcnt(12)
v_mfma_f32_32x32x16_bf16 v[16:31],v[116:119],v[204:207],v[16:31]
s_add_u32 m0, s58, 5120
s_add_u32 s57, s59, 393472
buffer_load_dwordx4 v230,s[32:35],s57 offen lds
ds_read_b64_tr_b16 v[200:201],v227 offset:40960
ds_read_b64_tr_b16 v[202:203],v227 offset:47104
s_waitcnt lgkmcnt(12)
v_mfma_f32_32x32x16_bf16 v[0:15],v[120:123],v[208:211],v[0:15]
ds_read_b64_tr_b16 v[204:205],v227 offset:41472
ds_read_b64_tr_b16 v[206:207],v227 offset:47616
s_waitcnt lgkmcnt(12)
v_mfma_f32_32x32x16_bf16 v[16:31],v[120:123],v[212:215],v[16:31]
ds_read_b64_tr_b16 v[208:209],v227 offset:29696
ds_read_b64_tr_b16 v[210:211],v227 offset:35840
s_waitcnt lgkmcnt(12)
v_mfma_f32_32x32x16_bf16 v[0:15],v[124:127],v[216:219],v[0:15]
ds_read_b64_tr_b16 v[212:213],v227 offset:30208
ds_read_b64_tr_b16 v[214:215],v227 offset:36352
s_waitcnt lgkmcnt(12)
v_mfma_f32_32x32x16_bf16 v[16:31],v[124:127],v[220:223],v[16:31]
ds_read_b64_tr_b16 v[216:217],v227 offset:41984
ds_read_b64_tr_b16 v[218:219],v227 offset:48128
s_waitcnt lgkmcnt(12)
v_mfma_f32_32x32x16_bf16 v[0:15],v[128:131],v[192:195],v[0:15]
ds_read_b64_tr_b16 v[220:221],v227 offset:42496
ds_read_b64_tr_b16 v[222:223],v227 offset:48640
s_waitcnt lgkmcnt(12)
v_mfma_f32_32x32x16_bf16 v[16:31],v[128:131],v[196:199],v[16:31]
s_waitcnt vmcnt(30)
s_barrier
ds_read_b64_tr_b16 v[192:193],v228 offset:0
ds_read_b64_tr_b16 v[194:195],v228 offset:6144
s_waitcnt lgkmcnt(12)
v_mfma_f32_32x32x16_bf16 v[0:15],v[132:135],v[200:203],v[0:15]
ds_read_b64_tr_b16 v[196:197],v228 offset:512
ds_read_b64_tr_b16 v[198:199],v228 offset:6656
s_waitcnt lgkmcnt(12)
v_mfma_f32_32x32x16_bf16 v[16:31],v[132:135],v[204:207],v[16:31]
ds_read_b64_tr_b16 v[200:201],v228 offset:12288
ds_read_b64_tr_b16 v[202:203],v228 offset:18432
s_waitcnt lgkmcnt(12)
v_mfma_f32_32x32x16_bf16 v[0:15],v[136:139],v[208:211],v[0:15]
ds_read_b64_tr_b16 v[204:205],v228 offset:12800
ds_read_b64_tr_b16 v[206:207],v228 offset:18944
s_waitcnt lgkmcnt(12)
v_mfma_f32_32x32x16_bf16 v[16:31],v[136:139],v[212:215],v[16:31]
ds_read_b64_tr_b16 v[208:209],v228 offset:1024
ds_read_b64_tr_b16 v[210:211],v228 offset:7168
s_waitcnt lgkmcnt(12)
v_mfma_f32_32x32x16_bf16 v[0:15],v[140:143],v[216:219],v[0:15]
ds_read_b64_tr_b16 v[212:213],v228 offset:1536
ds_read_b64_tr_b16 v[214:215],v228 offset:7680
s_waitcnt lgkmcnt(12)
v_mfma_f32_32x32x16_bf16 v[16:31],v[140:143],v[220:223],v[16:31]
ds_read_b64_tr_b16 v[216:217],v228 offset:13312
ds_read_b64_tr_b16 v[218:219],v228 offset:19456
s_waitcnt lgkmcnt(12)
v_mfma_f32_32x32x16_bf16 v[32:47],v[96:99],v[192:195],0
ds_read_b64_tr_b16 v[220:221],v228 offset:13824
ds_read_b64_tr_b16 v[222:223],v228 offset:19968
s_waitcnt lgkmcnt(12)
v_mfma_f32_32x32x16_bf16 v[48:63],v[96:99],v[196:199],0
s_add_u32 m0, s58, 24576
s_add_u32 s57, s59, 786432
buffer_load_dwordx4 v230,s[32:35],s57 offen lds
ds_read_b64_tr_b16 v[192:193],v228 offset:2048
ds_read_b64_tr_b16 v[194:195],v228 offset:8192
s_waitcnt lgkmcnt(12)
v_mfma_f32_32x32x16_bf16 v[32:47],v[100:103],v[200:203],v[32:47]
ds_read_b64_tr_b16 v[196:197],v228 offset:2560
ds_read_b64_tr_b16 v[198:199],v228 offset:8704
s_waitcnt lgkmcnt(12)
v_mfma_f32_32x32x16_bf16 v[48:63],v[100:103],v[204:207],v[48:63]
s_add_u32 m0, s58, 25600
s_add_u32 s57, s59, 786560
buffer_load_dwordx4 v230,s[32:35],s57 offen lds
ds_read_b64_tr_b16 v[200:201],v228 offset:14336
ds_read_b64_tr_b16 v[202:203],v228 offset:20480
s_waitcnt lgkmcnt(12)
v_mfma_f32_32x32x16_bf16 v[32:47],v[104:107],v[208:211],v[32:47]
ds_read_b64_tr_b16 v[204:205],v228 offset:14848
ds_read_b64_tr_b16 v[206:207],v228 offset:20992
s_waitcnt lgkmcnt(12)
v_mfma_f32_32x32x16_bf16 v[48:63],v[104:107],v[212:215],v[48:63]
s_add_u32 m0, s58, 26624
s_add_u32 s57, s59, 786688
buffer_load_dwordx4 v230,s[32:35],s57 offen lds
ds_read_b64_tr_b16 v[208:209],v228 offset:3072
ds_read_b64_tr_b16 v[210:211],v228 offset:9216
s_waitcnt lgkmcnt(12)
v_mfma_f32_32x32x16_bf16 v[32:47],v[108:111],v[216:219],v[32:47]
ds_read_b64_tr_b16 v[212:213],v228 offset:3584
ds_read_b64_tr_b16 v[214:215],v228 offset:9728
s_waitcnt lgkmcnt(12)
v_mfma_f32_32x32x16_bf16 v[48:63],v[108:111],v[220:223],v[48:63]
s_add_u32 m0, s58, 27648
s_add_u32 s57, s59, 1179648
buffer_load_dwordx4 v230,s[32:35],s57 offen lds
ds_read_b64_tr_b16 v[216:217],v228 offset:15360
ds_read_b64_tr_b16 v[218:219],v228 offset:21504
s_waitcnt lgkmcnt(12)
v_mfma_f32_32x32x16_bf16 v[32:47],v[112:115],v[192:195],v[32:47]
v_cvt_pk_bf16_f32 v144, v0, v1
v_cvt_pk_bf16_f32 v145, v2, v3
v_cvt_pk_bf16_f32 v146, v4, v5
v_cvt_pk_bf16_f32 v147, v6, v7
v_cvt_pk_bf16_f32 v148, v8, v9
v_cvt_pk_bf16_f32 v149, v10, v11
v_cvt_pk_bf16_f32 v150, v12, v13
v_cvt_pk_bf16_f32 v151, v14, v15
s_add_u32 s57, s67, 995328
buffer_store_dwordx4 v[144:147],v234,s[8:11],s57 offen sc1
buffer_store_dwordx4 v[148:151],v234,s[8:11],s57 offen offset:256 sc1
v_cvt_pk_bf16_f32 v152, v16, v17
v_cvt_pk_bf16_f32 v153, v18, v19
v_cvt_pk_bf16_f32 v154, v20, v21
v_cvt_pk_bf16_f32 v155, v22, v23
v_cvt_pk_bf16_f32 v156, v24, v25
v_cvt_pk_bf16_f32 v157, v26, v27
v_cvt_pk_bf16_f32 v158, v28, v29
v_cvt_pk_bf16_f32 v159, v30, v31
s_add_u32 s57, s67, 1078272
buffer_store_dwordx4 v[152:155],v234,s[8:11],s57 offen sc1
buffer_store_dwordx4 v[156:159],v234,s[8:11],s57 offen offset:256 sc1
ds_read_b64_tr_b16 v[220:221],v228 offset:15872
ds_read_b64_tr_b16 v[222:223],v228 offset:22016
s_waitcnt lgkmcnt(12)
v_mfma_f32_32x32x16_bf16 v[48:63],v[112:115],v[196:199],v[48:63]
s_add_u32 m0, s58, 28672
s_add_u32 s57, s59, 1179776
buffer_load_dwordx4 v230,s[32:35],s57 offen lds
ds_read_b64_tr_b16 v[192:193],v228 offset:4096
ds_read_b64_tr_b16 v[194:195],v228 offset:10240
s_waitcnt lgkmcnt(12)
v_mfma_f32_32x32x16_bf16 v[32:47],v[116:119],v[200:203],v[32:47]
ds_read_b64_tr_b16 v[196:197],v228 offset:4608
ds_read_b64_tr_b16 v[198:199],v228 offset:10752
s_waitcnt lgkmcnt(12)
v_mfma_f32_32x32x16_bf16 v[48:63],v[116:119],v[204:207],v[48:63]
s_add_u32 m0, s58, 29696
s_add_u32 s57, s59, 1179904
buffer_load_dwordx4 v230,s[32:35],s57 offen lds
ds_read_b64_tr_b16 v[200:201],v228 offset:16384
ds_read_b64_tr_b16 v[202:203],v228 offset:22528
s_waitcnt lgkmcnt(12)
v_mfma_f32_32x32x16_bf16 v[32:47],v[120:123],v[208:211],v[32:47]
ds_read_b64_tr_b16 v[204:205],v228 offset:16896
ds_read_b64_tr_b16 v[206:207],v228 offset:23040
s_waitcnt lgkmcnt(12)
v_mfma_f32_32x32x16_bf16 v[48:63],v[120:123],v[212:215],v[48:63]
ds_read_b64_tr_b16 v[208:209],v228 offset:5120
ds_read_b64_tr_b16 v[210:211],v228 offset:11264
s_waitcnt lgkmcnt(12)
v_mfma_f32_32x32x16_bf16 v[32:47],v[124:127],v[216:219],v[32:47]
ds_read_b64_tr_b16 v[212:213],v228 offset:5632
ds_read_b64_tr_b16 v[214:215],v228 offset:11776
s_waitcnt lgkmcnt(12)
v_mfma_f32_32x32x16_bf16 v[48:63],v[124:127],v[220:223],v[48:63]
ds_read_b64_tr_b16 v[216:217],v228 offset:17408
ds_read_b64_tr_b16 v[218:219],v228 offset:23552
s_waitcnt lgkmcnt(12)
v_mfma_f32_32x32x16_bf16 v[32:47],v[128:131],v[192:195],v[32:47]
ds_read_b64_tr_b16 v[220:221],v228 offset:17920
ds_read_b64_tr_b16 v[222:223],v228 offset:24064
s_waitcnt lgkmcnt(12)
v_mfma_f32_32x32x16_bf16 v[48:63],v[128:131],v[196:199],v[48:63]
s_waitcnt vmcnt(30)
s_barrier
ds_read_b64_tr_b16 v[192:193],v228 offset:24576
ds_read_b64_tr_b16 v[194:195],v228 offset:30720
s_waitcnt lgkmcnt(12)
v_mfma_f32_32x32x16_bf16 v[32:47],v[132:135],v[200:203],v[32:47]
ds_read_b64_tr_b16 v[196:197],v228 offset:25088
ds_read_b64_tr_b16 v[198:199],v228 offset:31232
s_waitcnt lgkmcnt(12)
v_mfma_f32_32x32x16_bf16 v[48:63],v[132:135],v[204:207],v[48:63]
ds_read_b64_tr_b16 v[200:201],v228 offset:36864
ds_read_b64_tr_b16 v[202:203],v228 offset:43008
s_waitcnt lgkmcnt(12)
v_mfma_f32_32x32x16_bf16 v[32:47],v[136:139],v[208:211],v[32:47]
ds_read_b64_tr_b16 v[204:205],v228 offset:37376
ds_read_b64_tr_b16 v[206:207],v228 offset:43520
s_waitcnt lgkmcnt(12)
v_mfma_f32_32x32x16_bf16 v[48:63],v[136:139],v[212:215],v[48:63]
ds_read_b64_tr_b16 v[208:209],v228 offset:25600
ds_read_b64_tr_b16 v[210:211],v228 offset:31744
s_waitcnt lgkmcnt(12)
v_mfma_f32_32x32x16_bf16 v[32:47],v[140:143],v[216:219],v[32:47]
ds_read_b64_tr_b16 v[212:213],v228 offset:26112
ds_read_b64_tr_b16 v[214:215],v228 offset:32256
s_waitcnt lgkmcnt(12)
v_mfma_f32_32x32x16_bf16 v[48:63],v[140:143],v[220:223],v[48:63]
ds_read_b64_tr_b16 v[216:217],v228 offset:37888
ds_read_b64_tr_b16 v[218:219],v228 offset:44032
s_waitcnt lgkmcnt(12)
v_mfma_f32_32x32x16_bf16 v[0:15],v[96:99],v[192:195],0
ds_read_b64_tr_b16 v[220:221],v228 offset:38400
ds_read_b64_tr_b16 v[222:223],v228 offset:44544
s_waitcnt lgkmcnt(12)
v_mfma_f32_32x32x16_bf16 v[16:31],v[96:99],v[196:199],0
s_add_u32 m0, s58, 49152
s_add_u32 s57, s59, 1572864
buffer_load_dwordx4 v230,s[32:35],s57 offen lds
ds_read_b64_tr_b16 v[192:193],v228 offset:26624
ds_read_b64_tr_b16 v[194:195],v228 offset:32768
s_waitcnt lgkmcnt(12)
v_mfma_f32_32x32x16_bf16 v[0:15],v[100:103],v[200:203],v[0:15]
ds_read_b64_tr_b16 v[196:197],v228 offset:27136
ds_read_b64_tr_b16 v[198:199],v228 offset:33280
s_waitcnt lgkmcnt(12)
v_mfma_f32_32x32x16_bf16 v[16:31],v[100:103],v[204:207],v[16:31]
s_add_u32 m0, s58, 50176
s_add_u32 s57, s59, 1572992
buffer_load_dwordx4 v230,s[32:35],s57 offen lds
ds_read_b64_tr_b16 v[200:201],v228 offset:38912
ds_read_b64_tr_b16 v[202:203],v228 offset:45056
s_waitcnt lgkmcnt(12)
v_mfma_f32_32x32x16_bf16 v[0:15],v[104:107],v[208:211],v[0:15]
ds_read_b64_tr_b16 v[204:205],v228 offset:39424
ds_read_b64_tr_b16 v[206:207],v228 offset:45568
s_waitcnt lgkmcnt(12)
v_mfma_f32_32x32x16_bf16 v[16:31],v[104:107],v[212:215],v[16:31]
s_add_u32 m0, s58, 51200
s_add_u32 s57, s59, 1573120
buffer_load_dwordx4 v230,s[32:35],s57 offen lds
ds_read_b64_tr_b16 v[208:209],v228 offset:27648
ds_read_b64_tr_b16 v[210:211],v228 offset:33792
s_waitcnt lgkmcnt(12)
v_mfma_f32_32x32x16_bf16 v[0:15],v[108:111],v[216:219],v[0:15]
ds_read_b64_tr_b16 v[212:213],v228 offset:28160
ds_read_b64_tr_b16 v[214:215],v228 offset:34304
s_waitcnt lgkmcnt(12)
v_mfma_f32_32x32x16_bf16 v[16:31],v[108:111],v[220:223],v[16:31]
s_add_u32 m0, s58, 52224
s_add_u32 s57, s59, 1966080
buffer_load_dwordx4 v230,s[32:35],s57 offen lds
ds_read_b64_tr_b16 v[216:217],v228 offset:39936
ds_read_b64_tr_b16 v[218:219],v228 offset:46080
s_waitcnt lgkmcnt(12)
v_mfma_f32_32x32x16_bf16 v[0:15],v[112:115],v[192:195],v[0:15]
v_cvt_pk_bf16_f32 v144, v32, v33
v_cvt_pk_bf16_f32 v145, v34, v35
v_cvt_pk_bf16_f32 v146, v36, v37
v_cvt_pk_bf16_f32 v147, v38, v39
v_cvt_pk_bf16_f32 v148, v40, v41
v_cvt_pk_bf16_f32 v149, v42, v43
v_cvt_pk_bf16_f32 v150, v44, v45
v_cvt_pk_bf16_f32 v151, v46, v47
s_add_u32 s57, s67, 1161216
buffer_store_dwordx4 v[144:147],v234,s[8:11],s57 offen sc1
buffer_store_dwordx4 v[148:151],v234,s[8:11],s57 offen offset:256 sc1
v_cvt_pk_bf16_f32 v152, v48, v49
v_cvt_pk_bf16_f32 v153, v50, v51
v_cvt_pk_bf16_f32 v154, v52, v53
v_cvt_pk_bf16_f32 v155, v54, v55
v_cvt_pk_bf16_f32 v156, v56, v57
v_cvt_pk_bf16_f32 v157, v58, v59
v_cvt_pk_bf16_f32 v158, v60, v61
v_cvt_pk_bf16_f32 v159, v62, v63
s_add_u32 s57, s67, 1244160
buffer_store_dwordx4 v[152:155],v234,s[8:11],s57 offen sc1
buffer_store_dwordx4 v[156:159],v234,s[8:11],s57 offen offset:256 sc1
ds_read_b64_tr_b16 v[220:221],v228 offset:40448
ds_read_b64_tr_b16 v[222:223],v228 offset:46592
s_waitcnt lgkmcnt(12)
v_mfma_f32_32x32x16_bf16 v[16:31],v[112:115],v[196:199],v[16:31]
s_add_u32 m0, s58, 53248
s_add_u32 s57, s59, 1966208
buffer_load_dwordx4 v230,s[32:35],s57 offen lds
ds_read_b64_tr_b16 v[192:193],v228 offset:28672
ds_read_b64_tr_b16 v[194:195],v228 offset:34816
s_waitcnt lgkmcnt(12)
v_mfma_f32_32x32x16_bf16 v[0:15],v[116:119],v[200:203],v[0:15]
ds_read_b64_tr_b16 v[196:197],v228 offset:29184
ds_read_b64_tr_b16 v[198:199],v228 offset:35328
s_waitcnt lgkmcnt(12)
v_mfma_f32_32x32x16_bf16 v[16:31],v[116:119],v[204:207],v[16:31]
s_add_u32 m0, s58, 54272
s_add_u32 s57, s59, 1966336
buffer_load_dwordx4 v230,s[32:35],s57 offen lds
ds_read_b64_tr_b16 v[200:201],v228 offset:40960
ds_read_b64_tr_b16 v[202:203],v228 offset:47104
s_waitcnt lgkmcnt(12)
v_mfma_f32_32x32x16_bf16 v[0:15],v[120:123],v[208:211],v[0:15]
ds_read_b64_tr_b16 v[204:205],v228 offset:41472
ds_read_b64_tr_b16 v[206:207],v228 offset:47616
s_waitcnt lgkmcnt(12)
v_mfma_f32_32x32x16_bf16 v[16:31],v[120:123],v[212:215],v[16:31]
ds_read_b64_tr_b16 v[208:209],v228 offset:29696
ds_read_b64_tr_b16 v[210:211],v228 offset:35840
s_waitcnt lgkmcnt(12)
v_mfma_f32_32x32x16_bf16 v[0:15],v[124:127],v[216:219],v[0:15]
ds_read_b64_tr_b16 v[212:213],v228 offset:30208
ds_read_b64_tr_b16 v[214:215],v228 offset:36352
s_waitcnt lgkmcnt(12)
v_mfma_f32_32x32x16_bf16 v[16:31],v[124:127],v[220:223],v[16:31]
ds_read_b64_tr_b16 v[216:217],v228 offset:41984
ds_read_b64_tr_b16 v[218:219],v228 offset:48128
s_waitcnt lgkmcnt(12)
v_mfma_f32_32x32x16_bf16 v[0:15],v[128:131],v[192:195],v[0:15]
ds_read_b64_tr_b16 v[220:221],v228 offset:42496
ds_read_b64_tr_b16 v[222:223],v228 offset:48640
s_waitcnt lgkmcnt(12)
v_mfma_f32_32x32x16_bf16 v[16:31],v[128:131],v[196:199],v[16:31]
s_waitcnt vmcnt(30)
s_barrier
ds_read_b64_tr_b16 v[192:193],v229 offset:0
ds_read_b64_tr_b16 v[194:195],v229 offset:6144
s_waitcnt lgkmcnt(12)
v_mfma_f32_32x32x16_bf16 v[0:15],v[132:135],v[200:203],v[0:15]
ds_read_b64_tr_b16 v[196:197],v229 offset:512
ds_read_b64_tr_b16 v[198:199],v229 offset:6656
s_waitcnt lgkmcnt(12)
v_mfma_f32_32x32x16_bf16 v[16:31],v[132:135],v[204:207],v[16:31]
ds_read_b64_tr_b16 v[200:201],v229 offset:12288
ds_read_b64_tr_b16 v[202:203],v229 offset:18432
s_waitcnt lgkmcnt(12)
v_mfma_f32_32x32x16_bf16 v[0:15],v[136:139],v[208:211],v[0:15]
ds_read_b64_tr_b16 v[204:205],v229 offset:12800
ds_read_b64_tr_b16 v[206:207],v229 offset:18944
s_waitcnt lgkmcnt(12)
v_mfma_f32_32x32x16_bf16 v[16:31],v[136:139],v[212:215],v[16:31]
ds_read_b64_tr_b16 v[208:209],v229 offset:1024
ds_read_b64_tr_b16 v[210:211],v229 offset:7168
s_waitcnt lgkmcnt(12)
v_mfma_f32_32x32x16_bf16 v[0:15],v[140:143],v[216:219],v[0:15]
ds_read_b64_tr_b16 v[212:213],v229 offset:1536
ds_read_b64_tr_b16 v[214:215],v229 offset:7680
s_waitcnt lgkmcnt(12)
v_mfma_f32_32x32x16_bf16 v[16:31],v[140:143],v[220:223],v[16:31]
ds_read_b64_tr_b16 v[216:217],v229 offset:13312
ds_read_b64_tr_b16 v[218:219],v229 offset:19456
s_waitcnt lgkmcnt(12)
v_mfma_f32_32x32x16_bf16 v[32:47],v[96:99],v[192:195],0
ds_read_b64_tr_b16 v[220:221],v229 offset:13824
ds_read_b64_tr_b16 v[222:223],v229 offset:19968
s_waitcnt lgkmcnt(12)
v_mfma_f32_32x32x16_bf16 v[48:63],v[96:99],v[196:199],0
s_add_u32 m0, s58, 73728
s_add_u32 s57, s59, 2359296
buffer_load_dwordx4 v230,s[32:35],s57 offen lds
ds_read_b64_tr_b16 v[192:193],v229 offset:2048
ds_read_b64_tr_b16 v[194:195],v229 offset:8192
s_waitcnt lgkmcnt(12)
v_mfma_f32_32x32x16_bf16 v[32:47],v[100:103],v[200:203],v[32:47]
ds_read_b64_tr_b16 v[196:197],v229 offset:2560
ds_read_b64_tr_b16 v[198:199],v229 offset:8704
s_waitcnt lgkmcnt(12)
v_mfma_f32_32x32x16_bf16 v[48:63],v[100:103],v[204:207],v[48:63]
s_add_u32 m0, s58, 74752
s_add_u32 s57, s59, 2359424
buffer_load_dwordx4 v230,s[32:35],s57 offen lds
ds_read_b64_tr_b16 v[200:201],v229 offset:14336
ds_read_b64_tr_b16 v[202:203],v229 offset:20480
s_waitcnt lgkmcnt(12)
v_mfma_f32_32x32x16_bf16 v[32:47],v[104:107],v[208:211],v[32:47]
ds_read_b64_tr_b16 v[204:205],v229 offset:14848
ds_read_b64_tr_b16 v[206:207],v229 offset:20992
s_waitcnt lgkmcnt(12)
v_mfma_f32_32x32x16_bf16 v[48:63],v[104:107],v[212:215],v[48:63]
s_add_u32 m0, s58, 75776
s_add_u32 s57, s59, 2359552
buffer_load_dwordx4 v230,s[32:35],s57 offen lds
ds_read_b64_tr_b16 v[208:209],v229 offset:3072
ds_read_b64_tr_b16 v[210:211],v229 offset:9216
s_waitcnt lgkmcnt(12)
v_mfma_f32_32x32x16_bf16 v[32:47],v[108:111],v[216:219],v[32:47]
ds_read_b64_tr_b16 v[212:213],v229 offset:3584
ds_read_b64_tr_b16 v[214:215],v229 offset:9728
s_waitcnt lgkmcnt(12)
v_mfma_f32_32x32x16_bf16 v[48:63],v[108:111],v[220:223],v[48:63]
s_add_u32 m0, s58, 76800
s_add_u32 s57, s59, 2752512
buffer_load_dwordx4 v230,s[32:35],s57 offen lds
ds_read_b64_tr_b16 v[216:217],v229 offset:15360
ds_read_b64_tr_b16 v[218:219],v229 offset:21504
s_waitcnt lgkmcnt(12)
v_mfma_f32_32x32x16_bf16 v[32:47],v[112:115],v[192:195],v[32:47]
v_cvt_pk_bf16_f32 v144, v0, v1
v_cvt_pk_bf16_f32 v145, v2, v3
v_cvt_pk_bf16_f32 v146, v4, v5
v_cvt_pk_bf16_f32 v147, v6, v7
v_cvt_pk_bf16_f32 v148, v8, v9
v_cvt_pk_bf16_f32 v149, v10, v11
v_cvt_pk_bf16_f32 v150, v12, v13
v_cvt_pk_bf16_f32 v151, v14, v15
s_add_u32 s57, s67, 1327104
buffer_store_dwordx4 v[144:147],v234,s[8:11],s57 offen sc1
buffer_store_dwordx4 v[148:151],v234,s[8:11],s57 offen offset:256 sc1
v_cvt_pk_bf16_f32 v152, v16, v17
v_cvt_pk_bf16_f32 v153, v18, v19
v_cvt_pk_bf16_f32 v154, v20, v21
v_cvt_pk_bf16_f32 v155, v22, v23
v_cvt_pk_bf16_f32 v156, v24, v25
v_cvt_pk_bf16_f32 v157, v26, v27
v_cvt_pk_bf16_f32 v158, v28, v29
v_cvt_pk_bf16_f32 v159, v30, v31
s_add_u32 s57, s67, 1410048
buffer_store_dwordx4 v[152:155],v234,s[8:11],s57 offen sc1
buffer_store_dwordx4 v[156:159],v234,s[8:11],s57 offen offset:256 sc1
ds_read_b64_tr_b16 v[220:221],v229 offset:15872
ds_read_b64_tr_b16 v[222:223],v229 offset:22016
s_waitcnt lgkmcnt(12)
v_mfma_f32_32x32x16_bf16 v[48:63],v[112:115],v[196:199],v[48:63]
s_add_u32 m0, s58, 77824
s_add_u32 s57, s59, 2752640
buffer_load_dwordx4 v230,s[32:35],s57 offen lds
ds_read_b64_tr_b16 v[192:193],v229 offset:4096
ds_read_b64_tr_b16 v[194:195],v229 offset:10240
s_waitcnt lgkmcnt(12)
v_mfma_f32_32x32x16_bf16 v[32:47],v[116:119],v[200:203],v[32:47]
ds_read_b64_tr_b16 v[196:197],v229 offset:4608
ds_read_b64_tr_b16 v[198:199],v229 offset:10752
s_waitcnt lgkmcnt(12)
v_mfma_f32_32x32x16_bf16 v[48:63],v[116:119],v[204:207],v[48:63]
s_add_u32 m0, s58, 78848
s_add_u32 s57, s59, 2752768
buffer_load_dwordx4 v230,s[32:35],s57 offen lds
ds_read_b64_tr_b16 v[200:201],v229 offset:16384
ds_read_b64_tr_b16 v[202:203],v229 offset:22528
s_waitcnt lgkmcnt(12)
v_mfma_f32_32x32x16_bf16 v[32:47],v[120:123],v[208:211],v[32:47]
ds_read_b64_tr_b16 v[204:205],v229 offset:16896
ds_read_b64_tr_b16 v[206:207],v229 offset:23040
s_waitcnt lgkmcnt(12)
v_mfma_f32_32x32x16_bf16 v[48:63],v[120:123],v[212:215],v[48:63]
ds_read_b64_tr_b16 v[208:209],v229 offset:5120
ds_read_b64_tr_b16 v[210:211],v229 offset:11264
s_waitcnt lgkmcnt(12)
v_mfma_f32_32x32x16_bf16 v[32:47],v[124:127],v[216:219],v[32:47]
ds_read_b64_tr_b16 v[212:213],v229 offset:5632
ds_read_b64_tr_b16 v[214:215],v229 offset:11776
s_waitcnt lgkmcnt(12)
v_mfma_f32_32x32x16_bf16 v[48:63],v[124:127],v[220:223],v[48:63]
ds_read_b64_tr_b16 v[216:217],v229 offset:17408
ds_read_b64_tr_b16 v[218:219],v229 offset:23552
s_waitcnt lgkmcnt(12)
v_mfma_f32_32x32x16_bf16 v[32:47],v[128:131],v[192:195],v[32:47]
ds_read_b64_tr_b16 v[220:221],v229 offset:17920
ds_read_b64_tr_b16 v[222:223],v229 offset:24064
s_waitcnt lgkmcnt(12)
v_mfma_f32_32x32x16_bf16 v[48:63],v[128:131],v[196:199],v[48:63]
s_waitcnt vmcnt(30)
s_barrier
ds_read_b64_tr_b16 v[192:193],v224 offset:0
ds_read_b64_tr_b16 v[194:195],v224 offset:256
s_waitcnt lgkmcnt(12)
v_mfma_f32_32x32x16_bf16 v[32:47],v[132:135],v[200:203],v[32:47]
ds_read_b64_tr_b16 v[196:197],v224 offset:512
ds_read_b64_tr_b16 v[198:199],v224 offset:768
s_waitcnt lgkmcnt(12)
v_mfma_f32_32x32x16_bf16 v[48:63],v[132:135],v[204:207],v[48:63]
ds_read_b64_tr_b16 v[200:201],v224 offset:1024
ds_read_b64_tr_b16 v[202:203],v224 offset:1280
s_waitcnt lgkmcnt(12)
v_mfma_f32_32x32x16_bf16 v[32:47],v[136:139],v[208:211],v[32:47]
ds_read_b64_tr_b16 v[204:205],v224 offset:1536
ds_read_b64_tr_b16 v[206:207],v224 offset:1792
s_waitcnt lgkmcnt(12)
v_mfma_f32_32x32x16_bf16 v[48:63],v[136:139],v[212:215],v[48:63]
ds_read_b64_tr_b16 v[208:209],v224 offset:2048
ds_read_b64_tr_b16 v[210:211],v224 offset:2304
s_waitcnt lgkmcnt(12)
v_mfma_f32_32x32x16_bf16 v[32:47],v[140:143],v[216:219],v[32:47]
ds_read_b64_tr_b16 v[212:213],v224 offset:2560
ds_read_b64_tr_b16 v[214:215],v224 offset:2816
s_waitcnt lgkmcnt(12)
v_mfma_f32_32x32x16_bf16 v[48:63],v[140:143],v[220:223],v[48:63]
s_nop 11
v_cvt_pk_bf16_f32 v144, v32, v33
v_cvt_pk_bf16_f32 v145, v34, v35
v_cvt_pk_bf16_f32 v146, v36, v37
v_cvt_pk_bf16_f32 v147, v38, v39
v_cvt_pk_bf16_f32 v148, v40, v41
v_cvt_pk_bf16_f32 v149, v42, v43
v_cvt_pk_bf16_f32 v150, v44, v45
v_cvt_pk_bf16_f32 v151, v46, v47
s_add_u32 s57, s67, 1492992
buffer_store_dwordx4 v[144:147],v234,s[8:11],s57 offen sc1
buffer_store_dwordx4 v[148:151],v234,s[8:11],s57 offen offset:256 sc1
v_cvt_pk_bf16_f32 v152, v48, v49
v_cvt_pk_bf16_f32 v153, v50, v51
v_cvt_pk_bf16_f32 v154, v52, v53
v_cvt_pk_bf16_f32 v155, v54, v55
v_cvt_pk_bf16_f32 v156, v56, v57
v_cvt_pk_bf16_f32 v157, v58, v59
v_cvt_pk_bf16_f32 v158, v60, v61
v_cvt_pk_bf16_f32 v159, v62, v63
s_add_u32 s57, s67, 1575936
buffer_store_dwordx4 v[152:155],v234,s[8:11],s57 offen sc1
buffer_store_dwordx4 v[156:159],v234,s[8:11],s57 offen offset:256 sc1
s_lshl_b32 s93, s63, 7
s_add_u32 s93, s93, s92
s_mov_b32 s62, s86
s_mov_b32 s63, s87
s_mov_b32 s61, s91
s_lshl_b32 s66, s63, 2
s_add_u32 s66, s66, s56
s_cmp_lt_u32 s65, 2
s_cbranch_scc0 TL1n
s_waitcnt vmcnt(0)
s_barrier
buffer_atomic_add v239,v238,s[8:11],s93 offen sc1
s_mov_b32 s93, 244486016
TL1n:
s_add_u32 s65, s65, 1
s_cmp_lt_u32 s65, 8
s_cbranch_scc1 TL1
s_waitcnt vmcnt(0)
s_barrier
buffer_atomic_add v239,v238,s[8:11],s93 offen sc1
s_branch W_A
EX1:
s_endpgm
W_A:
s_lshr_b32 s6, s5, 4
s_lshl_b32 s6, s6, 3
s_add_u32 s6, s6, s7
s_add_u32 s6, s6, 0
s_bitcmp1_b32 s7, 3
s_cbranch_scc1 W_AT
W_A2:
s_lshl_b32 s62, s4, 1
s_and_b32 s57, s6, 1
s_add_u32 s62, s62, s57
s_lshr_b32 s63, s6, 1
v_lshrrev_b32 v230, 2, v255
v_and_b32 v230, 7, v230
v_mul_u32_u24 v230, 3840, v230
v_lshrrev_b32 v254, 5, v255
v_and_b32 v254, 1, v254
v_mul_u32_u24 v254, 40, v254
v_add_u32 v230, v254, v230
v_and_b32 v254, 3, v255
v_mul_u32_u24 v254, 16, v254
v_add_u32 v230, v254, v230
s_mul_i32 s57, s56, 30720
v_add_u32 v230, s57, v230
s_lshl_b32 s66, s63, 2
s_add_u32 s66, s66, s56
s_mul_i32 s61, s66, 40960
s_add_u32 s61, s61, 236535808
s_mul_i32 s59, s62, 160
s_barrier
s_add_u32 m0, s58, 0
s_add_u32 s57, s59, 0
buffer_load_dwordx4 v230,s[16:19],s57 offen lds
s_add_u32 m0, s58, 1024
s_add_u32 s57, s59, 80
buffer_load_dwordx4 v230,s[16:19],s57 offen lds
s_add_u32 m0, s58, 2048
s_add_u32 s57, s59, 1280
buffer_load_dwordx4 v230,s[16:19],s57 offen lds
s_add_u32 m0, s58, 3072
s_add_u32 s57, s59, 1360
buffer_load_dwordx4 v230,s[16:19],s57 offen lds
s_add_u32 m0, s58, 4096
s_add_u32 s57, s59, 2560
buffer_load_dwordx4 v230,s[16:19],s57 offen lds
s_add_u32 m0, s58, 5120
s_add_u32 s57, s59, 2640
buffer_load_dwordx4 v230,s[16:19],s57 offen lds
s_add_u32 m0, s58, 24576
s_add_u32 s57, s59, 122880
buffer_load_dwordx4 v230,s[16:19],s57 offen lds
s_add_u32 m0, s58, 25600
s_add_u32 s57, s59, 122960
buffer_load_dwordx4 v230,s[16:19],s57 offen lds
s_add_u32 m0, s58, 26624
s_add_u32 s57, s59, 124160
buffer_load_dwordx4 v230,s[16:19],s57 offen lds
s_add_u32 m0, s58, 27648
s_add_u32 s57, s59, 124240
buffer_load_dwordx4 v230,s[16:19],s57 offen lds
s_add_u32 m0, s58, 28672
s_add_u32 s57, s59, 125440
buffer_load_dwordx4 v230,s[16:19],s57 offen lds
s_add_u32 m0, s58, 29696
s_add_u32 s57, s59, 125520
buffer_load_dwordx4 v230,s[16:19],s57 offen lds
s_add_u32 s57, s61, 0
buffer_load_dwordx4 a[0:3],v233,s[8:11],s57 offen
buffer_load_dwordx4 a[4:7],v233,s[8:11],s57 offen offset:1024
buffer_load_dwordx4 a[8:11],v233,s[8:11],s57 offen offset:2048
buffer_load_dwordx4 a[12:15],v233,s[8:11],s57 offen offset:3072
s_add_u32 s57, s61, 4096
buffer_load_dwordx4 a[16:19],v233,s[8:11],s57 offen
buffer_load_dwordx4 a[20:23],v233,s[8:11],s57 offen offset:1024
buffer_load_dwordx4 a[24:27],v233,s[8:11],s57 offen offset:2048
buffer_load_dwordx4 a[28:31],v233,s[8:11],s57 offen offset:3072
s_add_u32 s57, s61, 8192
buffer_load_dwordx4 a[32:35],v233,s[8:11],s57 offen
buffer_load_dwordx4 a[36:39],v233,s[8:11],s57 offen offset:1024
buffer_load_dwordx4 a[40:43],v233,s[8:11],s57 offen offset:2048
buffer_load_dwordx4 a[44:47],v233,s[8:11],s57 offen offset:3072
s_add_u32 s57, s61, 12288
buffer_load_dwordx4 a[48:51],v233,s[8:11],s57 offen
buffer_load_dwordx4 a[52:55],v233,s[8:11],s57 offen offset:1024
buffer_load_dwordx4 a[56:59],v233,s[8:11],s57 offen offset:2048
buffer_load_dwordx4 a[60:63],v233,s[8:11],s57 offen offset:3072
s_add_u32 s57, s61, 16384
buffer_load_dwordx4 a[64:67],v233,s[8:11],s57 offen
buffer_load_dwordx4 a[68:71],v233,s[8:11],s57 offen offset:1024
buffer_load_dwordx4 a[72:75],v233,s[8:11],s57 offen offset:2048
buffer_load_dwordx4 a[76:79],v233,s[8:11],s57 offen offset:3072
s_add_u32 s57, s61, 20480
buffer_load_dwordx4 a[80:83],v233,s[8:11],s57 offen
buffer_load_dwordx4 a[84:87],v233,s[8:11],s57 offen offset:1024
buffer_load_dwordx4 a[88:91],v233,s[8:11],s57 offen offset:2048
buffer_load_dwordx4 a[92:95],v233,s[8:11],s57 offen offset:3072
s_add_u32 s57, s61, 24576
buffer_load_dwordx4 a[96:99],v233,s[8:11],s57 offen
buffer_load_dwordx4 a[100:103],v233,s[8:11],s57 offen offset:1024
buffer_load_dwordx4 a[104:107],v233,s[8:11],s57 offen offset:2048
buffer_load_dwordx4 a[108:111],v233,s[8:11],s57 offen offset:3072
s_add_u32 s57, s61, 28672
buffer_load_dwordx4 a[112:115],v233,s[8:11],s57 offen
buffer_load_dwordx4 a[116:119],v233,s[8:11],s57 offen offset:1024
buffer_load_dwordx4 a[120:123],v233,s[8:11],s57 offen offset:2048
buffer_load_dwordx4 a[124:127],v233,s[8:11],s57 offen offset:3072
s_add_u32 s57, s61, 32768
buffer_load_dwordx4 a[128:131],v233,s[8:11],s57 offen
buffer_load_dwordx4 a[132:135],v233,s[8:11],s57 offen offset:1024
buffer_load_dwordx4 a[136:139],v233,s[8:11],s57 offen offset:2048
buffer_load_dwordx4 a[140:143],v233,s[8:11],s57 offen offset:3072
s_add_u32 s57, s61, 36864
buffer_load_dwordx4 a[144:147],v233,s[8:11],s57 offen
buffer_load_dwordx4 a[148:151],v233,s[8:11],s57 offen offset:1024
buffer_load_dwordx4 a[152:155],v233,s[8:11],s57 offen offset:2048
buffer_load_dwordx4 a[156:159],v233,s[8:11],s57 offen offset:3072
s_add_u32 m0, s58, 49152
s_add_u32 s57, s59, 245760
buffer_load_dwordx4 v230,s[16:19],s57 offen lds
s_add_u32 m0, s58, 50176
s_add_u32 s57, s59, 245840
buffer_load_dwordx4 v230,s[16:19],s57 offen lds
s_add_u32 m0, s58, 51200
s_add_u32 s57, s59, 247040
buffer_load_dwordx4 v230,s[16:19],s57 offen lds
s_add_u32 m0, s58, 52224
s_add_u32 s57, s59, 247120
buffer_load_dwordx4 v230,s[16:19],s57 offen lds
s_add_u32 m0, s58, 53248
s_add_u32 s57, s59, 248320
buffer_load_dwordx4 v230,s[16:19],s57 offen lds
s_add_u32 m0, s58, 54272
s_add_u32 s57, s59, 248400
buffer_load_dwordx4 v230,s[16:19],s57 offen lds
s_add_u32 m0, s58, 73728
s_add_u32 s57, s59, 368640
buffer_load_dwordx4 v230,s[16:19],s57 offen lds
s_add_u32 m0, s58, 74752
s_add_u32 s57, s59, 368720
buffer_load_dwordx4 v230,s[16:19],s57 offen lds
s_add_u32 m0, s58, 75776
s_add_u32 s57, s59, 369920
buffer_load_dwordx4 v230,s[16:19],s57 offen lds
s_add_u32 m0, s58, 76800
s_add_u32 s57, s59, 370000
buffer_load_dwordx4 v230,s[16:19],s57 offen lds
s_add_u32 m0, s58, 77824
s_add_u32 s57, s59, 371200
buffer_load_dwordx4 v230,s[16:19],s57 offen lds
s_add_u32 m0, s58, 78848
s_add_u32 s57, s59, 371280
buffer_load_dwordx4 v230,s[16:19],s57 offen lds
s_waitcnt vmcnt(58)
s_waitcnt vmcnt(12)
s_barrier
ds_read_b64_tr_b16 v[192:193],v224 offset:0
ds_read_b64_tr_b16 v[194:195],v224 offset:256
ds_read_b64_tr_b16 v[196:197],v224 offset:512
ds_read_b64_tr_b16 v[198:199],v224 offset:768
ds_read_b64_tr_b16 v[200:201],v224 offset:1024
ds_read_b64_tr_b16 v[202:203],v224 offset:1280
ds_read_b64_tr_b16 v[204:205],v224 offset:1536
ds_read_b64_tr_b16 v[206:207],v224 offset:1792
ds_read_b64_tr_b16 v[208:209],v224 offset:2048
ds_read_b64_tr_b16 v[210:211],v224 offset:2304
ds_read_b64_tr_b16 v[212:213],v224 offset:2560
ds_read_b64_tr_b16 v[214:215],v224 offset:2816
ds_read_b64_tr_b16 v[216:217],v224 offset:3072
ds_read_b64_tr_b16 v[218:219],v224 offset:3328
s_waitcnt lgkmcnt(12)
v_mfma_f32_32x32x16_bf16 v[0:15],v[192:195],a[0:3],0
ds_read_b64_tr_b16 v[220:221],v224 offset:3584
ds_read_b64_tr_b16 v[222:223],v224 offset:3840
s_waitcnt lgkmcnt(12)
v_mfma_f32_32x32x16_bf16 v[16:31],v[196:199],a[0:3],0
s_add_u32 m0, s58, 98304
s_add_u32 s57, s59, 491520
buffer_load_dwordx4 v230,s[16:19],s57 offen lds
ds_read_b64_tr_b16 v[192:193],v224 offset:4096
ds_read_b64_tr_b16 v[194:195],v224 offset:4352
s_waitcnt lgkmcnt(12)
v_mfma_f32_32x32x16_bf16 v[32:47],v[200:203],a[0:3],0
ds_read_b64_tr_b16 v[196:197],v224 offset:4608
ds_read_b64_tr_b16 v[198:199],v224 offset:4864
s_waitcnt lgkmcnt(12)
v_mfma_f32_32x32x16_bf16 v[48:63],v[204:207],a[0:3],0
s_add_u32 m0, s58, 99328
s_add_u32 s57, s59, 491600
buffer_load_dwordx4 v230,s[16:19],s57 offen lds
ds_read_b64_tr_b16 v[200:201],v224 offset:5120
ds_read_b64_tr_b16 v[202:203],v224 offset:5376
s_waitcnt lgkmcnt(12)
v_mfma_f32_32x32x16_bf16 v[64:79],v[208:211],a[0:3],0
ds_read_b64_tr_b16 v[204:205],v224 offset:5632
ds_read_b64_tr_b16 v[206:207],v224 offset:5888
s_waitcnt lgkmcnt(12)
v_mfma_f32_32x32x16_bf16 v[80:95],v[212:215],a[0:3],0
s_add_u32 m0, s58, 100352
s_add_u32 s57, s59, 492800
buffer_load_dwordx4 v230,s[16:19],s57 offen lds
ds_read_b64_tr_b16 v[208:209],v224 offset:12288
ds_read_b64_tr_b16 v[210:211],v224 offset:12544
s_waitcnt lgkmcnt(12)
v_mfma_f32_32x32x16_bf16 v[96:111],v[216:219],a[0:3],0
ds_read_b64_tr_b16 v[212:213],v224 offset:12800
ds_read_b64_tr_b16 v[214:215],v224 offset:13056
s_waitcnt lgkmcnt(12)
v_mfma_f32_32x32x16_bf16 v[112:127],v[220:223],a[0:3],0
s_add_u32 m0, s58, 101376
s_add_u32 s57, s59, 492880
buffer_load_dwordx4 v230,s[16:19],s57 offen lds
ds_read_b64_tr_b16 v[216:217],v224 offset:13312
ds_read_b64_tr_b16 v[218:219],v224 offset:13568
s_waitcnt lgkmcnt(12)
v_mfma_f32_32x32x16_bf16 v[128:143],a[0:3],v[192:195],0
ds_read_b64_tr_b16 v[220:221],v224 offset:13824
ds_read_b64_tr_b16 v[222:223],v224 offset:14080
s_waitcnt lgkmcnt(12)
v_mfma_f32_32x32x16_bf16 v[144:159],a[0:3],v[196:199],0
s_add_u32 m0, s58, 102400
s_add_u32 s57, s59, 494080
buffer_load_dwordx4 v230,s[16:19],s57 offen lds
ds_read_b64_tr_b16 v[192:193],v224 offset:14336
ds_read_b64_tr_b16 v[194:195],v224 offset:14592
s_waitcnt lgkmcnt(12)
v_mfma_f32_32x32x16_bf16 v[160:175],a[0:3],v[200:203],0
ds_read_b64_tr_b16 v[196:197],v224 offset:14848
ds_read_b64_tr_b16 v[198:199],v224 offset:15104
s_waitcnt lgkmcnt(12)
v_mfma_f32_32x32x16_bf16 v[176:191],a[0:3],v[204:207],0
s_add_u32 m0, s58, 103424
s_add_u32 s57, s59, 494160
buffer_load_dwordx4 v230,s[16:19],s57 offen lds
ds_read_b64_tr_b16 v[200:201],v224 offset:15360
ds_read_b64_tr_b16 v[202:203],v224 offset:15616
s_waitcnt lgkmcnt(12)
v_mfma_f32_32x32x16_bf16 v[0:15],v[208:211],a[4:7],v[0:15]
ds_read_b64_tr_b16 v[204:205],v224 offset:15872
ds_read_b64_tr_b16 v[206:207],v224 offset:16128
s_waitcnt lgkmcnt(12)
v_mfma_f32_32x32x16_bf16 v[16:31],v[212:215],a[4:7],v[16:31]
ds_read_b64_tr_b16 v[208:209],v224 offset:16384
ds_read_b64_tr_b16 v[210:211],v224 offset:16640
s_waitcnt lgkmcnt(12)
v_mfma_f32_32x32x16_bf16 v[32:47],v[216:219],a[4:7],v[32:47]
ds_read_b64_tr_b16 v[212:213],v224 offset:16896
ds_read_b64_tr_b16 v[214:215],v224 offset:17152
s_waitcnt lgkmcnt(12)
v_mfma_f32_32x32x16_bf16 v[48:63],v[220:223],a[4:7],v[48:63]
ds_read_b64_tr_b16 v[216:217],v224 offset:17408
ds_read_b64_tr_b16 v[218:219],v224 offset:17664
s_waitcnt lgkmcnt(12)
v_mfma_f32_32x32x16_bf16 v[64:79],v[192:195],a[4:7],v[64:79]
ds_read_b64_tr_b16 v[220:221],v224 offset:17920
ds_read_b64_tr_b16 v[222:223],v224 offset:18176
s_waitcnt lgkmcnt(12)
v_mfma_f32_32x32x16_bf16 v[80:95],v[196:199],a[4:7],v[80:95]
s_barrier
ds_read_b64_tr_b16 v[192:193],v224 offset:24576
ds_read_b64_tr_b16 v[194:195],v224 offset:24832
s_waitcnt lgkmcnt(12)
v_mfma_f32_32x32x16_bf16 v[96:111],v[200:203],a[4:7],v[96:111]
ds_read_b64_tr_b16 v[196:197],v224 offset:25088
ds_read_b64_tr_b16 v[198:199],v224 offset:25344
s_waitcnt lgkmcnt(12)
v_mfma_f32_32x32x16_bf16 v[112:127],v[204:207],a[4:7],v[112:127]
ds_read_b64_tr_b16 v[200:201],v224 offset:25600
ds_read_b64_tr_b16 v[202:203],v224 offset:25856
s_waitcnt lgkmcnt(12)
v_mfma_f32_32x32x16_bf16 v[128:143],a[4:7],v[208:211],v[128:143]
ds_read_b64_tr_b16 v[204:205],v224 offset:26112
ds_read_b64_tr_b16 v[206:207],v224 offset:26368
s_waitcnt lgkmcnt(12)
v_mfma_f32_32x32x16_bf16 v[144:159],a[4:7],v[212:215],v[144:159]
ds_read_b64_tr_b16 v[208:209],v224 offset:26624
ds_read_b64_tr_b16 v[210:211],v224 offset:26880
s_waitcnt lgkmcnt(12)
v_mfma_f32_32x32x16_bf16 v[160:175],a[4:7],v[216:219],v[160:175]
ds_read_b64_tr_b16 v[212:213],v224 offset:27136
ds_read_b64_tr_b16 v[214:215],v224 offset:27392
s_waitcnt lgkmcnt(12)
v_mfma_f32_32x32x16_bf16 v[176:191],a[4:7],v[220:223],v[176:191]
ds_read_b64_tr_b16 v[216:217],v224 offset:27648
ds_read_b64_tr_b16 v[218:219],v224 offset:27904
s_waitcnt lgkmcnt(12)
v_mfma_f32_32x32x16_bf16 v[0:15],v[192:195],a[8:11],v[0:15]
ds_read_b64_tr_b16 v[220:221],v224 offset:28160
ds_read_b64_tr_b16 v[222:223],v224 offset:28416
s_waitcnt lgkmcnt(12)
v_mfma_f32_32x32x16_bf16 v[16:31],v[196:199],a[8:11],v[16:31]
s_add_u32 m0, s58, 0
s_add_u32 s57, s59, 614400
buffer_load_dwordx4 v230,s[16:19],s57 offen lds
ds_read_b64_tr_b16 v[192:193],v224 offset:28672
ds_read_b64_tr_b16 v[194:195],v224 offset:28928
s_waitcnt lgkmcnt(12)
v_mfma_f32_32x32x16_bf16 v[32:47],v[200:203],a[8:11],v[32:47]
ds_read_b64_tr_b16 v[196:197],v224 offset:29184
ds_read_b64_tr_b16 v[198:199],v224 offset:29440
s_waitcnt lgkmcnt(12)
v_mfma_f32_32x32x16_bf16 v[48:63],v[204:207],a[8:11],v[48:63]
s_add_u32 m0, s58, 1024
s_add_u32 s57, s59, 614480
buffer_load_dwordx4 v230,s[16:19],s57 offen lds
ds_read_b64_tr_b16 v[200:201],v224 offset:29696
ds_read_b64_tr_b16 v[202:203],v224 offset:29952
s_waitcnt lgkmcnt(12)
v_mfma_f32_32x32x16_bf16 v[64:79],v[208:211],a[8:11],v[64:79]
ds_read_b64_tr_b16 v[204:205],v224 offset:30208
ds_read_b64_tr_b16 v[206:207],v224 offset:30464
s_waitcnt lgkmcnt(12)
v_mfma_f32_32x32x16_bf16 v[80:95],v[212:215],a[8:11],v[80:95]
s_add_u32 m0, s58, 2048
s_add_u32 s57, s59, 615680
buffer_load_dwordx4 v230,s[16:19],s57 offen lds
ds_read_b64_tr_b16 v[208:209],v224 offset:36864
ds_read_b64_tr_b16 v[210:211],v224 offset:37120
s_waitcnt lgkmcnt(12)
v_mfma_f32_32x32x16_bf16 v[96:111],v[216:219],a[8:11],v[96:111]
ds_read_b64_tr_b16 v[212:213],v224 offset:37376
ds_read_b64_tr_b16 v[214:215],v224 offset:37632
s_waitcnt lgkmcnt(12)
v_mfma_f32_32x32x16_bf16 v[112:127],v[220:223],a[8:11],v[112:127]
s_add_u32 m0, s58, 3072
s_add_u32 s57, s59, 615760
buffer_load_dwordx4 v230,s[16:19],s57 offen lds
ds_read_b64_tr_b16 v[216:217],v224 offset:37888
ds_read_b64_tr_b16 v[218:219],v224 offset:38144
s_waitcnt lgkmcnt(12)
v_mfma_f32_32x32x16_bf16 v[128:143],a[8:11],v[192:195],v[128:143]
ds_read_b64_tr_b16 v[220:221],v224 offset:38400
ds_read_b64_tr_b16 v[222:223],v224 offset:38656
s_waitcnt lgkmcnt(12)
v_mfma_f32_32x32x16_bf16 v[144:159],a[8:11],v[196:199],v[144:159]
s_add_u32 m0, s58, 4096
s_add_u32 s57, s59, 616960
buffer_load_dwordx4 v230,s[16:19],s57 offen lds
ds_read_b64_tr_b16 v[192:193],v224 offset:38912
ds_read_b64_tr_b16 v[194:195],v224 offset:39168
s_waitcnt lgkmcnt(12)
v_mfma_f32_32x32x16_bf16 v[160:175],a[8:11],v[200:203],v[160:175]
ds_read_b64_tr_b16 v[196:197],v224 offset:39424
ds_read_b64_tr_b16 v[198:199],v224 offset:39680
s_waitcnt lgkmcnt(12)
v_mfma_f32_32x32x16_bf16 v[176:191],a[8:11],v[204:207],v[176:191]
s_add_u32 m0, s58, 5120
s_add_u32 s57, s59, 617040
buffer_load_dwordx4 v230,s[16:19],s57 offen lds
ds_read_b64_tr_b16 v[200:201],v224 offset:39936
ds_read_b64_tr_b16 v[202:203],v224 offset:40192
s_waitcnt lgkmcnt(12)
v_mfma_f32_32x32x16_bf16 v[0:15],v[208:211],a[12:15],v[0:15]
ds_read_b64_tr_b16 v[204:205],v224 offset:40448
ds_read_b64_tr_b16 v[206:207],v224 offset:40704
s_waitcnt lgkmcnt(12)
v_mfma_f32_32x32x16_bf16 v[16:31],v[212:215],a[12:15],v[16:31]
ds_read_b64_tr_b16 v[208:209],v224 offset:40960
ds_read_b64_tr_b16 v[210:211],v224 offset:41216
s_waitcnt lgkmcnt(12)
v_mfma_f32_32x32x16_bf16 v[32:47],v[216:219],a[12:15],v[32:47]
ds_read_b64_tr_b16 v[212:213],v224 offset:41472
ds_read_b64_tr_b16 v[214:215],v224 offset:41728
s_waitcnt lgkmcnt(12)
v_mfma_f32_32x32x16_bf16 v[48:63],v[220:223],a[12:15],v[48:63]
ds_read_b64_tr_b16 v[216:217],v224 offset:41984
ds_read_b64_tr_b16 v[218:219],v224 offset:42240
s_waitcnt lgkmcnt(12)
v_mfma_f32_32x32x16_bf16 v[64:79],v[192:195],a[12:15],v[64:79]
ds_read_b64_tr_b16 v[220:221],v224 offset:42496
ds_read_b64_tr_b16 v[222:223],v224 offset:42752
s_waitcnt lgkmcnt(12)
v_mfma_f32_32x32x16_bf16 v[80:95],v[196:199],a[12:15],v[80:95]
s_waitcnt vmcnt(18)
s_barrier
ds_read_b64_tr_b16 v[192:193],v225 offset:0
ds_read_b64_tr_b16 v[194:195],v225 offset:256
s_waitcnt lgkmcnt(12)
v_mfma_f32_32x32x16_bf16 v[96:111],v[200:203],a[12:15],v[96:111]
ds_read_b64_tr_b16 v[196:197],v225 offset:512
ds_read_b64_tr_b16 v[198:199],v225 offset:768
s_waitcnt lgkmcnt(12)
v_mfma_f32_32x32x16_bf16 v[112:127],v[204:207],a[12:15],v[112:127]
ds_read_b64_tr_b16 v[200:201],v225 offset:1024
ds_read_b64_tr_b16 v[202:203],v225 offset:1280
s_waitcnt lgkmcnt(12)
v_mfma_f32_32x32x16_bf16 v[128:143],a[12:15],v[208:211],v[128:143]
ds_read_b64_tr_b16 v[204:205],v225 offset:1536
ds_read_b64_tr_b16 v[206:207],v225 offset:1792
s_waitcnt lgkmcnt(12)
v_mfma_f32_32x32x16_bf16 v[144:159],a[12:15],v[212:215],v[144:159]
ds_read_b64_tr_b16 v[208:209],v225 offset:2048
ds_read_b64_tr_b16 v[210:211],v225 offset:2304
s_waitcnt lgkmcnt(12)
v_mfma_f32_32x32x16_bf16 v[160:175],a[12:15],v[216:219],v[160:175]
ds_read_b64_tr_b16 v[212:213],v225 offset:2560
ds_read_b64_tr_b16 v[214:215],v225 offset:2816
s_waitcnt lgkmcnt(12)
v_mfma_f32_32x32x16_bf16 v[176:191],a[12:15],v[220:223],v[176:191]
ds_read_b64_tr_b16 v[216:217],v225 offset:3072
ds_read_b64_tr_b16 v[218:219],v225 offset:3328
s_waitcnt lgkmcnt(12)
v_mfma_f32_32x32x16_bf16 v[0:15],v[192:195],a[16:19],v[0:15]
ds_read_b64_tr_b16 v[220:221],v225 offset:3584
ds_read_b64_tr_b16 v[222:223],v225 offset:3840
s_waitcnt lgkmcnt(12)
v_mfma_f32_32x32x16_bf16 v[16:31],v[196:199],a[16:19],v[16:31]
s_add_u32 m0, s58, 24576
s_add_u32 s57, s59, 737280
buffer_load_dwordx4 v230,s[16:19],s57 offen lds
ds_read_b64_tr_b16 v[192:193],v225 offset:4096
ds_read_b64_tr_b16 v[194:195],v225 offset:4352
s_waitcnt lgkmcnt(12)
v_mfma_f32_32x32x16_bf16 v[32:47],v[200:203],a[16:19],v[32:47]
ds_read_b64_tr_b16 v[196:197],v225 offset:4608
ds_read_b64_tr_b16 v[198:199],v225 offset:4864
s_waitcnt lgkmcnt(12)
v_mfma_f32_32x32x16_bf16 v[48:63],v[204:207],a[16:19],v[48:63]
s_add_u32 m0, s58, 25600
s_add_u32 s57, s59, 737360
buffer_load_dwordx4 v230,s[16:19],s57 offen lds
ds_read_b64_tr_b16 v[200:201],v225 offset:5120
ds_read_b64_tr_b16 v[202:203],v225 offset:5376
s_waitcnt lgkmcnt(12)
v_mfma_f32_32x32x16_bf16 v[64:79],v[208:211],a[16:19],v[64:79]
ds_read_b64_tr_b16 v[204:205],v225 offset:5632
ds_read_b64_tr_b16 v[206:207],v225 offset:5888
s_waitcnt lgkmcnt(12)
v_mfma_f32_32x32x16_bf16 v[80:95],v[212:215],a[16:19],v[80:95]
s_add_u32 m0, s58, 26624
s_add_u32 s57, s59, 738560
buffer_load_dwordx4 v230,s[16:19],s57 offen lds
ds_read_b64_tr_b16 v[208:209],v225 offset:12288
ds_read_b64_tr_b16 v[210:211],v225 offset:12544
s_waitcnt lgkmcnt(12)
v_mfma_f32_32x32x16_bf16 v[96:111],v[216:219],a[16:19],v[96:111]
ds_read_b64_tr_b16 v[212:213],v225 offset:12800
ds_read_b64_tr_b16 v[214:215],v225 offset:13056
s_waitcnt lgkmcnt(12)
v_mfma_f32_32x32x16_bf16 v[112:127],v[220:223],a[16:19],v[112:127]
s_add_u32 m0, s58, 27648
s_add_u32 s57, s59, 738640
buffer_load_dwordx4 v230,s[16:19],s57 offen lds
ds_read_b64_tr_b16 v[216:217],v225 offset:13312
ds_read_b64_tr_b16 v[218:219],v225 offset:13568
s_waitcnt lgkmcnt(12)
v_mfma_f32_32x32x16_bf16 v[128:143],a[16:19],v[192:195],v[128:143]
ds_read_b64_tr_b16 v[220:221],v225 offset:13824
ds_read_b64_tr_b16 v[222:223],v225 offset:14080
s_waitcnt lgkmcnt(12)
v_mfma_f32_32x32x16_bf16 v[144:159],a[16:19],v[196:199],v[144:159]
s_add_u32 m0, s58, 28672
s_add_u32 s57, s59, 739840
buffer_load_dwordx4 v230,s[16:19],s57 offen lds
ds_read_b64_tr_b16 v[192:193],v225 offset:14336
ds_read_b64_tr_b16 v[194:195],v225 offset:14592
s_waitcnt lgkmcnt(12)
v_mfma_f32_32x32x16_bf16 v[160:175],a[16:19],v[200:203],v[160:175]
ds_read_b64_tr_b16 v[196:197],v225 offset:14848
ds_read_b64_tr_b16 v[198:199],v225 offset:15104
s_waitcnt lgkmcnt(12)
v_mfma_f32_32x32x16_bf16 v[176:191],a[16:19],v[204:207],v[176:191]
s_add_u32 m0, s58, 29696
s_add_u32 s57, s59, 739920
buffer_load_dwordx4 v230,s[16:19],s57 offen lds
ds_read_b64_tr_b16 v[200:201],v225 offset:15360
ds_read_b64_tr_b16 v[202:203],v225 offset:15616
s_waitcnt lgkmcnt(12)
v_mfma_f32_32x32x16_bf16 v[0:15],v[208:211],a[20:23],v[0:15]
ds_read_b64_tr_b16 v[204:205],v225 offset:15872
ds_read_b64_tr_b16 v[206:207],v225 offset:16128
s_waitcnt lgkmcnt(12)
v_mfma_f32_32x32x16_bf16 v[16:31],v[212:215],a[20:23],v[16:31]
ds_read_b64_tr_b16 v[208:209],v225 offset:16384
ds_read_b64_tr_b16 v[210:211],v225 offset:16640
s_waitcnt lgkmcnt(12)
v_mfma_f32_32x32x16_bf16 v[32:47],v[216:219],a[20:23],v[32:47]
ds_read_b64_tr_b16 v[212:213],v225 offset:16896
ds_read_b64_tr_b16 v[214:215],v225 offset:17152
s_waitcnt lgkmcnt(12)
v_mfma_f32_32x32x16_bf16 v[48:63],v[220:223],a[20:23],v[48:63]
ds_read_b64_tr_b16 v[216:217],v225 offset:17408
ds_read_b64_tr_b16 v[218:219],v225 offset:17664
s_waitcnt lgkmcnt(12)
v_mfma_f32_32x32x16_bf16 v[64:79],v[192:195],a[20:23],v[64:79]
ds_read_b64_tr_b16 v[220:221],v225 offset:17920
ds_read_b64_tr_b16 v[222:223],v225 offset:18176
s_waitcnt lgkmcnt(12)
v_mfma_f32_32x32x16_bf16 v[80:95],v[196:199],a[20:23],v[80:95]
s_waitcnt vmcnt(18)
s_barrier
ds_read_b64_tr_b16 v[192:193],v225 offset:24576
ds_read_b64_tr_b16 v[194:195],v225 offset:24832
s_waitcnt lgkmcnt(12)
v_mfma_f32_32x32x16_bf16 v[96:111],v[200:203],a[20:23],v[96:111]
ds_read_b64_tr_b16 v[196:197],v225 offset:25088
ds_read_b64_tr_b16 v[198:199],v225 offset:25344
s_waitcnt lgkmcnt(12)
v_mfma_f32_32x32x16_bf16 v[112:127],v[204:207],a[20:23],v[112:127]
ds_read_b64_tr_b16 v[200:201],v225 offset:25600
ds_read_b64_tr_b16 v[202:203],v225 offset:25856
s_waitcnt lgkmcnt(12)
v_mfma_f32_32x32x16_bf16 v[128:143],a[20:23],v[208:211],v[128:143]
ds_read_b64_tr_b16 v[204:205],v225 offset:26112
ds_read_b64_tr_b16 v[206:207],v225 offset:26368
s_waitcnt lgkmcnt(12)
v_mfma_f32_32x32x16_bf16 v[144:159],a[20:23],v[212:215],v[144:159]
ds_read_b64_tr_b16 v[208:209],v225 offset:26624
ds_read_b64_tr_b16 v[210:211],v225 offset:26880
s_waitcnt lgkmcnt(12)
v_mfma_f32_32x32x16_bf16 v[160:175],a[20:23],v[216:219],v[160:175]
ds_read_b64_tr_b16 v[212:213],v225 offset:27136
ds_read_b64_tr_b16 v[214:215],v225 offset:27392
s_waitcnt lgkmcnt(12)
v_mfma_f32_32x32x16_bf16 v[176:191],a[20:23],v[220:223],v[176:191]
ds_read_b64_tr_b16 v[216:217],v225 offset:27648
ds_read_b64_tr_b16 v[218:219],v225 offset:27904
s_waitcnt lgkmcnt(12)
v_mfma_f32_32x32x16_bf16 v[0:15],v[192:195],a[24:27],v[0:15]
ds_read_b64_tr_b16 v[220:221],v225 offset:28160
ds_read_b64_tr_b16 v[222:223],v225 offset:28416
s_waitcnt lgkmcnt(12)
v_mfma_f32_32x32x16_bf16 v[16:31],v[196:199],a[24:27],v[16:31]
s_add_u32 m0, s58, 49152
s_add_u32 s57, s59, 860160
buffer_load_dwordx4 v230,s[16:19],s57 offen lds
ds_read_b64_tr_b16 v[192:193],v225 offset:28672
ds_read_b64_tr_b16 v[194:195],v225 offset:28928
s_waitcnt lgkmcnt(12)
v_mfma_f32_32x32x16_bf16 v[32:47],v[200:203],a[24:27],v[32:47]
ds_read_b64_tr_b16 v[196:197],v225 offset:29184
ds_read_b64_tr_b16 v[198:199],v225 offset:29440
s_waitcnt lgkmcnt(12)
v_mfma_f32_32x32x16_bf16 v[48:63],v[204:207],a[24:27],v[48:63]
s_add_u32 m0, s58, 50176
s_add_u32 s57, s59, 860240
buffer_load_dwordx4 v230,s[16:19],s57 offen lds
ds_read_b64_tr_b16 v[200:201],v225 offset:29696
ds_read_b64_tr_b16 v[202:203],v225 offset:29952
s_waitcnt lgkmcnt(12)
v_mfma_f32_32x32x16_bf16 v[64:79],v[208:211],a[24:27],v[64:79]
ds_read_b64_tr_b16 v[204:205],v225 offset:30208
ds_read_b64_tr_b16 v[206:207],v225 offset:30464
s_waitcnt lgkmcnt(12)
v_mfma_f32_32x32x16_bf16 v[80:95],v[212:215],a[24:27],v[80:95]
s_add_u32 m0, s58, 51200
s_add_u32 s57, s59, 861440
buffer_load_dwordx4 v230,s[16:19],s57 offen lds
ds_read_b64_tr_b16 v[208:209],v225 offset:36864
ds_read_b64_tr_b16 v[210:211],v225 offset:37120
s_waitcnt lgkmcnt(12)
v_mfma_f32_32x32x16_bf16 v[96:111],v[216:219],a[24:27],v[96:111]
ds_read_b64_tr_b16 v[212:213],v225 offset:37376
ds_read_b64_tr_b16 v[214:215],v225 offset:37632
s_waitcnt lgkmcnt(12)
v_mfma_f32_32x32x16_bf16 v[112:127],v[220:223],a[24:27],v[112:127]
s_add_u32 m0, s58, 52224
s_add_u32 s57, s59, 861520
buffer_load_dwordx4 v230,s[16:19],s57 offen lds
ds_read_b64_tr_b16 v[216:217],v225 offset:37888
ds_read_b64_tr_b16 v[218:219],v225 offset:38144
s_waitcnt lgkmcnt(12)
v_mfma_f32_32x32x16_bf16 v[128:143],a[24:27],v[192:195],v[128:143]
ds_read_b64_tr_b16 v[220:221],v225 offset:38400
ds_read_b64_tr_b16 v[222:223],v225 offset:38656
s_waitcnt lgkmcnt(12)
v_mfma_f32_32x32x16_bf16 v[144:159],a[24:27],v[196:199],v[144:159]
s_add_u32 m0, s58, 53248
s_add_u32 s57, s59, 862720
buffer_load_dwordx4 v230,s[16:19],s57 offen lds
ds_read_b64_tr_b16 v[192:193],v225 offset:38912
ds_read_b64_tr_b16 v[194:195],v225 offset:39168
s_waitcnt lgkmcnt(12)
v_mfma_f32_32x32x16_bf16 v[160:175],a[24:27],v[200:203],v[160:175]
ds_read_b64_tr_b16 v[196:197],v225 offset:39424
ds_read_b64_tr_b16 v[198:199],v225 offset:39680
s_waitcnt lgkmcnt(12)
v_mfma_f32_32x32x16_bf16 v[176:191],a[24:27],v[204:207],v[176:191]
s_add_u32 m0, s58, 54272
s_add_u32 s57, s59, 862800
buffer_load_dwordx4 v230,s[16:19],s57 offen lds
ds_read_b64_tr_b16 v[200:201],v225 offset:39936
ds_read_b64_tr_b16 v[202:203],v225 offset:40192
s_waitcnt lgkmcnt(12)
v_mfma_f32_32x32x16_bf16 v[0:15],v[208:211],a[28:31],v[0:15]
ds_read_b64_tr_b16 v[204:205],v225 offset:40448
ds_read_b64_tr_b16 v[206:207],v225 offset:40704
s_waitcnt lgkmcnt(12)
v_mfma_f32_32x32x16_bf16 v[16:31],v[212:215],a[28:31],v[16:31]
ds_read_b64_tr_b16 v[208:209],v225 offset:40960
ds_read_b64_tr_b16 v[210:211],v225 offset:41216
s_waitcnt lgkmcnt(12)
v_mfma_f32_32x32x16_bf16 v[32:47],v[216:219],a[28:31],v[32:47]
ds_read_b64_tr_b16 v[212:213],v225 offset:41472
ds_read_b64_tr_b16 v[214:215],v225 offset:41728
s_waitcnt lgkmcnt(12)
v_mfma_f32_32x32x16_bf16 v[48:63],v[220:223],a[28:31],v[48:63]
ds_read_b64_tr_b16 v[216:217],v225 offset:41984
ds_read_b64_tr_b16 v[218:219],v225 offset:42240
s_waitcnt lgkmcnt(12)
v_mfma_f32_32x32x16_bf16 v[64:79],v[192:195],a[28:31],v[64:79]
ds_read_b64_tr_b16 v[220:221],v225 offset:42496
ds_read_b64_tr_b16 v[222:223],v225 offset:42752
s_waitcnt lgkmcnt(12)
v_mfma_f32_32x32x16_bf16 v[80:95],v[196:199],a[28:31],v[80:95]
s_waitcnt vmcnt(18)
s_barrier
ds_read_b64_tr_b16 v[192:193],v226 offset:0
ds_read_b64_tr_b16 v[194:195],v226 offset:256
s_waitcnt lgkmcnt(12)
v_mfma_f32_32x32x16_bf16 v[96:111],v[200:203],a[28:31],v[96:111]
ds_read_b64_tr_b16 v[196:197],v226 offset:512
ds_read_b64_tr_b16 v[198:199],v226 offset:768
s_waitcnt lgkmcnt(12)
v_mfma_f32_32x32x16_bf16 v[112:127],v[204:207],a[28:31],v[112:127]
ds_read_b64_tr_b16 v[200:201],v226 offset:1024
ds_read_b64_tr_b16 v[202:203],v226 offset:1280
s_waitcnt lgkmcnt(12)
v_mfma_f32_32x32x16_bf16 v[128:143],a[28:31],v[208:211],v[128:143]
ds_read_b64_tr_b16 v[204:205],v226 offset:1536
ds_read_b64_tr_b16 v[206:207],v226 offset:1792
s_waitcnt lgkmcnt(12)
v_mfma_f32_32x32x16_bf16 v[144:159],a[28:31],v[212:215],v[144:159]
ds_read_b64_tr_b16 v[208:209],v226 offset:2048
ds_read_b64_tr_b16 v[210:211],v226 offset:2304
s_waitcnt lgkmcnt(12)
v_mfma_f32_32x32x16_bf16 v[160:175],a[28:31],v[216:219],v[160:175]
ds_read_b64_tr_b16 v[212:213],v226 offset:2560
ds_read_b64_tr_b16 v[214:215],v226 offset:2816
s_waitcnt lgkmcnt(12)
v_mfma_f32_32x32x16_bf16 v[176:191],a[28:31],v[220:223],v[176:191]
ds_read_b64_tr_b16 v[216:217],v226 offset:3072
ds_read_b64_tr_b16 v[218:219],v226 offset:3328
s_waitcnt lgkmcnt(12)
v_mfma_f32_32x32x16_bf16 v[0:15],v[192:195],a[32:35],v[0:15]
ds_read_b64_tr_b16 v[220:221],v226 offset:3584
ds_read_b64_tr_b16 v[222:223],v226 offset:3840
s_waitcnt lgkmcnt(12)
v_mfma_f32_32x32x16_bf16 v[16:31],v[196:199],a[32:35],v[16:31]
s_add_u32 m0, s58, 73728
s_add_u32 s57, s59, 983040
buffer_load_dwordx4 v230,s[16:19],s57 offen lds
ds_read_b64_tr_b16 v[192:193],v226 offset:4096
ds_read_b64_tr_b16 v[194:195],v226 offset:4352
s_waitcnt lgkmcnt(12)
v_mfma_f32_32x32x16_bf16 v[32:47],v[200:203],a[32:35],v[32:47]
ds_read_b64_tr_b16 v[196:197],v226 offset:4608
ds_read_b64_tr_b16 v[198:199],v226 offset:4864
s_waitcnt lgkmcnt(12)
v_mfma_f32_32x32x16_bf16 v[48:63],v[204:207],a[32:35],v[48:63]
s_add_u32 m0, s58, 74752
s_add_u32 s57, s59, 983120
buffer_load_dwordx4 v230,s[16:19],s57 offen lds
ds_read_b64_tr_b16 v[200:201],v226 offset:5120
ds_read_b64_tr_b16 v[202:203],v226 offset:5376
s_waitcnt lgkmcnt(12)
v_mfma_f32_32x32x16_bf16 v[64:79],v[208:211],a[32:35],v[64:79]
ds_read_b64_tr_b16 v[204:205],v226 offset:5632
ds_read_b64_tr_b16 v[206:207],v226 offset:5888
s_waitcnt lgkmcnt(12)
v_mfma_f32_32x32x16_bf16 v[80:95],v[212:215],a[32:35],v[80:95]
s_add_u32 m0, s58, 75776
s_add_u32 s57, s59, 984320
buffer_load_dwordx4 v230,s[16:19],s57 offen lds
ds_read_b64_tr_b16 v[208:209],v226 offset:12288
ds_read_b64_tr_b16 v[210:211],v226 offset:12544
s_waitcnt lgkmcnt(12)
v_mfma_f32_32x32x16_bf16 v[96:111],v[216:219],a[32:35],v[96:111]
ds_read_b64_tr_b16 v[212:213],v226 offset:12800
ds_read_b64_tr_b16 v[214:215],v226 offset:13056
s_waitcnt lgkmcnt(12)
v_mfma_f32_32x32x16_bf16 v[112:127],v[220:223],a[32:35],v[112:127]
s_add_u32 m0, s58, 76800
s_add_u32 s57, s59, 984400
buffer_load_dwordx4 v230,s[16:19],s57 offen lds
ds_read_b64_tr_b16 v[216:217],v226 offset:13312
ds_read_b64_tr_b16 v[218:219],v226 offset:13568
s_waitcnt lgkmcnt(12)
v_mfma_f32_32x32x16_bf16 v[128:143],a[32:35],v[192:195],v[128:143]
ds_read_b64_tr_b16 v[220:221],v226 offset:13824
ds_read_b64_tr_b16 v[222:223],v226 offset:14080
s_waitcnt lgkmcnt(12)
v_mfma_f32_32x32x16_bf16 v[144:159],a[32:35],v[196:199],v[144:159]
s_add_u32 m0, s58, 77824
s_add_u32 s57, s59, 985600
buffer_load_dwordx4 v230,s[16:19],s57 offen lds
ds_read_b64_tr_b16 v[192:193],v226 offset:14336
ds_read_b64_tr_b16 v[194:195],v226 offset:14592
s_waitcnt lgkmcnt(12)
v_mfma_f32_32x32x16_bf16 v[160:175],a[32:35],v[200:203],v[160:175]
ds_read_b64_tr_b16 v[196:197],v226 offset:14848
ds_read_b64_tr_b16 v[198:199],v226 offset:15104
s_waitcnt lgkmcnt(12)
v_mfma_f32_32x32x16_bf16 v[176:191],a[32:35],v[204:207],v[176:191]
s_add_u32 m0, s58, 78848
s_add_u32 s57, s59, 985680
buffer_load_dwordx4 v230,s[16:19],s57 offen lds
ds_read_b64_tr_b16 v[200:201],v226 offset:15360
ds_read_b64_tr_b16 v[202:203],v226 offset:15616
s_waitcnt lgkmcnt(12)
v_mfma_f32_32x32x16_bf16 v[0:15],v[208:211],a[36:39],v[0:15]
ds_read_b64_tr_b16 v[204:205],v226 offset:15872
ds_read_b64_tr_b16 v[206:207],v226 offset:16128
s_waitcnt lgkmcnt(12)
v_mfma_f32_32x32x16_bf16 v[16:31],v[212:215],a[36:39],v[16:31]
ds_read_b64_tr_b16 v[208:209],v226 offset:16384
ds_read_b64_tr_b16 v[210:211],v226 offset:16640
s_waitcnt lgkmcnt(12)
v_mfma_f32_32x32x16_bf16 v[32:47],v[216:219],a[36:39],v[32:47]
ds_read_b64_tr_b16 v[212:213],v226 offset:16896
ds_read_b64_tr_b16 v[214:215],v226 offset:17152
s_waitcnt lgkmcnt(12)
v_mfma_f32_32x32x16_bf16 v[48:63],v[220:223],a[36:39],v[48:63]
ds_read_b64_tr_b16 v[216:217],v226 offset:17408
ds_read_b64_tr_b16 v[218:219],v226 offset:17664
s_waitcnt lgkmcnt(12)
v_mfma_f32_32x32x16_bf16 v[64:79],v[192:195],a[36:39],v[64:79]
ds_read_b64_tr_b16 v[220:221],v226 offset:17920
ds_read_b64_tr_b16 v[222:223],v226 offset:18176
s_waitcnt lgkmcnt(12)
v_mfma_f32_32x32x16_bf16 v[80:95],v[196:199],a[36:39],v[80:95]
s_waitcnt vmcnt(18)
s_barrier
ds_read_b64_tr_b16 v[192:193],v224 offset:0
ds_read_b64_tr_b16 v[194:195],v224 offset:256
s_waitcnt lgkmcnt(12)
v_mfma_f32_32x32x16_bf16 v[96:111],v[200:203],a[36:39],v[96:111]
ds_read_b64_tr_b16 v[196:197],v224 offset:512
ds_read_b64_tr_b16 v[198:199],v224 offset:768
s_waitcnt lgkmcnt(12)
v_mfma_f32_32x32x16_bf16 v[112:127],v[204:207],a[36:39],v[112:127]
ds_read_b64_tr_b16 v[200:201],v224 offset:1024
ds_read_b64_tr_b16 v[202:203],v224 offset:1280
s_waitcnt lgkmcnt(12)
v_mfma_f32_32x32x16_bf16 v[128:143],a[36:39],v[208:211],v[128:143]
ds_read_b64_tr_b16 v[204:205],v224 offset:1536
ds_read_b64_tr_b16 v[206:207],v224 offset:1792
s_waitcnt lgkmcnt(12)
v_mfma_f32_32x32x16_bf16 v[144:159],a[36:39],v[212:215],v[144:159]
ds_read_b64_tr_b16 v[208:209],v224 offset:2048
ds_read_b64_tr_b16 v[210:211],v224 offset:2304
s_waitcnt lgkmcnt(12)
v_mfma_f32_32x32x16_bf16 v[160:175],a[36:39],v[216:219],v[160:175]
ds_read_b64_tr_b16 v[212:213],v224 offset:2560
ds_read_b64_tr_b16 v[214:215],v224 offset:2816
s_waitcnt lgkmcnt(12)
v_mfma_f32_32x32x16_bf16 v[176:191],a[36:39],v[220:223],v[176:191]
ds_read_b64_tr_b16 v[216:217],v224 offset:3072
ds_read_b64_tr_b16 v[218:219],v224 offset:3328
s_waitcnt lgkmcnt(12)
v_mfma_f32_32x32x16_bf16 v[0:15],v[192:195],a[40:43],v[0:15]
ds_read_b64_tr_b16 v[220:221],v224 offset:3584
ds_read_b64_tr_b16 v[222:223],v224 offset:3840
s_waitcnt lgkmcnt(12)
v_mfma_f32_32x32x16_bf16 v[16:31],v[196:199],a[40:43],v[16:31]
s_add_u32 m0, s58, 98304
s_add_u32 s57, s59, 1105920
buffer_load_dwordx4 v230,s[16:19],s57 offen lds
ds_read_b64_tr_b16 v[192:193],v224 offset:4096
ds_read_b64_tr_b16 v[194:195],v224 offset:4352
s_waitcnt lgkmcnt(12)
v_mfma_f32_32x32x16_bf16 v[32:47],v[200:203],a[40:43],v[32:47]
ds_read_b64_tr_b16 v[196:197],v224 offset:4608
ds_read_b64_tr_b16 v[198:199],v224 offset:4864
s_waitcnt lgkmcnt(12)
v_mfma_f32_32x32x16_bf16 v[48:63],v[204:207],a[40:43],v[48:63]
s_add_u32 m0, s58, 99328
s_add_u32 s57, s59, 1106000
buffer_load_dwordx4 v230,s[16:19],s57 offen lds
ds_read_b64_tr_b16 v[200:201],v224 offset:5120
ds_read_b64_tr_b16 v[202:203],v224 offset:5376
s_waitcnt lgkmcnt(12)
v_mfma_f32_32x32x16_bf16 v[64:79],v[208:211],a[40:43],v[64:79]
ds_read_b64_tr_b16 v[204:205],v224 offset:5632
ds_read_b64_tr_b16 v[206:207],v224 offset:5888
s_waitcnt lgkmcnt(12)
v_mfma_f32_32x32x16_bf16 v[80:95],v[212:215],a[40:43],v[80:95]
s_add_u32 m0, s58, 100352
s_add_u32 s57, s59, 1107200
buffer_load_dwordx4 v230,s[16:19],s57 offen lds
ds_read_b64_tr_b16 v[208:209],v224 offset:12288
ds_read_b64_tr_b16 v[210:211],v224 offset:12544
s_waitcnt lgkmcnt(12)
v_mfma_f32_32x32x16_bf16 v[96:111],v[216:219],a[40:43],v[96:111]
ds_read_b64_tr_b16 v[212:213],v224 offset:12800
ds_read_b64_tr_b16 v[214:215],v224 offset:13056
s_waitcnt lgkmcnt(12)
v_mfma_f32_32x32x16_bf16 v[112:127],v[220:223],a[40:43],v[112:127]
s_add_u32 m0, s58, 101376
s_add_u32 s57, s59, 1107280
buffer_load_dwordx4 v230,s[16:19],s57 offen lds
ds_read_b64_tr_b16 v[216:217],v224 offset:13312
ds_read_b64_tr_b16 v[218:219],v224 offset:13568
s_waitcnt lgkmcnt(12)
v_mfma_f32_32x32x16_bf16 v[128:143],a[40:43],v[192:195],v[128:143]
ds_read_b64_tr_b16 v[220:221],v224 offset:13824
ds_read_b64_tr_b16 v[222:223],v224 offset:14080
s_waitcnt lgkmcnt(12)
v_mfma_f32_32x32x16_bf16 v[144:159],a[40:43],v[196:199],v[144:159]
s_add_u32 m0, s58, 102400
s_add_u32 s57, s59, 1108480
buffer_load_dwordx4 v230,s[16:19],s57 offen lds
ds_read_b64_tr_b16 v[192:193],v224 offset:14336
ds_read_b64_tr_b16 v[194:195],v224 offset:14592
s_waitcnt lgkmcnt(12)
v_mfma_f32_32x32x16_bf16 v[160:175],a[40:43],v[200:203],v[160:175]
ds_read_b64_tr_b16 v[196:197],v224 offset:14848
ds_read_b64_tr_b16 v[198:199],v224 offset:15104
s_waitcnt lgkmcnt(12)
v_mfma_f32_32x32x16_bf16 v[176:191],a[40:43],v[204:207],v[176:191]
s_add_u32 m0, s58, 103424
s_add_u32 s57, s59, 1108560
buffer_load_dwordx4 v230,s[16:19],s57 offen lds
ds_read_b64_tr_b16 v[200:201],v224 offset:15360
ds_read_b64_tr_b16 v[202:203],v224 offset:15616
s_waitcnt lgkmcnt(12)
v_mfma_f32_32x32x16_bf16 v[0:15],v[208:211],a[44:47],v[0:15]
ds_read_b64_tr_b16 v[204:205],v224 offset:15872
ds_read_b64_tr_b16 v[206:207],v224 offset:16128
s_waitcnt lgkmcnt(12)
v_mfma_f32_32x32x16_bf16 v[16:31],v[212:215],a[44:47],v[16:31]
ds_read_b64_tr_b16 v[208:209],v224 offset:16384
ds_read_b64_tr_b16 v[210:211],v224 offset:16640
s_waitcnt lgkmcnt(12)
v_mfma_f32_32x32x16_bf16 v[32:47],v[216:219],a[44:47],v[32:47]
ds_read_b64_tr_b16 v[212:213],v224 offset:16896
ds_read_b64_tr_b16 v[214:215],v224 offset:17152
s_waitcnt lgkmcnt(12)
v_mfma_f32_32x32x16_bf16 v[48:63],v[220:223],a[44:47],v[48:63]
ds_read_b64_tr_b16 v[216:217],v224 offset:17408
ds_read_b64_tr_b16 v[218:219],v224 offset:17664
s_waitcnt lgkmcnt(12)
v_mfma_f32_32x32x16_bf16 v[64:79],v[192:195],a[44:47],v[64:79]
ds_read_b64_tr_b16 v[220:221],v224 offset:17920
ds_read_b64_tr_b16 v[222:223],v224 offset:18176
s_waitcnt lgkmcnt(12)
v_mfma_f32_32x32x16_bf16 v[80:95],v[196:199],a[44:47],v[80:95]
s_waitcnt vmcnt(18)
s_barrier
ds_read_b64_tr_b16 v[192:193],v224 offset:24576
ds_read_b64_tr_b16 v[194:195],v224 offset:24832
s_waitcnt lgkmcnt(12)
v_mfma_f32_32x32x16_bf16 v[96:111],v[200:203],a[44:47],v[96:111]
ds_read_b64_tr_b16 v[196:197],v224 offset:25088
ds_read_b64_tr_b16 v[198:199],v224 offset:25344
s_waitcnt lgkmcnt(12)
v_mfma_f32_32x32x16_bf16 v[112:127],v[204:207],a[44:47],v[112:127]
ds_read_b64_tr_b16 v[200:201],v224 offset:25600
ds_read_b64_tr_b16 v[202:203],v224 offset:25856
s_waitcnt lgkmcnt(12)
v_mfma_f32_32x32x16_bf16 v[128:143],a[44:47],v[208:211],v[128:143]
ds_read_b64_tr_b16 v[204:205],v224 offset:26112
ds_read_b64_tr_b16 v[206:207],v224 offset:26368
s_waitcnt lgkmcnt(12)
v_mfma_f32_32x32x16_bf16 v[144:159],a[44:47],v[212:215],v[144:159]
ds_read_b64_tr_b16 v[208:209],v224 offset:26624
ds_read_b64_tr_b16 v[210:211],v224 offset:26880
s_waitcnt lgkmcnt(12)
v_mfma_f32_32x32x16_bf16 v[160:175],a[44:47],v[216:219],v[160:175]
ds_read_b64_tr_b16 v[212:213],v224 offset:27136
ds_read_b64_tr_b16 v[214:215],v224 offset:27392
s_waitcnt lgkmcnt(12)
v_mfma_f32_32x32x16_bf16 v[176:191],a[44:47],v[220:223],v[176:191]
ds_read_b64_tr_b16 v[216:217],v224 offset:27648
ds_read_b64_tr_b16 v[218:219],v224 offset:27904
s_waitcnt lgkmcnt(12)
v_mfma_f32_32x32x16_bf16 v[0:15],v[192:195],a[48:51],v[0:15]
ds_read_b64_tr_b16 v[220:221],v224 offset:28160
ds_read_b64_tr_b16 v[222:223],v224 offset:28416
s_waitcnt lgkmcnt(12)
v_mfma_f32_32x32x16_bf16 v[16:31],v[196:199],a[48:51],v[16:31]
s_add_u32 m0, s58, 0
s_add_u32 s57, s59, 1228800
buffer_load_dwordx4 v230,s[16:19],s57 offen lds
ds_read_b64_tr_b16 v[192:193],v224 offset:28672
ds_read_b64_tr_b16 v[194:195],v224 offset:28928
s_waitcnt lgkmcnt(12)
v_mfma_f32_32x32x16_bf16 v[32:47],v[200:203],a[48:51],v[32:47]
ds_read_b64_tr_b16 v[196:197],v224 offset:29184
ds_read_b64_tr_b16 v[198:199],v224 offset:29440
s_waitcnt lgkmcnt(12)
v_mfma_f32_32x32x16_bf16 v[48:63],v[204:207],a[48:51],v[48:63]
s_add_u32 m0, s58, 1024
s_add_u32 s57, s59, 1228880
buffer_load_dwordx4 v230,s[16:19],s57 offen lds
ds_read_b64_tr_b16 v[200:201],v224 offset:29696
ds_read_b64_tr_b16 v[202:203],v224 offset:29952
s_waitcnt lgkmcnt(12)
v_mfma_f32_32x32x16_bf16 v[64:79],v[208:211],a[48:51],v[64:79]
ds_read_b64_tr_b16 v[204:205],v224 offset:30208
ds_read_b64_tr_b16 v[206:207],v224 offset:30464
s_waitcnt lgkmcnt(12)
v_mfma_f32_32x32x16_bf16 v[80:95],v[212:215],a[48:51],v[80:95]
s_add_u32 m0, s58, 2048
s_add_u32 s57, s59, 1230080
buffer_load_dwordx4 v230,s[16:19],s57 offen lds
ds_read_b64_tr_b16 v[208:209],v224 offset:36864
ds_read_b64_tr_b16 v[210:211],v224 offset:37120
s_waitcnt lgkmcnt(12)
v_mfma_f32_32x32x16_bf16 v[96:111],v[216:219],a[48:51],v[96:111]
ds_read_b64_tr_b16 v[212:213],v224 offset:37376
ds_read_b64_tr_b16 v[214:215],v224 offset:37632
s_waitcnt lgkmcnt(12)
v_mfma_f32_32x32x16_bf16 v[112:127],v[220:223],a[48:51],v[112:127]
s_add_u32 m0, s58, 3072
s_add_u32 s57, s59, 1230160
buffer_load_dwordx4 v230,s[16:19],s57 offen lds
ds_read_b64_tr_b16 v[216:217],v224 offset:37888
ds_read_b64_tr_b16 v[218:219],v224 offset:38144
s_waitcnt lgkmcnt(12)
v_mfma_f32_32x32x16_bf16 v[128:143],a[48:51],v[192:195],v[128:143]
ds_read_b64_tr_b16 v[220:221],v224 offset:38400
ds_read_b64_tr_b16 v[222:223],v224 offset:38656
s_waitcnt lgkmcnt(12)
v_mfma_f32_32x32x16_bf16 v[144:159],a[48:51],v[196:199],v[144:159]
s_add_u32 m0, s58, 4096
s_add_u32 s57, s59, 1231360
buffer_load_dwordx4 v230,s[16:19],s57 offen lds
ds_read_b64_tr_b16 v[192:193],v224 offset:38912
ds_read_b64_tr_b16 v[194:195],v224 offset:39168
s_waitcnt lgkmcnt(12)
v_mfma_f32_32x32x16_bf16 v[160:175],a[48:51],v[200:203],v[160:175]
ds_read_b64_tr_b16 v[196:197],v224 offset:39424
ds_read_b64_tr_b16 v[198:199],v224 offset:39680
s_waitcnt lgkmcnt(12)
v_mfma_f32_32x32x16_bf16 v[176:191],a[48:51],v[204:207],v[176:191]
s_add_u32 m0, s58, 5120
s_add_u32 s57, s59, 1231440
buffer_load_dwordx4 v230,s[16:19],s57 offen lds
ds_read_b64_tr_b16 v[200:201],v224 offset:39936
ds_read_b64_tr_b16 v[202:203],v224 offset:40192
s_waitcnt lgkmcnt(12)
v_mfma_f32_32x32x16_bf16 v[0:15],v[208:211],a[52:55],v[0:15]
ds_read_b64_tr_b16 v[204:205],v224 offset:40448
ds_read_b64_tr_b16 v[206:207],v224 offset:40704
s_waitcnt lgkmcnt(12)
v_mfma_f32_32x32x16_bf16 v[16:31],v[212:215],a[52:55],v[16:31]
ds_read_b64_tr_b16 v[208:209],v224 offset:40960
ds_read_b64_tr_b16 v[210:211],v224 offset:41216
s_waitcnt lgkmcnt(12)
v_mfma_f32_32x32x16_bf16 v[32:47],v[216:219],a[52:55],v[32:47]
ds_read_b64_tr_b16 v[212:213],v224 offset:41472
ds_read_b64_tr_b16 v[214:215],v224 offset:41728
s_waitcnt lgkmcnt(12)
v_mfma_f32_32x32x16_bf16 v[48:63],v[220:223],a[52:55],v[48:63]
ds_read_b64_tr_b16 v[216:217],v224 offset:41984
ds_read_b64_tr_b16 v[218:219],v224 offset:42240
s_waitcnt lgkmcnt(12)
v_mfma_f32_32x32x16_bf16 v[64:79],v[192:195],a[52:55],v[64:79]
ds_read_b64_tr_b16 v[220:221],v224 offset:42496
ds_read_b64_tr_b16 v[222:223],v224 offset:42752
s_waitcnt lgkmcnt(12)
v_mfma_f32_32x32x16_bf16 v[80:95],v[196:199],a[52:55],v[80:95]
s_waitcnt vmcnt(18)
s_barrier
ds_read_b64_tr_b16 v[192:193],v225 offset:0
ds_read_b64_tr_b16 v[194:195],v225 offset:256
s_waitcnt lgkmcnt(12)
v_mfma_f32_32x32x16_bf16 v[96:111],v[200:203],a[52:55],v[96:111]
ds_read_b64_tr_b16 v[196:197],v225 offset:512
ds_read_b64_tr_b16 v[198:199],v225 offset:768
s_waitcnt lgkmcnt(12)
v_mfma_f32_32x32x16_bf16 v[112:127],v[204:207],a[52:55],v[112:127]
ds_read_b64_tr_b16 v[200:201],v225 offset:1024
ds_read_b64_tr_b16 v[202:203],v225 offset:1280
s_waitcnt lgkmcnt(12)
v_mfma_f32_32x32x16_bf16 v[128:143],a[52:55],v[208:211],v[128:143]
ds_read_b64_tr_b16 v[204:205],v225 offset:1536
ds_read_b64_tr_b16 v[206:207],v225 offset:1792
s_waitcnt lgkmcnt(12)
v_mfma_f32_32x32x16_bf16 v[144:159],a[52:55],v[212:215],v[144:159]
ds_read_b64_tr_b16 v[208:209],v225 offset:2048
ds_read_b64_tr_b16 v[210:211],v225 offset:2304
s_waitcnt lgkmcnt(12)
v_mfma_f32_32x32x16_bf16 v[160:175],a[52:55],v[216:219],v[160:175]
ds_read_b64_tr_b16 v[212:213],v225 offset:2560
ds_read_b64_tr_b16 v[214:215],v225 offset:2816
s_waitcnt lgkmcnt(12)
v_mfma_f32_32x32x16_bf16 v[176:191],a[52:55],v[220:223],v[176:191]
ds_read_b64_tr_b16 v[216:217],v225 offset:3072
ds_read_b64_tr_b16 v[218:219],v225 offset:3328
s_waitcnt lgkmcnt(12)
v_mfma_f32_32x32x16_bf16 v[0:15],v[192:195],a[56:59],v[0:15]
ds_read_b64_tr_b16 v[220:221],v225 offset:3584
ds_read_b64_tr_b16 v[222:223],v225 offset:3840
s_waitcnt lgkmcnt(12)
v_mfma_f32_32x32x16_bf16 v[16:31],v[196:199],a[56:59],v[16:31]
s_add_u32 m0, s58, 24576
s_add_u32 s57, s59, 1351680
buffer_load_dwordx4 v230,s[16:19],s57 offen lds
ds_read_b64_tr_b16 v[192:193],v225 offset:4096
ds_read_b64_tr_b16 v[194:195],v225 offset:4352
s_waitcnt lgkmcnt(12)
v_mfma_f32_32x32x16_bf16 v[32:47],v[200:203],a[56:59],v[32:47]
ds_read_b64_tr_b16 v[196:197],v225 offset:4608
ds_read_b64_tr_b16 v[198:199],v225 offset:4864
s_waitcnt lgkmcnt(12)
v_mfma_f32_32x32x16_bf16 v[48:63],v[204:207],a[56:59],v[48:63]
s_add_u32 m0, s58, 25600
s_add_u32 s57, s59, 1351760
buffer_load_dwordx4 v230,s[16:19],s57 offen lds
ds_read_b64_tr_b16 v[200:201],v225 offset:5120
ds_read_b64_tr_b16 v[202:203],v225 offset:5376
s_waitcnt lgkmcnt(12)
v_mfma_f32_32x32x16_bf16 v[64:79],v[208:211],a[56:59],v[64:79]
ds_read_b64_tr_b16 v[204:205],v225 offset:5632
ds_read_b64_tr_b16 v[206:207],v225 offset:5888
s_waitcnt lgkmcnt(12)
v_mfma_f32_32x32x16_bf16 v[80:95],v[212:215],a[56:59],v[80:95]
s_add_u32 m0, s58, 26624
s_add_u32 s57, s59, 1352960
buffer_load_dwordx4 v230,s[16:19],s57 offen lds
ds_read_b64_tr_b16 v[208:209],v225 offset:12288
ds_read_b64_tr_b16 v[210:211],v225 offset:12544
s_waitcnt lgkmcnt(12)
v_mfma_f32_32x32x16_bf16 v[96:111],v[216:219],a[56:59],v[96:111]
ds_read_b64_tr_b16 v[212:213],v225 offset:12800
ds_read_b64_tr_b16 v[214:215],v225 offset:13056
s_waitcnt lgkmcnt(12)
v_mfma_f32_32x32x16_bf16 v[112:127],v[220:223],a[56:59],v[112:127]
s_add_u32 m0, s58, 27648
s_add_u32 s57, s59, 1353040
buffer_load_dwordx4 v230,s[16:19],s57 offen lds
ds_read_b64_tr_b16 v[216:217],v225 offset:13312
ds_read_b64_tr_b16 v[218:219],v225 offset:13568
s_waitcnt lgkmcnt(12)
v_mfma_f32_32x32x16_bf16 v[128:143],a[56:59],v[192:195],v[128:143]
ds_read_b64_tr_b16 v[220:221],v225 offset:13824
ds_read_b64_tr_b16 v[222:223],v225 offset:14080
s_waitcnt lgkmcnt(12)
v_mfma_f32_32x32x16_bf16 v[144:159],a[56:59],v[196:199],v[144:159]
s_add_u32 m0, s58, 28672
s_add_u32 s57, s59, 1354240
buffer_load_dwordx4 v230,s[16:19],s57 offen lds
ds_read_b64_tr_b16 v[192:193],v225 offset:14336
ds_read_b64_tr_b16 v[194:195],v225 offset:14592
s_waitcnt lgkmcnt(12)
v_mfma_f32_32x32x16_bf16 v[160:175],a[56:59],v[200:203],v[160:175]
ds_read_b64_tr_b16 v[196:197],v225 offset:14848
ds_read_b64_tr_b16 v[198:199],v225 offset:15104
s_waitcnt lgkmcnt(12)
v_mfma_f32_32x32x16_bf16 v[176:191],a[56:59],v[204:207],v[176:191]
s_add_u32 m0, s58, 29696
s_add_u32 s57, s59, 1354320
buffer_load_dwordx4 v230,s[16:19],s57 offen lds
ds_read_b64_tr_b16 v[200:201],v225 offset:15360
ds_read_b64_tr_b16 v[202:203],v225 offset:15616
s_waitcnt lgkmcnt(12)
v_mfma_f32_32x32x16_bf16 v[0:15],v[208:211],a[60:63],v[0:15]
ds_read_b64_tr_b16 v[204:205],v225 offset:15872
ds_read_b64_tr_b16 v[206:207],v225 offset:16128
s_waitcnt lgkmcnt(12)
v_mfma_f32_32x32x16_bf16 v[16:31],v[212:215],a[60:63],v[16:31]
ds_read_b64_tr_b16 v[208:209],v225 offset:16384
ds_read_b64_tr_b16 v[210:211],v225 offset:16640
s_waitcnt lgkmcnt(12)
v_mfma_f32_32x32x16_bf16 v[32:47],v[216:219],a[60:63],v[32:47]
ds_read_b64_tr_b16 v[212:213],v225 offset:16896
ds_read_b64_tr_b16 v[214:215],v225 offset:17152
s_waitcnt lgkmcnt(12)
v_mfma_f32_32x32x16_bf16 v[48:63],v[220:223],a[60:63],v[48:63]
ds_read_b64_tr_b16 v[216:217],v225 offset:17408
ds_read_b64_tr_b16 v[218:219],v225 offset:17664
s_waitcnt lgkmcnt(12)
v_mfma_f32_32x32x16_bf16 v[64:79],v[192:195],a[60:63],v[64:79]
ds_read_b64_tr_b16 v[220:221],v225 offset:17920
ds_read_b64_tr_b16 v[222:223],v225 offset:18176
s_waitcnt lgkmcnt(12)
v_mfma_f32_32x32x16_bf16 v[80:95],v[196:199],a[60:63],v[80:95]
s_waitcnt vmcnt(18)
s_barrier
ds_read_b64_tr_b16 v[192:193],v225 offset:24576
ds_read_b64_tr_b16 v[194:195],v225 offset:24832
s_waitcnt lgkmcnt(12)
v_mfma_f32_32x32x16_bf16 v[96:111],v[200:203],a[60:63],v[96:111]
ds_read_b64_tr_b16 v[196:197],v225 offset:25088
ds_read_b64_tr_b16 v[198:199],v225 offset:25344
s_waitcnt lgkmcnt(12)
v_mfma_f32_32x32x16_bf16 v[112:127],v[204:207],a[60:63],v[112:127]
ds_read_b64_tr_b16 v[200:201],v225 offset:25600
ds_read_b64_tr_b16 v[202:203],v225 offset:25856
s_waitcnt lgkmcnt(12)
v_mfma_f32_32x32x16_bf16 v[128:143],a[60:63],v[208:211],v[128:143]
ds_read_b64_tr_b16 v[204:205],v225 offset:26112
ds_read_b64_tr_b16 v[206:207],v225 offset:26368
s_waitcnt lgkmcnt(12)
v_mfma_f32_32x32x16_bf16 v[144:159],a[60:63],v[212:215],v[144:159]
ds_read_b64_tr_b16 v[208:209],v225 offset:26624
ds_read_b64_tr_b16 v[210:211],v225 offset:26880
s_waitcnt lgkmcnt(12)
v_mfma_f32_32x32x16_bf16 v[160:175],a[60:63],v[216:219],v[160:175]
ds_read_b64_tr_b16 v[212:213],v225 offset:27136
ds_read_b64_tr_b16 v[214:215],v225 offset:27392
s_waitcnt lgkmcnt(12)
v_mfma_f32_32x32x16_bf16 v[176:191],a[60:63],v[220:223],v[176:191]
ds_read_b64_tr_b16 v[216:217],v225 offset:27648
ds_read_b64_tr_b16 v[218:219],v225 offset:27904
s_waitcnt lgkmcnt(12)
v_mfma_f32_32x32x16_bf16 v[0:15],v[192:195],a[64:67],v[0:15]
ds_read_b64_tr_b16 v[220:221],v225 offset:28160
ds_read_b64_tr_b16 v[222:223],v225 offset:28416
s_waitcnt lgkmcnt(12)
v_mfma_f32_32x32x16_bf16 v[16:31],v[196:199],a[64:67],v[16:31]
s_add_u32 m0, s58, 49152
s_add_u32 s57, s59, 1474560
buffer_load_dwordx4 v230,s[16:19],s57 offen lds
ds_read_b64_tr_b16 v[192:193],v225 offset:28672
ds_read_b64_tr_b16 v[194:195],v225 offset:28928
s_waitcnt lgkmcnt(12)
v_mfma_f32_32x32x16_bf16 v[32:47],v[200:203],a[64:67],v[32:47]
ds_read_b64_tr_b16 v[196:197],v225 offset:29184
ds_read_b64_tr_b16 v[198:199],v225 offset:29440
s_waitcnt lgkmcnt(12)
v_mfma_f32_32x32x16_bf16 v[48:63],v[204:207],a[64:67],v[48:63]
s_add_u32 m0, s58, 50176
s_add_u32 s57, s59, 1474640
buffer_load_dwordx4 v230,s[16:19],s57 offen lds
ds_read_b64_tr_b16 v[200:201],v225 offset:29696
ds_read_b64_tr_b16 v[202:203],v225 offset:29952
s_waitcnt lgkmcnt(12)
v_mfma_f32_32x32x16_bf16 v[64:79],v[208:211],a[64:67],v[64:79]
ds_read_b64_tr_b16 v[204:205],v225 offset:30208
ds_read_b64_tr_b16 v[206:207],v225 offset:30464
s_waitcnt lgkmcnt(12)
v_mfma_f32_32x32x16_bf16 v[80:95],v[212:215],a[64:67],v[80:95]
s_add_u32 m0, s58, 51200
s_add_u32 s57, s59, 1475840
buffer_load_dwordx4 v230,s[16:19],s57 offen lds
ds_read_b64_tr_b16 v[208:209],v225 offset:36864
ds_read_b64_tr_b16 v[210:211],v225 offset:37120
s_waitcnt lgkmcnt(12)
v_mfma_f32_32x32x16_bf16 v[96:111],v[216:219],a[64:67],v[96:111]
ds_read_b64_tr_b16 v[212:213],v225 offset:37376
ds_read_b64_tr_b16 v[214:215],v225 offset:37632
s_waitcnt lgkmcnt(12)
v_mfma_f32_32x32x16_bf16 v[112:127],v[220:223],a[64:67],v[112:127]
s_add_u32 m0, s58, 52224
s_add_u32 s57, s59, 1475920
buffer_load_dwordx4 v230,s[16:19],s57 offen lds
ds_read_b64_tr_b16 v[216:217],v225 offset:37888
ds_read_b64_tr_b16 v[218:219],v225 offset:38144
s_waitcnt lgkmcnt(12)
v_mfma_f32_32x32x16_bf16 v[128:143],a[64:67],v[192:195],v[128:143]
ds_read_b64_tr_b16 v[220:221],v225 offset:38400
ds_read_b64_tr_b16 v[222:223],v225 offset:38656
s_waitcnt lgkmcnt(12)
v_mfma_f32_32x32x16_bf16 v[144:159],a[64:67],v[196:199],v[144:159]
s_add_u32 m0, s58, 53248
s_add_u32 s57, s59, 1477120
buffer_load_dwordx4 v230,s[16:19],s57 offen lds
ds_read_b64_tr_b16 v[192:193],v225 offset:38912
ds_read_b64_tr_b16 v[194:195],v225 offset:39168
s_waitcnt lgkmcnt(12)
v_mfma_f32_32x32x16_bf16 v[160:175],a[64:67],v[200:203],v[160:175]
ds_read_b64_tr_b16 v[196:197],v225 offset:39424
ds_read_b64_tr_b16 v[198:199],v225 offset:39680
s_waitcnt lgkmcnt(12)
v_mfma_f32_32x32x16_bf16 v[176:191],a[64:67],v[204:207],v[176:191]
s_add_u32 m0, s58, 54272
s_add_u32 s57, s59, 1477200
buffer_load_dwordx4 v230,s[16:19],s57 offen lds
ds_read_b64_tr_b16 v[200:201],v225 offset:39936
ds_read_b64_tr_b16 v[202:203],v225 offset:40192
s_waitcnt lgkmcnt(12)
v_mfma_f32_32x32x16_bf16 v[0:15],v[208:211],a[68:71],v[0:15]
ds_read_b64_tr_b16 v[204:205],v225 offset:40448
ds_read_b64_tr_b16 v[206:207],v225 offset:40704
s_waitcnt lgkmcnt(12)
v_mfma_f32_32x32x16_bf16 v[16:31],v[212:215],a[68:71],v[16:31]
ds_read_b64_tr_b16 v[208:209],v225 offset:40960
ds_read_b64_tr_b16 v[210:211],v225 offset:41216
s_waitcnt lgkmcnt(12)
v_mfma_f32_32x32x16_bf16 v[32:47],v[216:219],a[68:71],v[32:47]
ds_read_b64_tr_b16 v[212:213],v225 offset:41472
ds_read_b64_tr_b16 v[214:215],v225 offset:41728
s_waitcnt lgkmcnt(12)
v_mfma_f32_32x32x16_bf16 v[48:63],v[220:223],a[68:71],v[48:63]
ds_read_b64_tr_b16 v[216:217],v225 offset:41984
ds_read_b64_tr_b16 v[218:219],v225 offset:42240
s_waitcnt lgkmcnt(12)
v_mfma_f32_32x32x16_bf16 v[64:79],v[192:195],a[68:71],v[64:79]
ds_read_b64_tr_b16 v[220:221],v225 offset:42496
ds_read_b64_tr_b16 v[222:223],v225 offset:42752
s_waitcnt lgkmcnt(12)
v_mfma_f32_32x32x16_bf16 v[80:95],v[196:199],a[68:71],v[80:95]
s_waitcnt vmcnt(18)
s_barrier
ds_read_b64_tr_b16 v[192:193],v226 offset:0
ds_read_b64_tr_b16 v[194:195],v226 offset:256
s_waitcnt lgkmcnt(12)
v_mfma_f32_32x32x16_bf16 v[96:111],v[200:203],a[68:71],v[96:111]
ds_read_b64_tr_b16 v[196:197],v226 offset:512
ds_read_b64_tr_b16 v[198:199],v226 offset:768
s_waitcnt lgkmcnt(12)
v_mfma_f32_32x32x16_bf16 v[112:127],v[204:207],a[68:71],v[112:127]
ds_read_b64_tr_b16 v[200:201],v226 offset:1024
ds_read_b64_tr_b16 v[202:203],v226 offset:1280
s_waitcnt lgkmcnt(12)
v_mfma_f32_32x32x16_bf16 v[128:143],a[68:71],v[208:211],v[128:143]
ds_read_b64_tr_b16 v[204:205],v226 offset:1536
ds_read_b64_tr_b16 v[206:207],v226 offset:1792
s_waitcnt lgkmcnt(12)
v_mfma_f32_32x32x16_bf16 v[144:159],a[68:71],v[212:215],v[144:159]
ds_read_b64_tr_b16 v[208:209],v226 offset:2048
ds_read_b64_tr_b16 v[210:211],v226 offset:2304
s_waitcnt lgkmcnt(12)
v_mfma_f32_32x32x16_bf16 v[160:175],a[68:71],v[216:219],v[160:175]
ds_read_b64_tr_b16 v[212:213],v226 offset:2560
ds_read_b64_tr_b16 v[214:215],v226 offset:2816
s_waitcnt lgkmcnt(12)
v_mfma_f32_32x32x16_bf16 v[176:191],a[68:71],v[220:223],v[176:191]
ds_read_b64_tr_b16 v[216:217],v226 offset:3072
ds_read_b64_tr_b16 v[218:219],v226 offset:3328
s_waitcnt lgkmcnt(12)
v_mfma_f32_32x32x16_bf16 v[0:15],v[192:195],a[72:75],v[0:15]
ds_read_b64_tr_b16 v[220:221],v226 offset:3584
ds_read_b64_tr_b16 v[222:223],v226 offset:3840
s_waitcnt lgkmcnt(12)
v_mfma_f32_32x32x16_bf16 v[16:31],v[196:199],a[72:75],v[16:31]
s_add_u32 m0, s58, 73728
s_add_u32 s57, s59, 1597440
buffer_load_dwordx4 v230,s[16:19],s57 offen lds
ds_read_b64_tr_b16 v[192:193],v226 offset:4096
ds_read_b64_tr_b16 v[194:195],v226 offset:4352
s_waitcnt lgkmcnt(12)
v_mfma_f32_32x32x16_bf16 v[32:47],v[200:203],a[72:75],v[32:47]
ds_read_b64_tr_b16 v[196:197],v226 offset:4608
ds_read_b64_tr_b16 v[198:199],v226 offset:4864
s_waitcnt lgkmcnt(12)
v_mfma_f32_32x32x16_bf16 v[48:63],v[204:207],a[72:75],v[48:63]
s_add_u32 m0, s58, 74752
s_add_u32 s57, s59, 1597520
buffer_load_dwordx4 v230,s[16:19],s57 offen lds
ds_read_b64_tr_b16 v[200:201],v226 offset:5120
ds_read_b64_tr_b16 v[202:203],v226 offset:5376
s_waitcnt lgkmcnt(12)
v_mfma_f32_32x32x16_bf16 v[64:79],v[208:211],a[72:75],v[64:79]
ds_read_b64_tr_b16 v[204:205],v226 offset:5632
ds_read_b64_tr_b16 v[206:207],v226 offset:5888
s_waitcnt lgkmcnt(12)
v_mfma_f32_32x32x16_bf16 v[80:95],v[212:215],a[72:75],v[80:95]
s_add_u32 m0, s58, 75776
s_add_u32 s57, s59, 1598720
buffer_load_dwordx4 v230,s[16:19],s57 offen lds
ds_read_b64_tr_b16 v[208:209],v226 offset:12288
ds_read_b64_tr_b16 v[210:211],v226 offset:12544
s_waitcnt lgkmcnt(12)
v_mfma_f32_32x32x16_bf16 v[96:111],v[216:219],a[72:75],v[96:111]
ds_read_b64_tr_b16 v[212:213],v226 offset:12800
ds_read_b64_tr_b16 v[214:215],v226 offset:13056
s_waitcnt lgkmcnt(12)
v_mfma_f32_32x32x16_bf16 v[112:127],v[220:223],a[72:75],v[112:127]
s_add_u32 m0, s58, 76800
s_add_u32 s57, s59, 1598800
buffer_load_dwordx4 v230,s[16:19],s57 offen lds
ds_read_b64_tr_b16 v[216:217],v226 offset:13312
ds_read_b64_tr_b16 v[218:219],v226 offset:13568
s_waitcnt lgkmcnt(12)
v_mfma_f32_32x32x16_bf16 v[128:143],a[72:75],v[192:195],v[128:143]
ds_read_b64_tr_b16 v[220:221],v226 offset:13824
ds_read_b64_tr_b16 v[222:223],v226 offset:14080
s_waitcnt lgkmcnt(12)
v_mfma_f32_32x32x16_bf16 v[144:159],a[72:75],v[196:199],v[144:159]
s_add_u32 m0, s58, 77824
s_add_u32 s57, s59, 1600000
buffer_load_dwordx4 v230,s[16:19],s57 offen lds
ds_read_b64_tr_b16 v[192:193],v226 offset:14336
ds_read_b64_tr_b16 v[194:195],v226 offset:14592
s_waitcnt lgkmcnt(12)
v_mfma_f32_32x32x16_bf16 v[160:175],a[72:75],v[200:203],v[160:175]
ds_read_b64_tr_b16 v[196:197],v226 offset:14848
ds_read_b64_tr_b16 v[198:199],v226 offset:15104
s_waitcnt lgkmcnt(12)
v_mfma_f32_32x32x16_bf16 v[176:191],a[72:75],v[204:207],v[176:191]
s_add_u32 m0, s58, 78848
s_add_u32 s57, s59, 1600080
buffer_load_dwordx4 v230,s[16:19],s57 offen lds
ds_read_b64_tr_b16 v[200:201],v226 offset:15360
ds_read_b64_tr_b16 v[202:203],v226 offset:15616
s_waitcnt lgkmcnt(12)
v_mfma_f32_32x32x16_bf16 v[0:15],v[208:211],a[76:79],v[0:15]
ds_read_b64_tr_b16 v[204:205],v226 offset:15872
ds_read_b64_tr_b16 v[206:207],v226 offset:16128
s_waitcnt lgkmcnt(12)
v_mfma_f32_32x32x16_bf16 v[16:31],v[212:215],a[76:79],v[16:31]
ds_read_b64_tr_b16 v[208:209],v226 offset:16384
ds_read_b64_tr_b16 v[210:211],v226 offset:16640
s_waitcnt lgkmcnt(12)
v_mfma_f32_32x32x16_bf16 v[32:47],v[216:219],a[76:79],v[32:47]
ds_read_b64_tr_b16 v[212:213],v226 offset:16896
ds_read_b64_tr_b16 v[214:215],v226 offset:17152
s_waitcnt lgkmcnt(12)
v_mfma_f32_32x32x16_bf16 v[48:63],v[220:223],a[76:79],v[48:63]
ds_read_b64_tr_b16 v[216:217],v226 offset:17408
ds_read_b64_tr_b16 v[218:219],v226 offset:17664
s_waitcnt lgkmcnt(12)
v_mfma_f32_32x32x16_bf16 v[64:79],v[192:195],a[76:79],v[64:79]
ds_read_b64_tr_b16 v[220:221],v226 offset:17920
ds_read_b64_tr_b16 v[222:223],v226 offset:18176
s_waitcnt lgkmcnt(12)
v_mfma_f32_32x32x16_bf16 v[80:95],v[196:199],a[76:79],v[80:95]
s_waitcnt vmcnt(18)
s_barrier
ds_read_b64_tr_b16 v[192:193],v224 offset:0
ds_read_b64_tr_b16 v[194:195],v224 offset:256
s_waitcnt lgkmcnt(12)
v_mfma_f32_32x32x16_bf16 v[96:111],v[200:203],a[76:79],v[96:111]
ds_read_b64_tr_b16 v[196:197],v224 offset:512
ds_read_b64_tr_b16 v[198:199],v224 offset:768
s_waitcnt lgkmcnt(12)
v_mfma_f32_32x32x16_bf16 v[112:127],v[204:207],a[76:79],v[112:127]
ds_read_b64_tr_b16 v[200:201],v224 offset:1024
ds_read_b64_tr_b16 v[202:203],v224 offset:1280
s_waitcnt lgkmcnt(12)
v_mfma_f32_32x32x16_bf16 v[128:143],a[76:79],v[208:211],v[128:143]
ds_read_b64_tr_b16 v[204:205],v224 offset:1536
ds_read_b64_tr_b16 v[206:207],v224 offset:1792
s_waitcnt lgkmcnt(12)
v_mfma_f32_32x32x16_bf16 v[144:159],a[76:79],v[212:215],v[144:159]
ds_read_b64_tr_b16 v[208:209],v224 offset:2048
ds_read_b64_tr_b16 v[210:211],v224 offset:2304
s_waitcnt lgkmcnt(12)
v_mfma_f32_32x32x16_bf16 v[160:175],a[76:79],v[216:219],v[160:175]
ds_read_b64_tr_b16 v[212:213],v224 offset:2560
ds_read_b64_tr_b16 v[214:215],v224 offset:2816
s_waitcnt lgkmcnt(12)
v_mfma_f32_32x32x16_bf16 v[176:191],a[76:79],v[220:223],v[176:191]
ds_read_b64_tr_b16 v[216:217],v224 offset:3072
ds_read_b64_tr_b16 v[218:219],v224 offset:3328
s_waitcnt lgkmcnt(12)
v_mfma_f32_32x32x16_bf16 v[0:15],v[192:195],a[80:83],v[0:15]
ds_read_b64_tr_b16 v[220:221],v224 offset:3584
ds_read_b64_tr_b16 v[222:223],v224 offset:3840
s_waitcnt lgkmcnt(12)
v_mfma_f32_32x32x16_bf16 v[16:31],v[196:199],a[80:83],v[16:31]
s_add_u32 m0, s58, 98304
s_add_u32 s57, s59, 1720320
buffer_load_dwordx4 v230,s[16:19],s57 offen lds
ds_read_b64_tr_b16 v[192:193],v224 offset:4096
ds_read_b64_tr_b16 v[194:195],v224 offset:4352
s_waitcnt lgkmcnt(12)
v_mfma_f32_32x32x16_bf16 v[32:47],v[200:203],a[80:83],v[32:47]
ds_read_b64_tr_b16 v[196:197],v224 offset:4608
ds_read_b64_tr_b16 v[198:199],v224 offset:4864
s_waitcnt lgkmcnt(12)
v_mfma_f32_32x32x16_bf16 v[48:63],v[204:207],a[80:83],v[48:63]
s_add_u32 m0, s58, 99328
s_add_u32 s57, s59, 1720400
buffer_load_dwordx4 v230,s[16:19],s57 offen lds
ds_read_b64_tr_b16 v[200:201],v224 offset:5120
ds_read_b64_tr_b16 v[202:203],v224 offset:5376
s_waitcnt lgkmcnt(12)
v_mfma_f32_32x32x16_bf16 v[64:79],v[208:211],a[80:83],v[64:79]
ds_read_b64_tr_b16 v[204:205],v224 offset:5632
ds_read_b64_tr_b16 v[206:207],v224 offset:5888
s_waitcnt lgkmcnt(12)
v_mfma_f32_32x32x16_bf16 v[80:95],v[212:215],a[80:83],v[80:95]
s_add_u32 m0, s58, 100352
s_add_u32 s57, s59, 1721600
buffer_load_dwordx4 v230,s[16:19],s57 offen lds
ds_read_b64_tr_b16 v[208:209],v224 offset:12288
ds_read_b64_tr_b16 v[210:211],v224 offset:12544
s_waitcnt lgkmcnt(12)
v_mfma_f32_32x32x16_bf16 v[96:111],v[216:219],a[80:83],v[96:111]
ds_read_b64_tr_b16 v[212:213],v224 offset:12800
ds_read_b64_tr_b16 v[214:215],v224 offset:13056
s_waitcnt lgkmcnt(12)
v_mfma_f32_32x32x16_bf16 v[112:127],v[220:223],a[80:83],v[112:127]
s_add_u32 m0, s58, 101376
s_add_u32 s57, s59, 1721680
buffer_load_dwordx4 v230,s[16:19],s57 offen lds
ds_read_b64_tr_b16 v[216:217],v224 offset:13312
ds_read_b64_tr_b16 v[218:219],v224 offset:13568
s_waitcnt lgkmcnt(12)
v_mfma_f32_32x32x16_bf16 v[128:143],a[80:83],v[192:195],v[128:143]
ds_read_b64_tr_b16 v[220:221],v224 offset:13824
ds_read_b64_tr_b16 v[222:223],v224 offset:14080
s_waitcnt lgkmcnt(12)
v_mfma_f32_32x32x16_bf16 v[144:159],a[80:83],v[196:199],v[144:159]
s_add_u32 m0, s58, 102400
s_add_u32 s57, s59, 1722880
buffer_load_dwordx4 v230,s[16:19],s57 offen lds
ds_read_b64_tr_b16 v[192:193],v224 offset:14336
ds_read_b64_tr_b16 v[194:195],v224 offset:14592
s_waitcnt lgkmcnt(12)
v_mfma_f32_32x32x16_bf16 v[160:175],a[80:83],v[200:203],v[160:175]
ds_read_b64_tr_b16 v[196:197],v224 offset:14848
ds_read_b64_tr_b16 v[198:199],v224 offset:15104
s_waitcnt lgkmcnt(12)
v_mfma_f32_32x32x16_bf16 v[176:191],a[80:83],v[204:207],v[176:191]
s_add_u32 m0, s58, 103424
s_add_u32 s57, s59, 1722960
buffer_load_dwordx4 v230,s[16:19],s57 offen lds
ds_read_b64_tr_b16 v[200:201],v224 offset:15360
ds_read_b64_tr_b16 v[202:203],v224 offset:15616
s_waitcnt lgkmcnt(12)
v_mfma_f32_32x32x16_bf16 v[0:15],v[208:211],a[84:87],v[0:15]
ds_read_b64_tr_b16 v[204:205],v224 offset:15872
ds_read_b64_tr_b16 v[206:207],v224 offset:16128
s_waitcnt lgkmcnt(12)
v_mfma_f32_32x32x16_bf16 v[16:31],v[212:215],a[84:87],v[16:31]
ds_read_b64_tr_b16 v[208:209],v224 offset:16384
ds_read_b64_tr_b16 v[210:211],v224 offset:16640
s_waitcnt lgkmcnt(12)
v_mfma_f32_32x32x16_bf16 v[32:47],v[216:219],a[84:87],v[32:47]
ds_read_b64_tr_b16 v[212:213],v224 offset:16896
ds_read_b64_tr_b16 v[214:215],v224 offset:17152
s_waitcnt lgkmcnt(12)
v_mfma_f32_32x32x16_bf16 v[48:63],v[220:223],a[84:87],v[48:63]
ds_read_b64_tr_b16 v[216:217],v224 offset:17408
ds_read_b64_tr_b16 v[218:219],v224 offset:17664
s_waitcnt lgkmcnt(12)
v_mfma_f32_32x32x16_bf16 v[64:79],v[192:195],a[84:87],v[64:79]
ds_read_b64_tr_b16 v[220:221],v224 offset:17920
ds_read_b64_tr_b16 v[222:223],v224 offset:18176
s_waitcnt lgkmcnt(12)
v_mfma_f32_32x32x16_bf16 v[80:95],v[196:199],a[84:87],v[80:95]
s_waitcnt vmcnt(18)
s_barrier
ds_read_b64_tr_b16 v[192:193],v224 offset:24576
ds_read_b64_tr_b16 v[194:195],v224 offset:24832
s_waitcnt lgkmcnt(12)
v_mfma_f32_32x32x16_bf16 v[96:111],v[200:203],a[84:87],v[96:111]
ds_read_b64_tr_b16 v[196:197],v224 offset:25088
ds_read_b64_tr_b16 v[198:199],v224 offset:25344
s_waitcnt lgkmcnt(12)
v_mfma_f32_32x32x16_bf16 v[112:127],v[204:207],a[84:87],v[112:127]
ds_read_b64_tr_b16 v[200:201],v224 offset:25600
ds_read_b64_tr_b16 v[202:203],v224 offset:25856
s_waitcnt lgkmcnt(12)
v_mfma_f32_32x32x16_bf16 v[128:143],a[84:87],v[208:211],v[128:143]
ds_read_b64_tr_b16 v[204:205],v224 offset:26112
ds_read_b64_tr_b16 v[206:207],v224 offset:26368
s_waitcnt lgkmcnt(12)
v_mfma_f32_32x32x16_bf16 v[144:159],a[84:87],v[212:215],v[144:159]
ds_read_b64_tr_b16 v[208:209],v224 offset:26624
ds_read_b64_tr_b16 v[210:211],v224 offset:26880
s_waitcnt lgkmcnt(12)
v_mfma_f32_32x32x16_bf16 v[160:175],a[84:87],v[216:219],v[160:175]
ds_read_b64_tr_b16 v[212:213],v224 offset:27136
ds_read_b64_tr_b16 v[214:215],v224 offset:27392
s_waitcnt lgkmcnt(12)
v_mfma_f32_32x32x16_bf16 v[176:191],a[84:87],v[220:223],v[176:191]
ds_read_b64_tr_b16 v[216:217],v224 offset:27648
ds_read_b64_tr_b16 v[218:219],v224 offset:27904
s_waitcnt lgkmcnt(12)
v_mfma_f32_32x32x16_bf16 v[0:15],v[192:195],a[88:91],v[0:15]
ds_read_b64_tr_b16 v[220:221],v224 offset:28160
ds_read_b64_tr_b16 v[222:223],v224 offset:28416
s_waitcnt lgkmcnt(12)
v_mfma_f32_32x32x16_bf16 v[16:31],v[196:199],a[88:91],v[16:31]
s_add_u32 m0, s58, 0
s_add_u32 s57, s59, 1843200
buffer_load_dwordx4 v230,s[16:19],s57 offen lds
ds_read_b64_tr_b16 v[192:193],v224 offset:28672
ds_read_b64_tr_b16 v[194:195],v224 offset:28928
s_waitcnt lgkmcnt(12)
v_mfma_f32_32x32x16_bf16 v[32:47],v[200:203],a[88:91],v[32:47]
ds_read_b64_tr_b16 v[196:197],v224 offset:29184
ds_read_b64_tr_b16 v[198:199],v224 offset:29440
s_waitcnt lgkmcnt(12)
v_mfma_f32_32x32x16_bf16 v[48:63],v[204:207],a[88:91],v[48:63]
s_add_u32 m0, s58, 1024
s_add_u32 s57, s59, 1843280
buffer_load_dwordx4 v230,s[16:19],s57 offen lds
ds_read_b64_tr_b16 v[200:201],v224 offset:29696
ds_read_b64_tr_b16 v[202:203],v224 offset:29952
s_waitcnt lgkmcnt(12)
v_mfma_f32_32x32x16_bf16 v[64:79],v[208:211],a[88:91],v[64:79]
ds_read_b64_tr_b16 v[204:205],v224 offset:30208
ds_read_b64_tr_b16 v[206:207],v224 offset:30464
s_waitcnt lgkmcnt(12)
v_mfma_f32_32x32x16_bf16 v[80:95],v[212:215],a[88:91],v[80:95]
s_add_u32 m0, s58, 2048
s_add_u32 s57, s59, 1844480
buffer_load_dwordx4 v230,s[16:19],s57 offen lds
ds_read_b64_tr_b16 v[208:209],v224 offset:36864
ds_read_b64_tr_b16 v[210:211],v224 offset:37120
s_waitcnt lgkmcnt(12)
v_mfma_f32_32x32x16_bf16 v[96:111],v[216:219],a[88:91],v[96:111]
ds_read_b64_tr_b16 v[212:213],v224 offset:37376
ds_read_b64_tr_b16 v[214:215],v224 offset:37632
s_waitcnt lgkmcnt(12)
v_mfma_f32_32x32x16_bf16 v[112:127],v[220:223],a[88:91],v[112:127]
s_add_u32 m0, s58, 3072
s_add_u32 s57, s59, 1844560
buffer_load_dwordx4 v230,s[16:19],s57 offen lds
ds_read_b64_tr_b16 v[216:217],v224 offset:37888
ds_read_b64_tr_b16 v[218:219],v224 offset:38144
s_waitcnt lgkmcnt(12)
v_mfma_f32_32x32x16_bf16 v[128:143],a[88:91],v[192:195],v[128:143]
ds_read_b64_tr_b16 v[220:221],v224 offset:38400
ds_read_b64_tr_b16 v[222:223],v224 offset:38656
s_waitcnt lgkmcnt(12)
v_mfma_f32_32x32x16_bf16 v[144:159],a[88:91],v[196:199],v[144:159]
s_add_u32 m0, s58, 4096
s_add_u32 s57, s59, 1845760
buffer_load_dwordx4 v230,s[16:19],s57 offen lds
ds_read_b64_tr_b16 v[192:193],v224 offset:38912
ds_read_b64_tr_b16 v[194:195],v224 offset:39168
s_waitcnt lgkmcnt(12)
v_mfma_f32_32x32x16_bf16 v[160:175],a[88:91],v[200:203],v[160:175]
ds_read_b64_tr_b16 v[196:197],v224 offset:39424
ds_read_b64_tr_b16 v[198:199],v224 offset:39680
s_waitcnt lgkmcnt(12)
v_mfma_f32_32x32x16_bf16 v[176:191],a[88:91],v[204:207],v[176:191]
s_add_u32 m0, s58, 5120
s_add_u32 s57, s59, 1845840
buffer_load_dwordx4 v230,s[16:19],s57 offen lds
ds_read_b64_tr_b16 v[200:201],v224 offset:39936
ds_read_b64_tr_b16 v[202:203],v224 offset:40192
s_waitcnt lgkmcnt(12)
v_mfma_f32_32x32x16_bf16 v[0:15],v[208:211],a[92:95],v[0:15]
ds_read_b64_tr_b16 v[204:205],v224 offset:40448
ds_read_b64_tr_b16 v[206:207],v224 offset:40704
s_waitcnt lgkmcnt(12)
v_mfma_f32_32x32x16_bf16 v[16:31],v[212:215],a[92:95],v[16:31]
ds_read_b64_tr_b16 v[208:209],v224 offset:40960
ds_read_b64_tr_b16 v[210:211],v224 offset:41216
s_waitcnt lgkmcnt(12)
v_mfma_f32_32x32x16_bf16 v[32:47],v[216:219],a[92:95],v[32:47]
ds_read_b64_tr_b16 v[212:213],v224 offset:41472
ds_read_b64_tr_b16 v[214:215],v224 offset:41728
s_waitcnt lgkmcnt(12)
v_mfma_f32_32x32x16_bf16 v[48:63],v[220:223],a[92:95],v[48:63]
ds_read_b64_tr_b16 v[216:217],v224 offset:41984
ds_read_b64_tr_b16 v[218:219],v224 offset:42240
s_waitcnt lgkmcnt(12)
v_mfma_f32_32x32x16_bf16 v[64:79],v[192:195],a[92:95],v[64:79]
ds_read_b64_tr_b16 v[220:221],v224 offset:42496
ds_read_b64_tr_b16 v[222:223],v224 offset:42752
s_waitcnt lgkmcnt(12)
v_mfma_f32_32x32x16_bf16 v[80:95],v[196:199],a[92:95],v[80:95]
s_waitcnt vmcnt(18)
s_barrier
ds_read_b64_tr_b16 v[192:193],v225 offset:0
ds_read_b64_tr_b16 v[194:195],v225 offset:256
s_waitcnt lgkmcnt(12)
v_mfma_f32_32x32x16_bf16 v[96:111],v[200:203],a[92:95],v[96:111]
ds_read_b64_tr_b16 v[196:197],v225 offset:512
ds_read_b64_tr_b16 v[198:199],v225 offset:768
s_waitcnt lgkmcnt(12)
v_mfma_f32_32x32x16_bf16 v[112:127],v[204:207],a[92:95],v[112:127]
ds_read_b64_tr_b16 v[200:201],v225 offset:1024
ds_read_b64_tr_b16 v[202:203],v225 offset:1280
s_waitcnt lgkmcnt(12)
v_mfma_f32_32x32x16_bf16 v[128:143],a[92:95],v[208:211],v[128:143]
ds_read_b64_tr_b16 v[204:205],v225 offset:1536
ds_read_b64_tr_b16 v[206:207],v225 offset:1792
s_waitcnt lgkmcnt(12)
v_mfma_f32_32x32x16_bf16 v[144:159],a[92:95],v[212:215],v[144:159]
ds_read_b64_tr_b16 v[208:209],v225 offset:2048
ds_read_b64_tr_b16 v[210:211],v225 offset:2304
s_waitcnt lgkmcnt(12)
v_mfma_f32_32x32x16_bf16 v[160:175],a[92:95],v[216:219],v[160:175]
ds_read_b64_tr_b16 v[212:213],v225 offset:2560
ds_read_b64_tr_b16 v[214:215],v225 offset:2816
s_waitcnt lgkmcnt(12)
v_mfma_f32_32x32x16_bf16 v[176:191],a[92:95],v[220:223],v[176:191]
ds_read_b64_tr_b16 v[216:217],v225 offset:3072
ds_read_b64_tr_b16 v[218:219],v225 offset:3328
s_waitcnt lgkmcnt(12)
v_mfma_f32_32x32x16_bf16 v[0:15],v[192:195],a[96:99],v[0:15]
ds_read_b64_tr_b16 v[220:221],v225 offset:3584
ds_read_b64_tr_b16 v[222:223],v225 offset:3840
s_waitcnt lgkmcnt(12)
v_mfma_f32_32x32x16_bf16 v[16:31],v[196:199],a[96:99],v[16:31]
s_add_u32 m0, s58, 24576
s_add_u32 s57, s59, 1966080
buffer_load_dwordx4 v230,s[16:19],s57 offen lds
ds_read_b64_tr_b16 v[192:193],v225 offset:4096
ds_read_b64_tr_b16 v[194:195],v225 offset:4352
s_waitcnt lgkmcnt(12)
v_mfma_f32_32x32x16_bf16 v[32:47],v[200:203],a[96:99],v[32:47]
ds_read_b64_tr_b16 v[196:197],v225 offset:4608
ds_read_b64_tr_b16 v[198:199],v225 offset:4864
s_waitcnt lgkmcnt(12)
v_mfma_f32_32x32x16_bf16 v[48:63],v[204:207],a[96:99],v[48:63]
s_add_u32 m0, s58, 25600
s_add_u32 s57, s59, 1966160
buffer_load_dwordx4 v230,s[16:19],s57 offen lds
ds_read_b64_tr_b16 v[200:201],v225 offset:5120
ds_read_b64_tr_b16 v[202:203],v225 offset:5376
s_waitcnt lgkmcnt(12)
v_mfma_f32_32x32x16_bf16 v[64:79],v[208:211],a[96:99],v[64:79]
ds_read_b64_tr_b16 v[204:205],v225 offset:5632
ds_read_b64_tr_b16 v[206:207],v225 offset:5888
s_waitcnt lgkmcnt(12)
v_mfma_f32_32x32x16_bf16 v[80:95],v[212:215],a[96:99],v[80:95]
s_add_u32 m0, s58, 26624
s_add_u32 s57, s59, 1967360
buffer_load_dwordx4 v230,s[16:19],s57 offen lds
ds_read_b64_tr_b16 v[208:209],v225 offset:12288
ds_read_b64_tr_b16 v[210:211],v225 offset:12544
s_waitcnt lgkmcnt(12)
v_mfma_f32_32x32x16_bf16 v[96:111],v[216:219],a[96:99],v[96:111]
ds_read_b64_tr_b16 v[212:213],v225 offset:12800
ds_read_b64_tr_b16 v[214:215],v225 offset:13056
s_waitcnt lgkmcnt(12)
v_mfma_f32_32x32x16_bf16 v[112:127],v[220:223],a[96:99],v[112:127]
s_add_u32 m0, s58, 27648
s_add_u32 s57, s59, 1967440
buffer_load_dwordx4 v230,s[16:19],s57 offen lds
ds_read_b64_tr_b16 v[216:217],v225 offset:13312
ds_read_b64_tr_b16 v[218:219],v225 offset:13568
s_waitcnt lgkmcnt(12)
v_mfma_f32_32x32x16_bf16 v[128:143],a[96:99],v[192:195],v[128:143]
ds_read_b64_tr_b16 v[220:221],v225 offset:13824
ds_read_b64_tr_b16 v[222:223],v225 offset:14080
s_waitcnt lgkmcnt(12)
v_mfma_f32_32x32x16_bf16 v[144:159],a[96:99],v[196:199],v[144:159]
s_add_u32 m0, s58, 28672
s_add_u32 s57, s59, 1968640
buffer_load_dwordx4 v230,s[16:19],s57 offen lds
ds_read_b64_tr_b16 v[192:193],v225 offset:14336
ds_read_b64_tr_b16 v[194:195],v225 offset:14592
s_waitcnt lgkmcnt(12)
v_mfma_f32_32x32x16_bf16 v[160:175],a[96:99],v[200:203],v[160:175]
ds_read_b64_tr_b16 v[196:197],v225 offset:14848
ds_read_b64_tr_b16 v[198:199],v225 offset:15104
s_waitcnt lgkmcnt(12)
v_mfma_f32_32x32x16_bf16 v[176:191],a[96:99],v[204:207],v[176:191]
s_add_u32 m0, s58, 29696
s_add_u32 s57, s59, 1968720
buffer_load_dwordx4 v230,s[16:19],s57 offen lds
ds_read_b64_tr_b16 v[200:201],v225 offset:15360
ds_read_b64_tr_b16 v[202:203],v225 offset:15616
s_waitcnt lgkmcnt(12)
v_mfma_f32_32x32x16_bf16 v[0:15],v[208:211],a[100:103],v[0:15]
ds_read_b64_tr_b16 v[204:205],v225 offset:15872
ds_read_b64_tr_b16 v[206:207],v225 offset:16128
s_waitcnt lgkmcnt(12)
v_mfma_f32_32x32x16_bf16 v[16:31],v[212:215],a[100:103],v[16:31]
ds_read_b64_tr_b16 v[208:209],v225 offset:16384
ds_read_b64_tr_b16 v[210:211],v225 offset:16640
s_waitcnt lgkmcnt(12)
v_mfma_f32_32x32x16_bf16 v[32:47],v[216:219],a[100:103],v[32:47]
ds_read_b64_tr_b16 v[212:213],v225 offset:16896
ds_read_b64_tr_b16 v[214:215],v225 offset:17152
s_waitcnt lgkmcnt(12)
v_mfma_f32_32x32x16_bf16 v[48:63],v[220:223],a[100:103],v[48:63]
ds_read_b64_tr_b16 v[216:217],v225 offset:17408
ds_read_b64_tr_b16 v[218:219],v225 offset:17664
s_waitcnt lgkmcnt(12)
v_mfma_f32_32x32x16_bf16 v[64:79],v[192:195],a[100:103],v[64:79]
ds_read_b64_tr_b16 v[220:221],v225 offset:17920
ds_read_b64_tr_b16 v[222:223],v225 offset:18176
s_waitcnt lgkmcnt(12)
v_mfma_f32_32x32x16_bf16 v[80:95],v[196:199],a[100:103],v[80:95]
s_waitcnt vmcnt(18)
s_barrier
ds_read_b64_tr_b16 v[192:193],v225 offset:24576
ds_read_b64_tr_b16 v[194:195],v225 offset:24832
s_waitcnt lgkmcnt(12)
v_mfma_f32_32x32x16_bf16 v[96:111],v[200:203],a[100:103],v[96:111]
ds_read_b64_tr_b16 v[196:197],v225 offset:25088
ds_read_b64_tr_b16 v[198:199],v225 offset:25344
s_waitcnt lgkmcnt(12)
v_mfma_f32_32x32x16_bf16 v[112:127],v[204:207],a[100:103],v[112:127]
ds_read_b64_tr_b16 v[200:201],v225 offset:25600
ds_read_b64_tr_b16 v[202:203],v225 offset:25856
s_waitcnt lgkmcnt(12)
v_mfma_f32_32x32x16_bf16 v[128:143],a[100:103],v[208:211],v[128:143]
ds_read_b64_tr_b16 v[204:205],v225 offset:26112
ds_read_b64_tr_b16 v[206:207],v225 offset:26368
s_waitcnt lgkmcnt(12)
v_mfma_f32_32x32x16_bf16 v[144:159],a[100:103],v[212:215],v[144:159]
ds_read_b64_tr_b16 v[208:209],v225 offset:26624
ds_read_b64_tr_b16 v[210:211],v225 offset:26880
s_waitcnt lgkmcnt(12)
v_mfma_f32_32x32x16_bf16 v[160:175],a[100:103],v[216:219],v[160:175]
ds_read_b64_tr_b16 v[212:213],v225 offset:27136
ds_read_b64_tr_b16 v[214:215],v225 offset:27392
s_waitcnt lgkmcnt(12)
v_mfma_f32_32x32x16_bf16 v[176:191],a[100:103],v[220:223],v[176:191]
ds_read_b64_tr_b16 v[216:217],v225 offset:27648
ds_read_b64_tr_b16 v[218:219],v225 offset:27904
s_waitcnt lgkmcnt(12)
v_mfma_f32_32x32x16_bf16 v[0:15],v[192:195],a[104:107],v[0:15]
ds_read_b64_tr_b16 v[220:221],v225 offset:28160
ds_read_b64_tr_b16 v[222:223],v225 offset:28416
s_waitcnt lgkmcnt(12)
v_mfma_f32_32x32x16_bf16 v[16:31],v[196:199],a[104:107],v[16:31]
s_add_u32 m0, s58, 49152
s_add_u32 s57, s59, 2088960
buffer_load_dwordx4 v230,s[16:19],s57 offen lds
ds_read_b64_tr_b16 v[192:193],v225 offset:28672
ds_read_b64_tr_b16 v[194:195],v225 offset:28928
s_waitcnt lgkmcnt(12)
v_mfma_f32_32x32x16_bf16 v[32:47],v[200:203],a[104:107],v[32:47]
ds_read_b64_tr_b16 v[196:197],v225 offset:29184
ds_read_b64_tr_b16 v[198:199],v225 offset:29440
s_waitcnt lgkmcnt(12)
v_mfma_f32_32x32x16_bf16 v[48:63],v[204:207],a[104:107],v[48:63]
s_add_u32 m0, s58, 50176
s_add_u32 s57, s59, 2089040
buffer_load_dwordx4 v230,s[16:19],s57 offen lds
ds_read_b64_tr_b16 v[200:201],v225 offset:29696
ds_read_b64_tr_b16 v[202:203],v225 offset:29952
s_waitcnt lgkmcnt(12)
v_mfma_f32_32x32x16_bf16 v[64:79],v[208:211],a[104:107],v[64:79]
ds_read_b64_tr_b16 v[204:205],v225 offset:30208
ds_read_b64_tr_b16 v[206:207],v225 offset:30464
s_waitcnt lgkmcnt(12)
v_mfma_f32_32x32x16_bf16 v[80:95],v[212:215],a[104:107],v[80:95]
s_add_u32 m0, s58, 51200
s_add_u32 s57, s59, 2090240
buffer_load_dwordx4 v230,s[16:19],s57 offen lds
ds_read_b64_tr_b16 v[208:209],v225 offset:36864
ds_read_b64_tr_b16 v[210:211],v225 offset:37120
s_waitcnt lgkmcnt(12)
v_mfma_f32_32x32x16_bf16 v[96:111],v[216:219],a[104:107],v[96:111]
ds_read_b64_tr_b16 v[212:213],v225 offset:37376
ds_read_b64_tr_b16 v[214:215],v225 offset:37632
s_waitcnt lgkmcnt(12)
v_mfma_f32_32x32x16_bf16 v[112:127],v[220:223],a[104:107],v[112:127]
s_add_u32 m0, s58, 52224
s_add_u32 s57, s59, 2090320
buffer_load_dwordx4 v230,s[16:19],s57 offen lds
ds_read_b64_tr_b16 v[216:217],v225 offset:37888
ds_read_b64_tr_b16 v[218:219],v225 offset:38144
s_waitcnt lgkmcnt(12)
v_mfma_f32_32x32x16_bf16 v[128:143],a[104:107],v[192:195],v[128:143]
ds_read_b64_tr_b16 v[220:221],v225 offset:38400
ds_read_b64_tr_b16 v[222:223],v225 offset:38656
s_waitcnt lgkmcnt(12)
v_mfma_f32_32x32x16_bf16 v[144:159],a[104:107],v[196:199],v[144:159]
s_add_u32 m0, s58, 53248
s_add_u32 s57, s59, 2091520
buffer_load_dwordx4 v230,s[16:19],s57 offen lds
ds_read_b64_tr_b16 v[192:193],v225 offset:38912
ds_read_b64_tr_b16 v[194:195],v225 offset:39168
s_waitcnt lgkmcnt(12)
v_mfma_f32_32x32x16_bf16 v[160:175],a[104:107],v[200:203],v[160:175]
ds_read_b64_tr_b16 v[196:197],v225 offset:39424
ds_read_b64_tr_b16 v[198:199],v225 offset:39680
s_waitcnt lgkmcnt(12)
v_mfma_f32_32x32x16_bf16 v[176:191],a[104:107],v[204:207],v[176:191]
s_add_u32 m0, s58, 54272
s_add_u32 s57, s59, 2091600
buffer_load_dwordx4 v230,s[16:19],s57 offen lds
ds_read_b64_tr_b16 v[200:201],v225 offset:39936
ds_read_b64_tr_b16 v[202:203],v225 offset:40192
s_waitcnt lgkmcnt(12)
v_mfma_f32_32x32x16_bf16 v[0:15],v[208:211],a[108:111],v[0:15]
ds_read_b64_tr_b16 v[204:205],v225 offset:40448
ds_read_b64_tr_b16 v[206:207],v225 offset:40704
s_waitcnt lgkmcnt(12)
v_mfma_f32_32x32x16_bf16 v[16:31],v[212:215],a[108:111],v[16:31]
ds_read_b64_tr_b16 v[208:209],v225 offset:40960
ds_read_b64_tr_b16 v[210:211],v225 offset:41216
s_waitcnt lgkmcnt(12)
v_mfma_f32_32x32x16_bf16 v[32:47],v[216:219],a[108:111],v[32:47]
ds_read_b64_tr_b16 v[212:213],v225 offset:41472
ds_read_b64_tr_b16 v[214:215],v225 offset:41728
s_waitcnt lgkmcnt(12)
v_mfma_f32_32x32x16_bf16 v[48:63],v[220:223],a[108:111],v[48:63]
ds_read_b64_tr_b16 v[216:217],v225 offset:41984
ds_read_b64_tr_b16 v[218:219],v225 offset:42240
s_waitcnt lgkmcnt(12)
v_mfma_f32_32x32x16_bf16 v[64:79],v[192:195],a[108:111],v[64:79]
ds_read_b64_tr_b16 v[220:221],v225 offset:42496
ds_read_b64_tr_b16 v[222:223],v225 offset:42752
s_waitcnt lgkmcnt(12)
v_mfma_f32_32x32x16_bf16 v[80:95],v[196:199],a[108:111],v[80:95]
s_waitcnt vmcnt(18)
s_barrier
ds_read_b64_tr_b16 v[192:193],v226 offset:0
ds_read_b64_tr_b16 v[194:195],v226 offset:256
s_waitcnt lgkmcnt(12)
v_mfma_f32_32x32x16_bf16 v[96:111],v[200:203],a[108:111],v[96:111]
ds_read_b64_tr_b16 v[196:197],v226 offset:512
ds_read_b64_tr_b16 v[198:199],v226 offset:768
s_waitcnt lgkmcnt(12)
v_mfma_f32_32x32x16_bf16 v[112:127],v[204:207],a[108:111],v[112:127]
ds_read_b64_tr_b16 v[200:201],v226 offset:1024
ds_read_b64_tr_b16 v[202:203],v226 offset:1280
s_waitcnt lgkmcnt(12)
v_mfma_f32_32x32x16_bf16 v[128:143],a[108:111],v[208:211],v[128:143]
ds_read_b64_tr_b16 v[204:205],v226 offset:1536
ds_read_b64_tr_b16 v[206:207],v226 offset:1792
s_waitcnt lgkmcnt(12)
v_mfma_f32_32x32x16_bf16 v[144:159],a[108:111],v[212:215],v[144:159]
ds_read_b64_tr_b16 v[208:209],v226 offset:2048
ds_read_b64_tr_b16 v[210:211],v226 offset:2304
s_waitcnt lgkmcnt(12)
v_mfma_f32_32x32x16_bf16 v[160:175],a[108:111],v[216:219],v[160:175]
ds_read_b64_tr_b16 v[212:213],v226 offset:2560
ds_read_b64_tr_b16 v[214:215],v226 offset:2816
s_waitcnt lgkmcnt(12)
v_mfma_f32_32x32x16_bf16 v[176:191],a[108:111],v[220:223],v[176:191]
ds_read_b64_tr_b16 v[216:217],v226 offset:3072
ds_read_b64_tr_b16 v[218:219],v226 offset:3328
s_waitcnt lgkmcnt(12)
v_mfma_f32_32x32x16_bf16 v[0:15],v[192:195],a[112:115],v[0:15]
ds_read_b64_tr_b16 v[220:221],v226 offset:3584
ds_read_b64_tr_b16 v[222:223],v226 offset:3840
s_waitcnt lgkmcnt(12)
v_mfma_f32_32x32x16_bf16 v[16:31],v[196:199],a[112:115],v[16:31]
s_add_u32 m0, s58, 73728
s_add_u32 s57, s59, 2211840
buffer_load_dwordx4 v230,s[16:19],s57 offen lds
ds_read_b64_tr_b16 v[192:193],v226 offset:4096
ds_read_b64_tr_b16 v[194:195],v226 offset:4352
s_waitcnt lgkmcnt(12)
v_mfma_f32_32x32x16_bf16 v[32:47],v[200:203],a[112:115],v[32:47]
ds_read_b64_tr_b16 v[196:197],v226 offset:4608
ds_read_b64_tr_b16 v[198:199],v226 offset:4864
s_waitcnt lgkmcnt(12)
v_mfma_f32_32x32x16_bf16 v[48:63],v[204:207],a[112:115],v[48:63]
s_add_u32 m0, s58, 74752
s_add_u32 s57, s59, 2211920
buffer_load_dwordx4 v230,s[16:19],s57 offen lds
ds_read_b64_tr_b16 v[200:201],v226 offset:5120
ds_read_b64_tr_b16 v[202:203],v226 offset:5376
s_waitcnt lgkmcnt(12)
v_mfma_f32_32x32x16_bf16 v[64:79],v[208:211],a[112:115],v[64:79]
ds_read_b64_tr_b16 v[204:205],v226 offset:5632
ds_read_b64_tr_b16 v[206:207],v226 offset:5888
s_waitcnt lgkmcnt(12)
v_mfma_f32_32x32x16_bf16 v[80:95],v[212:215],a[112:115],v[80:95]
s_add_u32 m0, s58, 75776
s_add_u32 s57, s59, 2213120
buffer_load_dwordx4 v230,s[16:19],s57 offen lds
ds_read_b64_tr_b16 v[208:209],v226 offset:12288
ds_read_b64_tr_b16 v[210:211],v226 offset:12544
s_waitcnt lgkmcnt(12)
v_mfma_f32_32x32x16_bf16 v[96:111],v[216:219],a[112:115],v[96:111]
ds_read_b64_tr_b16 v[212:213],v226 offset:12800
ds_read_b64_tr_b16 v[214:215],v226 offset:13056
s_waitcnt lgkmcnt(12)
v_mfma_f32_32x32x16_bf16 v[112:127],v[220:223],a[112:115],v[112:127]
s_add_u32 m0, s58, 76800
s_add_u32 s57, s59, 2213200
buffer_load_dwordx4 v230,s[16:19],s57 offen lds
ds_read_b64_tr_b16 v[216:217],v226 offset:13312
ds_read_b64_tr_b16 v[218:219],v226 offset:13568
s_waitcnt lgkmcnt(12)
v_mfma_f32_32x32x16_bf16 v[128:143],a[112:115],v[192:195],v[128:143]
ds_read_b64_tr_b16 v[220:221],v226 offset:13824
ds_read_b64_tr_b16 v[222:223],v226 offset:14080
s_waitcnt lgkmcnt(12)
v_mfma_f32_32x32x16_bf16 v[144:159],a[112:115],v[196:199],v[144:159]
s_add_u32 m0, s58, 77824
s_add_u32 s57, s59, 2214400
buffer_load_dwordx4 v230,s[16:19],s57 offen lds
ds_read_b64_tr_b16 v[192:193],v226 offset:14336
ds_read_b64_tr_b16 v[194:195],v226 offset:14592
s_waitcnt lgkmcnt(12)
v_mfma_f32_32x32x16_bf16 v[160:175],a[112:115],v[200:203],v[160:175]
ds_read_b64_tr_b16 v[196:197],v226 offset:14848
ds_read_b64_tr_b16 v[198:199],v226 offset:15104
s_waitcnt lgkmcnt(12)
v_mfma_f32_32x32x16_bf16 v[176:191],a[112:115],v[204:207],v[176:191]
s_add_u32 m0, s58, 78848
s_add_u32 s57, s59, 2214480
buffer_load_dwordx4 v230,s[16:19],s57 offen lds
ds_read_b64_tr_b16 v[200:201],v226 offset:15360
ds_read_b64_tr_b16 v[202:203],v226 offset:15616
s_waitcnt lgkmcnt(12)
v_mfma_f32_32x32x16_bf16 v[0:15],v[208:211],a[116:119],v[0:15]
ds_read_b64_tr_b16 v[204:205],v226 offset:15872
ds_read_b64_tr_b16 v[206:207],v226 offset:16128
s_waitcnt lgkmcnt(12)
v_mfma_f32_32x32x16_bf16 v[16:31],v[212:215],a[116:119],v[16:31]
ds_read_b64_tr_b16 v[208:209],v226 offset:16384
ds_read_b64_tr_b16 v[210:211],v226 offset:16640
s_waitcnt lgkmcnt(12)
v_mfma_f32_32x32x16_bf16 v[32:47],v[216:219],a[116:119],v[32:47]
ds_read_b64_tr_b16 v[212:213],v226 offset:16896
ds_read_b64_tr_b16 v[214:215],v226 offset:17152
s_waitcnt lgkmcnt(12)
v_mfma_f32_32x32x16_bf16 v[48:63],v[220:223],a[116:119],v[48:63]
ds_read_b64_tr_b16 v[216:217],v226 offset:17408
ds_read_b64_tr_b16 v[218:219],v226 offset:17664
s_waitcnt lgkmcnt(12)
v_mfma_f32_32x32x16_bf16 v[64:79],v[192:195],a[116:119],v[64:79]
ds_read_b64_tr_b16 v[220:221],v226 offset:17920
ds_read_b64_tr_b16 v[222:223],v226 offset:18176
s_waitcnt lgkmcnt(12)
v_mfma_f32_32x32x16_bf16 v[80:95],v[196:199],a[116:119],v[80:95]
s_waitcnt vmcnt(18)
s_barrier
ds_read_b64_tr_b16 v[192:193],v224 offset:0
ds_read_b64_tr_b16 v[194:195],v224 offset:256
s_waitcnt lgkmcnt(12)
v_mfma_f32_32x32x16_bf16 v[96:111],v[200:203],a[116:119],v[96:111]
ds_read_b64_tr_b16 v[196:197],v224 offset:512
ds_read_b64_tr_b16 v[198:199],v224 offset:768
s_waitcnt lgkmcnt(12)
v_mfma_f32_32x32x16_bf16 v[112:127],v[204:207],a[116:119],v[112:127]
ds_read_b64_tr_b16 v[200:201],v224 offset:1024
ds_read_b64_tr_b16 v[202:203],v224 offset:1280
s_waitcnt lgkmcnt(12)
v_mfma_f32_32x32x16_bf16 v[128:143],a[116:119],v[208:211],v[128:143]
ds_read_b64_tr_b16 v[204:205],v224 offset:1536
ds_read_b64_tr_b16 v[206:207],v224 offset:1792
s_waitcnt lgkmcnt(12)
v_mfma_f32_32x32x16_bf16 v[144:159],a[116:119],v[212:215],v[144:159]
ds_read_b64_tr_b16 v[208:209],v224 offset:2048
ds_read_b64_tr_b16 v[210:211],v224 offset:2304
s_waitcnt lgkmcnt(12)
v_mfma_f32_32x32x16_bf16 v[160:175],a[116:119],v[216:219],v[160:175]
ds_read_b64_tr_b16 v[212:213],v224 offset:2560
ds_read_b64_tr_b16 v[214:215],v224 offset:2816
s_waitcnt lgkmcnt(12)
v_mfma_f32_32x32x16_bf16 v[176:191],a[116:119],v[220:223],v[176:191]
ds_read_b64_tr_b16 v[216:217],v224 offset:3072
ds_read_b64_tr_b16 v[218:219],v224 offset:3328
s_waitcnt lgkmcnt(12)
v_mfma_f32_32x32x16_bf16 v[0:15],v[192:195],a[120:123],v[0:15]
ds_read_b64_tr_b16 v[220:221],v224 offset:3584
ds_read_b64_tr_b16 v[222:223],v224 offset:3840
s_waitcnt lgkmcnt(12)
v_mfma_f32_32x32x16_bf16 v[16:31],v[196:199],a[120:123],v[16:31]
s_add_u32 m0, s58, 98304
s_add_u32 s57, s59, 2334720
buffer_load_dwordx4 v230,s[16:19],s57 offen lds
ds_read_b64_tr_b16 v[192:193],v224 offset:4096
ds_read_b64_tr_b16 v[194:195],v224 offset:4352
s_waitcnt lgkmcnt(12)
v_mfma_f32_32x32x16_bf16 v[32:47],v[200:203],a[120:123],v[32:47]
ds_read_b64_tr_b16 v[196:197],v224 offset:4608
ds_read_b64_tr_b16 v[198:199],v224 offset:4864
s_waitcnt lgkmcnt(12)
v_mfma_f32_32x32x16_bf16 v[48:63],v[204:207],a[120:123],v[48:63]
s_add_u32 m0, s58, 99328
s_add_u32 s57, s59, 2334800
buffer_load_dwordx4 v230,s[16:19],s57 offen lds
ds_read_b64_tr_b16 v[200:201],v224 offset:5120
ds_read_b64_tr_b16 v[202:203],v224 offset:5376
s_waitcnt lgkmcnt(12)
v_mfma_f32_32x32x16_bf16 v[64:79],v[208:211],a[120:123],v[64:79]
ds_read_b64_tr_b16 v[204:205],v224 offset:5632
ds_read_b64_tr_b16 v[206:207],v224 offset:5888
s_waitcnt lgkmcnt(12)
v_mfma_f32_32x32x16_bf16 v[80:95],v[212:215],a[120:123],v[80:95]
s_add_u32 m0, s58, 100352
s_add_u32 s57, s59, 2336000
buffer_load_dwordx4 v230,s[16:19],s57 offen lds
ds_read_b64_tr_b16 v[208:209],v224 offset:12288
ds_read_b64_tr_b16 v[210:211],v224 offset:12544
s_waitcnt lgkmcnt(12)
v_mfma_f32_32x32x16_bf16 v[96:111],v[216:219],a[120:123],v[96:111]
ds_read_b64_tr_b16 v[212:213],v224 offset:12800
ds_read_b64_tr_b16 v[214:215],v224 offset:13056
s_waitcnt lgkmcnt(12)
v_mfma_f32_32x32x16_bf16 v[112:127],v[220:223],a[120:123],v[112:127]
s_add_u32 m0, s58, 101376
s_add_u32 s57, s59, 2336080
buffer_load_dwordx4 v230,s[16:19],s57 offen lds
ds_read_b64_tr_b16 v[216:217],v224 offset:13312
ds_read_b64_tr_b16 v[218:219],v224 offset:13568
s_waitcnt lgkmcnt(12)
v_mfma_f32_32x32x16_bf16 v[128:143],a[120:123],v[192:195],v[128:143]
ds_read_b64_tr_b16 v[220:221],v224 offset:13824
ds_read_b64_tr_b16 v[222:223],v224 offset:14080
s_waitcnt lgkmcnt(12)
v_mfma_f32_32x32x16_bf16 v[144:159],a[120:123],v[196:199],v[144:159]
s_add_u32 m0, s58, 102400
s_add_u32 s57, s59, 2337280
buffer_load_dwordx4 v230,s[16:19],s57 offen lds
ds_read_b64_tr_b16 v[192:193],v224 offset:14336
ds_read_b64_tr_b16 v[194:195],v224 offset:14592
s_waitcnt lgkmcnt(12)
v_mfma_f32_32x32x16_bf16 v[160:175],a[120:123],v[200:203],v[160:175]
ds_read_b64_tr_b16 v[196:197],v224 offset:14848
ds_read_b64_tr_b16 v[198:199],v224 offset:15104
s_waitcnt lgkmcnt(12)
v_mfma_f32_32x32x16_bf16 v[176:191],a[120:123],v[204:207],v[176:191]
s_add_u32 m0, s58, 103424
s_add_u32 s57, s59, 2337360
buffer_load_dwordx4 v230,s[16:19],s57 offen lds
ds_read_b64_tr_b16 v[200:201],v224 offset:15360
ds_read_b64_tr_b16 v[202:203],v224 offset:15616
s_waitcnt lgkmcnt(12)
v_mfma_f32_32x32x16_bf16 v[0:15],v[208:211],a[124:127],v[0:15]
ds_read_b64_tr_b16 v[204:205],v224 offset:15872
ds_read_b64_tr_b16 v[206:207],v224 offset:16128
s_waitcnt lgkmcnt(12)
v_mfma_f32_32x32x16_bf16 v[16:31],v[212:215],a[124:127],v[16:31]
ds_read_b64_tr_b16 v[208:209],v224 offset:16384
ds_read_b64_tr_b16 v[210:211],v224 offset:16640
s_waitcnt lgkmcnt(12)
v_mfma_f32_32x32x16_bf16 v[32:47],v[216:219],a[124:127],v[32:47]
ds_read_b64_tr_b16 v[212:213],v224 offset:16896
ds_read_b64_tr_b16 v[214:215],v224 offset:17152
s_waitcnt lgkmcnt(12)
v_mfma_f32_32x32x16_bf16 v[48:63],v[220:223],a[124:127],v[48:63]
ds_read_b64_tr_b16 v[216:217],v224 offset:17408
ds_read_b64_tr_b16 v[218:219],v224 offset:17664
s_waitcnt lgkmcnt(12)
v_mfma_f32_32x32x16_bf16 v[64:79],v[192:195],a[124:127],v[64:79]
ds_read_b64_tr_b16 v[220:221],v224 offset:17920
ds_read_b64_tr_b16 v[222:223],v224 offset:18176
s_waitcnt lgkmcnt(12)
v_mfma_f32_32x32x16_bf16 v[80:95],v[196:199],a[124:127],v[80:95]
s_waitcnt vmcnt(18)
s_barrier
ds_read_b64_tr_b16 v[192:193],v224 offset:24576
ds_read_b64_tr_b16 v[194:195],v224 offset:24832
s_waitcnt lgkmcnt(12)
v_mfma_f32_32x32x16_bf16 v[96:111],v[200:203],a[124:127],v[96:111]
ds_read_b64_tr_b16 v[196:197],v224 offset:25088
ds_read_b64_tr_b16 v[198:199],v224 offset:25344
s_waitcnt lgkmcnt(12)
v_mfma_f32_32x32x16_bf16 v[112:127],v[204:207],a[124:127],v[112:127]
ds_read_b64_tr_b16 v[200:201],v224 offset:25600
ds_read_b64_tr_b16 v[202:203],v224 offset:25856
s_waitcnt lgkmcnt(12)
v_mfma_f32_32x32x16_bf16 v[128:143],a[124:127],v[208:211],v[128:143]
ds_read_b64_tr_b16 v[204:205],v224 offset:26112
ds_read_b64_tr_b16 v[206:207],v224 offset:26368
s_waitcnt lgkmcnt(12)
v_mfma_f32_32x32x16_bf16 v[144:159],a[124:127],v[212:215],v[144:159]
ds_read_b64_tr_b16 v[208:209],v224 offset:26624
ds_read_b64_tr_b16 v[210:211],v224 offset:26880
s_waitcnt lgkmcnt(12)
v_mfma_f32_32x32x16_bf16 v[160:175],a[124:127],v[216:219],v[160:175]
ds_read_b64_tr_b16 v[212:213],v224 offset:27136
ds_read_b64_tr_b16 v[214:215],v224 offset:27392
s_waitcnt lgkmcnt(12)
v_mfma_f32_32x32x16_bf16 v[176:191],a[124:127],v[220:223],v[176:191]
ds_read_b64_tr_b16 v[216:217],v224 offset:27648
ds_read_b64_tr_b16 v[218:219],v224 offset:27904
s_waitcnt lgkmcnt(12)
v_mfma_f32_32x32x16_bf16 v[0:15],v[192:195],a[128:131],v[0:15]
ds_read_b64_tr_b16 v[220:221],v224 offset:28160
ds_read_b64_tr_b16 v[222:223],v224 offset:28416
s_waitcnt lgkmcnt(12)
v_mfma_f32_32x32x16_bf16 v[16:31],v[196:199],a[128:131],v[16:31]
ds_read_b64_tr_b16 v[192:193],v224 offset:28672
ds_read_b64_tr_b16 v[194:195],v224 offset:28928
s_waitcnt lgkmcnt(12)
v_mfma_f32_32x32x16_bf16 v[32:47],v[200:203],a[128:131],v[32:47]
ds_read_b64_tr_b16 v[196:197],v224 offset:29184
ds_read_b64_tr_b16 v[198:199],v224 offset:29440
s_waitcnt lgkmcnt(12)
v_mfma_f32_32x32x16_bf16 v[48:63],v[204:207],a[128:131],v[48:63]
ds_read_b64_tr_b16 v[200:201],v224 offset:29696
ds_read_b64_tr_b16 v[202:203],v224 offset:29952
s_waitcnt lgkmcnt(12)
v_mfma_f32_32x32x16_bf16 v[64:79],v[208:211],a[128:131],v[64:79]
ds_read_b64_tr_b16 v[204:205],v224 offset:30208
ds_read_b64_tr_b16 v[206:207],v224 offset:30464
s_waitcnt lgkmcnt(12)
v_mfma_f32_32x32x16_bf16 v[80:95],v[212:215],a[128:131],v[80:95]
ds_read_b64_tr_b16 v[208:209],v224 offset:36864
ds_read_b64_tr_b16 v[210:211],v224 offset:37120
s_waitcnt lgkmcnt(12)
v_mfma_f32_32x32x16_bf16 v[96:111],v[216:219],a[128:131],v[96:111]
ds_read_b64_tr_b16 v[212:213],v224 offset:37376
ds_read_b64_tr_b16 v[214:215],v224 offset:37632
s_waitcnt lgkmcnt(12)
v_mfma_f32_32x32x16_bf16 v[112:127],v[220:223],a[128:131],v[112:127]
ds_read_b64_tr_b16 v[216:217],v224 offset:37888
ds_read_b64_tr_b16 v[218:219],v224 offset:38144
s_waitcnt lgkmcnt(12)
v_mfma_f32_32x32x16_bf16 v[128:143],a[128:131],v[192:195],v[128:143]
ds_read_b64_tr_b16 v[220:221],v224 offset:38400
ds_read_b64_tr_b16 v[222:223],v224 offset:38656
s_waitcnt lgkmcnt(12)
v_mfma_f32_32x32x16_bf16 v[144:159],a[128:131],v[196:199],v[144:159]
ds_read_b64_tr_b16 v[192:193],v224 offset:38912
ds_read_b64_tr_b16 v[194:195],v224 offset:39168
s_waitcnt lgkmcnt(12)
v_mfma_f32_32x32x16_bf16 v[160:175],a[128:131],v[200:203],v[160:175]
ds_read_b64_tr_b16 v[196:197],v224 offset:39424
ds_read_b64_tr_b16 v[198:199],v224 offset:39680
s_waitcnt lgkmcnt(12)
v_mfma_f32_32x32x16_bf16 v[176:191],a[128:131],v[204:207],v[176:191]
ds_read_b64_tr_b16 v[200:201],v224 offset:39936
ds_read_b64_tr_b16 v[202:203],v224 offset:40192
s_waitcnt lgkmcnt(12)
v_mfma_f32_32x32x16_bf16 v[0:15],v[208:211],a[132:135],v[0:15]
ds_read_b64_tr_b16 v[204:205],v224 offset:40448
ds_read_b64_tr_b16 v[206:207],v224 offset:40704
s_waitcnt lgkmcnt(12)
v_mfma_f32_32x32x16_bf16 v[16:31],v[212:215],a[132:135],v[16:31]
ds_read_b64_tr_b16 v[208:209],v224 offset:40960
ds_read_b64_tr_b16 v[210:211],v224 offset:41216
s_waitcnt lgkmcnt(12)
v_mfma_f32_32x32x16_bf16 v[32:47],v[216:219],a[132:135],v[32:47]
ds_read_b64_tr_b16 v[212:213],v224 offset:41472
ds_read_b64_tr_b16 v[214:215],v224 offset:41728
s_waitcnt lgkmcnt(12)
v_mfma_f32_32x32x16_bf16 v[48:63],v[220:223],a[132:135],v[48:63]
ds_read_b64_tr_b16 v[216:217],v224 offset:41984
ds_read_b64_tr_b16 v[218:219],v224 offset:42240
s_waitcnt lgkmcnt(12)
v_mfma_f32_32x32x16_bf16 v[64:79],v[192:195],a[132:135],v[64:79]
ds_read_b64_tr_b16 v[220:221],v224 offset:42496
ds_read_b64_tr_b16 v[222:223],v224 offset:42752
s_waitcnt lgkmcnt(12)
v_mfma_f32_32x32x16_bf16 v[80:95],v[196:199],a[132:135],v[80:95]
s_waitcnt vmcnt(12)
s_barrier
ds_read_b64_tr_b16 v[192:193],v225 offset:0
ds_read_b64_tr_b16 v[194:195],v225 offset:256
s_waitcnt lgkmcnt(12)
v_mfma_f32_32x32x16_bf16 v[96:111],v[200:203],a[132:135],v[96:111]
ds_read_b64_tr_b16 v[196:197],v225 offset:512
ds_read_b64_tr_b16 v[198:199],v225 offset:768
s_waitcnt lgkmcnt(12)
v_mfma_f32_32x32x16_bf16 v[112:127],v[204:207],a[132:135],v[112:127]
ds_read_b64_tr_b16 v[200:201],v225 offset:1024
ds_read_b64_tr_b16 v[202:203],v225 offset:1280
s_waitcnt lgkmcnt(12)
v_mfma_f32_32x32x16_bf16 v[128:143],a[132:135],v[208:211],v[128:143]
ds_read_b64_tr_b16 v[204:205],v225 offset:1536
ds_read_b64_tr_b16 v[206:207],v225 offset:1792
s_waitcnt lgkmcnt(12)
v_mfma_f32_32x32x16_bf16 v[144:159],a[132:135],v[212:215],v[144:159]
ds_read_b64_tr_b16 v[208:209],v225 offset:2048
ds_read_b64_tr_b16 v[210:211],v225 offset:2304
s_waitcnt lgkmcnt(12)
v_mfma_f32_32x32x16_bf16 v[160:175],a[132:135],v[216:219],v[160:175]
ds_read_b64_tr_b16 v[212:213],v225 offset:2560
ds_read_b64_tr_b16 v[214:215],v225 offset:2816
s_waitcnt lgkmcnt(12)
v_mfma_f32_32x32x16_bf16 v[176:191],a[132:135],v[220:223],v[176:191]
ds_read_b64_tr_b16 v[216:217],v225 offset:3072
ds_read_b64_tr_b16 v[218:219],v225 offset:3328
s_waitcnt lgkmcnt(12)
v_mfma_f32_32x32x16_bf16 v[0:15],v[192:195],a[136:139],v[0:15]
ds_read_b64_tr_b16 v[220:221],v225 offset:3584
ds_read_b64_tr_b16 v[222:223],v225 offset:3840
s_waitcnt lgkmcnt(12)
v_mfma_f32_32x32x16_bf16 v[16:31],v[196:199],a[136:139],v[16:31]
ds_read_b64_tr_b16 v[192:193],v225 offset:4096
ds_read_b64_tr_b16 v[194:195],v225 offset:4352
s_waitcnt lgkmcnt(12)
v_mfma_f32_32x32x16_bf16 v[32:47],v[200:203],a[136:139],v[32:47]
ds_read_b64_tr_b16 v[196:197],v225 offset:4608
ds_read_b64_tr_b16 v[198:199],v225 offset:4864
s_waitcnt lgkmcnt(12)
v_mfma_f32_32x32x16_bf16 v[48:63],v[204:207],a[136:139],v[48:63]
ds_read_b64_tr_b16 v[200:201],v225 offset:5120
ds_read_b64_tr_b16 v[202:203],v225 offset:5376
s_waitcnt lgkmcnt(12)
v_mfma_f32_32x32x16_bf16 v[64:79],v[208:211],a[136:139],v[64:79]
ds_read_b64_tr_b16 v[204:205],v225 offset:5632
ds_read_b64_tr_b16 v[206:207],v225 offset:5888
s_waitcnt lgkmcnt(12)
v_mfma_f32_32x32x16_bf16 v[80:95],v[212:215],a[136:139],v[80:95]
ds_read_b64_tr_b16 v[208:209],v225 offset:12288
ds_read_b64_tr_b16 v[210:211],v225 offset:12544
s_waitcnt lgkmcnt(12)
v_mfma_f32_32x32x16_bf16 v[96:111],v[216:219],a[136:139],v[96:111]
ds_read_b64_tr_b16 v[212:213],v225 offset:12800
ds_read_b64_tr_b16 v[214:215],v225 offset:13056
s_waitcnt lgkmcnt(12)
v_mfma_f32_32x32x16_bf16 v[112:127],v[220:223],a[136:139],v[112:127]
ds_read_b64_tr_b16 v[216:217],v225 offset:13312
ds_read_b64_tr_b16 v[218:219],v225 offset:13568
s_waitcnt lgkmcnt(12)
v_mfma_f32_32x32x16_bf16 v[128:143],a[136:139],v[192:195],v[128:143]
ds_read_b64_tr_b16 v[220:221],v225 offset:13824
ds_read_b64_tr_b16 v[222:223],v225 offset:14080
s_waitcnt lgkmcnt(12)
v_mfma_f32_32x32x16_bf16 v[144:159],a[136:139],v[196:199],v[144:159]
ds_read_b64_tr_b16 v[192:193],v225 offset:14336
ds_read_b64_tr_b16 v[194:195],v225 offset:14592
s_waitcnt lgkmcnt(12)
v_mfma_f32_32x32x16_bf16 v[160:175],a[136:139],v[200:203],v[160:175]
ds_read_b64_tr_b16 v[196:197],v225 offset:14848
ds_read_b64_tr_b16 v[198:199],v225 offset:15104
s_waitcnt lgkmcnt(12)
v_mfma_f32_32x32x16_bf16 v[176:191],a[136:139],v[204:207],v[176:191]
ds_read_b64_tr_b16 v[200:201],v225 offset:15360
ds_read_b64_tr_b16 v[202:203],v225 offset:15616
s_waitcnt lgkmcnt(12)
v_mfma_f32_32x32x16_bf16 v[0:15],v[208:211],a[140:143],v[0:15]
ds_read_b64_tr_b16 v[204:205],v225 offset:15872
ds_read_b64_tr_b16 v[206:207],v225 offset:16128
s_waitcnt lgkmcnt(12)
v_mfma_f32_32x32x16_bf16 v[16:31],v[212:215],a[140:143],v[16:31]
ds_read_b64_tr_b16 v[208:209],v225 offset:16384
ds_read_b64_tr_b16 v[210:211],v225 offset:16640
s_waitcnt lgkmcnt(12)
v_mfma_f32_32x32x16_bf16 v[32:47],v[216:219],a[140:143],v[32:47]
ds_read_b64_tr_b16 v[212:213],v225 offset:16896
ds_read_b64_tr_b16 v[214:215],v225 offset:17152
s_waitcnt lgkmcnt(12)
v_mfma_f32_32x32x16_bf16 v[48:63],v[220:223],a[140:143],v[48:63]
ds_read_b64_tr_b16 v[216:217],v225 offset:17408
ds_read_b64_tr_b16 v[218:219],v225 offset:17664
s_waitcnt lgkmcnt(12)
v_mfma_f32_32x32x16_bf16 v[64:79],v[192:195],a[140:143],v[64:79]
ds_read_b64_tr_b16 v[220:221],v225 offset:17920
ds_read_b64_tr_b16 v[222:223],v225 offset:18176
s_waitcnt lgkmcnt(12)
v_mfma_f32_32x32x16_bf16 v[80:95],v[196:199],a[140:143],v[80:95]
s_waitcnt vmcnt(6)
s_barrier
ds_read_b64_tr_b16 v[192:193],v225 offset:24576
ds_read_b64_tr_b16 v[194:195],v225 offset:24832
s_waitcnt lgkmcnt(12)
v_mfma_f32_32x32x16_bf16 v[96:111],v[200:203],a[140:143],v[96:111]
ds_read_b64_tr_b16 v[196:197],v225 offset:25088
ds_read_b64_tr_b16 v[198:199],v225 offset:25344
s_waitcnt lgkmcnt(12)
v_mfma_f32_32x32x16_bf16 v[112:127],v[204:207],a[140:143],v[112:127]
ds_read_b64_tr_b16 v[200:201],v225 offset:25600
ds_read_b64_tr_b16 v[202:203],v225 offset:25856
s_waitcnt lgkmcnt(12)
v_mfma_f32_32x32x16_bf16 v[128:143],a[140:143],v[208:211],v[128:143]
ds_read_b64_tr_b16 v[204:205],v225 offset:26112
ds_read_b64_tr_b16 v[206:207],v225 offset:26368
s_waitcnt lgkmcnt(12)
v_mfma_f32_32x32x16_bf16 v[144:159],a[140:143],v[212:215],v[144:159]
ds_read_b64_tr_b16 v[208:209],v225 offset:26624
ds_read_b64_tr_b16 v[210:211],v225 offset:26880
s_waitcnt lgkmcnt(12)
v_mfma_f32_32x32x16_bf16 v[160:175],a[140:143],v[216:219],v[160:175]
ds_read_b64_tr_b16 v[212:213],v225 offset:27136
ds_read_b64_tr_b16 v[214:215],v225 offset:27392
s_waitcnt lgkmcnt(12)
v_mfma_f32_32x32x16_bf16 v[176:191],a[140:143],v[220:223],v[176:191]
ds_read_b64_tr_b16 v[216:217],v225 offset:27648
ds_read_b64_tr_b16 v[218:219],v225 offset:27904
s_waitcnt lgkmcnt(12)
v_mfma_f32_32x32x16_bf16 v[0:15],v[192:195],a[144:147],v[0:15]
ds_read_b64_tr_b16 v[220:221],v225 offset:28160
ds_read_b64_tr_b16 v[222:223],v225 offset:28416
s_waitcnt lgkmcnt(12)
v_mfma_f32_32x32x16_bf16 v[16:31],v[196:199],a[144:147],v[16:31]
ds_read_b64_tr_b16 v[192:193],v225 offset:28672
ds_read_b64_tr_b16 v[194:195],v225 offset:28928
s_waitcnt lgkmcnt(12)
v_mfma_f32_32x32x16_bf16 v[32:47],v[200:203],a[144:147],v[32:47]
ds_read_b64_tr_b16 v[196:197],v225 offset:29184
ds_read_b64_tr_b16 v[198:199],v225 offset:29440
s_waitcnt lgkmcnt(12)
v_mfma_f32_32x32x16_bf16 v[48:63],v[204:207],a[144:147],v[48:63]
ds_read_b64_tr_b16 v[200:201],v225 offset:29696
ds_read_b64_tr_b16 v[202:203],v225 offset:29952
s_waitcnt lgkmcnt(12)
v_mfma_f32_32x32x16_bf16 v[64:79],v[208:211],a[144:147],v[64:79]
ds_read_b64_tr_b16 v[204:205],v225 offset:30208
ds_read_b64_tr_b16 v[206:207],v225 offset:30464
s_waitcnt lgkmcnt(12)
v_mfma_f32_32x32x16_bf16 v[80:95],v[212:215],a[144:147],v[80:95]
ds_read_b64_tr_b16 v[208:209],v225 offset:36864
ds_read_b64_tr_b16 v[210:211],v225 offset:37120
s_waitcnt lgkmcnt(12)
v_mfma_f32_32x32x16_bf16 v[96:111],v[216:219],a[144:147],v[96:111]
ds_read_b64_tr_b16 v[212:213],v225 offset:37376
ds_read_b64_tr_b16 v[214:215],v225 offset:37632
s_waitcnt lgkmcnt(12)
v_mfma_f32_32x32x16_bf16 v[112:127],v[220:223],a[144:147],v[112:127]
ds_read_b64_tr_b16 v[216:217],v225 offset:37888
ds_read_b64_tr_b16 v[218:219],v225 offset:38144
s_waitcnt lgkmcnt(12)
v_mfma_f32_32x32x16_bf16 v[128:143],a[144:147],v[192:195],v[128:143]
ds_read_b64_tr_b16 v[220:221],v225 offset:38400
ds_read_b64_tr_b16 v[222:223],v225 offset:38656
s_waitcnt lgkmcnt(12)
v_mfma_f32_32x32x16_bf16 v[144:159],a[144:147],v[196:199],v[144:159]
ds_read_b64_tr_b16 v[192:193],v225 offset:38912
ds_read_b64_tr_b16 v[194:195],v225 offset:39168
s_waitcnt lgkmcnt(12)
v_mfma_f32_32x32x16_bf16 v[160:175],a[144:147],v[200:203],v[160:175]
ds_read_b64_tr_b16 v[196:197],v225 offset:39424
ds_read_b64_tr_b16 v[198:199],v225 offset:39680
s_waitcnt lgkmcnt(12)
v_mfma_f32_32x32x16_bf16 v[176:191],a[144:147],v[204:207],v[176:191]
ds_read_b64_tr_b16 v[200:201],v225 offset:39936
ds_read_b64_tr_b16 v[202:203],v225 offset:40192
s_waitcnt lgkmcnt(12)
v_mfma_f32_32x32x16_bf16 v[0:15],v[208:211],a[148:151],v[0:15]
ds_read_b64_tr_b16 v[204:205],v225 offset:40448
ds_read_b64_tr_b16 v[206:207],v225 offset:40704
s_waitcnt lgkmcnt(12)
v_mfma_f32_32x32x16_bf16 v[16:31],v[212:215],a[148:151],v[16:31]
ds_read_b64_tr_b16 v[208:209],v225 offset:40960
ds_read_b64_tr_b16 v[210:211],v225 offset:41216
s_waitcnt lgkmcnt(12)
v_mfma_f32_32x32x16_bf16 v[32:47],v[216:219],a[148:151],v[32:47]
ds_read_b64_tr_b16 v[212:213],v225 offset:41472
ds_read_b64_tr_b16 v[214:215],v225 offset:41728
s_waitcnt lgkmcnt(12)
v_mfma_f32_32x32x16_bf16 v[48:63],v[220:223],a[148:151],v[48:63]
ds_read_b64_tr_b16 v[216:217],v225 offset:41984
ds_read_b64_tr_b16 v[218:219],v225 offset:42240
s_waitcnt lgkmcnt(12)
v_mfma_f32_32x32x16_bf16 v[64:79],v[192:195],a[148:151],v[64:79]
ds_read_b64_tr_b16 v[220:221],v225 offset:42496
ds_read_b64_tr_b16 v[222:223],v225 offset:42752
s_waitcnt lgkmcnt(12)
v_mfma_f32_32x32x16_bf16 v[80:95],v[196:199],a[148:151],v[80:95]
s_waitcnt vmcnt(0)
s_barrier
ds_read_b64_tr_b16 v[192:193],v226 offset:0
ds_read_b64_tr_b16 v[194:195],v226 offset:256
s_waitcnt lgkmcnt(12)
v_mfma_f32_32x32x16_bf16 v[96:111],v[200:203],a[148:151],v[96:111]
ds_read_b64_tr_b16 v[196:197],v226 offset:512
ds_read_b64_tr_b16 v[198:199],v226 offset:768
s_waitcnt lgkmcnt(12)
v_mfma_f32_32x32x16_bf16 v[112:127],v[204:207],a[148:151],v[112:127]
ds_read_b64_tr_b16 v[200:201],v226 offset:1024
ds_read_b64_tr_b16 v[202:203],v226 offset:1280
s_waitcnt lgkmcnt(12)
v_mfma_f32_32x32x16_bf16 v[128:143],a[148:151],v[208:211],v[128:143]
ds_read_b64_tr_b16 v[204:205],v226 offset:1536
ds_read_b64_tr_b16 v[206:207],v226 offset:1792
s_waitcnt lgkmcnt(12)
v_mfma_f32_32x32x16_bf16 v[144:159],a[148:151],v[212:215],v[144:159]
ds_read_b64_tr_b16 v[208:209],v226 offset:2048
ds_read_b64_tr_b16 v[210:211],v226 offset:2304
s_waitcnt lgkmcnt(12)
v_mfma_f32_32x32x16_bf16 v[160:175],a[148:151],v[216:219],v[160:175]
ds_read_b64_tr_b16 v[212:213],v226 offset:2560
ds_read_b64_tr_b16 v[214:215],v226 offset:2816
s_waitcnt lgkmcnt(12)
v_mfma_f32_32x32x16_bf16 v[176:191],a[148:151],v[220:223],v[176:191]
ds_read_b64_tr_b16 v[216:217],v226 offset:3072
ds_read_b64_tr_b16 v[218:219],v226 offset:3328
s_waitcnt lgkmcnt(12)
v_mfma_f32_32x32x16_bf16 v[0:15],v[192:195],a[152:155],v[0:15]
ds_read_b64_tr_b16 v[220:221],v226 offset:3584
ds_read_b64_tr_b16 v[222:223],v226 offset:3840
s_waitcnt lgkmcnt(12)
v_mfma_f32_32x32x16_bf16 v[16:31],v[196:199],a[152:155],v[16:31]
ds_read_b64_tr_b16 v[192:193],v226 offset:4096
ds_read_b64_tr_b16 v[194:195],v226 offset:4352
s_waitcnt lgkmcnt(12)
v_mfma_f32_32x32x16_bf16 v[32:47],v[200:203],a[152:155],v[32:47]
ds_read_b64_tr_b16 v[196:197],v226 offset:4608
ds_read_b64_tr_b16 v[198:199],v226 offset:4864
s_waitcnt lgkmcnt(12)
v_mfma_f32_32x32x16_bf16 v[48:63],v[204:207],a[152:155],v[48:63]
ds_read_b64_tr_b16 v[200:201],v226 offset:5120
ds_read_b64_tr_b16 v[202:203],v226 offset:5376
s_waitcnt lgkmcnt(12)
v_mfma_f32_32x32x16_bf16 v[64:79],v[208:211],a[152:155],v[64:79]
ds_read_b64_tr_b16 v[204:205],v226 offset:5632
ds_read_b64_tr_b16 v[206:207],v226 offset:5888
s_waitcnt lgkmcnt(12)
v_mfma_f32_32x32x16_bf16 v[80:95],v[212:215],a[152:155],v[80:95]
ds_read_b64_tr_b16 v[208:209],v226 offset:12288
ds_read_b64_tr_b16 v[210:211],v226 offset:12544
s_waitcnt lgkmcnt(12)
v_mfma_f32_32x32x16_bf16 v[96:111],v[216:219],a[152:155],v[96:111]
ds_read_b64_tr_b16 v[212:213],v226 offset:12800
ds_read_b64_tr_b16 v[214:215],v226 offset:13056
s_waitcnt lgkmcnt(12)
v_mfma_f32_32x32x16_bf16 v[112:127],v[220:223],a[152:155],v[112:127]
ds_read_b64_tr_b16 v[216:217],v226 offset:13312
ds_read_b64_tr_b16 v[218:219],v226 offset:13568
s_waitcnt lgkmcnt(12)
v_mfma_f32_32x32x16_bf16 v[128:143],a[152:155],v[192:195],v[128:143]
ds_read_b64_tr_b16 v[220:221],v226 offset:13824
ds_read_b64_tr_b16 v[222:223],v226 offset:14080
s_waitcnt lgkmcnt(12)
v_mfma_f32_32x32x16_bf16 v[144:159],a[152:155],v[196:199],v[144:159]
ds_read_b64_tr_b16 v[192:193],v226 offset:14336
ds_read_b64_tr_b16 v[194:195],v226 offset:14592
s_waitcnt lgkmcnt(12)
v_mfma_f32_32x32x16_bf16 v[160:175],a[152:155],v[200:203],v[160:175]
ds_read_b64_tr_b16 v[196:197],v226 offset:14848
ds_read_b64_tr_b16 v[198:199],v226 offset:15104
s_waitcnt lgkmcnt(12)
v_mfma_f32_32x32x16_bf16 v[176:191],a[152:155],v[204:207],v[176:191]
ds_read_b64_tr_b16 v[200:201],v226 offset:15360
ds_read_b64_tr_b16 v[202:203],v226 offset:15616
s_waitcnt lgkmcnt(12)
v_mfma_f32_32x32x16_bf16 v[0:15],v[208:211],a[156:159],v[0:15]
ds_read_b64_tr_b16 v[204:205],v226 offset:15872
ds_read_b64_tr_b16 v[206:207],v226 offset:16128
s_waitcnt lgkmcnt(12)
v_mfma_f32_32x32x16_bf16 v[16:31],v[212:215],a[156:159],v[16:31]
ds_read_b64_tr_b16 v[208:209],v226 offset:16384
ds_read_b64_tr_b16 v[210:211],v226 offset:16640
s_waitcnt lgkmcnt(12)
v_mfma_f32_32x32x16_bf16 v[32:47],v[216:219],a[156:159],v[32:47]
ds_read_b64_tr_b16 v[212:213],v226 offset:16896
ds_read_b64_tr_b16 v[214:215],v226 offset:17152
s_waitcnt lgkmcnt(12)
v_mfma_f32_32x32x16_bf16 v[48:63],v[220:223],a[156:159],v[48:63]
ds_read_b64_tr_b16 v[216:217],v226 offset:17408
ds_read_b64_tr_b16 v[218:219],v226 offset:17664
s_waitcnt lgkmcnt(12)
v_mfma_f32_32x32x16_bf16 v[64:79],v[192:195],a[156:159],v[64:79]
ds_read_b64_tr_b16 v[220:221],v226 offset:17920
ds_read_b64_tr_b16 v[222:223],v226 offset:18176
s_waitcnt lgkmcnt(12)
v_mfma_f32_32x32x16_bf16 v[80:95],v[196:199],a[156:159],v[80:95]
s_waitcnt lgkmcnt(10)
v_mfma_f32_32x32x16_bf16 v[96:111],v[200:203],a[156:159],v[96:111]
s_waitcnt lgkmcnt(8)
v_mfma_f32_32x32x16_bf16 v[112:127],v[204:207],a[156:159],v[112:127]
s_waitcnt lgkmcnt(6)
v_mfma_f32_32x32x16_bf16 v[128:143],a[156:159],v[208:211],v[128:143]
s_waitcnt lgkmcnt(4)
v_mfma_f32_32x32x16_bf16 v[144:159],a[156:159],v[212:215],v[144:159]
s_waitcnt lgkmcnt(2)
v_mfma_f32_32x32x16_bf16 v[160:175],a[156:159],v[216:219],v[160:175]
s_waitcnt lgkmcnt(0)
v_mfma_f32_32x32x16_bf16 v[176:191],a[156:159],v[220:223],v[176:191]
v_cmp_gt_u32 vcc, 32, v255
v_and_b32 v236, 31, v255
v_cmp_eq_u32 s[94:95], 20, v236
s_mov_b32 s68, 0x3ea52b5c
v_mov_b32 v236, 0x3f803f80
s_lshl_b32 s67, s62, 8
s_add_u32 s67, s67, s66
s_lshl_b32 s67, s67, 11
s_nop 7
v_mul_f32 v0, s68, v0
v_mul_f32 v1, s68, v1
v_mul_f32 v2, s68, v2
v_mul_f32 v3, s68, v3
v_mul_f32 v4, s68, v4
v_mul_f32 v5, s68, v5
v_mul_f32 v6, s68, v6
v_mul_f32 v7, s68, v7
v_mul_f32 v8, s68, v8
v_mul_f32 v9, s68, v9
v_mul_f32 v10, s68, v10
v_mul_f32 v11, s68, v11
v_cvt_pk_bf16_f32 v0, v0, v1
v_cvt_pk_bf16_f32 v1, v2, v3
v_cvt_pk_bf16_f32 v2, v4, v5
v_cvt_pk_bf16_f32 v3, v6, v7
v_cvt_pk_bf16_f32 v4, v8, v9
v_cvt_pk_bf16_f32 v5, v10, v11
v_cndmask_b32 v4, 0, v4, vcc
v_cndmask_b32 v5, 0, v5, vcc
v_mov_b32 v6, 0
v_mov_b32 v7, 0
s_add_u32 s57, s67, 196755456
buffer_store_dwordx4 v[0:3],v233,s[8:11],s57 offen sc1
buffer_store_dwordx4 v[4:7],v233,s[8:11],s57 offen offset:1024 sc1
v_mul_f32 v16, s68, v16
v_mul_f32 v17, s68, v17
v_mul_f32 v18, s68, v18
v_mul_f32 v19, s68, v19
v_mul_f32 v20, s68, v20
v_mul_f32 v21, s68, v21
v_mul_f32 v22, s68, v22
v_mul_f32 v23, s68, v23
v_mul_f32 v24, s68, v24
v_mul_f32 v25, s68, v25
v_mul_f32 v26, s68, v26
v_mul_f32 v27, s68, v27
v_cvt_pk_bf16_f32 v16, v16, v17
v_cvt_pk_bf16_f32 v17, v18, v19
v_cvt_pk_bf16_f32 v18, v20, v21
v_cvt_pk_bf16_f32 v19, v22, v23
v_cvt_pk_bf16_f32 v20, v24, v25
v_cvt_pk_bf16_f32 v21, v26, v27
v_cndmask_b32 v20, 0, v20, vcc
v_cndmask_b32 v21, 0, v21, vcc
v_mov_b32 v22, 0
v_mov_b32 v23, 0
s_add_u32 s57, s67, 196886528
buffer_store_dwordx4 v[16:19],v233,s[8:11],s57 offen sc1
buffer_store_dwordx4 v[20:23],v233,s[8:11],s57 offen offset:1024 sc1
v_mul_f32 v32, s68, v32
v_mul_f32 v33, s68, v33
v_mul_f32 v34, s68, v34
v_mul_f32 v35, s68, v35
v_mul_f32 v36, s68, v36
v_mul_f32 v37, s68, v37
v_mul_f32 v38, s68, v38
v_mul_f32 v39, s68, v39
v_mul_f32 v40, s68, v40
v_mul_f32 v41, s68, v41
v_mul_f32 v42, s68, v42
v_mul_f32 v43, s68, v43
v_cvt_pk_bf16_f32 v32, v32, v33
v_cvt_pk_bf16_f32 v33, v34, v35
v_cvt_pk_bf16_f32 v34, v36, v37
v_cvt_pk_bf16_f32 v35, v38, v39
v_cvt_pk_bf16_f32 v36, v40, v41
v_cvt_pk_bf16_f32 v37, v42, v43
v_cndmask_b32 v36, 0, v36, vcc
v_cndmask_b32 v37, 0, v37, vcc
v_mov_b32 v38, 0
v_mov_b32 v39, 0
s_add_u32 s57, s67, 197017600
buffer_store_dwordx4 v[32:35],v233,s[8:11],s57 offen sc1
buffer_store_dwordx4 v[36:39],v233,s[8:11],s57 offen offset:1024 sc1
v_mul_f32 v48, s68, v48
v_mul_f32 v49, s68, v49
v_mul_f32 v50, s68, v50
v_mul_f32 v51, s68, v51
v_mul_f32 v52, s68, v52
v_mul_f32 v53, s68, v53
v_mul_f32 v54, s68, v54
v_mul_f32 v55, s68, v55
v_mul_f32 v56, s68, v56
v_mul_f32 v57, s68, v57
v_mul_f32 v58, s68, v58
v_mul_f32 v59, s68, v59
v_cvt_pk_bf16_f32 v48, v48, v49
v_cvt_pk_bf16_f32 v49, v50, v51
v_cvt_pk_bf16_f32 v50, v52, v53
v_cvt_pk_bf16_f32 v51, v54, v55
v_cvt_pk_bf16_f32 v52, v56, v57
v_cvt_pk_bf16_f32 v53, v58, v59
v_cndmask_b32 v52, 0, v52, vcc
v_cndmask_b32 v53, 0, v53, vcc
v_mov_b32 v54, 0
v_mov_b32 v55, 0
s_add_u32 s57, s67, 197148672
buffer_store_dwordx4 v[48:51],v233,s[8:11],s57 offen sc1
buffer_store_dwordx4 v[52:55],v233,s[8:11],s57 offen offset:1024 sc1
v_cvt_pk_bf16_f32 v64, v64, v65
v_cvt_pk_bf16_f32 v65, v66, v67
v_cvt_pk_bf16_f32 v66, v68, v69
v_cvt_pk_bf16_f32 v67, v70, v71
v_cvt_pk_bf16_f32 v68, v72, v73
v_cvt_pk_bf16_f32 v69, v74, v75
v_cndmask_b32 v68, 0, v68, vcc
v_cndmask_b32 v69, 0, v69, vcc
v_mov_b32 v70, 0
v_mov_b32 v71, 0
s_add_u32 s57, s67, 200949760
buffer_store_dwordx4 v[64:67],v233,s[8:11],s57 offen sc1
buffer_store_dwordx4 v[68:71],v233,s[8:11],s57 offen offset:1024 sc1
v_cvt_pk_bf16_f32 v80, v80, v81
v_cvt_pk_bf16_f32 v81, v82, v83
v_cvt_pk_bf16_f32 v82, v84, v85
v_cvt_pk_bf16_f32 v83, v86, v87
v_cvt_pk_bf16_f32 v84, v88, v89
v_cvt_pk_bf16_f32 v85, v90, v91
v_cndmask_b32 v84, 0, v84, vcc
v_cndmask_b32 v85, 0, v85, vcc
v_mov_b32 v86, 0
v_mov_b32 v87, 0
s_add_u32 s57, s67, 201080832
buffer_store_dwordx4 v[80:83],v233,s[8:11],s57 offen sc1
buffer_store_dwordx4 v[84:87],v233,s[8:11],s57 offen offset:1024 sc1
v_cvt_pk_bf16_f32 v96, v96, v97
v_cvt_pk_bf16_f32 v97, v98, v99
v_cvt_pk_bf16_f32 v98, v100, v101
v_cvt_pk_bf16_f32 v99, v102, v103
v_cvt_pk_bf16_f32 v100, v104, v105
v_cvt_pk_bf16_f32 v101, v106, v107
v_cndmask_b32 v100, 0, v100, vcc
v_cndmask_b32 v101, 0, v101, vcc
v_mov_b32 v102, 0
v_mov_b32 v103, 0
s_add_u32 s57, s67, 201211904
buffer_store_dwordx4 v[96:99],v233,s[8:11],s57 offen sc1
buffer_store_dwordx4 v[100:103],v233,s[8:11],s57 offen offset:1024 sc1
v_cvt_pk_bf16_f32 v112, v112, v113
v_cvt_pk_bf16_f32 v113, v114, v115
v_cvt_pk_bf16_f32 v114, v116, v117
v_cvt_pk_bf16_f32 v115, v118, v119
v_cvt_pk_bf16_f32 v116, v120, v121
v_cvt_pk_bf16_f32 v117, v122, v123
v_cndmask_b32 v116, 0, v116, vcc
v_cndmask_b32 v117, 0, v117, vcc
v_mov_b32 v118, 0
v_mov_b32 v119, 0
s_add_u32 s57, s67, 201342976
buffer_store_dwordx4 v[112:115],v233,s[8:11],s57 offen sc1
buffer_store_dwordx4 v[116:119],v233,s[8:11],s57 offen offset:1024 sc1
v_cvt_pk_bf16_f32 v128, v128, v129
v_cvt_pk_bf16_f32 v129, v130, v131
v_cvt_pk_bf16_f32 v130, v132, v133
v_cvt_pk_bf16_f32 v131, v134, v135
v_cvt_pk_bf16_f32 v132, v136, v137
v_cvt_pk_bf16_f32 v133, v138, v139
v_cvt_pk_bf16_f32 v134, v140, v141
v_cvt_pk_bf16_f32 v135, v142, v143
v_cndmask_b32 v128, v128, v236, s[94:95]
v_cndmask_b32 v129, v129, v236, s[94:95]
v_cndmask_b32 v130, v130, v236, s[94:95]
v_cndmask_b32 v131, v131, v236, s[94:95]
v_cndmask_b32 v132, v132, v236, s[94:95]
v_cndmask_b32 v133, v133, v236, s[94:95]
v_cndmask_b32 v134, v134, v236, s[94:95]
v_cndmask_b32 v135, v135, v236, s[94:95]
s_add_u32 s57, s67, 205144064
buffer_store_dwordx4 v[128:131],v233,s[8:11],s57 offen sc1
buffer_store_dwordx4 v[132:135],v233,s[8:11],s57 offen offset:1024 sc1
v_cvt_pk_bf16_f32 v144, v144, v145
v_cvt_pk_bf16_f32 v145, v146, v147
v_cvt_pk_bf16_f32 v146, v148, v149
v_cvt_pk_bf16_f32 v147, v150, v151
v_cvt_pk_bf16_f32 v148, v152, v153
v_cvt_pk_bf16_f32 v149, v154, v155
v_cvt_pk_bf16_f32 v150, v156, v157
v_cvt_pk_bf16_f32 v151, v158, v159
v_cndmask_b32 v144, v144, v236, s[94:95]
v_cndmask_b32 v145, v145, v236, s[94:95]
v_cndmask_b32 v146, v146, v236, s[94:95]
v_cndmask_b32 v147, v147, v236, s[94:95]
v_cndmask_b32 v148, v148, v236, s[94:95]
v_cndmask_b32 v149, v149, v236, s[94:95]
v_cndmask_b32 v150, v150, v236, s[94:95]
v_cndmask_b32 v151, v151, v236, s[94:95]
s_add_u32 s57, s67, 205275136
buffer_store_dwordx4 v[144:147],v233,s[8:11],s57 offen sc1
buffer_store_dwordx4 v[148:151],v233,s[8:11],s57 offen offset:1024 sc1
v_cvt_pk_bf16_f32 v160, v160, v161
v_cvt_pk_bf16_f32 v161, v162, v163
v_cvt_pk_bf16_f32 v162, v164, v165
v_cvt_pk_bf16_f32 v163, v166, v167
v_cvt_pk_bf16_f32 v164, v168, v169
v_cvt_pk_bf16_f32 v165, v170, v171
v_cvt_pk_bf16_f32 v166, v172, v173
v_cvt_pk_bf16_f32 v167, v174, v175
v_cndmask_b32 v160, v160, v236, s[94:95]
v_cndmask_b32 v161, v161, v236, s[94:95]
v_cndmask_b32 v162, v162, v236, s[94:95]
v_cndmask_b32 v163, v163, v236, s[94:95]
v_cndmask_b32 v164, v164, v236, s[94:95]
v_cndmask_b32 v165, v165, v236, s[94:95]
v_cndmask_b32 v166, v166, v236, s[94:95]
v_cndmask_b32 v167, v167, v236, s[94:95]
s_add_u32 s57, s67, 205406208
buffer_store_dwordx4 v[160:163],v233,s[8:11],s57 offen sc1
buffer_store_dwordx4 v[164:167],v233,s[8:11],s57 offen offset:1024 sc1
v_cvt_pk_bf16_f32 v176, v176, v177
v_cvt_pk_bf16_f32 v177, v178, v179
v_cvt_pk_bf16_f32 v178, v180, v181
v_cvt_pk_bf16_f32 v179, v182, v183
v_cvt_pk_bf16_f32 v180, v184, v185
v_cvt_pk_bf16_f32 v181, v186, v187
v_cvt_pk_bf16_f32 v182, v188, v189
v_cvt_pk_bf16_f32 v183, v190, v191
v_cndmask_b32 v176, v176, v236, s[94:95]
v_cndmask_b32 v177, v177, v236, s[94:95]
v_cndmask_b32 v178, v178, v236, s[94:95]
v_cndmask_b32 v179, v179, v236, s[94:95]
v_cndmask_b32 v180, v180, v236, s[94:95]
v_cndmask_b32 v181, v181, v236, s[94:95]
v_cndmask_b32 v182, v182, v236, s[94:95]
v_cndmask_b32 v183, v183, v236, s[94:95]
s_add_u32 s57, s67, 205537280
buffer_store_dwordx4 v[176:179],v233,s[8:11],s57 offen sc1
buffer_store_dwordx4 v[180:183],v233,s[8:11],s57 offen offset:1024 sc1
W_A3:
s_lshl_b32 s92, s62, 7
s_add_u32 s92, s92, 244453888
s_waitcnt vmcnt(0)
s_barrier
buffer_atomic_add v239,v238,s[8:11],s92 offen sc1
s_cmp_lt_u32 s6, 16
s_cbranch_scc1 W_AT
s_add_u32 s6, s6, 1
s_and_b32 s57, s6, 3
s_cbranch_scc1 W_A2
s_lshl_b32 s6, s4, 2
s_add_u32 s6, s6, s5
s_sub_u32 s6, s6, 28
SP1:
s_mul_i32 s63, s6, 52429
s_lshr_b32 s63, s63, 18
s_mul_i32 s57, s63, 5
s_sub_u32 s62, s6, s57
s_add_u32 s93, s63, 4
s_mov_b32 s92, 244473856
s_lshl_b32 s66, s62, 2
s_add_u32 s66, s66, s56
s_mul_i32 s67, s63, 20
s_add_u32 s67, s67, s66
s_lshl_b32 s59, s67, 14
s_lshl_b32 s67, s67, 11
s_add_u32 s67, s67, 211959808
v_and_b32 v245, 31, v255
v_mul_u32_u24 v245, 4, v245
s_lshl_b32 s57, s63, 7
s_add_u32 s57, s57, 239157248
buffer_load_dword v244,v245,s[8:11],s57 offen sc1
s_mul_i32 s61, s63, 40960
s_lshl_b32 s57, s66, 6
s_add_u32 s61, s61, s57
v_mov_b32 v0, 0
s_branch FW18b
FW18:
s_sleep 12
FW18b:
buffer_load_dword v1,v0,s[8:11],s92 offen sc1
s_sub_u32 s71, s71, 1
s_cbranch_scc1 EX1
s_waitcnt vmcnt(0)
v_cmp_gt_u32 vcc, s93, v1
s_cbranch_vccnz FW18
v_and_b32 v245, 31, v255
v_mul_u32_u24 v245, 1280, v245
v_lshrrev_b32 v254, 5, v255
v_and_b32 v254, 1, v254
v_mul_u32_u24 v254, 8, v254
v_add_u32 v245, v254, v245
s_add_u32 s57, s59, 215564288
buffer_load_dwordx4 v[64:67],v233,s[8:11],s57 offen sc1 nt
buffer_load_dwordx4 v[68:71],v233,s[8:11],s57 offen offset:1024 sc1 nt
buffer_load_dwordx4 v[72:75],v233,s[8:11],s57 offen offset:2048 sc1 nt
buffer_load_dwordx4 v[76:79],v233,s[8:11],s57 offen offset:3072 sc1 nt
s_add_u32 s57, s59, 215568384
buffer_load_dwordx4 v[80:83],v233,s[8:11],s57 offen sc1 nt
buffer_load_dwordx4 v[84:87],v233,s[8:11],s57 offen offset:1024 sc1 nt
buffer_load_dwordx4 v[88:91],v233,s[8:11],s57 offen offset:2048 sc1 nt
buffer_load_dwordx4 v[92:95],v233,s[8:11],s57 offen offset:3072 sc1 nt
s_add_u32 s57, s59, 215572480
buffer_load_dwordx4 v[96:99],v233,s[8:11],s57 offen sc1 nt
buffer_load_dwordx4 v[100:103],v233,s[8:11],s57 offen offset:1024 sc1 nt
buffer_load_dwordx4 v[104:107],v233,s[8:11],s57 offen offset:2048 sc1 nt
buffer_load_dwordx4 v[108:111],v233,s[8:11],s57 offen offset:3072 sc1 nt
s_add_u32 s57, s59, 215576576
buffer_load_dwordx4 v[112:115],v233,s[8:11],s57 offen sc1 nt
buffer_load_dwordx4 v[116:119],v233,s[8:11],s57 offen offset:1024 sc1 nt
buffer_load_dwordx4 v[120:123],v233,s[8:11],s57 offen offset:2048 sc1 nt
buffer_load_dwordx4 v[124:127],v233,s[8:11],s57 offen offset:3072 sc1 nt
s_waitcnt vmcnt(0)
v_sub_f32 v244, 1.0, v244
v_cvt_pk_bf16_f32 v244, v244, v244
v_lshlrev_b32 v244, 16, v244
v_pk_add_f32 v[64:65], v[64:65], v[68:69]
v_pk_add_f32 v[66:67], v[66:67], v[70:71]
v_pk_add_f32 v[72:73], v[72:73], v[76:77]
v_pk_add_f32 v[74:75], v[74:75], v[78:79]
v_pk_add_f32 v[64:65], v[64:65], v[72:73]
v_pk_add_f32 v[66:67], v[66:67], v[74:75]
v_cvt_pk_bf16_f32 v32, v64, v65
v_cvt_pk_bf16_f32 v33, v66, v67
v_pk_add_f32 v[80:81], v[80:81], v[84:85]
v_pk_add_f32 v[82:83], v[82:83], v[86:87]
v_pk_add_f32 v[88:89], v[88:89], v[92:93]
v_pk_add_f32 v[90:91], v[90:91], v[94:95]
v_pk_add_f32 v[80:81], v[80:81], v[88:89]
v_pk_add_f32 v[82:83], v[82:83], v[90:91]
v_cvt_pk_bf16_f32 v34, v80, v81
v_cvt_pk_bf16_f32 v35, v82, v83
v_pk_add_f32 v[96:97], v[96:97], v[100:101]
v_pk_add_f32 v[98:99], v[98:99], v[102:103]
v_pk_add_f32 v[104:105], v[104:105], v[108:109]
v_pk_add_f32 v[106:107], v[106:107], v[110:111]
v_pk_add_f32 v[96:97], v[96:97], v[104:105]
v_pk_add_f32 v[98:99], v[98:99], v[106:107]
v_cvt_pk_bf16_f32 v36, v96, v97
v_cvt_pk_bf16_f32 v37, v98, v99
v_pk_add_f32 v[112:113], v[112:113], v[116:117]
v_pk_add_f32 v[114:115], v[114:115], v[118:119]
v_pk_add_f32 v[120:121], v[120:121], v[124:125]
v_pk_add_f32 v[122:123], v[122:123], v[126:127]
v_pk_add_f32 v[112:113], v[112:113], v[120:121]
v_pk_add_f32 v[114:115], v[114:115], v[122:123]
v_cvt_pk_bf16_f32 v38, v112, v113
v_cvt_pk_bf16_f32 v39, v114, v115
v_lshlrev_b32 v240, 16, v32
v_and_b32 v241, 0xffff0000, v32
v_mul_f32 v240, v244, v240
v_mul_f32 v241, v244, v241
v_cvt_pk_bf16_f32 v32, v240, v241
v_lshlrev_b32 v240, 16, v33
v_and_b32 v241, 0xffff0000, v33
v_mul_f32 v240, v244, v240
v_mul_f32 v241, v244, v241
v_cvt_pk_bf16_f32 v33, v240, v241
v_lshlrev_b32 v240, 16, v34
v_and_b32 v241, 0xffff0000, v34
v_mul_f32 v240, v244, v240
v_mul_f32 v241, v244, v241
v_cvt_pk_bf16_f32 v34, v240, v241
v_lshlrev_b32 v240, 16, v35
v_and_b32 v241, 0xffff0000, v35
v_mul_f32 v240, v244, v240
v_mul_f32 v241, v244, v241
v_cvt_pk_bf16_f32 v35, v240, v241
v_lshlrev_b32 v240, 16, v36
v_and_b32 v241, 0xffff0000, v36
v_mul_f32 v240, v244, v240
v_mul_f32 v241, v244, v241
v_cvt_pk_bf16_f32 v36, v240, v241
v_lshlrev_b32 v240, 16, v37
v_and_b32 v241, 0xffff0000, v37
v_mul_f32 v240, v244, v240
v_mul_f32 v241, v244, v241
v_cvt_pk_bf16_f32 v37, v240, v241
v_lshlrev_b32 v240, 16, v38
v_and_b32 v241, 0xffff0000, v38
v_mul_f32 v240, v244, v240
v_mul_f32 v241, v244, v241
v_cvt_pk_bf16_f32 v38, v240, v241
v_lshlrev_b32 v240, 16, v39
v_and_b32 v241, 0xffff0000, v39
v_mul_f32 v240, v244, v240
v_mul_f32 v241, v244, v241
v_cvt_pk_bf16_f32 v39, v240, v241
buffer_store_dwordx4 v[32:35],v233,s[8:11],s67 offen sc1
buffer_store_dwordx4 v[36:39],v233,s[8:11],s67 offen offset:1024 sc1
s_lshr_b32 s57, s63, 2
s_mul_i32 s57, s57, 5
s_add_u32 s57, s57, s62
s_lshl_b32 s92, s57, 7
s_add_u32 s92, s92, 244474880
s_waitcnt vmcnt(0)
s_barrier
buffer_atomic_add v239,v238,s[8:11],s92 offen sc1
s_add_u32 s6, s6, 16
s_cmp_lt_u32 s6, 280
s_cbranch_scc1 SP1
s_endpgm
W_AT:
s_lshl_b32 s62, s4, 3
s_lshr_b32 s57, s5, 2
s_add_u32 s62, s62, s57
s_and_b32 s63, s5, 3
s_lshr_b32 s57, s62, 2
s_lshl_b32 s92, s57, 7
s_add_u32 s92, s92, 244453888
s_cmp_eq_u32 s56, 0
s_cbranch_scc0 W_AQ
v_mov_b32 v0, 0
s_branch FW19b
FW19:
s_sleep 2
FW19b:
buffer_load_dword v1,v0,s[8:11],s92 offen sc1
s_sub_u32 s71, s71, 1
s_cbranch_scc1 EX1
s_waitcnt vmcnt(0)
v_cmp_gt_u32 vcc, 16, v1
s_cbranch_vccnz FW19
buffer_inv sc1
s_waitcnt vmcnt(0)
W_AQ:
s_barrier
s_lshl_b32 s61, s62, 17
s_add_u32 s61, s61, 196755456
s_lshl_b32 s66, s63, 2
s_add_u32 s66, s66, s56
s_lshl_b32 s57, s66, 13
s_add_u32 s57, s57, s61
v_lshlrev_b32 v250, 4, v255
buffer_load_dwordx4 v[0:3],v250,s[8:11],s57 offen
buffer_load_dwordx4 v[4:7],v250,s[8:11],s57 offen offset:1024
buffer_load_dwordx4 v[8:11],v250,s[8:11],s57 offen offset:2048
buffer_load_dwordx4 v[12:15],v250,s[8:11],s57 offen offset:3072
s_add_u32 s57, s57, 4096
buffer_load_dwordx4 v[16:19],v250,s[8:11],s57 offen
buffer_load_dwordx4 v[20:23],v250,s[8:11],s57 offen offset:1024
buffer_load_dwordx4 v[24:27],v250,s[8:11],s57 offen offset:2048
buffer_load_dwordx4 v[28:31],v250,s[8:11],s57 offen offset:3072
s_lshl_b32 s58, s56, 12
s_add_u32 s59, s61, s58
v_mov_b32 v251, v250
s_add_u32 m0, s58, 0
s_add_u32 s57, s59, 4194304
buffer_load_dwordx4 v250,s[8:11],s57 offen offset:0 lds
buffer_load_dwordx4 v250,s[8:11],s57 offen offset:1024 lds
buffer_load_dwordx4 v250,s[8:11],s57 offen offset:2048 lds
buffer_load_dwordx4 v250,s[8:11],s57 offen offset:3072 lds
s_add_u32 m0, s58, 16384
s_add_u32 s57, s59, 4210688
buffer_load_dwordx4 v250,s[8:11],s57 offen offset:0 lds
buffer_load_dwordx4 v250,s[8:11],s57 offen offset:1024 lds
buffer_load_dwordx4 v250,s[8:11],s57 offen offset:2048 lds
buffer_load_dwordx4 v250,s[8:11],s57 offen offset:3072 lds
s_add_u32 m0, s58, 32768
s_add_u32 s57, s59, 4227072
buffer_load_dwordx4 v250,s[8:11],s57 offen offset:0 lds
buffer_load_dwordx4 v250,s[8:11],s57 offen offset:1024 lds
buffer_load_dwordx4 v250,s[8:11],s57 offen offset:2048 lds
buffer_load_dwordx4 v250,s[8:11],s57 offen offset:3072 lds
s_add_u32 m0, s58, 49152
s_add_u32 s57, s59, 4243456
buffer_load_dwordx4 v250,s[8:11],s57 offen offset:0 lds
buffer_load_dwordx4 v250,s[8:11],s57 offen offset:1024 lds
buffer_load_dwordx4 v250,s[8:11],s57 offen offset:2048 lds
buffer_load_dwordx4 v250,s[8:11],s57 offen offset:3072 lds
s_add_u32 m0, s58, 65536
s_add_u32 s57, s59, 4259840
buffer_load_dwordx4 v250,s[8:11],s57 offen offset:0 lds
buffer_load_dwordx4 v250,s[8:11],s57 offen offset:1024 lds
buffer_load_dwordx4 v250,s[8:11],s57 offen offset:2048 lds
buffer_load_dwordx4 v250,s[8:11],s57 offen offset:3072 lds
s_add_u32 m0, s58, 81920
s_add_u32 s57, s59, 4276224
buffer_load_dwordx4 v250,s[8:11],s57 offen offset:0 lds
buffer_load_dwordx4 v250,s[8:11],s57 offen offset:1024 lds
buffer_load_dwordx4 v250,s[8:11],s57 offen offset:2048 lds
buffer_load_dwordx4 v250,s[8:11],s57 offen offset:3072 lds
s_add_u32 m0, s58, 98304
s_add_u32 s57, s59, 4292608
buffer_load_dwordx4 v250,s[8:11],s57 offen offset:0 lds
buffer_load_dwordx4 v250,s[8:11],s57 offen offset:1024 lds
buffer_load_dwordx4 v250,s[8:11],s57 offen offset:2048 lds
buffer_load_dwordx4 v250,s[8:11],s57 offen offset:3072 lds
s_add_u32 m0, s58, 114688
s_add_u32 s57, s59, 4308992
buffer_load_dwordx4 v250,s[8:11],s57 offen offset:0 lds
buffer_load_dwordx4 v250,s[8:11],s57 offen offset:1024 lds
buffer_load_dwordx4 v250,s[8:11],s57 offen offset:2048 lds
buffer_load_dwordx4 v250,s[8:11],s57 offen offset:3072 lds
v_mov_b32 v240, 0xff800000
v_mov_b32 v241, 0xff800000
v_mov_b32 v242, 0xff800000
v_mov_b32 v243, 0xff800000
v_mov_b32 v64, 0xff800000
v_mov_b32 v65, 0xff800000
v_mov_b32 v66, 0xff800000
v_mov_b32 v67, 0xff800000
v_mov_b32 v68, 0xff800000
v_mov_b32 v69, 0xff800000
v_mov_b32 v70, 0xff800000
v_mov_b32 v71, 0xff800000
v_mov_b32 v72, 0xff800000
v_mov_b32 v73, 0xff800000
v_mov_b32 v74, 0xff800000
v_mov_b32 v75, 0xff800000
v_mov_b32 v76, 0xff800000
v_mov_b32 v77, 0xff800000
v_mov_b32 v78, 0xff800000
v_mov_b32 v79, 0xff800000
v_mov_b32 v80, 0xff800000
v_mov_b32 v81, 0xff800000
v_mov_b32 v82, 0xff800000
v_mov_b32 v83, 0xff800000
v_mov_b32 v84, 0xff800000
v_mov_b32 v85, 0xff800000
v_mov_b32 v86, 0xff800000
v_mov_b32 v87, 0xff800000
v_mov_b32 v88, 0xff800000
v_mov_b32 v89, 0xff800000
v_mov_b32 v90, 0xff800000
v_mov_b32 v91, 0xff800000
v_mov_b32 v92, 0xff800000
v_mov_b32 v93, 0xff800000
v_mov_b32 v94, 0xff800000
v_mov_b32 v95, 0xff800000
s_waitcnt vmcnt(24)
s_barrier
ds_read_b128 v[192:195], v251 offset:0
ds_read_b128 v[196:199], v251 offset:1024
ds_read_b128 v[200:203], v251 offset:2048
ds_read_b128 v[204:207], v251 offset:3072
s_mov_b32 s68, 3
AT_P10:
ds_read_b128 v[208:211], v251 offset:4096
ds_read_b128 v[212:215], v251 offset:5120
ds_read_b128 v[216:219], v251 offset:6144
ds_read_b128 v[220:223], v251 offset:7168
s_waitcnt lgkmcnt(4)
v_mfma_f32_32x32x16_bf16 v[32:47],v[192:195],v[0:3],0
v_max3_f32 v242, v242, v64, v65
v_max3_f32 v242, v242, v66, v67
v_max3_f32 v242, v242, v68, v69
v_max3_f32 v242, v242, v70, v71
v_mfma_f32_32x32x16_bf16 v[32:47],v[196:199],v[4:7],v[32:47]
v_max3_f32 v242, v242, v72, v73
v_max3_f32 v242, v242, v74, v75
v_max3_f32 v242, v242, v76, v77
v_max3_f32 v242, v242, v78, v79
v_mfma_f32_32x32x16_bf16 v[48:63],v[192:195],v[8:11],0
v_max3_f32 v243, v243, v80, v81
v_max3_f32 v243, v243, v82, v83
v_max3_f32 v243, v243, v84, v85
v_max3_f32 v243, v243, v86, v87
v_mfma_f32_32x32x16_bf16 v[48:63],v[196:199],v[12:15],v[48:63]
v_max3_f32 v243, v243, v88, v89
v_max3_f32 v243, v243, v90, v91
v_max3_f32 v243, v243, v92, v93
v_max3_f32 v243, v243, v94, v95
v_mfma_f32_32x32x16_bf16 v[64:79],v[192:195],v[16:19],0
v_max3_f32 v240, v240, v32, v33
v_max3_f32 v240, v240, v34, v35
v_max3_f32 v240, v240, v36, v37
v_max3_f32 v240, v240, v38, v39
v_mfma_f32_32x32x16_bf16 v[64:79],v[196:199],v[20:23],v[64:79]
v_max3_f32 v240, v240, v40, v41
v_max3_f32 v240, v240, v42, v43
v_max3_f32 v240, v240, v44, v45
v_max3_f32 v240, v240, v46, v47
v_mfma_f32_32x32x16_bf16 v[80:95],v[192:195],v[24:27],0
v_max3_f32 v241, v241, v48, v49
v_max3_f32 v241, v241, v50, v51
v_max3_f32 v241, v241, v52, v53
v_max3_f32 v241, v241, v54, v55
v_mfma_f32_32x32x16_bf16 v[80:95],v[196:199],v[28:31],v[80:95]
v_max3_f32 v241, v241, v56, v57
v_max3_f32 v241, v241, v58, v59
v_max3_f32 v241, v241, v60, v61
v_max3_f32 v241, v241, v62, v63
v_mfma_f32_32x32x16_bf16 v[32:47],v[200:203],v[0:3],0
v_max3_f32 v242, v242, v64, v65
v_max3_f32 v242, v242, v66, v67
v_max3_f32 v242, v242, v68, v69
v_max3_f32 v242, v242, v70, v71
v_mfma_f32_32x32x16_bf16 v[32:47],v[204:207],v[4:7],v[32:47]
v_max3_f32 v242, v242, v72, v73
v_max3_f32 v242, v242, v74, v75
v_max3_f32 v242, v242, v76, v77
v_max3_f32 v242, v242, v78, v79
v_mfma_f32_32x32x16_bf16 v[48:63],v[200:203],v[8:11],0
v_max3_f32 v243, v243, v80, v81
v_max3_f32 v243, v243, v82, v83
v_max3_f32 v243, v243, v84, v85
v_max3_f32 v243, v243, v86, v87
v_mfma_f32_32x32x16_bf16 v[48:63],v[204:207],v[12:15],v[48:63]
v_max3_f32 v243, v243, v88, v89
v_max3_f32 v243, v243, v90, v91
v_max3_f32 v243, v243, v92, v93
v_max3_f32 v243, v243, v94, v95
v_mfma_f32_32x32x16_bf16 v[64:79],v[200:203],v[16:19],0
v_max3_f32 v240, v240, v32, v33
v_max3_f32 v240, v240, v34, v35
v_max3_f32 v240, v240, v36, v37
v_max3_f32 v240, v240, v38, v39
v_mfma_f32_32x32x16_bf16 v[64:79],v[204:207],v[20:23],v[64:79]
v_max3_f32 v240, v240, v40, v41
v_max3_f32 v240, v240, v42, v43
v_max3_f32 v240, v240, v44, v45
v_max3_f32 v240, v240, v46, v47
v_mfma_f32_32x32x16_bf16 v[80:95],v[200:203],v[24:27],0
v_max3_f32 v241, v241, v48, v49
v_max3_f32 v241, v241, v50, v51
v_max3_f32 v241, v241, v52, v53
v_max3_f32 v241, v241, v54, v55
v_mfma_f32_32x32x16_bf16 v[80:95],v[204:207],v[28:31],v[80:95]
v_max3_f32 v241, v241, v56, v57
v_max3_f32 v241, v241, v58, v59
v_max3_f32 v241, v241, v60, v61
v_max3_f32 v241, v241, v62, v63
ds_read_b128 v[192:195], v251 offset:8192
ds_read_b128 v[196:199], v251 offset:9216
ds_read_b128 v[200:203], v251 offset:10240
ds_read_b128 v[204:207], v251 offset:11264
s_waitcnt lgkmcnt(4)
v_mfma_f32_32x32x16_bf16 v[32:47],v[208:211],v[0:3],0
v_max3_f32 v242, v242, v64, v65
v_max3_f32 v242, v242, v66, v67
v_max3_f32 v242, v242, v68, v69
v_max3_f32 v242, v242, v70, v71
v_mfma_f32_32x32x16_bf16 v[32:47],v[212:215],v[4:7],v[32:47]
v_max3_f32 v242, v242, v72, v73
v_max3_f32 v242, v242, v74, v75
v_max3_f32 v242, v242, v76, v77
v_max3_f32 v242, v242, v78, v79
v_mfma_f32_32x32x16_bf16 v[48:63],v[208:211],v[8:11],0
v_max3_f32 v243, v243, v80, v81
v_max3_f32 v243, v243, v82, v83
v_max3_f32 v243, v243, v84, v85
v_max3_f32 v243, v243, v86, v87
v_mfma_f32_32x32x16_bf16 v[48:63],v[212:215],v[12:15],v[48:63]
v_max3_f32 v243, v243, v88, v89
v_max3_f32 v243, v243, v90, v91
v_max3_f32 v243, v243, v92, v93
v_max3_f32 v243, v243, v94, v95
v_mfma_f32_32x32x16_bf16 v[64:79],v[208:211],v[16:19],0
v_max3_f32 v240, v240, v32, v33
v_max3_f32 v240, v240, v34, v35
v_max3_f32 v240, v240, v36, v37
v_max3_f32 v240, v240, v38, v39
v_mfma_f32_32x32x16_bf16 v[64:79],v[212:215],v[20:23],v[64:79]
v_max3_f32 v240, v240, v40, v41
v_max3_f32 v240, v240, v42, v43
v_max3_f32 v240, v240, v44, v45
v_max3_f32 v240, v240, v46, v47
v_mfma_f32_32x32x16_bf16 v[80:95],v[208:211],v[24:27],0
v_max3_f32 v241, v241, v48, v49
v_max3_f32 v241, v241, v50, v51
v_max3_f32 v241, v241, v52, v53
v_max3_f32 v241, v241, v54, v55
v_mfma_f32_32x32x16_bf16 v[80:95],v[212:215],v[28:31],v[80:95]
v_max3_f32 v241, v241, v56, v57
v_max3_f32 v241, v241, v58, v59
v_max3_f32 v241, v241, v60, v61
v_max3_f32 v241, v241, v62, v63
v_mfma_f32_32x32x16_bf16 v[32:47],v[216:219],v[0:3],0
v_max3_f32 v242, v242, v64, v65
v_max3_f32 v242, v242, v66, v67
v_max3_f32 v242, v242, v68, v69
v_max3_f32 v242, v242, v70, v71
v_mfma_f32_32x32x16_bf16 v[32:47],v[220:223],v[4:7],v[32:47]
v_max3_f32 v242, v242, v72, v73
v_max3_f32 v242, v242, v74, v75
v_max3_f32 v242, v242, v76, v77
v_max3_f32 v242, v242, v78, v79
v_mfma_f32_32x32x16_bf16 v[48:63],v[216:219],v[8:11],0
v_max3_f32 v243, v243, v80, v81
v_max3_f32 v243, v243, v82, v83
v_max3_f32 v243, v243, v84, v85
v_max3_f32 v243, v243, v86, v87
v_mfma_f32_32x32x16_bf16 v[48:63],v[220:223],v[12:15],v[48:63]
v_max3_f32 v243, v243, v88, v89
v_max3_f32 v243, v243, v90, v91
v_max3_f32 v243, v243, v92, v93
v_max3_f32 v243, v243, v94, v95
v_mfma_f32_32x32x16_bf16 v[64:79],v[216:219],v[16:19],0
v_max3_f32 v240, v240, v32, v33
v_max3_f32 v240, v240, v34, v35
v_max3_f32 v240, v240, v36, v37
v_max3_f32 v240, v240, v38, v39
v_mfma_f32_32x32x16_bf16 v[64:79],v[220:223],v[20:23],v[64:79]
v_max3_f32 v240, v240, v40, v41
v_max3_f32 v240, v240, v42, v43
v_max3_f32 v240, v240, v44, v45
v_max3_f32 v240, v240, v46, v47
v_mfma_f32_32x32x16_bf16 v[80:95],v[216:219],v[24:27],0
v_max3_f32 v241, v241, v48, v49
v_max3_f32 v241, v241, v50, v51
v_max3_f32 v241, v241, v52, v53
v_max3_f32 v241, v241, v54, v55
v_mfma_f32_32x32x16_bf16 v[80:95],v[220:223],v[28:31],v[80:95]
v_max3_f32 v241, v241, v56, v57
v_max3_f32 v241, v241, v58, v59
v_max3_f32 v241, v241, v60, v61
v_max3_f32 v241, v241, v62, v63
v_add_u32 v251, 8192, v251
s_sub_u32 s68, s68, 1
s_cmp_lg_u32 s68, 0
s_cbranch_scc1 AT_P10
s_waitcnt vmcnt(0)
s_barrier
s_mov_b32 s68, 13
AT_P11:
ds_read_b128 v[208:211], v251 offset:4096
ds_read_b128 v[212:215], v251 offset:5120
ds_read_b128 v[216:219], v251 offset:6144
ds_read_b128 v[220:223], v251 offset:7168
s_waitcnt lgkmcnt(4)
v_mfma_f32_32x32x16_bf16 v[32:47],v[192:195],v[0:3],0
v_max3_f32 v242, v242, v64, v65
v_max3_f32 v242, v242, v66, v67
v_max3_f32 v242, v242, v68, v69
v_max3_f32 v242, v242, v70, v71
v_mfma_f32_32x32x16_bf16 v[32:47],v[196:199],v[4:7],v[32:47]
v_max3_f32 v242, v242, v72, v73
v_max3_f32 v242, v242, v74, v75
v_max3_f32 v242, v242, v76, v77
v_max3_f32 v242, v242, v78, v79
v_mfma_f32_32x32x16_bf16 v[48:63],v[192:195],v[8:11],0
v_max3_f32 v243, v243, v80, v81
v_max3_f32 v243, v243, v82, v83
v_max3_f32 v243, v243, v84, v85
v_max3_f32 v243, v243, v86, v87
v_mfma_f32_32x32x16_bf16 v[48:63],v[196:199],v[12:15],v[48:63]
v_max3_f32 v243, v243, v88, v89
v_max3_f32 v243, v243, v90, v91
v_max3_f32 v243, v243, v92, v93
v_max3_f32 v243, v243, v94, v95
v_mfma_f32_32x32x16_bf16 v[64:79],v[192:195],v[16:19],0
v_max3_f32 v240, v240, v32, v33
v_max3_f32 v240, v240, v34, v35
v_max3_f32 v240, v240, v36, v37
v_max3_f32 v240, v240, v38, v39
v_mfma_f32_32x32x16_bf16 v[64:79],v[196:199],v[20:23],v[64:79]
v_max3_f32 v240, v240, v40, v41
v_max3_f32 v240, v240, v42, v43
v_max3_f32 v240, v240, v44, v45
v_max3_f32 v240, v240, v46, v47
v_mfma_f32_32x32x16_bf16 v[80:95],v[192:195],v[24:27],0
v_max3_f32 v241, v241, v48, v49
v_max3_f32 v241, v241, v50, v51
v_max3_f32 v241, v241, v52, v53
v_max3_f32 v241, v241, v54, v55
v_mfma_f32_32x32x16_bf16 v[80:95],v[196:199],v[28:31],v[80:95]
v_max3_f32 v241, v241, v56, v57
v_max3_f32 v241, v241, v58, v59
v_max3_f32 v241, v241, v60, v61
v_max3_f32 v241, v241, v62, v63
v_mfma_f32_32x32x16_bf16 v[32:47],v[200:203],v[0:3],0
v_max3_f32 v242, v242, v64, v65
v_max3_f32 v242, v242, v66, v67
v_max3_f32 v242, v242, v68, v69
v_max3_f32 v242, v242, v70, v71
v_mfma_f32_32x32x16_bf16 v[32:47],v[204:207],v[4:7],v[32:47]
v_max3_f32 v242, v242, v72, v73
v_max3_f32 v242, v242, v74, v75
v_max3_f32 v242, v242, v76, v77
v_max3_f32 v242, v242, v78, v79
v_mfma_f32_32x32x16_bf16 v[48:63],v[200:203],v[8:11],0
v_max3_f32 v243, v243, v80, v81
v_max3_f32 v243, v243, v82, v83
v_max3_f32 v243, v243, v84, v85
v_max3_f32 v243, v243, v86, v87
v_mfma_f32_32x32x16_bf16 v[48:63],v[204:207],v[12:15],v[48:63]
v_max3_f32 v243, v243, v88, v89
v_max3_f32 v243, v243, v90, v91
v_max3_f32 v243, v243, v92, v93
v_max3_f32 v243, v243, v94, v95
v_mfma_f32_32x32x16_bf16 v[64:79],v[200:203],v[16:19],0
v_max3_f32 v240, v240, v32, v33
v_max3_f32 v240, v240, v34, v35
v_max3_f32 v240, v240, v36, v37
v_max3_f32 v240, v240, v38, v39
v_mfma_f32_32x32x16_bf16 v[64:79],v[204:207],v[20:23],v[64:79]
v_max3_f32 v240, v240, v40, v41
v_max3_f32 v240, v240, v42, v43
v_max3_f32 v240, v240, v44, v45
v_max3_f32 v240, v240, v46, v47
v_mfma_f32_32x32x16_bf16 v[80:95],v[200:203],v[24:27],0
v_max3_f32 v241, v241, v48, v49
v_max3_f32 v241, v241, v50, v51
v_max3_f32 v241, v241, v52, v53
v_max3_f32 v241, v241, v54, v55
v_mfma_f32_32x32x16_bf16 v[80:95],v[204:207],v[28:31],v[80:95]
v_max3_f32 v241, v241, v56, v57
v_max3_f32 v241, v241, v58, v59
v_max3_f32 v241, v241, v60, v61
v_max3_f32 v241, v241, v62, v63
ds_read_b128 v[192:195], v251 offset:8192
ds_read_b128 v[196:199], v251 offset:9216
ds_read_b128 v[200:203], v251 offset:10240
ds_read_b128 v[204:207], v251 offset:11264
s_waitcnt lgkmcnt(4)
v_mfma_f32_32x32x16_bf16 v[32:47],v[208:211],v[0:3],0
v_max3_f32 v242, v242, v64, v65
v_max3_f32 v242, v242, v66, v67
v_max3_f32 v242, v242, v68, v69
v_max3_f32 v242, v242, v70, v71
v_mfma_f32_32x32x16_bf16 v[32:47],v[212:215],v[4:7],v[32:47]
v_max3_f32 v242, v242, v72, v73
v_max3_f32 v242, v242, v74, v75
v_max3_f32 v242, v242, v76, v77
v_max3_f32 v242, v242, v78, v79
v_mfma_f32_32x32x16_bf16 v[48:63],v[208:211],v[8:11],0
v_max3_f32 v243, v243, v80, v81
v_max3_f32 v243, v243, v82, v83
v_max3_f32 v243, v243, v84, v85
v_max3_f32 v243, v243, v86, v87
v_mfma_f32_32x32x16_bf16 v[48:63],v[212:215],v[12:15],v[48:63]
v_max3_f32 v243, v243, v88, v89
v_max3_f32 v243, v243, v90, v91
v_max3_f32 v243, v243, v92, v93
v_max3_f32 v243, v243, v94, v95
v_mfma_f32_32x32x16_bf16 v[64:79],v[208:211],v[16:19],0
v_max3_f32 v240, v240, v32, v33
v_max3_f32 v240, v240, v34, v35
v_max3_f32 v240, v240, v36, v37
v_max3_f32 v240, v240, v38, v39
v_mfma_f32_32x32x16_bf16 v[64:79],v[212:215],v[20:23],v[64:79]
v_max3_f32 v240, v240, v40, v41
v_max3_f32 v240, v240, v42, v43
v_max3_f32 v240, v240, v44, v45
v_max3_f32 v240, v240, v46, v47
v_mfma_f32_32x32x16_bf16 v[80:95],v[208:211],v[24:27],0
v_max3_f32 v241, v241, v48, v49
v_max3_f32 v241, v241, v50, v51
v_max3_f32 v241, v241, v52, v53
v_max3_f32 v241, v241, v54, v55
v_mfma_f32_32x32x16_bf16 v[80:95],v[212:215],v[28:31],v[80:95]
v_max3_f32 v241, v241, v56, v57
v_max3_f32 v241, v241, v58, v59
v_max3_f32 v241, v241, v60, v61
v_max3_f32 v241, v241, v62, v63
v_mfma_f32_32x32x16_bf16 v[32:47],v[216:219],v[0:3],0
v_max3_f32 v242, v242, v64, v65
v_max3_f32 v242, v242, v66, v67
v_max3_f32 v242, v242, v68, v69
v_max3_f32 v242, v242, v70, v71
v_mfma_f32_32x32x16_bf16 v[32:47],v[220:223],v[4:7],v[32:47]
v_max3_f32 v242, v242, v72, v73
v_max3_f32 v242, v242, v74, v75
v_max3_f32 v242, v242, v76, v77
v_max3_f32 v242, v242, v78, v79
v_mfma_f32_32x32x16_bf16 v[48:63],v[216:219],v[8:11],0
v_max3_f32 v243, v243, v80, v81
v_max3_f32 v243, v243, v82, v83
v_max3_f32 v243, v243, v84, v85
v_max3_f32 v243, v243, v86, v87
v_mfma_f32_32x32x16_bf16 v[48:63],v[220:223],v[12:15],v[48:63]
v_max3_f32 v243, v243, v88, v89
v_max3_f32 v243, v243, v90, v91
v_max3_f32 v243, v243, v92, v93
v_max3_f32 v243, v243, v94, v95
v_mfma_f32_32x32x16_bf16 v[64:79],v[216:219],v[16:19],0
v_max3_f32 v240, v240, v32, v33
v_max3_f32 v240, v240, v34, v35
v_max3_f32 v240, v240, v36, v37
v_max3_f32 v240, v240, v38, v39
v_mfma_f32_32x32x16_bf16 v[64:79],v[220:223],v[20:23],v[64:79]
v_max3_f32 v240, v240, v40, v41
v_max3_f32 v240, v240, v42, v43
v_max3_f32 v240, v240, v44, v45
v_max3_f32 v240, v240, v46, v47
v_mfma_f32_32x32x16_bf16 v[80:95],v[216:219],v[24:27],0
v_max3_f32 v241, v241, v48, v49
v_max3_f32 v241, v241, v50, v51
v_max3_f32 v241, v241, v52, v53
v_max3_f32 v241, v241, v54, v55
v_mfma_f32_32x32x16_bf16 v[80:95],v[220:223],v[28:31],v[80:95]
v_max3_f32 v241, v241, v56, v57
v_max3_f32 v241, v241, v58, v59
v_max3_f32 v241, v241, v60, v61
v_max3_f32 v241, v241, v62, v63
v_add_u32 v251, 8192, v251
s_sub_u32 s68, s68, 1
s_cmp_lg_u32 s68, 0
s_cbranch_scc1 AT_P11
s_add_u32 s59, s61, 8388608
s_add_u32 s60, s59, 129024
v_mov_b32 v251, v250
s_waitcnt lgkmcnt(0)
ds_read_b128 v[192:195], v251 offset:0
ds_read_b128 v[196:199], v251 offset:1024
buffer_load_dwordx4 v[200:203],v250,s[8:11],s59 offen
buffer_load_dwordx4 v[204:207],v250,s[8:11],s59 offen offset:1024
s_nop 7
v_max3_f32 v242, v242, v64, v65
v_max3_f32 v242, v242, v66, v67
v_max3_f32 v242, v242, v68, v69
v_max3_f32 v242, v242, v70, v71
v_max3_f32 v242, v242, v72, v73
v_max3_f32 v242, v242, v74, v75
v_max3_f32 v242, v242, v76, v77
v_max3_f32 v242, v242, v78, v79
v_max3_f32 v243, v243, v80, v81
v_max3_f32 v243, v243, v82, v83
v_max3_f32 v243, v243, v84, v85
v_max3_f32 v243, v243, v86, v87
v_max3_f32 v243, v243, v88, v89
v_max3_f32 v243, v243, v90, v91
v_max3_f32 v243, v243, v92, v93
v_max3_f32 v243, v243, v94, v95
v_mov_b32 v244, v240
s_nop 1
v_permlane32_swap_b32 v240, v244
v_max_f32 v240, v240, v244
v_sub_f32 v32, 0, v240
v_mov_b32 v96, 0
v_sub_f32 v33, 0, v240
v_mov_b32 v97, 0
v_sub_f32 v34, 0, v240
v_mov_b32 v98, 0
v_sub_f32 v35, 0, v240
v_mov_b32 v99, 0
v_sub_f32 v36, 0, v240
v_mov_b32 v100, 0
v_sub_f32 v37, 0, v240
v_mov_b32 v101, 0
v_sub_f32 v38, 0, v240
v_mov_b32 v102, 0
v_sub_f32 v39, 0, v240
v_mov_b32 v103, 0
v_sub_f32 v40, 0, v240
v_mov_b32 v104, 0
v_sub_f32 v41, 0, v240
v_mov_b32 v105, 0
v_sub_f32 v42, 0, v240
v_mov_b32 v106, 0
v_sub_f32 v43, 0, v240
v_mov_b32 v107, 0
v_sub_f32 v44, 0, v240
v_mov_b32 v108, 0
v_sub_f32 v45, 0, v240
v_mov_b32 v109, 0
v_sub_f32 v46, 0, v240
v_mov_b32 v110, 0
v_sub_f32 v47, 0, v240
v_mov_b32 v111, 0
v_mov_b32 v244, v241
s_nop 1
v_permlane32_swap_b32 v241, v244
v_max_f32 v241, v241, v244
v_sub_f32 v48, 0, v241
v_mov_b32 v112, 0
v_sub_f32 v49, 0, v241
v_mov_b32 v113, 0
v_sub_f32 v50, 0, v241
v_mov_b32 v114, 0
v_sub_f32 v51, 0, v241
v_mov_b32 v115, 0
v_sub_f32 v52, 0, v241
v_mov_b32 v116, 0
v_sub_f32 v53, 0, v241
v_mov_b32 v117, 0
v_sub_f32 v54, 0, v241
v_mov_b32 v118, 0
v_sub_f32 v55, 0, v241
v_mov_b32 v119, 0
v_sub_f32 v56, 0, v241
v_mov_b32 v120, 0
v_sub_f32 v57, 0, v241
v_mov_b32 v121, 0
v_sub_f32 v58, 0, v241
v_mov_b32 v122, 0
v_sub_f32 v59, 0, v241
v_mov_b32 v123, 0
v_sub_f32 v60, 0, v241
v_mov_b32 v124, 0
v_sub_f32 v61, 0, v241
v_mov_b32 v125, 0
v_sub_f32 v62, 0, v241
v_mov_b32 v126, 0
v_sub_f32 v63, 0, v241
v_mov_b32 v127, 0
v_mov_b32 v244, v242
s_nop 1
v_permlane32_swap_b32 v242, v244
v_max_f32 v242, v242, v244
v_sub_f32 v64, 0, v242
v_mov_b32 v128, 0
v_sub_f32 v65, 0, v242
v_mov_b32 v129, 0
v_sub_f32 v66, 0, v242
v_mov_b32 v130, 0
v_sub_f32 v67, 0, v242
v_mov_b32 v131, 0
v_sub_f32 v68, 0, v242
v_mov_b32 v132, 0
v_sub_f32 v69, 0, v242
v_mov_b32 v133, 0
v_sub_f32 v70, 0, v242
v_mov_b32 v134, 0
v_sub_f32 v71, 0, v242
v_mov_b32 v135, 0
v_sub_f32 v72, 0, v242
v_mov_b32 v136, 0
v_sub_f32 v73, 0, v242
v_mov_b32 v137, 0
v_sub_f32 v74, 0, v242
v_mov_b32 v138, 0
v_sub_f32 v75, 0, v242
v_mov_b32 v139, 0
v_sub_f32 v76, 0, v242
v_mov_b32 v140, 0
v_sub_f32 v77, 0, v242
v_mov_b32 v141, 0
v_sub_f32 v78, 0, v242
v_mov_b32 v142, 0
v_sub_f32 v79, 0, v242
v_mov_b32 v143, 0
v_mov_b32 v244, v243
s_nop 1
v_permlane32_swap_b32 v243, v244
v_max_f32 v243, v243, v244
v_sub_f32 v80, 0, v243
v_mov_b32 v144, 0
v_sub_f32 v81, 0, v243
v_mov_b32 v145, 0
v_sub_f32 v82, 0, v243
v_mov_b32 v146, 0
v_sub_f32 v83, 0, v243
v_mov_b32 v147, 0
v_sub_f32 v84, 0, v243
v_mov_b32 v148, 0
v_sub_f32 v85, 0, v243
v_mov_b32 v149, 0
v_sub_f32 v86, 0, v243
v_mov_b32 v150, 0
v_sub_f32 v87, 0, v243
v_mov_b32 v151, 0
v_sub_f32 v88, 0, v243
v_mov_b32 v152, 0
v_sub_f32 v89, 0, v243
v_mov_b32 v153, 0
v_sub_f32 v90, 0, v243
v_mov_b32 v154, 0
v_sub_f32 v91, 0, v243
v_mov_b32 v155, 0
v_sub_f32 v92, 0, v243
v_mov_b32 v156, 0
v_sub_f32 v93, 0, v243
v_mov_b32 v157, 0
v_sub_f32 v94, 0, v243
v_mov_b32 v158, 0
v_sub_f32 v95, 0, v243
v_mov_b32 v159, 0
s_waitcnt vmcnt(0) lgkmcnt(0)
v_mfma_f32_32x32x16_bf16 v[160:175],v[192:195],v[0:3],v[32:47]
v_mfma_f32_32x32x16_bf16 v[160:175],v[196:199],v[4:7],v[160:175]
s_nop 7
s_mov_b32 s68, 32
AT_P2:
s_add_u32 s59, s59, 2048
s_min_u32 s57, s59, s60
ds_read_b128 v[208:211], v251 offset:2048
ds_read_b128 v[212:215], v251 offset:3072
buffer_load_dwordx4 v[216:219],v250,s[8:11],s57 offen
buffer_load_dwordx4 v[220:223],v250,s[8:11],s57 offen offset:1024
v_mfma_f32_32x32x16_bf16 v[176:191],v[192:195],v[8:11],v[48:63]
v_exp_f32 v160, v160
v_exp_f32 v161, v161
v_exp_f32 v162, v162
v_exp_f32 v163, v163
v_mfma_f32_32x32x16_bf16 v[176:191],v[196:199],v[12:15],v[176:191]
v_exp_f32 v164, v164
v_exp_f32 v165, v165
v_exp_f32 v166, v166
v_exp_f32 v167, v167
v_exp_f32 v168, v168
v_cvt_pk_bf16_f32 v224, v160, v161
v_cvt_pk_bf16_f32 v225, v162, v163
v_cvt_pk_bf16_f32 v226, v164, v165
v_cvt_pk_bf16_f32 v227, v166, v167
v_exp_f32 v169, v169
v_exp_f32 v170, v170
s_waitcnt vmcnt(2)
v_mfma_f32_32x32x16_bf16 v[96:111],v[200:203],v[224:227],v[96:111]
v_exp_f32 v171, v171
v_exp_f32 v172, v172
v_exp_f32 v173, v173
v_exp_f32 v174, v174
v_exp_f32 v175, v175
s_nop 0
v_cvt_pk_bf16_f32 v228, v168, v169
v_cvt_pk_bf16_f32 v229, v170, v171
v_cvt_pk_bf16_f32 v230, v172, v173
v_cvt_pk_bf16_f32 v231, v174, v175
s_nop 1
v_mfma_f32_32x32x16_bf16 v[96:111],v[204:207],v[228:231],v[96:111]
v_mfma_f32_32x32x16_bf16 v[160:175],v[192:195],v[16:19],v[64:79]
v_exp_f32 v176, v176
v_exp_f32 v177, v177
v_exp_f32 v178, v178
v_exp_f32 v179, v179
v_mfma_f32_32x32x16_bf16 v[160:175],v[196:199],v[20:23],v[160:175]
v_exp_f32 v180, v180
v_exp_f32 v181, v181
v_exp_f32 v182, v182
v_exp_f32 v183, v183
v_exp_f32 v184, v184
v_cvt_pk_bf16_f32 v232, v176, v177
v_cvt_pk_bf16_f32 v233, v178, v179
v_cvt_pk_bf16_f32 v234, v180, v181
v_cvt_pk_bf16_f32 v235, v182, v183
v_exp_f32 v185, v185
v_exp_f32 v186, v186
v_mfma_f32_32x32x16_bf16 v[112:127],v[200:203],v[232:235],v[112:127]
v_exp_f32 v187, v187
v_exp_f32 v188, v188
v_exp_f32 v189, v189
v_exp_f32 v190, v190
v_exp_f32 v191, v191
s_nop 0
v_cvt_pk_bf16_f32 v236, v184, v185
v_cvt_pk_bf16_f32 v237, v186, v187
v_cvt_pk_bf16_f32 v238, v188, v189
v_cvt_pk_bf16_f32 v239, v190, v191
s_nop 1
v_mfma_f32_32x32x16_bf16 v[112:127],v[204:207],v[236:239],v[112:127]
v_mfma_f32_32x32x16_bf16 v[176:191],v[192:195],v[24:27],v[80:95]
v_exp_f32 v160, v160
v_exp_f32 v161, v161
v_exp_f32 v162, v162
v_exp_f32 v163, v163
v_mfma_f32_32x32x16_bf16 v[176:191],v[196:199],v[28:31],v[176:191]
v_exp_f32 v164, v164
v_exp_f32 v165, v165
v_exp_f32 v166, v166
v_exp_f32 v167, v167
v_exp_f32 v168, v168
v_cvt_pk_bf16_f32 v224, v160, v161
v_cvt_pk_bf16_f32 v225, v162, v163
v_cvt_pk_bf16_f32 v226, v164, v165
v_cvt_pk_bf16_f32 v227, v166, v167
v_exp_f32 v169, v169
v_exp_f32 v170, v170
v_mfma_f32_32x32x16_bf16 v[128:143],v[200:203],v[224:227],v[128:143]
v_exp_f32 v171, v171
v_exp_f32 v172, v172
v_exp_f32 v173, v173
v_exp_f32 v174, v174
v_exp_f32 v175, v175
s_nop 0
v_cvt_pk_bf16_f32 v228, v168, v169
v_cvt_pk_bf16_f32 v229, v170, v171
v_cvt_pk_bf16_f32 v230, v172, v173
v_cvt_pk_bf16_f32 v231, v174, v175
s_nop 1
v_mfma_f32_32x32x16_bf16 v[128:143],v[204:207],v[228:231],v[128:143]
s_waitcnt lgkmcnt(0)
v_mfma_f32_32x32x16_bf16 v[160:175],v[208:211],v[0:3],v[32:47]
v_exp_f32 v176, v176
v_exp_f32 v177, v177
v_exp_f32 v178, v178
v_exp_f32 v179, v179
v_mfma_f32_32x32x16_bf16 v[160:175],v[212:215],v[4:7],v[160:175]
v_exp_f32 v180, v180
v_exp_f32 v181, v181
v_exp_f32 v182, v182
v_exp_f32 v183, v183
v_exp_f32 v184, v184
v_cvt_pk_bf16_f32 v232, v176, v177
v_cvt_pk_bf16_f32 v233, v178, v179
v_cvt_pk_bf16_f32 v234, v180, v181
v_cvt_pk_bf16_f32 v235, v182, v183
v_exp_f32 v185, v185
v_exp_f32 v186, v186
v_mfma_f32_32x32x16_bf16 v[144:159],v[200:203],v[232:235],v[144:159]
v_exp_f32 v187, v187
v_exp_f32 v188, v188
v_exp_f32 v189, v189
v_exp_f32 v190, v190
v_exp_f32 v191, v191
s_nop 0
v_cvt_pk_bf16_f32 v236, v184, v185
v_cvt_pk_bf16_f32 v237, v186, v187
v_cvt_pk_bf16_f32 v238, v188, v189
v_cvt_pk_bf16_f32 v239, v190, v191
s_nop 1
v_mfma_f32_32x32x16_bf16 v[144:159],v[204:207],v[236:239],v[144:159]
s_add_u32 s59, s59, 2048
s_min_u32 s57, s59, s60
ds_read_b128 v[192:195], v251 offset:4096
ds_read_b128 v[196:199], v251 offset:5120
buffer_load_dwordx4 v[200:203],v250,s[8:11],s57 offen
buffer_load_dwordx4 v[204:207],v250,s[8:11],s57 offen offset:1024
v_mfma_f32_32x32x16_bf16 v[176:191],v[208:211],v[8:11],v[48:63]
v_exp_f32 v160, v160
v_exp_f32 v161, v161
v_exp_f32 v162, v162
v_exp_f32 v163, v163
v_mfma_f32_32x32x16_bf16 v[176:191],v[212:215],v[12:15],v[176:191]
v_exp_f32 v164, v164
v_exp_f32 v165, v165
v_exp_f32 v166, v166
v_exp_f32 v167, v167
v_exp_f32 v168, v168
v_cvt_pk_bf16_f32 v224, v160, v161
v_cvt_pk_bf16_f32 v225, v162, v163
v_cvt_pk_bf16_f32 v226, v164, v165
v_cvt_pk_bf16_f32 v227, v166, v167
v_exp_f32 v169, v169
v_exp_f32 v170, v170
s_waitcnt vmcnt(2)
v_mfma_f32_32x32x16_bf16 v[96:111],v[216:219],v[224:227],v[96:111]
v_exp_f32 v171, v171
v_exp_f32 v172, v172
v_exp_f32 v173, v173
v_exp_f32 v174, v174
v_exp_f32 v175, v175
s_nop 0
v_cvt_pk_bf16_f32 v228, v168, v169
v_cvt_pk_bf16_f32 v229, v170, v171
v_cvt_pk_bf16_f32 v230, v172, v173
v_cvt_pk_bf16_f32 v231, v174, v175
s_nop 1
v_mfma_f32_32x32x16_bf16 v[96:111],v[220:223],v[228:231],v[96:111]
v_mfma_f32_32x32x16_bf16 v[160:175],v[208:211],v[16:19],v[64:79]
v_exp_f32 v176, v176
v_exp_f32 v177, v177
v_exp_f32 v178, v178
v_exp_f32 v179, v179
v_mfma_f32_32x32x16_bf16 v[160:175],v[212:215],v[20:23],v[160:175]
v_exp_f32 v180, v180
v_exp_f32 v181, v181
v_exp_f32 v182, v182
v_exp_f32 v183, v183
v_exp_f32 v184, v184
v_cvt_pk_bf16_f32 v232, v176, v177
v_cvt_pk_bf16_f32 v233, v178, v179
v_cvt_pk_bf16_f32 v234, v180, v181
v_cvt_pk_bf16_f32 v235, v182, v183
v_exp_f32 v185, v185
v_exp_f32 v186, v186
v_mfma_f32_32x32x16_bf16 v[112:127],v[216:219],v[232:235],v[112:127]
v_exp_f32 v187, v187
v_exp_f32 v188, v188
v_exp_f32 v189, v189
v_exp_f32 v190, v190
v_exp_f32 v191, v191
s_nop 0
v_cvt_pk_bf16_f32 v236, v184, v185
v_cvt_pk_bf16_f32 v237, v186, v187
v_cvt_pk_bf16_f32 v238, v188, v189
v_cvt_pk_bf16_f32 v239, v190, v191
s_nop 1
v_mfma_f32_32x32x16_bf16 v[112:127],v[220:223],v[236:239],v[112:127]
v_mfma_f32_32x32x16_bf16 v[176:191],v[208:211],v[24:27],v[80:95]
v_exp_f32 v160, v160
v_exp_f32 v161, v161
v_exp_f32 v162, v162
v_exp_f32 v163, v163
v_mfma_f32_32x32x16_bf16 v[176:191],v[212:215],v[28:31],v[176:191]
v_exp_f32 v164, v164
v_exp_f32 v165, v165
v_exp_f32 v166, v166
v_exp_f32 v167, v167
v_exp_f32 v168, v168
v_cvt_pk_bf16_f32 v224, v160, v161
v_cvt_pk_bf16_f32 v225, v162, v163
v_cvt_pk_bf16_f32 v226, v164, v165
v_cvt_pk_bf16_f32 v227, v166, v167
v_exp_f32 v169, v169
v_exp_f32 v170, v170
v_mfma_f32_32x32x16_bf16 v[128:143],v[216:219],v[224:227],v[128:143]
v_exp_f32 v171, v171
v_exp_f32 v172, v172
v_exp_f32 v173, v173
v_exp_f32 v174, v174
v_exp_f32 v175, v175
s_nop 0
v_cvt_pk_bf16_f32 v228, v168, v169
v_cvt_pk_bf16_f32 v229, v170, v171
v_cvt_pk_bf16_f32 v230, v172, v173
v_cvt_pk_bf16_f32 v231, v174, v175
s_nop 1
v_mfma_f32_32x32x16_bf16 v[128:143],v[220:223],v[228:231],v[128:143]
s_waitcnt lgkmcnt(0)
v_mfma_f32_32x32x16_bf16 v[160:175],v[192:195],v[0:3],v[32:47]
v_exp_f32 v176, v176
v_exp_f32 v177, v177
v_exp_f32 v178, v178
v_exp_f32 v179, v179
v_mfma_f32_32x32x16_bf16 v[160:175],v[196:199],v[4:7],v[160:175]
v_exp_f32 v180, v180
v_exp_f32 v181, v181
v_exp_f32 v182, v182
v_exp_f32 v183, v183
v_exp_f32 v184, v184
v_cvt_pk_bf16_f32 v232, v176, v177
v_cvt_pk_bf16_f32 v233, v178, v179
v_cvt_pk_bf16_f32 v234, v180, v181
v_cvt_pk_bf16_f32 v235, v182, v183
v_exp_f32 v185, v185
v_exp_f32 v186, v186
v_mfma_f32_32x32x16_bf16 v[144:159],v[216:219],v[232:235],v[144:159]
v_exp_f32 v187, v187
v_exp_f32 v188, v188
v_exp_f32 v189, v189
v_exp_f32 v190, v190
v_exp_f32 v191, v191
s_nop 0
v_cvt_pk_bf16_f32 v236, v184, v185
v_cvt_pk_bf16_f32 v237, v186, v187
v_cvt_pk_bf16_f32 v238, v188, v189
v_cvt_pk_bf16_f32 v239, v190, v191
s_nop 1
v_mfma_f32_32x32x16_bf16 v[144:159],v[220:223],v[236:239],v[144:159]
v_add_u32 v251, 4096, v251
s_sub_u32 s68, s68, 1
s_cmp_lg_u32 s68, 0
s_cbranch_scc1 AT_P2
s_mul_i32 s57, s62, 5
v_lshrrev_b32 v250, 5, v255
v_add_u32 v250, s57, v250
v_and_b32 v251, 1, v250
v_lshrrev_b32 v250, 1, v250
v_lshlrev_b32 v250, 9, v250
v_lshl_add_u32 v250, v251, 3, v250
v_and_b32 v254, 31, v255
v_mul_u32_u24 v254, 16, v254
v_add_u32 v250, v254, v250
v_cmp_gt_u32 vcc, 32, v255
v_mov_b32 v251, 1073741824
s_nop 0
v_cndmask_b32 v251, v251, v250, vcc
s_mul_i32 s67, s66, 163840
s_nop 7
v_mov_b32 v240, v104
v_mov_b32 v241, v104
s_nop 1
v_permlane32_swap_b32 v240, v241
v_rcp_f32 v241, v241
s_nop 0
v_mul_f32 v96, v96, v241
v_mul_f32 v97, v97, v241
v_mul_f32 v98, v98, v241
v_mul_f32 v99, v99, v241
v_mul_f32 v100, v100, v241
v_mul_f32 v101, v101, v241
v_mul_f32 v102, v102, v241
v_mul_f32 v103, v103, v241
v_mul_f32 v104, v104, v241
v_mul_f32 v105, v105, v241
v_mul_f32 v106, v106, v241
v_mul_f32 v107, v107, v241
v_cvt_pk_bf16_f32 v96, v96, v97
v_cvt_pk_bf16_f32 v97, v98, v99
v_cvt_pk_bf16_f32 v98, v100, v101
v_cvt_pk_bf16_f32 v99, v102, v103
v_cvt_pk_bf16_f32 v100, v104, v105
v_cvt_pk_bf16_f32 v101, v106, v107
s_add_u32 s57, s67, 209338368
buffer_store_dwordx2 v[96:97],v250,s[8:11],s57 offen sc1
buffer_store_dwordx2 v[98:99],v250,s[8:11],s57 offen offset:512 sc1
buffer_store_dwordx2 v[100:101],v251,s[8:11],s57 offen offset:1024 sc1
v_mov_b32 v240, v120
v_mov_b32 v241, v120
s_nop 1
v_permlane32_swap_b32 v240, v241
v_rcp_f32 v241, v241
s_nop 0
v_mul_f32 v112, v112, v241
v_mul_f32 v113, v113, v241
v_mul_f32 v114, v114, v241
v_mul_f32 v115, v115, v241
v_mul_f32 v116, v116, v241
v_mul_f32 v117, v117, v241
v_mul_f32 v118, v118, v241
v_mul_f32 v119, v119, v241
v_mul_f32 v120, v120, v241
v_mul_f32 v121, v121, v241
v_mul_f32 v122, v122, v241
v_mul_f32 v123, v123, v241
v_cvt_pk_bf16_f32 v112, v112, v113
v_cvt_pk_bf16_f32 v113, v114, v115
v_cvt_pk_bf16_f32 v114, v116, v117
v_cvt_pk_bf16_f32 v115, v118, v119
v_cvt_pk_bf16_f32 v116, v120, v121
v_cvt_pk_bf16_f32 v117, v122, v123
s_add_u32 s57, s67, 209379328
buffer_store_dwordx2 v[112:113],v250,s[8:11],s57 offen sc1
buffer_store_dwordx2 v[114:115],v250,s[8:11],s57 offen offset:512 sc1
buffer_store_dwordx2 v[116:117],v251,s[8:11],s57 offen offset:1024 sc1
v_mov_b32 v240, v136
v_mov_b32 v241, v136
s_nop 1
v_permlane32_swap_b32 v240, v241
v_rcp_f32 v241, v241
s_nop 0
v_mul_f32 v128, v128, v241
v_mul_f32 v129, v129, v241
v_mul_f32 v130, v130, v241
v_mul_f32 v131, v131, v241
v_mul_f32 v132, v132, v241
v_mul_f32 v133, v133, v241
v_mul_f32 v134, v134, v241
v_mul_f32 v135, v135, v241
v_mul_f32 v136, v136, v241
v_mul_f32 v137, v137, v241
v_mul_f32 v138, v138, v241
v_mul_f32 v139, v139, v241
v_cvt_pk_bf16_f32 v128, v128, v129
v_cvt_pk_bf16_f32 v129, v130, v131
v_cvt_pk_bf16_f32 v130, v132, v133
v_cvt_pk_bf16_f32 v131, v134, v135
v_cvt_pk_bf16_f32 v132, v136, v137
v_cvt_pk_bf16_f32 v133, v138, v139
s_add_u32 s57, s67, 209420288
buffer_store_dwordx2 v[128:129],v250,s[8:11],s57 offen sc1
buffer_store_dwordx2 v[130:131],v250,s[8:11],s57 offen offset:512 sc1
buffer_store_dwordx2 v[132:133],v251,s[8:11],s57 offen offset:1024 sc1
v_mov_b32 v240, v152
v_mov_b32 v241, v152
s_nop 1
v_permlane32_swap_b32 v240, v241
v_rcp_f32 v241, v241
s_nop 0
v_mul_f32 v144, v144, v241
v_mul_f32 v145, v145, v241
v_mul_f32 v146, v146, v241
v_mul_f32 v147, v147, v241
v_mul_f32 v148, v148, v241
v_mul_f32 v149, v149, v241
v_mul_f32 v150, v150, v241
v_mul_f32 v151, v151, v241
v_mul_f32 v152, v152, v241
v_mul_f32 v153, v153, v241
v_mul_f32 v154, v154, v241
v_mul_f32 v155, v155, v241
v_cvt_pk_bf16_f32 v144, v144, v145
v_cvt_pk_bf16_f32 v145, v146, v147
v_cvt_pk_bf16_f32 v146, v148, v149
v_cvt_pk_bf16_f32 v147, v150, v151
v_cvt_pk_bf16_f32 v148, v152, v153
v_cvt_pk_bf16_f32 v149, v154, v155
s_add_u32 s57, s67, 209461248
buffer_store_dwordx2 v[144:145],v250,s[8:11],s57 offen sc1
buffer_store_dwordx2 v[146:147],v250,s[8:11],s57 offen offset:512 sc1
buffer_store_dwordx2 v[148:149],v251,s[8:11],s57 offen offset:1024 sc1
v_lshrrev_b32 v224, 5, v255
v_and_b32 v224, 1, v224
v_mul_u32_u24 v224, 6144, v224
v_lshrrev_b32 v254, 2, v255
v_and_b32 v254, 3, v254
v_mul_u32_u24 v254, 64, v254
v_add_u32 v224, v254, v224
v_lshrrev_b32 v254, 4, v255
v_and_b32 v254, 1, v254
v_mul_u32_u24 v254, 32, v254
v_add_u32 v224, v254, v224
v_and_b32 v254, 3, v255
v_mul_u32_u24 v254, 8, v254
v_add_u32 v224, v254, v224
v_add_u32 v225, 49152, v224
v_add_u32 v226, 98304, v224
v_lshrrev_b32 v227, 5, v255
v_and_b32 v227, 1, v227
v_mul_u32_u24 v227, 256, v227
v_lshrrev_b32 v254, 2, v255
v_and_b32 v254, 3, v254
v_mul_u32_u24 v254, 64, v254
v_add_u32 v227, v254, v227
v_lshrrev_b32 v254, 4, v255
v_and_b32 v254, 1, v254
v_mul_u32_u24 v254, 32, v254
v_add_u32 v227, v254, v227
v_and_b32 v254, 3, v255
v_mul_u32_u24 v254, 8, v254
v_add_u32 v227, v254, v227
v_add_u32 v228, 49152, v227
v_add_u32 v229, 98304, v227
v_lshlrev_b32 v233, 4, v255
v_lshrrev_b32 v231, 2, v255
v_and_b32 v231, 7, v231
v_mul_u32_u24 v231, 1280, v231
v_lshrrev_b32 v254, 5, v255
v_and_b32 v254, 1, v254
v_mul_u32_u24 v254, 64, v254
v_add_u32 v231, v254, v231
v_and_b32 v254, 3, v255
v_mul_u32_u24 v254, 16, v254
v_add_u32 v231, v254, v231
s_mul_i32 s57, s56, 10240
v_add_u32 v231, s57, v231
s_mul_i32 s58, s56, 6144
v_or_b32 v239, s56, v255
v_cmp_eq_u32 vcc, 0, v239
v_mov_b32 v239, 1
v_mov_b32 v238, 1073741824
v_cndmask_b32 v238, v238, 0, vcc
s_lshl_b32 s92, s63, 7
s_add_u32 s92, s92, 244454912
s_waitcnt vmcnt(0)
s_barrier
buffer_atomic_add v239,v238,s[8:11],s92 offen sc1
s_lshl_b32 s6, s5, 2
s_add_u32 s6, s6, s4
s_cmp_lt_u32 s6, 80
s_cbranch_scc0 FIN0
s_mul_i32 s63, s6, 52429
s_lshr_b32 s63, s63, 18
s_mul_i32 s57, s63, 5
s_sub_u32 s62, s6, s57
s_lshr_b32 s57, s63, 2
s_lshl_b32 s92, s57, 7
s_add_u32 s92, s92, 244454912
v_mov_b32 v0, 0
s_branch FW20b
FW20:
s_sleep 4
FW20b:
buffer_load_dword v1,v0,s[8:11],s92 offen sc1
s_sub_u32 s71, s71, 1
s_cbranch_scc1 EX1
s_waitcnt vmcnt(0)
v_cmp_gt_u32 vcc, 32, v1
s_cbranch_vccnz FW20
s_mov_b32 s57, s63
s_mul_i32 s57, s57, 5
s_add_u32 s57, s57, s62
s_lshl_b32 s92, s57, 7
s_add_u32 s92, s92, 244474880
v_lshrrev_b32 v230, 2, v255
v_and_b32 v230, 7, v230
v_mul_u32_u24 v230, 1280, v230
v_lshrrev_b32 v254, 5, v255
v_and_b32 v254, 1, v254
v_mul_u32_u24 v254, 64, v254
v_add_u32 v230, v254, v230
v_and_b32 v254, 3, v255
v_mul_u32_u24 v254, 16, v254
v_add_u32 v230, v254, v230
s_mul_i32 s57, s56, 10240
v_add_u32 v230, s57, v230
s_lshl_b32 s66, s63, 2
s_add_u32 s66, s66, s56
s_mul_i32 s61, s66, 40960
s_add_u32 s61, s61, 209338368
s_lshl_b32 s59, s62, 8
s_mul_i32 s67, s66, 5
s_add_u32 s67, s67, s62
s_lshl_b32 s67, s67, 13
s_add_u32 s67, s67, 211959808
s_add_u32 s68, s67, 4096
s_barrier
s_add_u32 m0, s58, 0
s_add_u32 s57, s59, 0
buffer_load_dwordx4 v230,s[20:23],s57 offen lds
s_add_u32 m0, s58, 1024
s_add_u32 s57, s59, 128
buffer_load_dwordx4 v230,s[20:23],s57 offen lds
s_add_u32 m0, s58, 2048
s_add_u32 s57, s59, 40960
buffer_load_dwordx4 v230,s[20:23],s57 offen lds
s_add_u32 m0, s58, 3072
s_add_u32 s57, s59, 41088
buffer_load_dwordx4 v230,s[20:23],s57 offen lds
s_add_u32 m0, s58, 24576
s_add_u32 s57, s59, 81920
buffer_load_dwordx4 v230,s[20:23],s57 offen lds
s_add_u32 m0, s58, 25600
s_add_u32 s57, s59, 82048
buffer_load_dwordx4 v230,s[20:23],s57 offen lds
s_add_u32 m0, s58, 26624
s_add_u32 s57, s59, 122880
buffer_load_dwordx4 v230,s[20:23],s57 offen lds
s_add_u32 m0, s58, 27648
s_add_u32 s57, s59, 123008
buffer_load_dwordx4 v230,s[20:23],s57 offen lds
s_add_u32 s57, s61, 0
buffer_load_dwordx4 a[0:3],v233,s[8:11],s57 offen sc1
buffer_load_dwordx4 a[4:7],v233,s[8:11],s57 offen offset:1024 sc1
buffer_load_dwordx4 a[8:11],v233,s[8:11],s57 offen offset:2048 sc1
buffer_load_dwordx4 a[12:15],v233,s[8:11],s57 offen offset:3072 sc1
s_add_u32 s57, s61, 4096
buffer_load_dwordx4 a[16:19],v233,s[8:11],s57 offen sc1
buffer_load_dwordx4 a[20:23],v233,s[8:11],s57 offen offset:1024 sc1
buffer_load_dwordx4 a[24:27],v233,s[8:11],s57 offen offset:2048 sc1
buffer_load_dwordx4 a[28:31],v233,s[8:11],s57 offen offset:3072 sc1
s_add_u32 s57, s61, 8192
buffer_load_dwordx4 a[32:35],v233,s[8:11],s57 offen sc1
buffer_load_dwordx4 a[36:39],v233,s[8:11],s57 offen offset:1024 sc1
buffer_load_dwordx4 a[40:43],v233,s[8:11],s57 offen offset:2048 sc1
buffer_load_dwordx4 a[44:47],v233,s[8:11],s57 offen offset:3072 sc1
s_add_u32 s57, s61, 12288
buffer_load_dwordx4 a[48:51],v233,s[8:11],s57 offen sc1
buffer_load_dwordx4 a[52:55],v233,s[8:11],s57 offen offset:1024 sc1
buffer_load_dwordx4 a[56:59],v233,s[8:11],s57 offen offset:2048 sc1
buffer_load_dwordx4 a[60:63],v233,s[8:11],s57 offen offset:3072 sc1
s_add_u32 s57, s61, 16384
buffer_load_dwordx4 a[64:67],v233,s[8:11],s57 offen sc1
buffer_load_dwordx4 a[68:71],v233,s[8:11],s57 offen offset:1024 sc1
buffer_load_dwordx4 a[72:75],v233,s[8:11],s57 offen offset:2048 sc1
buffer_load_dwordx4 a[76:79],v233,s[8:11],s57 offen offset:3072 sc1
s_add_u32 s57, s61, 20480
buffer_load_dwordx4 a[80:83],v233,s[8:11],s57 offen sc1
buffer_load_dwordx4 a[84:87],v233,s[8:11],s57 offen offset:1024 sc1
buffer_load_dwordx4 a[88:91],v233,s[8:11],s57 offen offset:2048 sc1
buffer_load_dwordx4 a[92:95],v233,s[8:11],s57 offen offset:3072 sc1
s_add_u32 s57, s61, 24576
buffer_load_dwordx4 a[96:99],v233,s[8:11],s57 offen sc1
buffer_load_dwordx4 a[100:103],v233,s[8:11],s57 offen offset:1024 sc1
buffer_load_dwordx4 a[104:107],v233,s[8:11],s57 offen offset:2048 sc1
buffer_load_dwordx4 a[108:111],v233,s[8:11],s57 offen offset:3072 sc1
s_add_u32 s57, s61, 28672
buffer_load_dwordx4 a[112:115],v233,s[8:11],s57 offen sc1
buffer_load_dwordx4 a[116:119],v233,s[8:11],s57 offen offset:1024 sc1
buffer_load_dwordx4 a[120:123],v233,s[8:11],s57 offen offset:2048 sc1
buffer_load_dwordx4 a[124:127],v233,s[8:11],s57 offen offset:3072 sc1
s_add_u32 s57, s61, 32768
buffer_load_dwordx4 a[128:131],v233,s[8:11],s57 offen sc1
buffer_load_dwordx4 a[132:135],v233,s[8:11],s57 offen offset:1024 sc1
buffer_load_dwordx4 a[136:139],v233,s[8:11],s57 offen offset:2048 sc1
buffer_load_dwordx4 a[140:143],v233,s[8:11],s57 offen offset:3072 sc1
s_add_u32 s57, s61, 36864
buffer_load_dwordx4 a[144:147],v233,s[8:11],s57 offen sc1
buffer_load_dwordx4 a[148:151],v233,s[8:11],s57 offen offset:1024 sc1
buffer_load_dwordx4 a[152:155],v233,s[8:11],s57 offen offset:2048 sc1
buffer_load_dwordx4 a[156:159],v233,s[8:11],s57 offen offset:3072 sc1
v_and_b32 v245, 31, v255
v_mul_u32_u24 v245, 4, v245
s_lshl_b32 s57, s66, 7
s_add_u32 s57, s57, 239157248
buffer_load_dword v244,v245,s[8:11],s57 offen sc1
s_add_u32 m0, s58, 49152
s_add_u32 s57, s59, 163840
buffer_load_dwordx4 v230,s[20:23],s57 offen lds
s_add_u32 m0, s58, 50176
s_add_u32 s57, s59, 163968
buffer_load_dwordx4 v230,s[20:23],s57 offen lds
s_add_u32 m0, s58, 51200
s_add_u32 s57, s59, 204800
buffer_load_dwordx4 v230,s[20:23],s57 offen lds
s_add_u32 m0, s58, 52224
s_add_u32 s57, s59, 204928
buffer_load_dwordx4 v230,s[20:23],s57 offen lds
s_add_u32 m0, s58, 73728
s_add_u32 s57, s59, 245760
buffer_load_dwordx4 v230,s[20:23],s57 offen lds
s_add_u32 m0, s58, 74752
s_add_u32 s57, s59, 245888
buffer_load_dwordx4 v230,s[20:23],s57 offen lds
s_add_u32 m0, s58, 75776
s_add_u32 s57, s59, 286720
buffer_load_dwordx4 v230,s[20:23],s57 offen lds
s_add_u32 m0, s58, 76800
s_add_u32 s57, s59, 286848
buffer_load_dwordx4 v230,s[20:23],s57 offen lds
s_waitcnt vmcnt(53)
s_waitcnt vmcnt(9)
s_barrier
ds_read_b64_tr_b16 v[192:193],v224 offset:0
ds_read_b64_tr_b16 v[194:195],v224 offset:256
ds_read_b64_tr_b16 v[196:197],v224 offset:512
ds_read_b64_tr_b16 v[198:199],v224 offset:768
ds_read_b64_tr_b16 v[200:201],v224 offset:1024
ds_read_b64_tr_b16 v[202:203],v224 offset:1280
ds_read_b64_tr_b16 v[204:205],v224 offset:1536
ds_read_b64_tr_b16 v[206:207],v224 offset:1792
ds_read_b64_tr_b16 v[208:209],v224 offset:12288
ds_read_b64_tr_b16 v[210:211],v224 offset:12544
ds_read_b64_tr_b16 v[212:213],v224 offset:12800
ds_read_b64_tr_b16 v[214:215],v224 offset:13056
ds_read_b64_tr_b16 v[216:217],v224 offset:13312
ds_read_b64_tr_b16 v[218:219],v224 offset:13568
s_waitcnt lgkmcnt(12)
v_mfma_f32_32x32x16_bf16 v[0:15],v[192:195],a[0:3],0
ds_read_b64_tr_b16 v[220:221],v224 offset:13824
ds_read_b64_tr_b16 v[222:223],v224 offset:14080
s_waitcnt lgkmcnt(12)
v_mfma_f32_32x32x16_bf16 v[16:31],v[196:199],a[0:3],0
s_add_u32 m0, s58, 98304
s_add_u32 s57, s59, 327680
buffer_load_dwordx4 v230,s[20:23],s57 offen lds
ds_read_b64_tr_b16 v[192:193],v224 offset:2048
ds_read_b64_tr_b16 v[194:195],v224 offset:2304
s_waitcnt lgkmcnt(12)
v_mfma_f32_32x32x16_bf16 v[32:47],v[200:203],a[0:3],0
ds_read_b64_tr_b16 v[196:197],v224 offset:2560
ds_read_b64_tr_b16 v[198:199],v224 offset:2816
s_waitcnt lgkmcnt(12)
v_mfma_f32_32x32x16_bf16 v[48:63],v[204:207],a[0:3],0
s_add_u32 m0, s58, 99328
s_add_u32 s57, s59, 327808
buffer_load_dwordx4 v230,s[20:23],s57 offen lds
ds_read_b64_tr_b16 v[200:201],v224 offset:3072
ds_read_b64_tr_b16 v[202:203],v224 offset:3328
s_waitcnt lgkmcnt(12)
v_mfma_f32_32x32x16_bf16 v[0:15],v[208:211],a[4:7],v[0:15]
ds_read_b64_tr_b16 v[204:205],v224 offset:3584
ds_read_b64_tr_b16 v[206:207],v224 offset:3840
s_waitcnt lgkmcnt(12)
v_mfma_f32_32x32x16_bf16 v[16:31],v[212:215],a[4:7],v[16:31]
s_add_u32 m0, s58, 100352
s_add_u32 s57, s59, 368640
buffer_load_dwordx4 v230,s[20:23],s57 offen lds
ds_read_b64_tr_b16 v[208:209],v224 offset:14336
ds_read_b64_tr_b16 v[210:211],v224 offset:14592
s_waitcnt lgkmcnt(12)
v_mfma_f32_32x32x16_bf16 v[32:47],v[216:219],a[4:7],v[32:47]
ds_read_b64_tr_b16 v[212:213],v224 offset:14848
ds_read_b64_tr_b16 v[214:215],v224 offset:15104
s_waitcnt lgkmcnt(12)
v_mfma_f32_32x32x16_bf16 v[48:63],v[220:223],a[4:7],v[48:63]
s_add_u32 m0, s58, 101376
s_add_u32 s57, s59, 368768
buffer_load_dwordx4 v230,s[20:23],s57 offen lds
ds_read_b64_tr_b16 v[216:217],v224 offset:15360
ds_read_b64_tr_b16 v[218:219],v224 offset:15616
s_waitcnt lgkmcnt(12)
v_mfma_f32_32x32x16_bf16 v[0:15],v[192:195],a[8:11],v[0:15]
ds_read_b64_tr_b16 v[220:221],v224 offset:15872
ds_read_b64_tr_b16 v[222:223],v224 offset:16128
s_waitcnt lgkmcnt(12)
v_mfma_f32_32x32x16_bf16 v[16:31],v[196:199],a[8:11],v[16:31]
s_barrier
ds_read_b64_tr_b16 v[192:193],v224 offset:24576
ds_read_b64_tr_b16 v[194:195],v224 offset:24832
s_waitcnt lgkmcnt(12)
v_mfma_f32_32x32x16_bf16 v[32:47],v[200:203],a[8:11],v[32:47]
ds_read_b64_tr_b16 v[196:197],v224 offset:25088
ds_read_b64_tr_b16 v[198:199],v224 offset:25344
s_waitcnt lgkmcnt(12)
v_mfma_f32_32x32x16_bf16 v[48:63],v[204:207],a[8:11],v[48:63]
ds_read_b64_tr_b16 v[200:201],v224 offset:25600
ds_read_b64_tr_b16 v[202:203],v224 offset:25856
s_waitcnt lgkmcnt(12)
v_mfma_f32_32x32x16_bf16 v[0:15],v[208:211],a[12:15],v[0:15]
ds_read_b64_tr_b16 v[204:205],v224 offset:26112
ds_read_b64_tr_b16 v[206:207],v224 offset:26368
s_waitcnt lgkmcnt(12)
v_mfma_f32_32x32x16_bf16 v[16:31],v[212:215],a[12:15],v[16:31]
ds_read_b64_tr_b16 v[208:209],v224 offset:36864
ds_read_b64_tr_b16 v[210:211],v224 offset:37120
s_waitcnt lgkmcnt(12)
v_mfma_f32_32x32x16_bf16 v[32:47],v[216:219],a[12:15],v[32:47]
ds_read_b64_tr_b16 v[212:213],v224 offset:37376
ds_read_b64_tr_b16 v[214:215],v224 offset:37632
s_waitcnt lgkmcnt(12)
v_mfma_f32_32x32x16_bf16 v[48:63],v[220:223],a[12:15],v[48:63]
ds_read_b64_tr_b16 v[216:217],v224 offset:37888
ds_read_b64_tr_b16 v[218:219],v224 offset:38144
s_waitcnt lgkmcnt(12)
v_mfma_f32_32x32x16_bf16 v[0:15],v[192:195],a[16:19],v[0:15]
ds_read_b64_tr_b16 v[220:221],v224 offset:38400
ds_read_b64_tr_b16 v[222:223],v224 offset:38656
s_waitcnt lgkmcnt(12)
v_mfma_f32_32x32x16_bf16 v[16:31],v[196:199],a[16:19],v[16:31]
s_add_u32 m0, s58, 0
s_add_u32 s57, s59, 409600
buffer_load_dwordx4 v230,s[20:23],s57 offen lds
ds_read_b64_tr_b16 v[192:193],v224 offset:26624
ds_read_b64_tr_b16 v[194:195],v224 offset:26880
s_waitcnt lgkmcnt(12)
v_mfma_f32_32x32x16_bf16 v[32:47],v[200:203],a[16:19],v[32:47]
ds_read_b64_tr_b16 v[196:197],v224 offset:27136
ds_read_b64_tr_b16 v[198:199],v224 offset:27392
s_waitcnt lgkmcnt(12)
v_mfma_f32_32x32x16_bf16 v[48:63],v[204:207],a[16:19],v[48:63]
s_add_u32 m0, s58, 1024
s_add_u32 s57, s59, 409728
buffer_load_dwordx4 v230,s[20:23],s57 offen lds
ds_read_b64_tr_b16 v[200:201],v224 offset:27648
ds_read_b64_tr_b16 v[202:203],v224 offset:27904
s_waitcnt lgkmcnt(12)
v_mfma_f32_32x32x16_bf16 v[0:15],v[208:211],a[20:23],v[0:15]
ds_read_b64_tr_b16 v[204:205],v224 offset:28160
ds_read_b64_tr_b16 v[206:207],v224 offset:28416
s_waitcnt lgkmcnt(12)
v_mfma_f32_32x32x16_bf16 v[16:31],v[212:215],a[20:23],v[16:31]
s_add_u32 m0, s58, 2048
s_add_u32 s57, s59, 450560
buffer_load_dwordx4 v230,s[20:23],s57 offen lds
ds_read_b64_tr_b16 v[208:209],v224 offset:38912
ds_read_b64_tr_b16 v[210:211],v224 offset:39168
s_waitcnt lgkmcnt(12)
v_mfma_f32_32x32x16_bf16 v[32:47],v[216:219],a[20:23],v[32:47]
ds_read_b64_tr_b16 v[212:213],v224 offset:39424
ds_read_b64_tr_b16 v[214:215],v224 offset:39680
s_waitcnt lgkmcnt(12)
v_mfma_f32_32x32x16_bf16 v[48:63],v[220:223],a[20:23],v[48:63]
s_add_u32 m0, s58, 3072
s_add_u32 s57, s59, 450688
buffer_load_dwordx4 v230,s[20:23],s57 offen lds
ds_read_b64_tr_b16 v[216:217],v224 offset:39936
ds_read_b64_tr_b16 v[218:219],v224 offset:40192
s_waitcnt lgkmcnt(12)
v_mfma_f32_32x32x16_bf16 v[0:15],v[192:195],a[24:27],v[0:15]
ds_read_b64_tr_b16 v[220:221],v224 offset:40448
ds_read_b64_tr_b16 v[222:223],v224 offset:40704
s_waitcnt lgkmcnt(12)
v_mfma_f32_32x32x16_bf16 v[16:31],v[196:199],a[24:27],v[16:31]
s_waitcnt vmcnt(12)
s_barrier
ds_read_b64_tr_b16 v[192:193],v225 offset:0
ds_read_b64_tr_b16 v[194:195],v225 offset:256
s_waitcnt lgkmcnt(12)
v_mfma_f32_32x32x16_bf16 v[32:47],v[200:203],a[24:27],v[32:47]
ds_read_b64_tr_b16 v[196:197],v225 offset:512
ds_read_b64_tr_b16 v[198:199],v225 offset:768
s_waitcnt lgkmcnt(12)
v_mfma_f32_32x32x16_bf16 v[48:63],v[204:207],a[24:27],v[48:63]
ds_read_b64_tr_b16 v[200:201],v225 offset:1024
ds_read_b64_tr_b16 v[202:203],v225 offset:1280
s_waitcnt lgkmcnt(12)
v_mfma_f32_32x32x16_bf16 v[0:15],v[208:211],a[28:31],v[0:15]
ds_read_b64_tr_b16 v[204:205],v225 offset:1536
ds_read_b64_tr_b16 v[206:207],v225 offset:1792
s_waitcnt lgkmcnt(12)
v_mfma_f32_32x32x16_bf16 v[16:31],v[212:215],a[28:31],v[16:31]
ds_read_b64_tr_b16 v[208:209],v225 offset:12288
ds_read_b64_tr_b16 v[210:211],v225 offset:12544
s_waitcnt lgkmcnt(12)
v_mfma_f32_32x32x16_bf16 v[32:47],v[216:219],a[28:31],v[32:47]
ds_read_b64_tr_b16 v[212:213],v225 offset:12800
ds_read_b64_tr_b16 v[214:215],v225 offset:13056
s_waitcnt lgkmcnt(12)
v_mfma_f32_32x32x16_bf16 v[48:63],v[220:223],a[28:31],v[48:63]
ds_read_b64_tr_b16 v[216:217],v225 offset:13312
ds_read_b64_tr_b16 v[218:219],v225 offset:13568
s_waitcnt lgkmcnt(12)
v_mfma_f32_32x32x16_bf16 v[0:15],v[192:195],a[32:35],v[0:15]
ds_read_b64_tr_b16 v[220:221],v225 offset:13824
ds_read_b64_tr_b16 v[222:223],v225 offset:14080
s_waitcnt lgkmcnt(12)
v_mfma_f32_32x32x16_bf16 v[16:31],v[196:199],a[32:35],v[16:31]
s_add_u32 m0, s58, 24576
s_add_u32 s57, s59, 491520
buffer_load_dwordx4 v230,s[20:23],s57 offen lds
ds_read_b64_tr_b16 v[192:193],v225 offset:2048
ds_read_b64_tr_b16 v[194:195],v225 offset:2304
s_waitcnt lgkmcnt(12)
v_mfma_f32_32x32x16_bf16 v[32:47],v[200:203],a[32:35],v[32:47]
ds_read_b64_tr_b16 v[196:197],v225 offset:2560
ds_read_b64_tr_b16 v[198:199],v225 offset:2816
s_waitcnt lgkmcnt(12)
v_mfma_f32_32x32x16_bf16 v[48:63],v[204:207],a[32:35],v[48:63]
s_add_u32 m0, s58, 25600
s_add_u32 s57, s59, 491648
buffer_load_dwordx4 v230,s[20:23],s57 offen lds
ds_read_b64_tr_b16 v[200:201],v225 offset:3072
ds_read_b64_tr_b16 v[202:203],v225 offset:3328
s_waitcnt lgkmcnt(12)
v_mfma_f32_32x32x16_bf16 v[0:15],v[208:211],a[36:39],v[0:15]
ds_read_b64_tr_b16 v[204:205],v225 offset:3584
ds_read_b64_tr_b16 v[206:207],v225 offset:3840
s_waitcnt lgkmcnt(12)
v_mfma_f32_32x32x16_bf16 v[16:31],v[212:215],a[36:39],v[16:31]
s_add_u32 m0, s58, 26624
s_add_u32 s57, s59, 532480
buffer_load_dwordx4 v230,s[20:23],s57 offen lds
ds_read_b64_tr_b16 v[208:209],v225 offset:14336
ds_read_b64_tr_b16 v[210:211],v225 offset:14592
s_waitcnt lgkmcnt(12)
v_mfma_f32_32x32x16_bf16 v[32:47],v[216:219],a[36:39],v[32:47]
ds_read_b64_tr_b16 v[212:213],v225 offset:14848
ds_read_b64_tr_b16 v[214:215],v225 offset:15104
s_waitcnt lgkmcnt(12)
v_mfma_f32_32x32x16_bf16 v[48:63],v[220:223],a[36:39],v[48:63]
s_add_u32 m0, s58, 27648
s_add_u32 s57, s59, 532608
buffer_load_dwordx4 v230,s[20:23],s57 offen lds
ds_read_b64_tr_b16 v[216:217],v225 offset:15360
ds_read_b64_tr_b16 v[218:219],v225 offset:15616
s_waitcnt lgkmcnt(12)
v_mfma_f32_32x32x16_bf16 v[0:15],v[192:195],a[40:43],v[0:15]
ds_read_b64_tr_b16 v[220:221],v225 offset:15872
ds_read_b64_tr_b16 v[222:223],v225 offset:16128
s_waitcnt lgkmcnt(12)
v_mfma_f32_32x32x16_bf16 v[16:31],v[196:199],a[40:43],v[16:31]
s_waitcnt vmcnt(12)
s_barrier
ds_read_b64_tr_b16 v[192:193],v225 offset:24576
ds_read_b64_tr_b16 v[194:195],v225 offset:24832
s_waitcnt lgkmcnt(12)
v_mfma_f32_32x32x16_bf16 v[32:47],v[200:203],a[40:43],v[32:47]
ds_read_b64_tr_b16 v[196:197],v225 offset:25088
ds_read_b64_tr_b16 v[198:199],v225 offset:25344
s_waitcnt lgkmcnt(12)
v_mfma_f32_32x32x16_bf16 v[48:63],v[204:207],a[40:43],v[48:63]
ds_read_b64_tr_b16 v[200:201],v225 offset:25600
ds_read_b64_tr_b16 v[202:203],v225 offset:25856
s_waitcnt lgkmcnt(12)
v_mfma_f32_32x32x16_bf16 v[0:15],v[208:211],a[44:47],v[0:15]
ds_read_b64_tr_b16 v[204:205],v225 offset:26112
ds_read_b64_tr_b16 v[206:207],v225 offset:26368
s_waitcnt lgkmcnt(12)
v_mfma_f32_32x32x16_bf16 v[16:31],v[212:215],a[44:47],v[16:31]
ds_read_b64_tr_b16 v[208:209],v225 offset:36864
ds_read_b64_tr_b16 v[210:211],v225 offset:37120
s_waitcnt lgkmcnt(12)
v_mfma_f32_32x32x16_bf16 v[32:47],v[216:219],a[44:47],v[32:47]
ds_read_b64_tr_b16 v[212:213],v225 offset:37376
ds_read_b64_tr_b16 v[214:215],v225 offset:37632
s_waitcnt lgkmcnt(12)
v_mfma_f32_32x32x16_bf16 v[48:63],v[220:223],a[44:47],v[48:63]
ds_read_b64_tr_b16 v[216:217],v225 offset:37888
ds_read_b64_tr_b16 v[218:219],v225 offset:38144
s_waitcnt lgkmcnt(12)
v_mfma_f32_32x32x16_bf16 v[0:15],v[192:195],a[48:51],v[0:15]
ds_read_b64_tr_b16 v[220:221],v225 offset:38400
ds_read_b64_tr_b16 v[222:223],v225 offset:38656
s_waitcnt lgkmcnt(12)
v_mfma_f32_32x32x16_bf16 v[16:31],v[196:199],a[48:51],v[16:31]
s_add_u32 m0, s58, 49152
s_add_u32 s57, s59, 573440
buffer_load_dwordx4 v230,s[20:23],s57 offen lds
ds_read_b64_tr_b16 v[192:193],v225 offset:26624
ds_read_b64_tr_b16 v[194:195],v225 offset:26880
s_waitcnt lgkmcnt(12)
v_mfma_f32_32x32x16_bf16 v[32:47],v[200:203],a[48:51],v[32:47]
ds_read_b64_tr_b16 v[196:197],v225 offset:27136
ds_read_b64_tr_b16 v[198:199],v225 offset:27392
s_waitcnt lgkmcnt(12)
v_mfma_f32_32x32x16_bf16 v[48:63],v[204:207],a[48:51],v[48:63]
s_add_u32 m0, s58, 50176
s_add_u32 s57, s59, 573568
buffer_load_dwordx4 v230,s[20:23],s57 offen lds
ds_read_b64_tr_b16 v[200:201],v225 offset:27648
ds_read_b64_tr_b16 v[202:203],v225 offset:27904
s_waitcnt lgkmcnt(12)
v_mfma_f32_32x32x16_bf16 v[0:15],v[208:211],a[52:55],v[0:15]
ds_read_b64_tr_b16 v[204:205],v225 offset:28160
ds_read_b64_tr_b16 v[206:207],v225 offset:28416
s_waitcnt lgkmcnt(12)
v_mfma_f32_32x32x16_bf16 v[16:31],v[212:215],a[52:55],v[16:31]
s_add_u32 m0, s58, 51200
s_add_u32 s57, s59, 614400
buffer_load_dwordx4 v230,s[20:23],s57 offen lds
ds_read_b64_tr_b16 v[208:209],v225 offset:38912
ds_read_b64_tr_b16 v[210:211],v225 offset:39168
s_waitcnt lgkmcnt(12)
v_mfma_f32_32x32x16_bf16 v[32:47],v[216:219],a[52:55],v[32:47]
ds_read_b64_tr_b16 v[212:213],v225 offset:39424
ds_read_b64_tr_b16 v[214:215],v225 offset:39680
s_waitcnt lgkmcnt(12)
v_mfma_f32_32x32x16_bf16 v[48:63],v[220:223],a[52:55],v[48:63]
s_add_u32 m0, s58, 52224
s_add_u32 s57, s59, 614528
buffer_load_dwordx4 v230,s[20:23],s57 offen lds
ds_read_b64_tr_b16 v[216:217],v225 offset:39936
ds_read_b64_tr_b16 v[218:219],v225 offset:40192
s_waitcnt lgkmcnt(12)
v_mfma_f32_32x32x16_bf16 v[0:15],v[192:195],a[56:59],v[0:15]
ds_read_b64_tr_b16 v[220:221],v225 offset:40448
ds_read_b64_tr_b16 v[222:223],v225 offset:40704
s_waitcnt lgkmcnt(12)
v_mfma_f32_32x32x16_bf16 v[16:31],v[196:199],a[56:59],v[16:31]
s_waitcnt vmcnt(12)
s_barrier
ds_read_b64_tr_b16 v[192:193],v226 offset:0
ds_read_b64_tr_b16 v[194:195],v226 offset:256
s_waitcnt lgkmcnt(12)
v_mfma_f32_32x32x16_bf16 v[32:47],v[200:203],a[56:59],v[32:47]
ds_read_b64_tr_b16 v[196:197],v226 offset:512
ds_read_b64_tr_b16 v[198:199],v226 offset:768
s_waitcnt lgkmcnt(12)
v_mfma_f32_32x32x16_bf16 v[48:63],v[204:207],a[56:59],v[48:63]
ds_read_b64_tr_b16 v[200:201],v226 offset:1024
ds_read_b64_tr_b16 v[202:203],v226 offset:1280
s_waitcnt lgkmcnt(12)
v_mfma_f32_32x32x16_bf16 v[0:15],v[208:211],a[60:63],v[0:15]
ds_read_b64_tr_b16 v[204:205],v226 offset:1536
ds_read_b64_tr_b16 v[206:207],v226 offset:1792
s_waitcnt lgkmcnt(12)
v_mfma_f32_32x32x16_bf16 v[16:31],v[212:215],a[60:63],v[16:31]
ds_read_b64_tr_b16 v[208:209],v226 offset:12288
ds_read_b64_tr_b16 v[210:211],v226 offset:12544
s_waitcnt lgkmcnt(12)
v_mfma_f32_32x32x16_bf16 v[32:47],v[216:219],a[60:63],v[32:47]
ds_read_b64_tr_b16 v[212:213],v226 offset:12800
ds_read_b64_tr_b16 v[214:215],v226 offset:13056
s_waitcnt lgkmcnt(12)
v_mfma_f32_32x32x16_bf16 v[48:63],v[220:223],a[60:63],v[48:63]
ds_read_b64_tr_b16 v[216:217],v226 offset:13312
ds_read_b64_tr_b16 v[218:219],v226 offset:13568
s_waitcnt lgkmcnt(12)
v_mfma_f32_32x32x16_bf16 v[0:15],v[192:195],a[64:67],v[0:15]
ds_read_b64_tr_b16 v[220:221],v226 offset:13824
ds_read_b64_tr_b16 v[222:223],v226 offset:14080
s_waitcnt lgkmcnt(12)
v_mfma_f32_32x32x16_bf16 v[16:31],v[196:199],a[64:67],v[16:31]
s_add_u32 m0, s58, 73728
s_add_u32 s57, s59, 655360
buffer_load_dwordx4 v230,s[20:23],s57 offen lds
ds_read_b64_tr_b16 v[192:193],v226 offset:2048
ds_read_b64_tr_b16 v[194:195],v226 offset:2304
s_waitcnt lgkmcnt(12)
v_mfma_f32_32x32x16_bf16 v[32:47],v[200:203],a[64:67],v[32:47]
ds_read_b64_tr_b16 v[196:197],v226 offset:2560
ds_read_b64_tr_b16 v[198:199],v226 offset:2816
s_waitcnt lgkmcnt(12)
v_mfma_f32_32x32x16_bf16 v[48:63],v[204:207],a[64:67],v[48:63]
s_add_u32 m0, s58, 74752
s_add_u32 s57, s59, 655488
buffer_load_dwordx4 v230,s[20:23],s57 offen lds
ds_read_b64_tr_b16 v[200:201],v226 offset:3072
ds_read_b64_tr_b16 v[202:203],v226 offset:3328
s_waitcnt lgkmcnt(12)
v_mfma_f32_32x32x16_bf16 v[0:15],v[208:211],a[68:71],v[0:15]
ds_read_b64_tr_b16 v[204:205],v226 offset:3584
ds_read_b64_tr_b16 v[206:207],v226 offset:3840
s_waitcnt lgkmcnt(12)
v_mfma_f32_32x32x16_bf16 v[16:31],v[212:215],a[68:71],v[16:31]
s_add_u32 m0, s58, 75776
s_add_u32 s57, s59, 696320
buffer_load_dwordx4 v230,s[20:23],s57 offen lds
ds_read_b64_tr_b16 v[208:209],v226 offset:14336
ds_read_b64_tr_b16 v[210:211],v226 offset:14592
s_waitcnt lgkmcnt(12)
v_mfma_f32_32x32x16_bf16 v[32:47],v[216:219],a[68:71],v[32:47]
ds_read_b64_tr_b16 v[212:213],v226 offset:14848
ds_read_b64_tr_b16 v[214:215],v226 offset:15104
s_waitcnt lgkmcnt(12)
v_mfma_f32_32x32x16_bf16 v[48:63],v[220:223],a[68:71],v[48:63]
s_add_u32 m0, s58, 76800
s_add_u32 s57, s59, 696448
buffer_load_dwordx4 v230,s[20:23],s57 offen lds
ds_read_b64_tr_b16 v[216:217],v226 offset:15360
ds_read_b64_tr_b16 v[218:219],v226 offset:15616
s_waitcnt lgkmcnt(12)
v_mfma_f32_32x32x16_bf16 v[0:15],v[192:195],a[72:75],v[0:15]
ds_read_b64_tr_b16 v[220:221],v226 offset:15872
ds_read_b64_tr_b16 v[222:223],v226 offset:16128
s_waitcnt lgkmcnt(12)
v_mfma_f32_32x32x16_bf16 v[16:31],v[196:199],a[72:75],v[16:31]
s_waitcnt vmcnt(12)
s_barrier
ds_read_b64_tr_b16 v[192:193],v224 offset:0
ds_read_b64_tr_b16 v[194:195],v224 offset:256
s_waitcnt lgkmcnt(12)
v_mfma_f32_32x32x16_bf16 v[32:47],v[200:203],a[72:75],v[32:47]
ds_read_b64_tr_b16 v[196:197],v224 offset:512
ds_read_b64_tr_b16 v[198:199],v224 offset:768
s_waitcnt lgkmcnt(12)
v_mfma_f32_32x32x16_bf16 v[48:63],v[204:207],a[72:75],v[48:63]
ds_read_b64_tr_b16 v[200:201],v224 offset:1024
ds_read_b64_tr_b16 v[202:203],v224 offset:1280
s_waitcnt lgkmcnt(12)
v_mfma_f32_32x32x16_bf16 v[0:15],v[208:211],a[76:79],v[0:15]
ds_read_b64_tr_b16 v[204:205],v224 offset:1536
ds_read_b64_tr_b16 v[206:207],v224 offset:1792
s_waitcnt lgkmcnt(12)
v_mfma_f32_32x32x16_bf16 v[16:31],v[212:215],a[76:79],v[16:31]
ds_read_b64_tr_b16 v[208:209],v224 offset:12288
ds_read_b64_tr_b16 v[210:211],v224 offset:12544
s_waitcnt lgkmcnt(12)
v_mfma_f32_32x32x16_bf16 v[32:47],v[216:219],a[76:79],v[32:47]
ds_read_b64_tr_b16 v[212:213],v224 offset:12800
ds_read_b64_tr_b16 v[214:215],v224 offset:13056
s_waitcnt lgkmcnt(12)
v_mfma_f32_32x32x16_bf16 v[48:63],v[220:223],a[76:79],v[48:63]
ds_read_b64_tr_b16 v[216:217],v224 offset:13312
ds_read_b64_tr_b16 v[218:219],v224 offset:13568
s_waitcnt lgkmcnt(12)
v_mfma_f32_32x32x16_bf16 v[0:15],v[192:195],a[80:83],v[0:15]
ds_read_b64_tr_b16 v[220:221],v224 offset:13824
ds_read_b64_tr_b16 v[222:223],v224 offset:14080
s_waitcnt lgkmcnt(12)
v_mfma_f32_32x32x16_bf16 v[16:31],v[196:199],a[80:83],v[16:31]
s_add_u32 m0, s58, 98304
s_add_u32 s57, s59, 737280
buffer_load_dwordx4 v230,s[20:23],s57 offen lds
ds_read_b64_tr_b16 v[192:193],v224 offset:2048
ds_read_b64_tr_b16 v[194:195],v224 offset:2304
s_waitcnt lgkmcnt(12)
v_mfma_f32_32x32x16_bf16 v[32:47],v[200:203],a[80:83],v[32:47]
ds_read_b64_tr_b16 v[196:197],v224 offset:2560
ds_read_b64_tr_b16 v[198:199],v224 offset:2816
s_waitcnt lgkmcnt(12)
v_mfma_f32_32x32x16_bf16 v[48:63],v[204:207],a[80:83],v[48:63]
s_add_u32 m0, s58, 99328
s_add_u32 s57, s59, 737408
buffer_load_dwordx4 v230,s[20:23],s57 offen lds
ds_read_b64_tr_b16 v[200:201],v224 offset:3072
ds_read_b64_tr_b16 v[202:203],v224 offset:3328
s_waitcnt lgkmcnt(12)
v_mfma_f32_32x32x16_bf16 v[0:15],v[208:211],a[84:87],v[0:15]
ds_read_b64_tr_b16 v[204:205],v224 offset:3584
ds_read_b64_tr_b16 v[206:207],v224 offset:3840
s_waitcnt lgkmcnt(12)
v_mfma_f32_32x32x16_bf16 v[16:31],v[212:215],a[84:87],v[16:31]
s_add_u32 m0, s58, 100352
s_add_u32 s57, s59, 778240
buffer_load_dwordx4 v230,s[20:23],s57 offen lds
ds_read_b64_tr_b16 v[208:209],v224 offset:14336
ds_read_b64_tr_b16 v[210:211],v224 offset:14592
s_waitcnt lgkmcnt(12)
v_mfma_f32_32x32x16_bf16 v[32:47],v[216:219],a[84:87],v[32:47]
ds_read_b64_tr_b16 v[212:213],v224 offset:14848
ds_read_b64_tr_b16 v[214:215],v224 offset:15104
s_waitcnt lgkmcnt(12)
v_mfma_f32_32x32x16_bf16 v[48:63],v[220:223],a[84:87],v[48:63]
s_add_u32 m0, s58, 101376
s_add_u32 s57, s59, 778368
buffer_load_dwordx4 v230,s[20:23],s57 offen lds
ds_read_b64_tr_b16 v[216:217],v224 offset:15360
ds_read_b64_tr_b16 v[218:219],v224 offset:15616
s_waitcnt lgkmcnt(12)
v_mfma_f32_32x32x16_bf16 v[0:15],v[192:195],a[88:91],v[0:15]
ds_read_b64_tr_b16 v[220:221],v224 offset:15872
ds_read_b64_tr_b16 v[222:223],v224 offset:16128
s_waitcnt lgkmcnt(12)
v_mfma_f32_32x32x16_bf16 v[16:31],v[196:199],a[88:91],v[16:31]
s_waitcnt vmcnt(12)
s_barrier
ds_read_b64_tr_b16 v[192:193],v224 offset:24576
ds_read_b64_tr_b16 v[194:195],v224 offset:24832
s_waitcnt lgkmcnt(12)
v_mfma_f32_32x32x16_bf16 v[32:47],v[200:203],a[88:91],v[32:47]
ds_read_b64_tr_b16 v[196:197],v224 offset:25088
ds_read_b64_tr_b16 v[198:199],v224 offset:25344
s_waitcnt lgkmcnt(12)
v_mfma_f32_32x32x16_bf16 v[48:63],v[204:207],a[88:91],v[48:63]
ds_read_b64_tr_b16 v[200:201],v224 offset:25600
ds_read_b64_tr_b16 v[202:203],v224 offset:25856
s_waitcnt lgkmcnt(12)
v_mfma_f32_32x32x16_bf16 v[0:15],v[208:211],a[92:95],v[0:15]
ds_read_b64_tr_b16 v[204:205],v224 offset:26112
ds_read_b64_tr_b16 v[206:207],v224 offset:26368
s_waitcnt lgkmcnt(12)
v_mfma_f32_32x32x16_bf16 v[16:31],v[212:215],a[92:95],v[16:31]
ds_read_b64_tr_b16 v[208:209],v224 offset:36864
ds_read_b64_tr_b16 v[210:211],v224 offset:37120
s_waitcnt lgkmcnt(12)
v_mfma_f32_32x32x16_bf16 v[32:47],v[216:219],a[92:95],v[32:47]
ds_read_b64_tr_b16 v[212:213],v224 offset:37376
ds_read_b64_tr_b16 v[214:215],v224 offset:37632
s_waitcnt lgkmcnt(12)
v_mfma_f32_32x32x16_bf16 v[48:63],v[220:223],a[92:95],v[48:63]
ds_read_b64_tr_b16 v[216:217],v224 offset:37888
ds_read_b64_tr_b16 v[218:219],v224 offset:38144
s_waitcnt lgkmcnt(12)
v_mfma_f32_32x32x16_bf16 v[0:15],v[192:195],a[96:99],v[0:15]
ds_read_b64_tr_b16 v[220:221],v224 offset:38400
ds_read_b64_tr_b16 v[222:223],v224 offset:38656
s_waitcnt lgkmcnt(12)
v_mfma_f32_32x32x16_bf16 v[16:31],v[196:199],a[96:99],v[16:31]
ds_read_b64_tr_b16 v[192:193],v224 offset:26624
ds_read_b64_tr_b16 v[194:195],v224 offset:26880
s_waitcnt lgkmcnt(12)
v_mfma_f32_32x32x16_bf16 v[32:47],v[200:203],a[96:99],v[32:47]
ds_read_b64_tr_b16 v[196:197],v224 offset:27136
ds_read_b64_tr_b16 v[198:199],v224 offset:27392
s_waitcnt lgkmcnt(12)
v_mfma_f32_32x32x16_bf16 v[48:63],v[204:207],a[96:99],v[48:63]
ds_read_b64_tr_b16 v[200:201],v224 offset:27648
ds_read_b64_tr_b16 v[202:203],v224 offset:27904
s_waitcnt lgkmcnt(12)
v_mfma_f32_32x32x16_bf16 v[0:15],v[208:211],a[100:103],v[0:15]
ds_read_b64_tr_b16 v[204:205],v224 offset:28160
ds_read_b64_tr_b16 v[206:207],v224 offset:28416
s_waitcnt lgkmcnt(12)
v_mfma_f32_32x32x16_bf16 v[16:31],v[212:215],a[100:103],v[16:31]
ds_read_b64_tr_b16 v[208:209],v224 offset:38912
ds_read_b64_tr_b16 v[210:211],v224 offset:39168
s_waitcnt lgkmcnt(12)
v_mfma_f32_32x32x16_bf16 v[32:47],v[216:219],a[100:103],v[32:47]
ds_read_b64_tr_b16 v[212:213],v224 offset:39424
ds_read_b64_tr_b16 v[214:215],v224 offset:39680
s_waitcnt lgkmcnt(12)
v_mfma_f32_32x32x16_bf16 v[48:63],v[220:223],a[100:103],v[48:63]
ds_read_b64_tr_b16 v[216:217],v224 offset:39936
ds_read_b64_tr_b16 v[218:219],v224 offset:40192
s_waitcnt lgkmcnt(12)
v_mfma_f32_32x32x16_bf16 v[0:15],v[192:195],a[104:107],v[0:15]
ds_read_b64_tr_b16 v[220:221],v224 offset:40448
ds_read_b64_tr_b16 v[222:223],v224 offset:40704
s_waitcnt lgkmcnt(12)
v_mfma_f32_32x32x16_bf16 v[16:31],v[196:199],a[104:107],v[16:31]
s_waitcnt vmcnt(8)
s_barrier
ds_read_b64_tr_b16 v[192:193],v225 offset:0
ds_read_b64_tr_b16 v[194:195],v225 offset:256
s_waitcnt lgkmcnt(12)
v_mfma_f32_32x32x16_bf16 v[32:47],v[200:203],a[104:107],v[32:47]
ds_read_b64_tr_b16 v[196:197],v225 offset:512
ds_read_b64_tr_b16 v[198:199],v225 offset:768
s_waitcnt lgkmcnt(12)
v_mfma_f32_32x32x16_bf16 v[48:63],v[204:207],a[104:107],v[48:63]
ds_read_b64_tr_b16 v[200:201],v225 offset:1024
ds_read_b64_tr_b16 v[202:203],v225 offset:1280
s_waitcnt lgkmcnt(12)
v_mfma_f32_32x32x16_bf16 v[0:15],v[208:211],a[108:111],v[0:15]
ds_read_b64_tr_b16 v[204:205],v225 offset:1536
ds_read_b64_tr_b16 v[206:207],v225 offset:1792
s_waitcnt lgkmcnt(12)
v_mfma_f32_32x32x16_bf16 v[16:31],v[212:215],a[108:111],v[16:31]
ds_read_b64_tr_b16 v[208:209],v225 offset:12288
ds_read_b64_tr_b16 v[210:211],v225 offset:12544
s_waitcnt lgkmcnt(12)
v_mfma_f32_32x32x16_bf16 v[32:47],v[216:219],a[108:111],v[32:47]
ds_read_b64_tr_b16 v[212:213],v225 offset:12800
ds_read_b64_tr_b16 v[214:215],v225 offset:13056
s_waitcnt lgkmcnt(12)
v_mfma_f32_32x32x16_bf16 v[48:63],v[220:223],a[108:111],v[48:63]
ds_read_b64_tr_b16 v[216:217],v225 offset:13312
ds_read_b64_tr_b16 v[218:219],v225 offset:13568
s_waitcnt lgkmcnt(12)
v_mfma_f32_32x32x16_bf16 v[0:15],v[192:195],a[112:115],v[0:15]
ds_read_b64_tr_b16 v[220:221],v225 offset:13824
ds_read_b64_tr_b16 v[222:223],v225 offset:14080
s_waitcnt lgkmcnt(12)
v_mfma_f32_32x32x16_bf16 v[16:31],v[196:199],a[112:115],v[16:31]
ds_read_b64_tr_b16 v[192:193],v225 offset:2048
ds_read_b64_tr_b16 v[194:195],v225 offset:2304
s_waitcnt lgkmcnt(12)
v_mfma_f32_32x32x16_bf16 v[32:47],v[200:203],a[112:115],v[32:47]
ds_read_b64_tr_b16 v[196:197],v225 offset:2560
ds_read_b64_tr_b16 v[198:199],v225 offset:2816
s_waitcnt lgkmcnt(12)
v_mfma_f32_32x32x16_bf16 v[48:63],v[204:207],a[112:115],v[48:63]
ds_read_b64_tr_b16 v[200:201],v225 offset:3072
ds_read_b64_tr_b16 v[202:203],v225 offset:3328
s_waitcnt lgkmcnt(12)
v_mfma_f32_32x32x16_bf16 v[0:15],v[208:211],a[116:119],v[0:15]
ds_read_b64_tr_b16 v[204:205],v225 offset:3584
ds_read_b64_tr_b16 v[206:207],v225 offset:3840
s_waitcnt lgkmcnt(12)
v_mfma_f32_32x32x16_bf16 v[16:31],v[212:215],a[116:119],v[16:31]
ds_read_b64_tr_b16 v[208:209],v225 offset:14336
ds_read_b64_tr_b16 v[210:211],v225 offset:14592
s_waitcnt lgkmcnt(12)
v_mfma_f32_32x32x16_bf16 v[32:47],v[216:219],a[116:119],v[32:47]
ds_read_b64_tr_b16 v[212:213],v225 offset:14848
ds_read_b64_tr_b16 v[214:215],v225 offset:15104
s_waitcnt lgkmcnt(12)
v_mfma_f32_32x32x16_bf16 v[48:63],v[220:223],a[116:119],v[48:63]
ds_read_b64_tr_b16 v[216:217],v225 offset:15360
ds_read_b64_tr_b16 v[218:219],v225 offset:15616
s_waitcnt lgkmcnt(12)
v_mfma_f32_32x32x16_bf16 v[0:15],v[192:195],a[120:123],v[0:15]
ds_read_b64_tr_b16 v[220:221],v225 offset:15872
ds_read_b64_tr_b16 v[222:223],v225 offset:16128
s_waitcnt lgkmcnt(12)
v_mfma_f32_32x32x16_bf16 v[16:31],v[196:199],a[120:123],v[16:31]
s_waitcnt vmcnt(4)
s_barrier
ds_read_b64_tr_b16 v[192:193],v225 offset:24576
ds_read_b64_tr_b16 v[194:195],v225 offset:24832
s_waitcnt lgkmcnt(12)
v_mfma_f32_32x32x16_bf16 v[32:47],v[200:203],a[120:123],v[32:47]
ds_read_b64_tr_b16 v[196:197],v225 offset:25088
ds_read_b64_tr_b16 v[198:199],v225 offset:25344
s_waitcnt lgkmcnt(12)
v_mfma_f32_32x32x16_bf16 v[48:63],v[204:207],a[120:123],v[48:63]
ds_read_b64_tr_b16 v[200:201],v225 offset:25600
ds_read_b64_tr_b16 v[202:203],v225 offset:25856
s_waitcnt lgkmcnt(12)
v_mfma_f32_32x32x16_bf16 v[0:15],v[208:211],a[124:127],v[0:15]
ds_read_b64_tr_b16 v[204:205],v225 offset:26112
ds_read_b64_tr_b16 v[206:207],v225 offset:26368
s_waitcnt lgkmcnt(12)
v_mfma_f32_32x32x16_bf16 v[16:31],v[212:215],a[124:127],v[16:31]
ds_read_b64_tr_b16 v[208:209],v225 offset:36864
ds_read_b64_tr_b16 v[210:211],v225 offset:37120
s_waitcnt lgkmcnt(12)
v_mfma_f32_32x32x16_bf16 v[32:47],v[216:219],a[124:127],v[32:47]
ds_read_b64_tr_b16 v[212:213],v225 offset:37376
ds_read_b64_tr_b16 v[214:215],v225 offset:37632
s_waitcnt lgkmcnt(12)
v_mfma_f32_32x32x16_bf16 v[48:63],v[220:223],a[124:127],v[48:63]
ds_read_b64_tr_b16 v[216:217],v225 offset:37888
ds_read_b64_tr_b16 v[218:219],v225 offset:38144
s_waitcnt lgkmcnt(12)
v_mfma_f32_32x32x16_bf16 v[0:15],v[192:195],a[128:131],v[0:15]
ds_read_b64_tr_b16 v[220:221],v225 offset:38400
ds_read_b64_tr_b16 v[222:223],v225 offset:38656
s_waitcnt lgkmcnt(12)
v_mfma_f32_32x32x16_bf16 v[16:31],v[196:199],a[128:131],v[16:31]
ds_read_b64_tr_b16 v[192:193],v225 offset:26624
ds_read_b64_tr_b16 v[194:195],v225 offset:26880
s_waitcnt lgkmcnt(12)
v_mfma_f32_32x32x16_bf16 v[32:47],v[200:203],a[128:131],v[32:47]
ds_read_b64_tr_b16 v[196:197],v225 offset:27136
ds_read_b64_tr_b16 v[198:199],v225 offset:27392
s_waitcnt lgkmcnt(12)
v_mfma_f32_32x32x16_bf16 v[48:63],v[204:207],a[128:131],v[48:63]
ds_read_b64_tr_b16 v[200:201],v225 offset:27648
ds_read_b64_tr_b16 v[202:203],v225 offset:27904
s_waitcnt lgkmcnt(12)
v_mfma_f32_32x32x16_bf16 v[0:15],v[208:211],a[132:135],v[0:15]
ds_read_b64_tr_b16 v[204:205],v225 offset:28160
ds_read_b64_tr_b16 v[206:207],v225 offset:28416
s_waitcnt lgkmcnt(12)
v_mfma_f32_32x32x16_bf16 v[16:31],v[212:215],a[132:135],v[16:31]
ds_read_b64_tr_b16 v[208:209],v225 offset:38912
ds_read_b64_tr_b16 v[210:211],v225 offset:39168
s_waitcnt lgkmcnt(12)
v_mfma_f32_32x32x16_bf16 v[32:47],v[216:219],a[132:135],v[32:47]
ds_read_b64_tr_b16 v[212:213],v225 offset:39424
ds_read_b64_tr_b16 v[214:215],v225 offset:39680
s_waitcnt lgkmcnt(12)
v_mfma_f32_32x32x16_bf16 v[48:63],v[220:223],a[132:135],v[48:63]
ds_read_b64_tr_b16 v[216:217],v225 offset:39936
ds_read_b64_tr_b16 v[218:219],v225 offset:40192
s_waitcnt lgkmcnt(12)
v_mfma_f32_32x32x16_bf16 v[0:15],v[192:195],a[136:139],v[0:15]
ds_read_b64_tr_b16 v[220:221],v225 offset:40448
ds_read_b64_tr_b16 v[222:223],v225 offset:40704
s_waitcnt lgkmcnt(12)
v_mfma_f32_32x32x16_bf16 v[16:31],v[196:199],a[136:139],v[16:31]
s_waitcnt vmcnt(0)
s_barrier
ds_read_b64_tr_b16 v[192:193],v226 offset:0
ds_read_b64_tr_b16 v[194:195],v226 offset:256
s_waitcnt lgkmcnt(12)
v_mfma_f32_32x32x16_bf16 v[32:47],v[200:203],a[136:139],v[32:47]
ds_read_b64_tr_b16 v[196:197],v226 offset:512
ds_read_b64_tr_b16 v[198:199],v226 offset:768
s_waitcnt lgkmcnt(12)
v_mfma_f32_32x32x16_bf16 v[48:63],v[204:207],a[136:139],v[48:63]
ds_read_b64_tr_b16 v[200:201],v226 offset:1024
ds_read_b64_tr_b16 v[202:203],v226 offset:1280
s_waitcnt lgkmcnt(12)
v_mfma_f32_32x32x16_bf16 v[0:15],v[208:211],a[140:143],v[0:15]
ds_read_b64_tr_b16 v[204:205],v226 offset:1536
ds_read_b64_tr_b16 v[206:207],v226 offset:1792
s_waitcnt lgkmcnt(12)
v_mfma_f32_32x32x16_bf16 v[16:31],v[212:215],a[140:143],v[16:31]
ds_read_b64_tr_b16 v[208:209],v226 offset:12288
ds_read_b64_tr_b16 v[210:211],v226 offset:12544
s_waitcnt lgkmcnt(12)
v_mfma_f32_32x32x16_bf16 v[32:47],v[216:219],a[140:143],v[32:47]
ds_read_b64_tr_b16 v[212:213],v226 offset:12800
ds_read_b64_tr_b16 v[214:215],v226 offset:13056
s_waitcnt lgkmcnt(12)
v_mfma_f32_32x32x16_bf16 v[48:63],v[220:223],a[140:143],v[48:63]
ds_read_b64_tr_b16 v[216:217],v226 offset:13312
ds_read_b64_tr_b16 v[218:219],v226 offset:13568
s_waitcnt lgkmcnt(12)
v_mfma_f32_32x32x16_bf16 v[0:15],v[192:195],a[144:147],v[0:15]
ds_read_b64_tr_b16 v[220:221],v226 offset:13824
ds_read_b64_tr_b16 v[222:223],v226 offset:14080
s_waitcnt lgkmcnt(12)
v_mfma_f32_32x32x16_bf16 v[16:31],v[196:199],a[144:147],v[16:31]
ds_read_b64_tr_b16 v[192:193],v226 offset:2048
ds_read_b64_tr_b16 v[194:195],v226 offset:2304
s_waitcnt lgkmcnt(12)
v_mfma_f32_32x32x16_bf16 v[32:47],v[200:203],a[144:147],v[32:47]
ds_read_b64_tr_b16 v[196:197],v226 offset:2560
ds_read_b64_tr_b16 v[198:199],v226 offset:2816
s_waitcnt lgkmcnt(12)
v_mfma_f32_32x32x16_bf16 v[48:63],v[204:207],a[144:147],v[48:63]
ds_read_b64_tr_b16 v[200:201],v226 offset:3072
ds_read_b64_tr_b16 v[202:203],v226 offset:3328
s_waitcnt lgkmcnt(12)
v_mfma_f32_32x32x16_bf16 v[0:15],v[208:211],a[148:151],v[0:15]
ds_read_b64_tr_b16 v[204:205],v226 offset:3584
ds_read_b64_tr_b16 v[206:207],v226 offset:3840
s_waitcnt lgkmcnt(12)
v_mfma_f32_32x32x16_bf16 v[16:31],v[212:215],a[148:151],v[16:31]
ds_read_b64_tr_b16 v[208:209],v226 offset:14336
ds_read_b64_tr_b16 v[210:211],v226 offset:14592
s_waitcnt lgkmcnt(12)
v_mfma_f32_32x32x16_bf16 v[32:47],v[216:219],a[148:151],v[32:47]
ds_read_b64_tr_b16 v[212:213],v226 offset:14848
ds_read_b64_tr_b16 v[214:215],v226 offset:15104
s_waitcnt lgkmcnt(12)
v_mfma_f32_32x32x16_bf16 v[48:63],v[220:223],a[148:151],v[48:63]
ds_read_b64_tr_b16 v[216:217],v226 offset:15360
ds_read_b64_tr_b16 v[218:219],v226 offset:15616
s_waitcnt lgkmcnt(12)
v_mfma_f32_32x32x16_bf16 v[0:15],v[192:195],a[152:155],v[0:15]
ds_read_b64_tr_b16 v[220:221],v226 offset:15872
ds_read_b64_tr_b16 v[222:223],v226 offset:16128
s_waitcnt lgkmcnt(12)
v_mfma_f32_32x32x16_bf16 v[16:31],v[196:199],a[152:155],v[16:31]
s_waitcnt lgkmcnt(10)
v_mfma_f32_32x32x16_bf16 v[32:47],v[200:203],a[152:155],v[32:47]
s_waitcnt lgkmcnt(8)
v_mfma_f32_32x32x16_bf16 v[48:63],v[204:207],a[152:155],v[48:63]
s_waitcnt lgkmcnt(6)
v_mfma_f32_32x32x16_bf16 v[0:15],v[208:211],a[156:159],v[0:15]
s_waitcnt lgkmcnt(4)
v_mfma_f32_32x32x16_bf16 v[16:31],v[212:215],a[156:159],v[16:31]
s_waitcnt lgkmcnt(2)
v_mfma_f32_32x32x16_bf16 v[32:47],v[216:219],a[156:159],v[32:47]
s_waitcnt lgkmcnt(0)
v_mfma_f32_32x32x16_bf16 v[48:63],v[220:223],a[156:159],v[48:63]
v_and_b32 v245, 31, v255
v_mul_u32_u24 v245, 1280, v245
v_lshrrev_b32 v254, 5, v255
v_and_b32 v254, 1, v254
v_mul_u32_u24 v254, 8, v254
v_add_u32 v245, v254, v245
s_mul_i32 s61, s66, 40960
s_add_u32 s61, s61, s59
s_nop 5
v_cvt_pk_bf16_f32 v0, v0, v1
v_cvt_pk_bf16_f32 v1, v2, v3
v_cvt_pk_bf16_f32 v2, v4, v5
v_cvt_pk_bf16_f32 v3, v6, v7
v_cvt_pk_bf16_f32 v4, v8, v9
v_cvt_pk_bf16_f32 v5, v10, v11
v_cvt_pk_bf16_f32 v6, v12, v13
v_cvt_pk_bf16_f32 v7, v14, v15
v_cvt_pk_bf16_f32 v8, v16, v17
v_cvt_pk_bf16_f32 v9, v18, v19
v_cvt_pk_bf16_f32 v10, v20, v21
v_cvt_pk_bf16_f32 v11, v22, v23
v_cvt_pk_bf16_f32 v12, v24, v25
v_cvt_pk_bf16_f32 v13, v26, v27
v_cvt_pk_bf16_f32 v14, v28, v29
v_cvt_pk_bf16_f32 v15, v30, v31
v_cvt_pk_bf16_f32 v16, v32, v33
v_cvt_pk_bf16_f32 v17, v34, v35
v_cvt_pk_bf16_f32 v18, v36, v37
v_cvt_pk_bf16_f32 v19, v38, v39
v_cvt_pk_bf16_f32 v20, v40, v41
v_cvt_pk_bf16_f32 v21, v42, v43
v_cvt_pk_bf16_f32 v22, v44, v45
v_cvt_pk_bf16_f32 v23, v46, v47
v_cvt_pk_bf16_f32 v24, v48, v49
v_cvt_pk_bf16_f32 v25, v50, v51
v_cvt_pk_bf16_f32 v26, v52, v53
v_cvt_pk_bf16_f32 v27, v54, v55
v_cvt_pk_bf16_f32 v28, v56, v57
v_cvt_pk_bf16_f32 v29, v58, v59
v_cvt_pk_bf16_f32 v30, v60, v61
v_cvt_pk_bf16_f32 v31, v62, v63
v_lshlrev_b32 v240, 16, v0
v_and_b32 v241, 0xffff0000, v0
v_mul_f32 v240, v244, v240
v_mul_f32 v241, v244, v241
v_cvt_pk_bf16_f32 v0, v240, v241
v_lshlrev_b32 v240, 16, v1
v_and_b32 v241, 0xffff0000, v1
v_mul_f32 v240, v244, v240
v_mul_f32 v241, v244, v241
v_cvt_pk_bf16_f32 v1, v240, v241
v_lshlrev_b32 v240, 16, v2
v_and_b32 v241, 0xffff0000, v2
v_mul_f32 v240, v244, v240
v_mul_f32 v241, v244, v241
v_cvt_pk_bf16_f32 v2, v240, v241
v_lshlrev_b32 v240, 16, v3
v_and_b32 v241, 0xffff0000, v3
v_mul_f32 v240, v244, v240
v_mul_f32 v241, v244, v241
v_cvt_pk_bf16_f32 v3, v240, v241
v_lshlrev_b32 v240, 16, v4
v_and_b32 v241, 0xffff0000, v4
v_mul_f32 v240, v244, v240
v_mul_f32 v241, v244, v241
v_cvt_pk_bf16_f32 v4, v240, v241
v_lshlrev_b32 v240, 16, v5
v_and_b32 v241, 0xffff0000, v5
v_mul_f32 v240, v244, v240
v_mul_f32 v241, v244, v241
v_cvt_pk_bf16_f32 v5, v240, v241
v_lshlrev_b32 v240, 16, v6
v_and_b32 v241, 0xffff0000, v6
v_mul_f32 v240, v244, v240
v_mul_f32 v241, v244, v241
v_cvt_pk_bf16_f32 v6, v240, v241
v_lshlrev_b32 v240, 16, v7
v_and_b32 v241, 0xffff0000, v7
v_mul_f32 v240, v244, v240
v_mul_f32 v241, v244, v241
v_cvt_pk_bf16_f32 v7, v240, v241
v_lshlrev_b32 v240, 16, v8
v_and_b32 v241, 0xffff0000, v8
v_mul_f32 v240, v244, v240
v_mul_f32 v241, v244, v241
v_cvt_pk_bf16_f32 v8, v240, v241
v_lshlrev_b32 v240, 16, v9
v_and_b32 v241, 0xffff0000, v9
v_mul_f32 v240, v244, v240
v_mul_f32 v241, v244, v241
v_cvt_pk_bf16_f32 v9, v240, v241
v_lshlrev_b32 v240, 16, v10
v_and_b32 v241, 0xffff0000, v10
v_mul_f32 v240, v244, v240
v_mul_f32 v241, v244, v241
v_cvt_pk_bf16_f32 v10, v240, v241
v_lshlrev_b32 v240, 16, v11
v_and_b32 v241, 0xffff0000, v11
v_mul_f32 v240, v244, v240
v_mul_f32 v241, v244, v241
v_cvt_pk_bf16_f32 v11, v240, v241
v_lshlrev_b32 v240, 16, v12
v_and_b32 v241, 0xffff0000, v12
v_mul_f32 v240, v244, v240
v_mul_f32 v241, v244, v241
v_cvt_pk_bf16_f32 v12, v240, v241
v_lshlrev_b32 v240, 16, v13
v_and_b32 v241, 0xffff0000, v13
v_mul_f32 v240, v244, v240
v_mul_f32 v241, v244, v241
v_cvt_pk_bf16_f32 v13, v240, v241
v_lshlrev_b32 v240, 16, v14
v_and_b32 v241, 0xffff0000, v14
v_mul_f32 v240, v244, v240
v_mul_f32 v241, v244, v241
v_cvt_pk_bf16_f32 v14, v240, v241
v_lshlrev_b32 v240, 16, v15
v_and_b32 v241, 0xffff0000, v15
v_mul_f32 v240, v244, v240
v_mul_f32 v241, v244, v241
v_cvt_pk_bf16_f32 v15, v240, v241
v_lshlrev_b32 v240, 16, v16
v_and_b32 v241, 0xffff0000, v16
v_mul_f32 v240, v244, v240
v_mul_f32 v241, v244, v241
v_cvt_pk_bf16_f32 v16, v240, v241
v_lshlrev_b32 v240, 16, v17
v_and_b32 v241, 0xffff0000, v17
v_mul_f32 v240, v244, v240
v_mul_f32 v241, v244, v241
v_cvt_pk_bf16_f32 v17, v240, v241
v_lshlrev_b32 v240, 16, v18
v_and_b32 v241, 0xffff0000, v18
v_mul_f32 v240, v244, v240
v_mul_f32 v241, v244, v241
v_cvt_pk_bf16_f32 v18, v240, v241
v_lshlrev_b32 v240, 16, v19
v_and_b32 v241, 0xffff0000, v19
v_mul_f32 v240, v244, v240
v_mul_f32 v241, v244, v241
v_cvt_pk_bf16_f32 v19, v240, v241
v_lshlrev_b32 v240, 16, v20
v_and_b32 v241, 0xffff0000, v20
v_mul_f32 v240, v244, v240
v_mul_f32 v241, v244, v241
v_cvt_pk_bf16_f32 v20, v240, v241
v_lshlrev_b32 v240, 16, v21
v_and_b32 v241, 0xffff0000, v21
v_mul_f32 v240, v244, v240
v_mul_f32 v241, v244, v241
v_cvt_pk_bf16_f32 v21, v240, v241
v_lshlrev_b32 v240, 16, v22
v_and_b32 v241, 0xffff0000, v22
v_mul_f32 v240, v244, v240
v_mul_f32 v241, v244, v241
v_cvt_pk_bf16_f32 v22, v240, v241
v_lshlrev_b32 v240, 16, v23
v_and_b32 v241, 0xffff0000, v23
v_mul_f32 v240, v244, v240
v_mul_f32 v241, v244, v241
v_cvt_pk_bf16_f32 v23, v240, v241
v_lshlrev_b32 v240, 16, v24
v_and_b32 v241, 0xffff0000, v24
v_mul_f32 v240, v244, v240
v_mul_f32 v241, v244, v241
v_cvt_pk_bf16_f32 v24, v240, v241
v_lshlrev_b32 v240, 16, v25
v_and_b32 v241, 0xffff0000, v25
v_mul_f32 v240, v244, v240
v_mul_f32 v241, v244, v241
v_cvt_pk_bf16_f32 v25, v240, v241
v_lshlrev_b32 v240, 16, v26
v_and_b32 v241, 0xffff0000, v26
v_mul_f32 v240, v244, v240
v_mul_f32 v241, v244, v241
v_cvt_pk_bf16_f32 v26, v240, v241
v_lshlrev_b32 v240, 16, v27
v_and_b32 v241, 0xffff0000, v27
v_mul_f32 v240, v244, v240
v_mul_f32 v241, v244, v241
v_cvt_pk_bf16_f32 v27, v240, v241
v_lshlrev_b32 v240, 16, v28
v_and_b32 v241, 0xffff0000, v28
v_mul_f32 v240, v244, v240
v_mul_f32 v241, v244, v241
v_cvt_pk_bf16_f32 v28, v240, v241
v_lshlrev_b32 v240, 16, v29
v_and_b32 v241, 0xffff0000, v29
v_mul_f32 v240, v244, v240
v_mul_f32 v241, v244, v241
v_cvt_pk_bf16_f32 v29, v240, v241
v_lshlrev_b32 v240, 16, v30
v_and_b32 v241, 0xffff0000, v30
v_mul_f32 v240, v244, v240
v_mul_f32 v241, v244, v241
v_cvt_pk_bf16_f32 v30, v240, v241
v_lshlrev_b32 v240, 16, v31
v_and_b32 v241, 0xffff0000, v31
v_mul_f32 v240, v244, v240
v_mul_f32 v241, v244, v241
v_cvt_pk_bf16_f32 v31, v240, v241
s_cmp_lt_u32 s63, 14
s_cbranch_scc1 AO_C
buffer_store_dwordx4 v[0:3],v233,s[8:11],s67 offen sc1
buffer_store_dwordx4 v[4:7],v233,s[8:11],s67 offen offset:1024 sc1
buffer_store_dwordx4 v[8:11],v233,s[8:11],s67 offen offset:2048 sc1
buffer_store_dwordx4 v[12:15],v233,s[8:11],s67 offen offset:3072 sc1
buffer_store_dwordx4 v[16:19],v233,s[8:11],s68 offen sc1
buffer_store_dwordx4 v[20:23],v233,s[8:11],s68 offen offset:1024 sc1
buffer_store_dwordx4 v[24:27],v233,s[8:11],s68 offen offset:2048 sc1
buffer_store_dwordx4 v[28:31],v233,s[8:11],s68 offen offset:3072 sc1
s_waitcnt vmcnt(0)
s_barrier
buffer_atomic_add v239,v238,s[8:11],s92 offen sc1
s_endpgm
AO_C:
v_mov_b32 v240, 0
s_branch FW21b
FW21:
s_sleep 4
FW21b:
buffer_load_dword v241,v240,s[8:11],s92 offen sc1
s_sub_u32 s71, s71, 1
s_cbranch_scc1 EX1
s_waitcnt vmcnt(0)
v_cmp_gt_u32 vcc, 4, v241
s_cbranch_vccnz FW21
buffer_load_dwordx4 v[64:67],v233,s[8:11],s67 offen sc1
buffer_load_dwordx4 v[68:71],v233,s[8:11],s67 offen offset:1024 sc1
buffer_load_dwordx4 v[72:75],v233,s[8:11],s67 offen offset:2048 sc1
buffer_load_dwordx4 v[76:79],v233,s[8:11],s67 offen offset:3072 sc1
buffer_load_dwordx4 v[80:83],v233,s[8:11],s68 offen sc1
buffer_load_dwordx4 v[84:87],v233,s[8:11],s68 offen offset:1024 sc1
buffer_load_dwordx4 v[88:91],v233,s[8:11],s68 offen offset:2048 sc1
buffer_load_dwordx4 v[92:95],v233,s[8:11],s68 offen offset:3072 sc1
s_waitcnt vmcnt(6)
v_lshlrev_b32 v240, 16, v0
v_and_b32 v241, 0xffff0000, v0
v_lshlrev_b32 v242, 16, v64
v_and_b32 v243, 0xffff0000, v64
v_add_f32 v240, v240, v242
v_add_f32 v241, v241, v243
v_cvt_pk_bf16_f32 v0, v240, v241
v_lshlrev_b32 v240, 16, v1
v_and_b32 v241, 0xffff0000, v1
v_lshlrev_b32 v242, 16, v65
v_and_b32 v243, 0xffff0000, v65
v_add_f32 v240, v240, v242
v_add_f32 v241, v241, v243
v_cvt_pk_bf16_f32 v1, v240, v241
v_lshlrev_b32 v240, 16, v2
v_and_b32 v241, 0xffff0000, v2
v_lshlrev_b32 v242, 16, v66
v_and_b32 v243, 0xffff0000, v66
v_add_f32 v240, v240, v242
v_add_f32 v241, v241, v243
v_cvt_pk_bf16_f32 v2, v240, v241
v_lshlrev_b32 v240, 16, v3
v_and_b32 v241, 0xffff0000, v3
v_lshlrev_b32 v242, 16, v67
v_and_b32 v243, 0xffff0000, v67
v_add_f32 v240, v240, v242
v_add_f32 v241, v241, v243
v_cvt_pk_bf16_f32 v3, v240, v241
v_lshlrev_b32 v240, 16, v4
v_and_b32 v241, 0xffff0000, v4
v_lshlrev_b32 v242, 16, v68
v_and_b32 v243, 0xffff0000, v68
v_add_f32 v240, v240, v242
v_add_f32 v241, v241, v243
v_cvt_pk_bf16_f32 v4, v240, v241
v_lshlrev_b32 v240, 16, v5
v_and_b32 v241, 0xffff0000, v5
v_lshlrev_b32 v242, 16, v69
v_and_b32 v243, 0xffff0000, v69
v_add_f32 v240, v240, v242
v_add_f32 v241, v241, v243
v_cvt_pk_bf16_f32 v5, v240, v241
v_lshlrev_b32 v240, 16, v6
v_and_b32 v241, 0xffff0000, v6
v_lshlrev_b32 v242, 16, v70
v_and_b32 v243, 0xffff0000, v70
v_add_f32 v240, v240, v242
v_add_f32 v241, v241, v243
v_cvt_pk_bf16_f32 v6, v240, v241
v_lshlrev_b32 v240, 16, v7
v_and_b32 v241, 0xffff0000, v7
v_lshlrev_b32 v242, 16, v71
v_and_b32 v243, 0xffff0000, v71
v_add_f32 v240, v240, v242
v_add_f32 v241, v241, v243
v_cvt_pk_bf16_f32 v7, v240, v241
buffer_store_dwordx2 v[0:1],v245,s[40:43],s61 offen
buffer_store_dwordx2 v[2:3],v245,s[40:43],s61 offen offset:16
buffer_store_dwordx2 v[4:5],v245,s[40:43],s61 offen offset:32
buffer_store_dwordx2 v[6:7],v245,s[40:43],s61 offen offset:48
s_waitcnt vmcnt(8)
v_lshlrev_b32 v240, 16, v8
v_and_b32 v241, 0xffff0000, v8
v_lshlrev_b32 v242, 16, v72
v_and_b32 v243, 0xffff0000, v72
v_add_f32 v240, v240, v242
v_add_f32 v241, v241, v243
v_cvt_pk_bf16_f32 v8, v240, v241
v_lshlrev_b32 v240, 16, v9
v_and_b32 v241, 0xffff0000, v9
v_lshlrev_b32 v242, 16, v73
v_and_b32 v243, 0xffff0000, v73
v_add_f32 v240, v240, v242
v_add_f32 v241, v241, v243
v_cvt_pk_bf16_f32 v9, v240, v241
v_lshlrev_b32 v240, 16, v10
v_and_b32 v241, 0xffff0000, v10
v_lshlrev_b32 v242, 16, v74
v_and_b32 v243, 0xffff0000, v74
v_add_f32 v240, v240, v242
v_add_f32 v241, v241, v243
v_cvt_pk_bf16_f32 v10, v240, v241
v_lshlrev_b32 v240, 16, v11
v_and_b32 v241, 0xffff0000, v11
v_lshlrev_b32 v242, 16, v75
v_and_b32 v243, 0xffff0000, v75
v_add_f32 v240, v240, v242
v_add_f32 v241, v241, v243
v_cvt_pk_bf16_f32 v11, v240, v241
v_lshlrev_b32 v240, 16, v12
v_and_b32 v241, 0xffff0000, v12
v_lshlrev_b32 v242, 16, v76
v_and_b32 v243, 0xffff0000, v76
v_add_f32 v240, v240, v242
v_add_f32 v241, v241, v243
v_cvt_pk_bf16_f32 v12, v240, v241
v_lshlrev_b32 v240, 16, v13
v_and_b32 v241, 0xffff0000, v13
v_lshlrev_b32 v242, 16, v77
v_and_b32 v243, 0xffff0000, v77
v_add_f32 v240, v240, v242
v_add_f32 v241, v241, v243
v_cvt_pk_bf16_f32 v13, v240, v241
v_lshlrev_b32 v240, 16, v14
v_and_b32 v241, 0xffff0000, v14
v_lshlrev_b32 v242, 16, v78
v_and_b32 v243, 0xffff0000, v78
v_add_f32 v240, v240, v242
v_add_f32 v241, v241, v243
v_cvt_pk_bf16_f32 v14, v240, v241
v_lshlrev_b32 v240, 16, v15
v_and_b32 v241, 0xffff0000, v15
v_lshlrev_b32 v242, 16, v79
v_and_b32 v243, 0xffff0000, v79
v_add_f32 v240, v240, v242
v_add_f32 v241, v241, v243
v_cvt_pk_bf16_f32 v15, v240, v241
buffer_store_dwordx2 v[8:9],v245,s[40:43],s61 offen offset:64
buffer_store_dwordx2 v[10:11],v245,s[40:43],s61 offen offset:80
buffer_store_dwordx2 v[12:13],v245,s[40:43],s61 offen offset:96
buffer_store_dwordx2 v[14:15],v245,s[40:43],s61 offen offset:112
s_waitcnt vmcnt(10)
v_lshlrev_b32 v240, 16, v16
v_and_b32 v241, 0xffff0000, v16
v_lshlrev_b32 v242, 16, v80
v_and_b32 v243, 0xffff0000, v80
v_add_f32 v240, v240, v242
v_add_f32 v241, v241, v243
v_cvt_pk_bf16_f32 v16, v240, v241
v_lshlrev_b32 v240, 16, v17
v_and_b32 v241, 0xffff0000, v17
v_lshlrev_b32 v242, 16, v81
v_and_b32 v243, 0xffff0000, v81
v_add_f32 v240, v240, v242
v_add_f32 v241, v241, v243
v_cvt_pk_bf16_f32 v17, v240, v241
v_lshlrev_b32 v240, 16, v18
v_and_b32 v241, 0xffff0000, v18
v_lshlrev_b32 v242, 16, v82
v_and_b32 v243, 0xffff0000, v82
v_add_f32 v240, v240, v242
v_add_f32 v241, v241, v243
v_cvt_pk_bf16_f32 v18, v240, v241
v_lshlrev_b32 v240, 16, v19
v_and_b32 v241, 0xffff0000, v19
v_lshlrev_b32 v242, 16, v83
v_and_b32 v243, 0xffff0000, v83
v_add_f32 v240, v240, v242
v_add_f32 v241, v241, v243
v_cvt_pk_bf16_f32 v19, v240, v241
v_lshlrev_b32 v240, 16, v20
v_and_b32 v241, 0xffff0000, v20
v_lshlrev_b32 v242, 16, v84
v_and_b32 v243, 0xffff0000, v84
v_add_f32 v240, v240, v242
v_add_f32 v241, v241, v243
v_cvt_pk_bf16_f32 v20, v240, v241
v_lshlrev_b32 v240, 16, v21
v_and_b32 v241, 0xffff0000, v21
v_lshlrev_b32 v242, 16, v85
v_and_b32 v243, 0xffff0000, v85
v_add_f32 v240, v240, v242
v_add_f32 v241, v241, v243
v_cvt_pk_bf16_f32 v21, v240, v241
v_lshlrev_b32 v240, 16, v22
v_and_b32 v241, 0xffff0000, v22
v_lshlrev_b32 v242, 16, v86
v_and_b32 v243, 0xffff0000, v86
v_add_f32 v240, v240, v242
v_add_f32 v241, v241, v243
v_cvt_pk_bf16_f32 v22, v240, v241
v_lshlrev_b32 v240, 16, v23
v_and_b32 v241, 0xffff0000, v23
v_lshlrev_b32 v242, 16, v87
v_and_b32 v243, 0xffff0000, v87
v_add_f32 v240, v240, v242
v_add_f32 v241, v241, v243
v_cvt_pk_bf16_f32 v23, v240, v241
buffer_store_dwordx2 v[16:17],v245,s[40:43],s61 offen offset:128
buffer_store_dwordx2 v[18:19],v245,s[40:43],s61 offen offset:144
buffer_store_dwordx2 v[20:21],v245,s[40:43],s61 offen offset:160
buffer_store_dwordx2 v[22:23],v245,s[40:43],s61 offen offset:176
s_waitcnt vmcnt(12)
v_lshlrev_b32 v240, 16, v24
v_and_b32 v241, 0xffff0000, v24
v_lshlrev_b32 v242, 16, v88
v_and_b32 v243, 0xffff0000, v88
v_add_f32 v240, v240, v242
v_add_f32 v241, v241, v243
v_cvt_pk_bf16_f32 v24, v240, v241
v_lshlrev_b32 v240, 16, v25
v_and_b32 v241, 0xffff0000, v25
v_lshlrev_b32 v242, 16, v89
v_and_b32 v243, 0xffff0000, v89
v_add_f32 v240, v240, v242
v_add_f32 v241, v241, v243
v_cvt_pk_bf16_f32 v25, v240, v241
v_lshlrev_b32 v240, 16, v26
v_and_b32 v241, 0xffff0000, v26
v_lshlrev_b32 v242, 16, v90
v_and_b32 v243, 0xffff0000, v90
v_add_f32 v240, v240, v242
v_add_f32 v241, v241, v243
v_cvt_pk_bf16_f32 v26, v240, v241
v_lshlrev_b32 v240, 16, v27
v_and_b32 v241, 0xffff0000, v27
v_lshlrev_b32 v242, 16, v91
v_and_b32 v243, 0xffff0000, v91
v_add_f32 v240, v240, v242
v_add_f32 v241, v241, v243
v_cvt_pk_bf16_f32 v27, v240, v241
v_lshlrev_b32 v240, 16, v28
v_and_b32 v241, 0xffff0000, v28
v_lshlrev_b32 v242, 16, v92
v_and_b32 v243, 0xffff0000, v92
v_add_f32 v240, v240, v242
v_add_f32 v241, v241, v243
v_cvt_pk_bf16_f32 v28, v240, v241
v_lshlrev_b32 v240, 16, v29
v_and_b32 v241, 0xffff0000, v29
v_lshlrev_b32 v242, 16, v93
v_and_b32 v243, 0xffff0000, v93
v_add_f32 v240, v240, v242
v_add_f32 v241, v241, v243
v_cvt_pk_bf16_f32 v29, v240, v241
v_lshlrev_b32 v240, 16, v30
v_and_b32 v241, 0xffff0000, v30
v_lshlrev_b32 v242, 16, v94
v_and_b32 v243, 0xffff0000, v94
v_add_f32 v240, v240, v242
v_add_f32 v241, v241, v243
v_cvt_pk_bf16_f32 v30, v240, v241
v_lshlrev_b32 v240, 16, v31
v_and_b32 v241, 0xffff0000, v31
v_lshlrev_b32 v242, 16, v95
v_and_b32 v243, 0xffff0000, v95
v_add_f32 v240, v240, v242
v_add_f32 v241, v241, v243
v_cvt_pk_bf16_f32 v31, v240, v241
buffer_store_dwordx2 v[24:25],v245,s[40:43],s61 offen offset:192
buffer_store_dwordx2 v[26:27],v245,s[40:43],s61 offen offset:208
buffer_store_dwordx2 v[28:29],v245,s[40:43],s61 offen offset:224
buffer_store_dwordx2 v[30:31],v245,s[40:43],s61 offen offset:240
s_endpgm
FIN0:
s_add_u32 s6, s6, 200
s_cmp_lt_u32 s6, 320
s_cbranch_scc0 EX2
s_mul_i32 s63, s6, 52429
s_lshr_b32 s63, s63, 18
s_mul_i32 s57, s63, 5
s_sub_u32 s62, s6, s57
s_lshr_b32 s57, s63, 2
s_mul_i32 s57, s57, 5
s_add_u32 s57, s57, s62
s_lshl_b32 s92, s57, 7
s_add_u32 s92, s92, 244474880
v_mov_b32 v0, 0
s_branch FW22b
FW22:
s_sleep 4
FW22b:
buffer_load_dword v1,v0,s[8:11],s92 offen sc1
s_sub_u32 s71, s71, 1
s_cbranch_scc1 EX2
s_waitcnt vmcnt(0)
v_cmp_gt_u32 vcc, 1, v1
s_cbranch_vccnz FW22
s_lshl_b32 s92, s62, 7
s_add_u32 s92, s92, 244473984
s_add_u32 s93, s63, 4
s_cmp_lt_u32 s63, 60
s_cselect_b32 s92, 244473856, s92
s_cselect_b32 s93, s93, 16
s_lshl_b32 s66, s62, 2
s_add_u32 s66, s66, s56
s_mul_i32 s67, s63, 20
s_add_u32 s67, s67, s66
s_lshl_b32 s59, s67, 14
s_lshl_b32 s67, s67, 11
s_add_u32 s67, s67, 211959808
v_and_b32 v245, 31, v255
v_mul_u32_u24 v245, 4, v245
s_lshl_b32 s57, s63, 7
s_add_u32 s57, s57, 239157248
buffer_load_dword v244,v245,s[8:11],s57 offen sc1
buffer_load_dwordx4 v[8:11],v233,s[8:11],s67 offen sc1
buffer_load_dwordx4 v[12:15],v233,s[8:11],s67 offen offset:1024 sc1
s_mul_i32 s61, s63, 40960
s_lshl_b32 s57, s66, 6
s_add_u32 s61, s61, s57
v_mov_b32 v0, 0
s_branch FW23b
FW23:
s_sleep 2
FW23b:
buffer_load_dword v1,v0,s[8:11],s92 offen sc1
s_sub_u32 s71, s71, 1
s_cbranch_scc1 EX2
s_waitcnt vmcnt(0)
v_cmp_gt_u32 vcc, s93, v1
s_cbranch_vccnz FW23
v_and_b32 v245, 31, v255
v_mul_u32_u24 v245, 1280, v245
v_lshrrev_b32 v254, 5, v255
v_and_b32 v254, 1, v254
v_mul_u32_u24 v254, 8, v254
v_add_u32 v245, v254, v245
s_add_u32 s57, s59, 215564288
buffer_load_dwordx4 v[64:67],v233,s[8:11],s57 offen sc1
buffer_load_dwordx4 v[68:71],v233,s[8:11],s57 offen offset:1024 sc1
buffer_load_dwordx4 v[72:75],v233,s[8:11],s57 offen offset:2048 sc1
buffer_load_dwordx4 v[76:79],v233,s[8:11],s57 offen offset:3072 sc1
s_add_u32 s57, s59, 215568384
buffer_load_dwordx4 v[80:83],v233,s[8:11],s57 offen sc1
buffer_load_dwordx4 v[84:87],v233,s[8:11],s57 offen offset:1024 sc1
buffer_load_dwordx4 v[88:91],v233,s[8:11],s57 offen offset:2048 sc1
buffer_load_dwordx4 v[92:95],v233,s[8:11],s57 offen offset:3072 sc1
s_add_u32 s57, s59, 215572480
buffer_load_dwordx4 v[96:99],v233,s[8:11],s57 offen sc1
buffer_load_dwordx4 v[100:103],v233,s[8:11],s57 offen offset:1024 sc1
buffer_load_dwordx4 v[104:107],v233,s[8:11],s57 offen offset:2048 sc1
buffer_load_dwordx4 v[108:111],v233,s[8:11],s57 offen offset:3072 sc1
s_add_u32 s57, s59, 215576576
buffer_load_dwordx4 v[112:115],v233,s[8:11],s57 offen sc1
buffer_load_dwordx4 v[116:119],v233,s[8:11],s57 offen offset:1024 sc1
buffer_load_dwordx4 v[120:123],v233,s[8:11],s57 offen offset:2048 sc1
buffer_load_dwordx4 v[124:127],v233,s[8:11],s57 offen offset:3072 sc1
s_waitcnt vmcnt(0)
v_sub_f32 v244, 1.0, v244
v_cvt_pk_bf16_f32 v244, v244, v244
v_lshlrev_b32 v244, 16, v244
v_pk_add_f32 v[64:65], v[64:65], v[68:69]
v_pk_add_f32 v[66:67], v[66:67], v[70:71]
v_pk_add_f32 v[72:73], v[72:73], v[76:77]
v_pk_add_f32 v[74:75], v[74:75], v[78:79]
v_pk_add_f32 v[64:65], v[64:65], v[72:73]
v_pk_add_f32 v[66:67], v[66:67], v[74:75]
v_cvt_pk_bf16_f32 v32, v64, v65
v_cvt_pk_bf16_f32 v33, v66, v67
v_pk_add_f32 v[80:81], v[80:81], v[84:85]
v_pk_add_f32 v[82:83], v[82:83], v[86:87]
v_pk_add_f32 v[88:89], v[88:89], v[92:93]
v_pk_add_f32 v[90:91], v[90:91], v[94:95]
v_pk_add_f32 v[80:81], v[80:81], v[88:89]
v_pk_add_f32 v[82:83], v[82:83], v[90:91]
v_cvt_pk_bf16_f32 v34, v80, v81
v_cvt_pk_bf16_f32 v35, v82, v83
v_pk_add_f32 v[96:97], v[96:97], v[100:101]
v_pk_add_f32 v[98:99], v[98:99], v[102:103]
v_pk_add_f32 v[104:105], v[104:105], v[108:109]
v_pk_add_f32 v[106:107], v[106:107], v[110:111]
v_pk_add_f32 v[96:97], v[96:97], v[104:105]
v_pk_add_f32 v[98:99], v[98:99], v[106:107]
v_cvt_pk_bf16_f32 v36, v96, v97
v_cvt_pk_bf16_f32 v37, v98, v99
v_pk_add_f32 v[112:113], v[112:113], v[116:117]
v_pk_add_f32 v[114:115], v[114:115], v[118:119]
v_pk_add_f32 v[120:121], v[120:121], v[124:125]
v_pk_add_f32 v[122:123], v[122:123], v[126:127]
v_pk_add_f32 v[112:113], v[112:113], v[120:121]
v_pk_add_f32 v[114:115], v[114:115], v[122:123]
v_cvt_pk_bf16_f32 v38, v112, v113
v_cvt_pk_bf16_f32 v39, v114, v115
v_lshlrev_b32 v240, 16, v32
v_and_b32 v241, 0xffff0000, v32
v_mul_f32 v240, v244, v240
v_mul_f32 v241, v244, v241
v_cvt_pk_bf16_f32 v32, v240, v241
v_lshlrev_b32 v240, 16, v33
v_and_b32 v241, 0xffff0000, v33
v_mul_f32 v240, v244, v240
v_mul_f32 v241, v244, v241
v_cvt_pk_bf16_f32 v33, v240, v241
v_lshlrev_b32 v240, 16, v34
v_and_b32 v241, 0xffff0000, v34
v_mul_f32 v240, v244, v240
v_mul_f32 v241, v244, v241
v_cvt_pk_bf16_f32 v34, v240, v241
v_lshlrev_b32 v240, 16, v35
v_and_b32 v241, 0xffff0000, v35
v_mul_f32 v240, v244, v240
v_mul_f32 v241, v244, v241
v_cvt_pk_bf16_f32 v35, v240, v241
v_lshlrev_b32 v240, 16, v36
v_and_b32 v241, 0xffff0000, v36
v_mul_f32 v240, v244, v240
v_mul_f32 v241, v244, v241
v_cvt_pk_bf16_f32 v36, v240, v241
v_lshlrev_b32 v240, 16, v37
v_and_b32 v241, 0xffff0000, v37
v_mul_f32 v240, v244, v240
v_mul_f32 v241, v244, v241
v_cvt_pk_bf16_f32 v37, v240, v241
v_lshlrev_b32 v240, 16, v38
v_and_b32 v241, 0xffff0000, v38
v_mul_f32 v240, v244, v240
v_mul_f32 v241, v244, v241
v_cvt_pk_bf16_f32 v38, v240, v241
v_lshlrev_b32 v240, 16, v39
v_and_b32 v241, 0xffff0000, v39
v_mul_f32 v240, v244, v240
v_mul_f32 v241, v244, v241
v_cvt_pk_bf16_f32 v39, v240, v241
v_lshlrev_b32 v240, 16, v8
v_and_b32 v241, 0xffff0000, v8
v_lshlrev_b32 v242, 16, v32
v_and_b32 v243, 0xffff0000, v32
v_add_f32 v240, v240, v242
v_add_f32 v241, v241, v243
v_cvt_pk_bf16_f32 v8, v240, v241
v_lshlrev_b32 v240, 16, v9
v_and_b32 v241, 0xffff0000, v9
v_lshlrev_b32 v242, 16, v33
v_and_b32 v243, 0xffff0000, v33
v_add_f32 v240, v240, v242
v_add_f32 v241, v241, v243
v_cvt_pk_bf16_f32 v9, v240, v241
v_lshlrev_b32 v240, 16, v10
v_and_b32 v241, 0xffff0000, v10
v_lshlrev_b32 v242, 16, v34
v_and_b32 v243, 0xffff0000, v34
v_add_f32 v240, v240, v242
v_add_f32 v241, v241, v243
v_cvt_pk_bf16_f32 v10, v240, v241
v_lshlrev_b32 v240, 16, v11
v_and_b32 v241, 0xffff0000, v11
v_lshlrev_b32 v242, 16, v35
v_and_b32 v243, 0xffff0000, v35
v_add_f32 v240, v240, v242
v_add_f32 v241, v241, v243
v_cvt_pk_bf16_f32 v11, v240, v241
v_lshlrev_b32 v240, 16, v12
v_and_b32 v241, 0xffff0000, v12
v_lshlrev_b32 v242, 16, v36
v_and_b32 v243, 0xffff0000, v36
v_add_f32 v240, v240, v242
v_add_f32 v241, v241, v243
v_cvt_pk_bf16_f32 v12, v240, v241
v_lshlrev_b32 v240, 16, v13
v_and_b32 v241, 0xffff0000, v13
v_lshlrev_b32 v242, 16, v37
v_and_b32 v243, 0xffff0000, v37
v_add_f32 v240, v240, v242
v_add_f32 v241, v241, v243
v_cvt_pk_bf16_f32 v13, v240, v241
v_lshlrev_b32 v240, 16, v14
v_and_b32 v241, 0xffff0000, v14
v_lshlrev_b32 v242, 16, v38
v_and_b32 v243, 0xffff0000, v38
v_add_f32 v240, v240, v242
v_add_f32 v241, v241, v243
v_cvt_pk_bf16_f32 v14, v240, v241
v_lshlrev_b32 v240, 16, v15
v_and_b32 v241, 0xffff0000, v15
v_lshlrev_b32 v242, 16, v39
v_and_b32 v243, 0xffff0000, v39
v_add_f32 v240, v240, v242
v_add_f32 v241, v241, v243
v_cvt_pk_bf16_f32 v15, v240, v241
buffer_store_dwordx2 v[8:9],v245,s[40:43],s61 offen
buffer_store_dwordx2 v[10:11],v245,s[40:43],s61 offen offset:16
buffer_store_dwordx2 v[12:13],v245,s[40:43],s61 offen offset:32
buffer_store_dwordx2 v[14:15],v245,s[40:43],s61 offen offset:48
EX2:
s_endpgm
.section .rodata,"a"
.p2align 6
.amdhsa_kernel init_kernel
.amdhsa_next_free_vgpr 512
.amdhsa_next_free_sgpr 102
.amdhsa_accum_offset 256
.amdhsa_group_segment_fixed_size 0
.amdhsa_kernarg_size 112
.amdhsa_user_sgpr_count 2
.amdhsa_user_sgpr_kernarg_segment_ptr 1
.amdhsa_system_sgpr_workgroup_id_x 1
.end_amdhsa_kernel
.p2align 6
.amdhsa_kernel main_kernel
.amdhsa_next_free_vgpr 512
.amdhsa_next_free_sgpr 102
.amdhsa_accum_offset 256
.amdhsa_group_segment_fixed_size 0
.amdhsa_kernarg_size 112
.amdhsa_user_sgpr_count 2
.amdhsa_user_sgpr_kernarg_segment_ptr 1
.amdhsa_system_sgpr_workgroup_id_x 1
.end_amdhsa_kernel
```
